```python
import torch

def _softmax(x, axis=-1):
    return torch.softmax(x, dim=axis)
def _gelu(x):
    return torch.nn.functional.gelu(x, approximate="tanh")
def _silu(x):
    return torch.nn.functional.silu(x)
def _sigmoid(x):
    return torch.sigmoid(x)
def _layernorm(x, axis=-1, eps=1e-5):
    m = x.mean(dim=axis, keepdim=True)
    v = x.var(dim=axis, keepdim=True, unbiased=False)
    return (x - m) / torch.sqrt(v + eps)
def _scatter_add(tgt, idx, src, axis=0):
    return tgt.clone().index_add_(axis, idx, src)
def _segment_sum(src, seg, n):
    out = torch.zeros((n,) + src.shape[1:], dtype=src.dtype)
    return out.index_add_(0, seg, src)
def _pad(x, pw):
    flat = tuple(v for pair in reversed(pw) for v in pair)
    return torch.nn.functional.pad(x, flat)

kernel_name = 'interleave_layers__ssm_conv_h3__swiglu_ffn__prompt'

def setup_inputs():

    _w = (lambda a: (lambda t: t.to(torch.bfloat16) if t.is_floating_point() else t)(torch.as_tensor(a)))
    def _A_setup():
        B, S, D = 1, 2048, 512
        ks = 4
        return {
            "q": _w((lambda *s: torch.randn(*s, dtype=torch.bfloat16) * 0.05)(B, S, D)),
            "k": _w((lambda *s: torch.randn(*s, dtype=torch.bfloat16) * 1.6)(B, S, D)),
            "v": _w((lambda *s: torch.randn(*s, dtype=torch.bfloat16) * 1.6)(B, S, D)),
            "shift_k": _w((lambda *s: torch.randn(*s, dtype=torch.bfloat16) * 1.6)(D, ks) * 0.5),
            "ssm_k": _w((lambda *s: torch.randn(*s, dtype=torch.bfloat16) * 1.6)(D, S) * (1.0 / S ** 0.5)),
            "ssm_D": _w((lambda *s: torch.randn(*s, dtype=torch.bfloat16) * 1.6)(D)),
        }
    _A_in = _A_setup()

    def _B_setup():
        B, S, D, F = 1, 2048, 512, 1792
        return {
            "x": _w((lambda *s: torch.randn(*s, dtype=torch.bfloat16) * 0.05)(B, S, D)),
            "w_gate": _w((lambda *s: torch.randn(*s, dtype=torch.bfloat16) * 0.2)(D, F)),
            "w_up": _w((lambda *s: torch.randn(*s, dtype=torch.bfloat16) * 0.2)(D, F)),
            "w_down": _w((lambda *s: torch.randn(*s, dtype=torch.bfloat16) * 0.2)(F, D)),
        }
    _B_in = _B_setup()

    return {
        "A_q": _A_in["q"],
        "A_k": _A_in["k"],
        "A_v": _A_in["v"],
        "A_shift_k": _A_in["shift_k"],
        "A_ssm_k": _A_in["ssm_k"],
        "A_ssm_D": _A_in["ssm_D"],
        "B_x": _B_in["x"],
        "B_w_gate": _B_in["w_gate"],
        "B_w_up": _B_in["w_up"],
        "B_w_down": _B_in["w_down"],
    }

def reference(A_q, A_k, A_v, A_shift_k, A_ssm_k, A_ssm_D, B_x, B_w_gate, B_w_up, B_w_down):
    def _A_ref(q, k, v, shift_k, ssm_k, ssm_D):
        B, S, D = q.shape
        ks = shift_k.shape[-1]
        k_pad = _pad(k, ((0, 0), (ks - 1, 0), (0, 0)))
        k_shift = torch.zeros_like(k)
        for t in range(ks):
            k_shift = k_shift + k_pad[:, t:t + S, :] * shift_k[:, ks - 1 - t][None, None, :]
        kv = k_shift * v
        L = 2 * S
        kv_pad = _pad(kv, ((0, 0), (0, S), (0, 0)))
        kf_pad = _pad(ssm_k, ((0, 0), (0, S)))
        kv_f = (lambda x, axes=(-2,-1): torch.fft.rfft2(x.float(), dim=axes))(kv_pad[:, None, :, :], axes=(1, 2))
        kf_f = (lambda x, axes=(-2,-1): torch.fft.rfft2(x.float(), dim=axes))(kf_pad[:, None, :], axes=(1, 2))
        kf_f = (lambda x, *d: x.permute(*d))(kf_f, 1, 2, 0)
        y_f = kv_f * kf_f[None, :, :, :]
        y = (lambda x, s, axes=(-2,-1): torch.fft.irfft2(x, s=s, dim=axes).to(torch.bfloat16))(y_f, (1, L), axes=(1, 2))[:, 0, :S, :]
        y = y + kv * ssm_D[None, None, :]
        return q * y

    def _B_ref(x, w_gate, w_up, w_down):
        g = _silu(x @ w_gate)
        u = x @ w_up
        return (g * u) @ w_down

    x = A_q
    x = x + _A_ref(_layernorm(x, axis=-1), A_k, A_v, A_shift_k, A_ssm_k, A_ssm_D)
    x = x + _B_ref(_layernorm(x, axis=-1), B_w_gate, B_w_up, B_w_down)
    x = x + _A_ref(_layernorm(x, axis=-1), A_k, A_v, A_shift_k, A_ssm_k, A_ssm_D)
    x = x + _B_ref(_layernorm(x, axis=-1), B_w_gate, B_w_up, B_w_down)
    return x
```

```asm
; @launch grid=(256,1,1) block=(256,1,1) lds=163840
.amdgcn_target "amdgcn-amd-amdhsa--gfx950"
.text
.globl interleave_layers__ssm_conv_h3__swiglu_ffn__prompt_kernel
.p2align 8
.type interleave_layers__ssm_conv_h3__swiglu_ffn__prompt_kernel,@function
interleave_layers__ssm_conv_h3__swiglu_ffn__prompt_kernel:
    s_cmp_ge_u32 s2, 256
    s_cbranch_scc1 L_exit
    s_load_dwordx16 s[4:19], s[0:1], 0
    s_load_dwordx8 s[20:27], s[0:1], 64
    s_load_dwordx2 s[28:29], s[0:1], 96
    s_lshr_b32 s31, s2, 3
    s_getpc_b64 s[100:101]
L_pfbase:
    s_mul_i32 s81, s31, CODE_SHARE
    v_lshlrev_b32 v56, 7, v0
    v_cmp_gt_u32 vcc, CODE_SHARE, v56
    v_add_u32 v56, s81, v56
    v_min_u32 v56, CODE_LEN-4, v56
    s_cbranch_vccz L_nopf
    s_mov_b64 exec, vcc
    global_load_dword v255, v56, s[100:101]
    s_mov_b64 exec, -1
L_nopf:
    v_lshrrev_b32 v81, 6, v0
    v_lshrrev_b32 v80, 5, v0
    v_readfirstlane_b32 s76, v81
    s_and_b32 s30, s2, 7
    v_and_b32 v81, 31, v0
    v_lshlrev_b32 v82, 13, v80
    v_lshl_add_u32 v82, v81, 2, v82
    s_lshl_b32 s80, s31, 16
    s_lshl_b32 s89, s30, 7
    s_add_u32 s80, s80, s89
    v_add_u32 v82, s80, v82
    v_add_u32 v83, 0xfffff400, v82
    s_lshl_b32 s81, s30, 9
    v_lshl_add_u32 v84, v81, 4, s81
    v_and_b32 v1, 63, v0
    s_mov_b32 s68, 4096
    s_mul_i32 s88, s30, 10496
    s_add_u32 s88, s88, 0x860000
    s_lshl_b32 s82, s31, 2
    s_lshl_b32 s89, s76, 0
    s_add_u32 s82, s82, s89
    s_mov_b32 s34, 0x200000
    s_mov_b32 s35, 0x20000
    s_mov_b32 s38, 0x200000
    s_mov_b32 s39, 0x20000
    s_mov_b32 s66, 0x10000000
    s_mov_b32 s67, 0x20000
    s_waitcnt lgkmcnt(0)
    s_mov_b32 s32, s6
    s_and_b32 s33, s7, 0xffff
    s_mov_b32 s64, s28
    s_and_b32 s65, s29, 0xffff
    s_mov_b32 s36, s8
    s_and_b32 s37, s9, 0xffff
    s_cmp_lg_u32 s82, 3
    s_cbranch_scc1 L_nolead_1
    v_lshrrev_b32 v56, 3, v1
    v_and_b32 v57, 7, v1
    v_lshlrev_b32 v56, 8, v56
    v_lshl_add_u32 v56, v57, 4, v56
    v_mov_b32 v58, 0
    v_mov_b32 v59, 0
    v_mov_b32 v60, 0
    v_mov_b32 v61, 0
    s_add_u32 s81, s88, 4096
    s_add_u32 s83, s88, 8192
    buffer_store_dwordx4 v[58:61], v56, s[64:67], s88 offen offset:0 sc1
    buffer_store_dwordx4 v[58:61], v56, s[64:67], s88 offen offset:2048 sc1
    buffer_store_dwordx4 v[58:61], v56, s[64:67], s81 offen offset:0 sc1
    buffer_store_dwordx4 v[58:61], v56, s[64:67], s81 offen offset:2048 sc1
    buffer_store_dwordx4 v[58:61], v56, s[64:67], s83 offen offset:0 sc1
L_nolead_1:
    buffer_load_dword v96, v83, s[32:35], 0 offen offset:0
    buffer_load_dword v97, v83, s[32:35], 0 offen offset:1024
    buffer_load_dword v98, v83, s[32:35], 0 offen offset:2048
    buffer_load_dword v99, v82, s[32:35], 0 offen offset:0
    buffer_load_dword v100, v82, s[32:35], 0 offen offset:1024
    buffer_load_dword v101, v82, s[32:35], 0 offen offset:2048
    buffer_load_dword v102, v82, s[32:35], 0 offen offset:3072
    buffer_load_dword v103, v82, s[32:35], s68 offen offset:0
    buffer_load_dword v104, v82, s[32:35], s68 offen offset:1024
    buffer_load_dword v105, v82, s[32:35], s68 offen offset:2048
    buffer_load_dword v106, v82, s[32:35], s68 offen offset:3072
    buffer_load_dword v108, v82, s[36:39], 0 offen offset:0
    buffer_load_dword v109, v82, s[36:39], 0 offen offset:1024
    buffer_load_dword v110, v82, s[36:39], 0 offen offset:2048
    buffer_load_dword v111, v82, s[36:39], 0 offen offset:3072
    buffer_load_dword v112, v82, s[36:39], s68 offen offset:0
    buffer_load_dword v113, v82, s[36:39], s68 offen offset:1024
    buffer_load_dword v114, v82, s[36:39], s68 offen offset:2048
    buffer_load_dword v115, v82, s[36:39], s68 offen offset:3072
    s_mov_b32 s96, s10
    s_and_b32 s97, s11, 0xffff
    s_mov_b32 s98, 0x1000
    s_mov_b32 s99, 0x20000
    buffer_load_dwordx4 v[116:119], v84, s[96:99], 0 offen
    s_mov_b32 s44, s12
    s_and_b32 s45, s13, 0xffff
    s_mov_b32 s46, 0x200000
    s_mov_b32 s47, 0x20000
    s_barrier
    v_lshlrev_b32 v90, 4, v0
    s_lshl_b32 s81, s30, 18
    s_lshl_b32 s89, s31, 13
    s_add_u32 s81, s81, s89
    s_add_u32 s83, s81, 4096
    buffer_load_dwordx4 v[24:27], v90, s[44:47], s81 offen offset:0
    buffer_load_dwordx4 v[28:31], v90, s[44:47], s81 offen offset:8
    buffer_load_dwordx4 v[32:35], v90, s[44:47], s83 offen offset:0
    buffer_load_dwordx4 v[36:39], v90, s[44:47], s83 offen offset:8
    s_lshr_b32 s80, s81, 11
    s_load_dword s75, s[14:15], s80
    s_mov_b32 s92, s26
    s_and_b32 s93, s27, 0xffff
    s_mov_b32 s94, 0x100
    s_mov_b32 s95, 0x20000
    v_mov_b32 v23, 1
    s_mov_b32 s40, s4
    s_and_b32 s41, s5, 0xffff
    s_mov_b32 s42, 0x200000
    s_mov_b32 s43, 0x20000
    s_mov_b32 s48, s18
    s_and_b32 s49, s19, 0xffff
    s_mov_b32 s50, 0x1c0000
    s_mov_b32 s51, 0x20000
    s_mov_b32 s52, s20
    s_and_b32 s53, s21, 0xffff
    s_mov_b32 s54, 0x1c0000
    s_mov_b32 s55, 0x20000
    s_mov_b32 s56, s22
    s_and_b32 s57, s23, 0xffff
    s_mov_b32 s58, 0x1c0000
    s_mov_b32 s59, 0x20000
    s_mov_b32 s60, s24
    s_and_b32 s61, s25, 0xffff
    s_mov_b32 s62, 0x200000
    s_mov_b32 s63, 0x20000
    s_and_b32 s77, s31, 1
    s_and_b32 s78, s31, 7
    s_lshr_b32 s79, s31, 3
    v_lshlrev_b32 v2, 4, v1
    v_lshlrev_b32 v17, 3, v1
    v_add_u32 v90, 48928, v90
    v_add_u32 v91, 65536, v90
    v_sub_u32 v85, 7, v80
    v_and_b32 v86, 7, v81
    v_xor_b32 v85, v85, v86
    v_lshlrev_b32 v85, 4, v85
    v_lshl_add_u32 v85, v81, 8, v85
    v_add_u32 v85, 147456, v85
    v_lshrrev_b32 v86, 3, v0
    v_bfe_u32 v87, v0, 4, 3
    v_and_b32 v88, 7, v0
    v_xor_b32 v87, v87, v88
    v_lshlrev_b32 v87, 4, v87
    v_lshl_add_u32 v87, v86, 7, v87
    v_add_u32 v87, 147456, v87
    v_lshlrev_b32 v88, 4, v88
    v_mul_u32_u24 v86, 4096, v86
    v_add_u32 v88, v86, v88
    s_lshl_b32 s28, s88, 0
    s_lshl_b32 s89, s31, 2
    s_add_u32 s28, s28, s89
    s_lshr_b32 s82, s76, 1
    s_and_b32 s83, s76, 1
    s_mul_i32 s21, s82, 4608
    s_lshl_b32 s89, s83, 11
    s_add_u32 s21, s21, s89
    s_add_u32 s21, s21, 0x20000
    s_lshl_b32 s19, s30, 18
    s_lshl_b32 s89, s31, 13
    s_add_u32 s19, s19, s89
    s_lshl_b32 s89, s82, 12
    s_add_u32 s19, s19, s89
    s_lshl_b32 s89, s83, 11
    s_add_u32 s19, s19, s89
    s_add_u32 s19, s19, 0x1800000
    s_getreg_b32 s80, hwreg(HW_REG_XCC_ID, 0, 4)
    s_and_b32 s80, s80, 7
    s_add_u32 s22, s80, 1
    v_and_b32 v4, 31, v1
    v_and_b32 v58, 15, v1
    v_lshrrev_b32 v59, 4, v1
    v_add_u32 v60, 1, v58
    v_and_b32 v61, 3, v60
    v_mul_u32_u24 v78, 4160, v61
    v_lshrrev_b32 v60, 2, v60
    v_lshl_add_u32 v78, v60, 3, v78
    v_lshlrev_b32 v59, 4, v59
    v_sub_u32 v78, v78, v59
    s_lshl_b32 s80, s82, 16
    s_lshl_b32 s89, s83, 8
    s_add_u32 s80, s80, s89
    s_add_u32 s80, s80, 0xbf30
    v_add_u32 v78, s80, v78
    v_lshl_add_u32 v79, v58, 5, v59
    s_mul_i32 s80, s82, 4608
    s_lshl_b32 s89, s83, 8
    s_add_u32 s80, s80, s89
    s_add_u32 s80, s80, 0x20210
    v_sub_u32 v79, s80, v79
    v_mov_b32 v66, 0
    v_mov_b32 v67, 0
    v_mov_b32 v68, 0
    v_mov_b32 v69, 0
    v_lshlrev_b32 v58, 4, v4
    v_add_u32 v58, 135168, v58
    ds_write_b128 v58, v[66:69]
    ds_write_b128 v58, v[66:69] offset:4608
    v_lshlrev_b32 v4, 2, v4
    v_bfe_u32 v58, v1, 1, 2
    v_mul_u32_u24 v58, 4160, v58
    v_bfe_u32 v59, v1, 3, 1
    v_lshl_add_u32 v58, v59, 16, v58
    v_and_b32 v59, 1, v1
    v_lshl_add_u32 v58, v59, 4, v58
    ds_write_b128 v58, v[66:69] offset:48896
    v_lshrrev_b32 v58, 3, v1
    v_mul_u32_u24 v7, 3584, v58
    v_bfe_u32 v59, v1, 1, 2
    v_bfe_u32 v60, v1, 4, 1
    v_xor_b32 v59, v59, v60
    v_lshl_add_u32 v7, v59, 5, v7
    v_and_b32 v59, 1, v1
    v_lshl_add_u32 v7, v59, 4, v7
    v_xor_b32 v6, 64, v7
    v_mul_u32_u24 v14, 2560, v58
    v_sub_u32 v14, v7, v14
    v_xor_b32 v15, 64, v14
    s_lshr_b32 s81, s31, 1
    s_mul_i32 s85, s81, 224
    s_mul_i32 s89, s77, 96
    s_add_u32 s85, s85, s89
    s_add_u32 s29, s85, 1835008
    s_add_u32 s80, s78, s30
    s_lshl_b32 s80, s80, 1
    s_add_u32 s80, s80, s76
    s_and_b32 s80, s80, 15
    s_mul_i32 s80, s80, 114688
    s_add_u32 s85, s85, s80
    s_lshl_b32 s84, s76, 12
    v_and_b32 v59, 7, v1
    v_lshlrev_b32 v12, 4, v59
    v_lshl_add_u32 v12, v58, 9, v12
    v_lshlrev_b32 v13, 10, v59
    v_lshl_add_u32 v13, v58, 4, v13
    v_lshlrev_b32 v5, 2, v59
    s_lshl_b32 s7, s30, 18
    s_lshl_b32 s89, s79, 16
    s_add_u32 s7, s7, s89
    s_lshl_b32 s89, s76, 13
    s_add_u32 s7, s7, s89
    s_lshl_b32 s89, s78, 7
    s_add_u32 s7, s7, s89
    v_lshlrev_b32 v89, 10, v80
    v_lshl_add_u32 v89, v81, 4, v89
    v_bfe_u32 v92, v0, 4, 1
    v_lshlrev_b32 v92, 2, v92
    v_lshl_add_u32 v92, v80, 3, v92
    s_lshl_b32 s82, s31, 2
    s_lshl_b32 s89, s76, 0
    s_add_u32 s82, s82, s89
    s_cmp_lg_u32 s82, 3
    s_cbranch_scc1 L_nolead_2
    s_waitcnt vmcnt(24)
    s_lshl_b32 s81, s30, 5
    buffer_store_dword v23, off, s[92:95], s81 sc1
L_nolead_2:
    s_cmp_ge_u32 s76, 2
    s_cbranch_scc1 L_nowdt_3
    s_cmp_ge_u32 s31, 28
    s_cbranch_scc1 L_nowdt_3
    s_lshl_b32 s80, s31, 16
    s_lshl_b32 s89, s76, 15
    s_add_u32 s80, s80, s89
    s_lshl_b32 s89, s30, 7
    s_add_u32 s80, s80, s89
    s_lshl_b32 s81, s76, 12
    s_add_u32 s81, s81, 0x8000
    s_mov_b32 m0, s81
    s_nop 0
    buffer_load_dwordx4 v14, s[56:59], s80 offen offset:0 lds
    s_add_u32 s80, s80, 7168
    buffer_load_dwordx4 v15, s[56:59], s80 offen offset:1024 lds
    s_add_u32 s80, s80, 7168
    buffer_load_dwordx4 v14, s[56:59], s80 offen offset:2048 lds
    s_add_u32 s80, s80, 7168
    buffer_load_dwordx4 v15, s[56:59], s80 offen offset:3072 lds
L_nowdt_3:
    s_lshl_b32 s80, s30, 18
    s_add_u32 s80, s80, 0x1800f80
    s_lshl_b32 s81, s31, 7
    s_sub_u32 s80, s80, s81
    s_add_u32 s81, s80, 131072
    s_waitcnt vmcnt(23)
    v_lshlrev_b32 v120, 16, v96
    v_and_b32 v121, 0xffff0000, v96
    s_waitcnt vmcnt(22)
    v_lshlrev_b32 v122, 16, v97
    v_and_b32 v123, 0xffff0000, v97
    s_waitcnt vmcnt(21)
    v_lshlrev_b32 v124, 16, v98
    v_and_b32 v125, 0xffff0000, v98
    s_waitcnt vmcnt(20)
    v_lshlrev_b32 v126, 16, v99
    v_and_b32 v127, 0xffff0000, v99
    s_waitcnt vmcnt(19)
    v_lshlrev_b32 v128, 16, v100
    v_and_b32 v129, 0xffff0000, v100
    s_waitcnt vmcnt(18)
    v_lshlrev_b32 v130, 16, v101
    v_and_b32 v131, 0xffff0000, v101
    s_waitcnt vmcnt(17)
    v_lshlrev_b32 v132, 16, v102
    v_and_b32 v133, 0xffff0000, v102
    s_waitcnt vmcnt(16)
    v_lshlrev_b32 v134, 16, v103
    v_and_b32 v135, 0xffff0000, v103
    s_waitcnt vmcnt(15)
    v_lshlrev_b32 v136, 16, v104
    v_and_b32 v137, 0xffff0000, v104
    s_waitcnt vmcnt(14)
    v_lshlrev_b32 v138, 16, v105
    v_and_b32 v139, 0xffff0000, v105
    s_waitcnt vmcnt(13)
    v_lshlrev_b32 v140, 16, v106
    v_and_b32 v141, 0xffff0000, v106
    s_waitcnt vmcnt(12)
    v_lshlrev_b32 v152, 16, v108
    v_and_b32 v153, 0xffff0000, v108
    s_waitcnt vmcnt(11)
    v_lshlrev_b32 v154, 16, v109
    v_and_b32 v155, 0xffff0000, v109
    s_waitcnt vmcnt(10)
    v_lshlrev_b32 v156, 16, v110
    v_and_b32 v157, 0xffff0000, v110
    s_waitcnt vmcnt(9)
    v_lshlrev_b32 v158, 16, v111
    v_and_b32 v159, 0xffff0000, v111
    s_waitcnt vmcnt(8)
    v_lshlrev_b32 v160, 16, v112
    v_and_b32 v161, 0xffff0000, v112
    s_waitcnt vmcnt(7)
    v_lshlrev_b32 v162, 16, v113
    v_and_b32 v163, 0xffff0000, v113
    s_waitcnt vmcnt(6)
    v_lshlrev_b32 v164, 16, v114
    v_and_b32 v165, 0xffff0000, v114
    s_waitcnt vmcnt(5)
    v_lshlrev_b32 v166, 16, v115
    v_and_b32 v167, 0xffff0000, v115
    s_waitcnt vmcnt(4)
    v_lshlrev_b32 v144, 16, v116
    v_lshlrev_b32 v145, 16, v118
    v_and_b32 v146, 0xffff0000, v116
    v_and_b32 v147, 0xffff0000, v118
    v_lshlrev_b32 v148, 16, v117
    v_lshlrev_b32 v149, 16, v119
    v_and_b32 v150, 0xffff0000, v117
    v_and_b32 v151, 0xffff0000, v119
    v_pk_mul_f32 v[168:169], v[150:151], v[120:121]
    v_pk_mul_f32 v[170:171], v[150:151], v[122:123]
    v_pk_mul_f32 v[172:173], v[150:151], v[124:125]
    v_pk_mul_f32 v[174:175], v[150:151], v[126:127]
    v_pk_mul_f32 v[176:177], v[150:151], v[128:129]
    v_pk_mul_f32 v[178:179], v[150:151], v[130:131]
    v_pk_mul_f32 v[180:181], v[150:151], v[132:133]
    v_pk_mul_f32 v[182:183], v[150:151], v[134:135]
    v_pk_fma_f32 v[168:169], v[148:149], v[122:123], v[168:169]
    v_pk_fma_f32 v[170:171], v[148:149], v[124:125], v[170:171]
    v_pk_fma_f32 v[172:173], v[148:149], v[126:127], v[172:173]
    v_pk_fma_f32 v[174:175], v[148:149], v[128:129], v[174:175]
    v_pk_fma_f32 v[176:177], v[148:149], v[130:131], v[176:177]
    v_pk_fma_f32 v[178:179], v[148:149], v[132:133], v[178:179]
    v_pk_fma_f32 v[180:181], v[148:149], v[134:135], v[180:181]
    v_pk_fma_f32 v[182:183], v[148:149], v[136:137], v[182:183]
    v_pk_fma_f32 v[168:169], v[146:147], v[124:125], v[168:169]
    v_pk_fma_f32 v[170:171], v[146:147], v[126:127], v[170:171]
    v_pk_fma_f32 v[172:173], v[146:147], v[128:129], v[172:173]
    v_pk_fma_f32 v[174:175], v[146:147], v[130:131], v[174:175]
    v_pk_fma_f32 v[176:177], v[146:147], v[132:133], v[176:177]
    v_pk_fma_f32 v[178:179], v[146:147], v[134:135], v[178:179]
    v_pk_fma_f32 v[180:181], v[146:147], v[136:137], v[180:181]
    v_pk_fma_f32 v[182:183], v[146:147], v[138:139], v[182:183]
    v_pk_fma_f32 v[168:169], v[144:145], v[126:127], v[168:169]
    v_pk_fma_f32 v[170:171], v[144:145], v[128:129], v[170:171]
    v_pk_fma_f32 v[172:173], v[144:145], v[130:131], v[172:173]
    v_pk_fma_f32 v[174:175], v[144:145], v[132:133], v[174:175]
    v_pk_fma_f32 v[176:177], v[144:145], v[134:135], v[176:177]
    v_pk_fma_f32 v[178:179], v[144:145], v[136:137], v[178:179]
    v_pk_fma_f32 v[180:181], v[144:145], v[138:139], v[180:181]
    v_pk_fma_f32 v[182:183], v[144:145], v[140:141], v[182:183]
    v_pk_mul_f32 v[168:169], v[168:169], v[152:153]
    v_pk_mul_f32 v[170:171], v[170:171], v[154:155]
    v_pk_mul_f32 v[172:173], v[172:173], v[156:157]
    v_pk_mul_f32 v[174:175], v[174:175], v[158:159]
    v_pk_mul_f32 v[176:177], v[176:177], v[160:161]
    v_pk_mul_f32 v[178:179], v[178:179], v[162:163]
    v_pk_mul_f32 v[180:181], v[180:181], v[164:165]
    v_pk_mul_f32 v[182:183], v[182:183], v[166:167]
    v_cvt_pk_bf16_f32 v184, v182, v180
    v_cvt_pk_bf16_f32 v185, v178, v176
    v_cvt_pk_bf16_f32 v186, v174, v172
    v_cvt_pk_bf16_f32 v187, v170, v168
    ds_write_b128 v85, v[184:187] offset:0
    v_cvt_pk_bf16_f32 v188, v183, v181
    v_cvt_pk_bf16_f32 v189, v179, v177
    v_cvt_pk_bf16_f32 v190, v175, v173
    v_cvt_pk_bf16_f32 v191, v171, v169
    ds_write_b128 v85, v[188:191] offset:128
    s_lshl_b32 s82, s30, 5
    s_waitcnt lgkmcnt(0)
    s_barrier
    ds_read_b128 v[184:187], v87
    ds_read_b128 v[188:191], v87 offset:4096
    s_waitcnt lgkmcnt(1)
    buffer_store_dwordx4 v[184:187], v88, s[64:67], s80 offen sc1
    s_waitcnt lgkmcnt(0)
    buffer_store_dwordx4 v[188:191], v88, s[64:67], s81 offen sc1
    buffer_load_dword v64, off, s[92:95], s82 sc1
    s_lshl_b32 s83, s30, 18
    s_lshl_b32 s89, s31, 13
    s_add_u32 s83, s83, s89
    buffer_load_dwordx4 v[48:51], v89, s[40:43], s83 offen offset:0
    buffer_load_dwordx4 v[52:55], v89, s[40:43], s83 offen offset:512
    s_waitcnt vmcnt(5)
    v_pk_mov_b32 v[168:169], v[24:25], v[28:29] op_sel:[1,0]
    v_pk_mov_b32 v[170:171], v[28:29], v[30:31] op_sel:[1,0]
    v_alignbit_b32 v124, v25, v24, 16
    v_alignbit_b32 v128, v26, v25, 16
    v_alignbit_b32 v125, v26, v25, 16
    v_alignbit_b32 v129, v27, v26, 16
    v_alignbit_b32 v126, v27, v26, 16
    v_alignbit_b32 v130, v30, v27, 16
    v_alignbit_b32 v127, v30, v27, 16
    v_alignbit_b32 v131, v31, v30, 16
    ds_write_b128 v90, v[24:27] offset:0
    ds_write_b128 v90, v[124:127] offset:4160
    ds_write_b128 v90, v[168:171] offset:8320
    ds_write_b128 v90, v[128:131] offset:12480
    v_pk_mov_b32 v[172:173], v[32:33], v[36:37] op_sel:[1,0]
    v_pk_mov_b32 v[174:175], v[36:37], v[38:39] op_sel:[1,0]
    v_alignbit_b32 v132, v33, v32, 16
    v_alignbit_b32 v136, v34, v33, 16
    v_alignbit_b32 v133, v34, v33, 16
    v_alignbit_b32 v137, v35, v34, 16
    v_alignbit_b32 v134, v35, v34, 16
    v_alignbit_b32 v138, v38, v35, 16
    v_alignbit_b32 v135, v38, v35, 16
    v_alignbit_b32 v139, v39, v38, 16
    ds_write_b128 v91, v[32:35] offset:0
    ds_write_b128 v91, v[132:135] offset:4160
    ds_write_b128 v91, v[172:175] offset:8320
    ds_write_b128 v91, v[136:139] offset:12480
    s_cmp_lg_u32 s76, 0
    s_cbranch_scc1 L_nohead_4
    s_mov_b64 exec, 1
    v_subrev_u32 v158, 8, v90
    v_lshlrev_b32 v153, 16, v24
    v_mov_b32 v152, 0
    v_mov_b32 v154, 0
    v_mov_b32 v155, v24
    v_mov_b32 v156, v153
    v_mov_b32 v157, v124
    ds_write_b64 v158, v[152:153] offset:4160
    ds_write_b64 v158, v[154:155] offset:8320
    ds_write_b64 v158, v[156:157] offset:12480
    v_subrev_u32 v166, 8, v91
    v_lshlrev_b32 v161, 16, v32
    v_mov_b32 v160, 0
    v_mov_b32 v162, 0
    v_mov_b32 v163, v32
    v_mov_b32 v164, v161
    v_mov_b32 v165, v132
    ds_write_b64 v166, v[160:161] offset:4160
    ds_write_b64 v166, v[162:163] offset:8320
    ds_write_b64 v166, v[164:165] offset:12480
    s_mov_b64 exec, -1
L_nohead_4:
    s_lshl_b32 s82, s30, 5
    s_waitcnt vmcnt(2)
    s_waitcnt lgkmcnt(0)
    s_barrier
    s_cmp_lg_u32 s76, 0
    s_cbranch_scc1 L_nopoll_5
    v_readfirstlane_b32 s101, v64
    v_mov_b32 v56, s22
    s_cmp_lg_u32 s101, 0
    s_cbranch_scc1 L_ini_6
    s_mov_b32 s87, 0
L_poll_7:
    buffer_load_dword v16, off, s[92:95], s82 sc1
    s_waitcnt vmcnt(0)
    v_readfirstlane_b32 s101, v16
    s_cmp_ge_u32 s101, 1
    s_cbranch_scc1 L_polld_8
    s_add_u32 s87, s87, 1
    s_cmp_lt_u32 s87, 0x200000
    s_cbranch_scc1 L_poll_7
    s_branch L_end
L_polld_8:
L_ini_6:
    buffer_store_dword v56, off, s[64:67], s28
L_nopoll_5:
    s_and_b32 s83, s76, 1
    v_add_u32 v3, 65536, v2
    s_lshl_b32 s80, s76, 12
    s_add_u32 s80, s80, 0x24000
    v_add_u32 v200, s80, v2
    v_xor_b32 v201, 4096, v200
    v_and_b32 v60, 15, v1
    v_lshrrev_b32 v62, 4, v1
    v_lshlrev_b32 v61, 3, v62
    v_lshl_add_u32 v61, v60, 5, v61
    s_lshl_b32 s81, s83, 12
    s_sub_u32 s80, s21, s81
    s_add_u32 s80, s80, 2552
    v_sub_u32 v203, s80, v61
    v_lshlrev_b32 v60, 5, v60
    v_lshrrev_b32 v63, 1, v62
    v_lshl_add_u32 v60, v63, 4, v60
    v_and_b32 v63, 1, v62
    v_lshl_add_u32 v202, v63, 9, v60
    v_lshrrev_b32 v58, 4, v1
    v_bfe_u32 v60, v1, 2, 2
    v_lshl_add_u32 v61, v58, 3, v60
    v_lshlrev_b32 v61, 7, v61
    v_and_b32 v62, 3, v1
    v_lshl_add_u32 v61, v62, 3, v61
    v_lshrrev_b32 v60, 1, v60
    v_and_b32 v58, 1, v58
    v_lshl_add_u32 v64, v58, 1, v60
    s_lshl_b32 s80, s76, 12
    s_add_u32 s80, s80, 0x8000
    v_lshl_add_u32 v93, v64, 5, v61
    v_add_u32 v93, s80, v93
    s_lshl_b32 s81, s76, 12
    v_add_u32 v63, s81, v61
    s_add_u32 s80, s77, 0
    s_and_b32 s80, s80, 3
    v_xor_b32 v65, s80, v64
    v_lshl_add_u32 v132, v65, 5, v63
    v_add_u32 v136, 65536, v132
    s_add_u32 s80, s77, 1
    s_and_b32 s80, s80, 3
    v_xor_b32 v65, s80, v64
    v_lshl_add_u32 v133, v65, 5, v63
    v_add_u32 v137, 65536, v133
    s_add_u32 s80, s77, 2
    s_and_b32 s80, s80, 3
    v_xor_b32 v65, s80, v64
    v_lshl_add_u32 v134, v65, 5, v63
    v_add_u32 v138, 65536, v134
    s_add_u32 s80, s77, 3
    s_and_b32 s80, s80, 3
    v_xor_b32 v65, s80, v64
    v_lshl_add_u32 v135, v65, 5, v63
    v_add_u32 v139, 65536, v135
    v_add_u32 v140, s81, v2
    v_add_u32 v141, s81, v3
    s_add_u32 s18, s19, 3145728
    s_lshl_b32 s6, s30, 14
    s_lshl_b32 s89, s79, 12
    s_add_u32 s6, s6, s89
    s_lshl_b32 s89, s76, 9
    s_add_u32 s6, s6, s89
    s_add_u32 s6, s6, 0x840000
    s_lshl_b32 s25, s78, 6
    s_lshl_b32 s89, s6, 0
    s_add_u32 s25, s25, s89
    s_lshl_b32 s5, s30, 14
    s_lshl_b32 s89, s79, 12
    s_add_u32 s5, s5, s89
    s_lshl_b32 s89, s78, 8
    s_add_u32 s5, s5, s89
    s_lshl_b32 s89, s76, 6
    s_add_u32 s5, s5, s89
    s_add_u32 s5, s5, 0x800000
    s_cmp_lg_u32 s76, 0
    s_cbranch_scc1 L_nopoll_9
    s_mov_b32 s87, 0
    v_mov_b32 v57, 140352
    v_mov_b32 v58, 1
L_c1l_10:
    buffer_load_dword v16, v4, s[64:67], s88 offen offset:0 sc1
    s_waitcnt vmcnt(0)
    v_cmp_ne_u32 vcc, v16, v56
    s_cbranch_vccnz L_c1s_11
L_c1d_12:
    ds_write_b32 v57, v58
    s_waitcnt lgkmcnt(0)
L_nopoll_9:
    s_waitcnt lgkmcnt(0)
    s_barrier
    s_mov_b32 m0, s21
    v_mov_b32 v57, 140352
    buffer_load_dwordx4 v2, s[64:67], s19 offen sc1 lds
    buffer_load_dwordx4 v2, s[64:67], s19 offen offset:1024 sc1 lds
    ds_read_b32 v56, v57
    s_waitcnt lgkmcnt(0)
    v_readfirstlane_b32 s16, v56
    s_add_u32 m0, s84, 0
    s_add_u32 s89, s85, 0
    s_add_u32 s86, s85, 27648
    buffer_load_dwordx4 v7, s[48:51], s89 offen lds
    buffer_load_dwordx4 v6, s[48:51], s86 offen offset:1024 lds
    s_mov_b32 s100, 0x3f803f80
    s_waitcnt vmcnt(4)
    v_dot2_f32_bf16 v104, v48, s100, 0
    v_dot2_f32_bf16 v105, v48, v48, 0
    v_dot2_f32_bf16 v104, v49, s100, v104
    v_dot2_f32_bf16 v105, v49, v49, v105
    v_dot2_f32_bf16 v104, v50, s100, v104
    v_dot2_f32_bf16 v105, v50, v50, v105
    v_dot2_f32_bf16 v104, v51, s100, v104
    v_dot2_f32_bf16 v105, v51, v51, v105
    v_dot2_f32_bf16 v104, v52, s100, v104
    v_dot2_f32_bf16 v105, v52, v52, v105
    v_dot2_f32_bf16 v104, v53, s100, v104
    v_dot2_f32_bf16 v105, v53, v53, v105
    v_dot2_f32_bf16 v104, v54, s100, v104
    v_dot2_f32_bf16 v105, v54, v54, v105
    v_dot2_f32_bf16 v104, v55, s100, v104
    v_dot2_f32_bf16 v105, v55, v55, v105
    v_mov_b32 v106, 0xbf800000
    v_mov_b32 v107, 0xbf800000
    s_nop 0
    v_permlane16_swap_b32 v104, v105
    v_add_f32 v104, v104, v105
    s_nop 1
    v_add_f32_dpp v104, v104, v104 quad_perm:[1,0,3,2] row_mask:0xf bank_mask:0xf
    s_nop 1
    v_add_f32_dpp v104, v104, v104 quad_perm:[2,3,0,1] row_mask:0xf bank_mask:0xf
    s_nop 1
    v_add_f32_dpp v104, v104, v104 row_half_mirror row_mask:0xf bank_mask:0xf
    s_nop 1
    v_add_f32_dpp v104, v104, v104 row_mirror row_mask:0xf bank_mask:0xf
    s_waitcnt vmcnt(2)
    s_barrier
    ds_read_b128 a[32:35], v79 offset:3584
    ds_read_b64 a[0:1], v78 offset:0
    ds_read_b64 a[2:3], v78 offset:8
    ds_read_b128 a[36:39], v79 offset:3072
    ds_read_b64 a[4:5], v78 offset:512
    ds_read_b64 a[6:7], v78 offset:520
    ds_read_b128 a[40:43], v79 offset:2560
    ds_read_b64 a[8:9], v78 offset:1024
    ds_read_b64 a[10:11], v78 offset:1032
    s_waitcnt lgkmcnt(6)
    v_mfma_f32_16x16x32_bf16 v[144:147], a[0:3], a[32:35], 0
    ds_read_b128 a[44:47], v79 offset:2048
    s_waitcnt lgkmcnt(6)
    v_mfma_f32_16x16x32_bf16 v[148:151], a[0:3], a[36:39], 0
    ds_read_b64 a[12:13], v78 offset:1536
    ds_read_b64 a[14:15], v78 offset:1544
    s_waitcnt lgkmcnt(6)
    v_mfma_f32_16x16x32_bf16 v[148:151], a[4:7], a[32:35], v[148:151]
    ds_read_b128 a[48:51], v79 offset:1536
    v_mfma_f32_16x16x32_bf16 v[152:155], a[4:7], a[36:39], 0
    ds_read_b64 a[16:17], v78 offset:2048
    ds_read_b64 a[18:19], v78 offset:2056
    s_waitcnt lgkmcnt(8)
    v_mfma_f32_16x16x32_bf16 v[152:155], a[0:3], a[40:43], v[152:155]
    ds_read_b128 a[52:55], v79 offset:1024
    v_mfma_f32_16x16x32_bf16 v[156:159], a[4:7], a[40:43], 0
    ds_read_b64 a[20:21], v78 offset:2560
    ds_read_b64 a[22:23], v78 offset:2568
    s_waitcnt lgkmcnt(9)
    v_mfma_f32_16x16x32_bf16 v[152:155], a[8:11], a[32:35], v[152:155]
    ds_read_b128 a[56:59], v79 offset:512
    v_mfma_f32_16x16x32_bf16 v[156:159], a[8:11], a[36:39], v[156:159]
    ds_read_b64 a[24:25], v78 offset:3072
    ds_read_b64 a[26:27], v78 offset:3080
    v_mfma_f32_16x16x32_bf16 v[160:163], a[8:11], a[40:43], 0
    ds_read_b128 a[60:63], v79 offset:0
    s_waitcnt lgkmcnt(12)
    v_mfma_f32_16x16x32_bf16 v[156:159], a[0:3], a[44:47], v[156:159]
    ds_read_b64 a[28:29], v78 offset:3584
    ds_read_b64 a[30:31], v78 offset:3592
    v_mfma_f32_16x16x32_bf16 v[160:163], a[4:7], a[44:47], v[160:163]
    s_add_u32 s83, s7, 32768
    buffer_load_dwordx4 v[40:43], v13, s[40:43], s7 offen
    buffer_load_dwordx4 v[44:47], v13, s[40:43], s83 offen
    v_mfma_f32_16x16x32_bf16 v[164:167], a[8:11], a[44:47], 0
    ds_read_b128 a[96:99], v79 offset:3648
    s_waitcnt lgkmcnt(13)
    v_mfma_f32_16x16x32_bf16 v[156:159], a[12:15], a[32:35], v[156:159]
    s_add_u32 m0, s84, 2048
    s_add_u32 s89, s85, 57344
    s_add_u32 s86, s85, 84992
    buffer_load_dwordx4 v7, s[48:51], s89 offen lds
    buffer_load_dwordx4 v6, s[48:51], s86 offen offset:1024 lds
    v_mfma_f32_16x16x32_bf16 v[160:163], a[12:15], a[36:39], v[160:163]
    ds_read_b64 a[64:65], v78 offset:64
    ds_read_b64 a[66:67], v78 offset:72
    v_mfma_f32_16x16x32_bf16 v[164:167], a[12:15], a[40:43], v[164:167]
    ds_read_b128 a[100:103], v79 offset:3136
    v_mfma_f32_16x16x32_bf16 v[168:171], a[12:15], a[44:47], 0
    ds_read_b64 a[68:69], v78 offset:576
    ds_read_b64 a[70:71], v78 offset:584
    s_waitcnt lgkmcnt(15)
    v_mfma_f32_16x16x32_bf16 v[160:163], a[0:3], a[48:51], v[160:163]
    ds_read_b128 a[104:107], v79 offset:2624
    v_mfma_f32_16x16x32_bf16 v[164:167], a[4:7], a[48:51], v[164:167]
    ds_read_b64 a[72:73], v78 offset:1088
    ds_read_b64 a[74:75], v78 offset:1096
    v_mfma_f32_16x16x32_bf16 v[168:171], a[8:11], a[48:51], v[168:171]
    ds_read_b128 a[108:111], v79 offset:2112
    v_mfma_f32_16x16x32_bf16 v[172:175], a[12:15], a[48:51], 0
    ds_read_b64 a[76:77], v78 offset:1600
    ds_read_b64 a[78:79], v78 offset:1608
    v_mfma_f32_16x16x32_bf16 v[160:163], a[16:19], a[32:35], v[160:163]
    ds_read_b128 a[112:115], v79 offset:1600
    v_mfma_f32_16x16x32_bf16 v[164:167], a[16:19], a[36:39], v[164:167]
    ds_read_b64 a[80:81], v78 offset:2112
    ds_read_b64 a[82:83], v78 offset:2120
    v_mfma_f32_16x16x32_bf16 v[168:171], a[16:19], a[40:43], v[168:171]
    ds_read_b128 a[116:119], v79 offset:1088
    v_mfma_f32_16x16x32_bf16 v[172:175], a[16:19], a[44:47], v[172:175]
    ds_read_b64 a[84:85], v78 offset:2624
    ds_read_b64 a[86:87], v78 offset:2632
    s_waitcnt lgkmcnt(15)
    v_mfma_f32_16x16x32_bf16 v[164:167], a[0:3], a[52:55], v[164:167]
    ds_read_b128 a[120:123], v79 offset:576
    v_mfma_f32_16x16x32_bf16 v[168:171], a[4:7], a[52:55], v[168:171]
    ds_read_b64 a[88:89], v78 offset:3136
    ds_read_b64 a[90:91], v78 offset:3144
    v_mfma_f32_16x16x32_bf16 v[172:175], a[8:11], a[52:55], v[172:175]
    ds_read_b128 a[124:127], v79 offset:64
    v_mfma_f32_16x16x32_bf16 v[164:167], a[20:23], a[32:35], v[164:167]
    ds_read_b64 a[92:93], v78 offset:3648
    ds_read_b64 a[94:95], v78 offset:3656
    v_mfma_f32_16x16x32_bf16 v[168:171], a[20:23], a[36:39], v[168:171]
    v_mfma_f32_16x16x32_bf16 v[172:175], a[20:23], a[40:43], v[172:175]
    s_lshl_b32 s80, s30, 11
    s_lshl_b32 s89, s31, 6
    s_add_u32 s80, s80, s89
    s_add_u32 s80, s80, 0x8a0000
    s_mov_b32 exec_lo, 0x00010001
    s_mov_b32 exec_hi, 0x00010001
    s_cmp_eq_u32 s16, 0
    s_cbranch_scc1 L_ps_13
    buffer_store_dword v104, v92, s[64:67], s80 offen
L_pb_14:
    s_mov_b64 exec, -1
    v_mfma_f32_16x16x32_bf16 v[168:171], a[0:3], a[56:59], v[168:171]
    s_add_u32 m0, s84, 65536
    s_add_u32 s89, s85, 0
    s_add_u32 s86, s85, 27648
    buffer_load_dwordx4 v7, s[52:55], s89 offen lds
    buffer_load_dwordx4 v6, s[52:55], s86 offen offset:1024 lds
    v_mfma_f32_16x16x32_bf16 v[172:175], a[4:7], a[56:59], v[172:175]
    s_cmp_ge_u32 s76, 2
    s_cbranch_scc1 L_nowdt_15
    s_cmp_ge_u32 s31, 28
    s_cbranch_scc1 L_nowdt_15
    s_waitcnt vmcnt(16)
    ds_read_b64_tr_b16 v[208:209], v93 offset:0
    ds_read_b64_tr_b16 v[210:211], v93 offset:512
    v_xor_b32 v94, 32, v93
    ds_read_b64_tr_b16 v[212:213], v94 offset:0
    ds_read_b64_tr_b16 v[214:215], v94 offset:512
    v_xor_b32 v94, 64, v93
    ds_read_b64_tr_b16 v[216:217], v94 offset:0
    ds_read_b64_tr_b16 v[218:219], v94 offset:512
    v_xor_b32 v94, 96, v93
    ds_read_b64_tr_b16 v[220:221], v94 offset:0
    ds_read_b64_tr_b16 v[222:223], v94 offset:512
    s_waitcnt lgkmcnt(0)
    s_mul_i32 s80, s30, 229376
    s_lshl_b32 s89, s31, 13
    s_add_u32 s80, s80, s89
    s_lshl_b32 s89, s76, 12
    s_add_u32 s80, s80, s89
    buffer_store_dwordx4 v[208:211], v2, s[64:67], s80 offen offset:0 sc1
    buffer_store_dwordx4 v[212:215], v2, s[64:67], s80 offen offset:1024 sc1
    buffer_store_dwordx4 v[216:219], v2, s[64:67], s80 offen offset:2048 sc1
    buffer_store_dwordx4 v[220:223], v2, s[64:67], s80 offen offset:3072 sc1
L_nowdt_15:
    v_mfma_f32_16x16x32_bf16 v[168:171], a[24:27], a[32:35], v[168:171]
    s_add_u32 s80, s25, 0
    s_mov_b64 exec, 0xff
    s_cmp_eq_u32 s16, 0
    s_cbranch_scc1 L_ps_16
    buffer_store_dwordx2 v[106:107], v17, s[64:67], s80 offen offset:0
    buffer_store_dwordx2 v[106:107], v17, s[64:67], s80 offen offset:2048
L_pb_17:
    s_mov_b64 exec, -1
    v_mfma_f32_16x16x32_bf16 v[172:175], a[24:27], a[36:39], v[172:175]
    s_add_u32 s80, s5, 0
    s_mov_b64 exec, 0xff
    s_cmp_eq_u32 s16, 0
    s_cbranch_scc1 L_ps_18
    buffer_store_dwordx2 v[106:107], v17, s[64:67], s80 offen offset:0
    buffer_store_dwordx2 v[106:107], v17, s[64:67], s80 offen offset:2048
L_pb_19:
    s_mov_b64 exec, -1
    v_mfma_f32_16x16x32_bf16 v[172:175], a[0:3], a[60:63], v[172:175]
    s_add_u32 s80, s5, 131072
    s_mov_b64 exec, 0xff
    s_cmp_eq_u32 s16, 0
    s_cbranch_scc1 L_ps_20
    buffer_store_dwordx2 v[106:107], v17, s[64:67], s80 offen offset:0
    buffer_store_dwordx2 v[106:107], v17, s[64:67], s80 offen offset:2048
L_pb_21:
    s_mov_b64 exec, -1
    v_mfma_f32_16x16x32_bf16 v[172:175], a[28:31], a[32:35], v[172:175]
    v_mfma_f32_16x16x32_bf16 v[144:147], a[64:67], a[96:99], v[144:147]
    s_waitcnt lgkmcnt(15)
    v_mfma_f32_16x16x32_bf16 v[148:151], a[64:67], a[100:103], v[148:151]
    ds_read_b128 a[32:35], v79 offset:3712
    v_mfma_f32_16x16x32_bf16 v[148:151], a[68:71], a[96:99], v[148:151]
    v_mfma_f32_16x16x32_bf16 v[152:155], a[68:71], a[100:103], v[152:155]
    ds_read_b64 a[0:1], v78 offset:128
    ds_read_b64 a[2:3], v78 offset:136
    v_mfma_f32_16x16x32_bf16 v[152:155], a[64:67], a[104:107], v[152:155]
    v_mfma_f32_16x16x32_bf16 v[156:159], a[68:71], a[104:107], v[156:159]
    ds_read_b128 a[36:39], v79 offset:3200
    v_mfma_f32_16x16x32_bf16 v[152:155], a[72:75], a[96:99], v[152:155]
    v_mfma_f32_16x16x32_bf16 v[156:159], a[72:75], a[100:103], v[156:159]
    ds_read_b64 a[4:5], v78 offset:640
    ds_read_b64 a[6:7], v78 offset:648
    v_mfma_f32_16x16x32_bf16 v[160:163], a[72:75], a[104:107], v[160:163]
    s_waitcnt lgkmcnt(15)
    v_mfma_f32_16x16x32_bf16 v[156:159], a[64:67], a[108:111], v[156:159]
    ds_read_b128 a[40:43], v79 offset:2688
    v_mfma_f32_16x16x32_bf16 v[160:163], a[68:71], a[108:111], v[160:163]
    v_mfma_f32_16x16x32_bf16 v[164:167], a[72:75], a[108:111], v[164:167]
    ds_read_b64 a[8:9], v78 offset:1152
    ds_read_b64 a[10:11], v78 offset:1160
    v_mfma_f32_16x16x32_bf16 v[156:159], a[76:79], a[96:99], v[156:159]
    v_mfma_f32_16x16x32_bf16 v[160:163], a[76:79], a[100:103], v[160:163]
    ds_read_b128 a[44:47], v79 offset:2176
    v_mfma_f32_16x16x32_bf16 v[164:167], a[76:79], a[104:107], v[164:167]
    s_add_u32 m0, s84, 67584
    s_add_u32 s89, s85, 57344
    s_add_u32 s86, s85, 84992
    buffer_load_dwordx4 v7, s[52:55], s89 offen lds
    buffer_load_dwordx4 v6, s[52:55], s86 offen offset:1024 lds
    s_add_u32 s84, s84, 16384
    s_add_u32 s85, s85, 458752
    s_cmp_ge_u32 s85, s29
    s_cselect_b32 s89, 1835008, 0
    s_sub_u32 s85, s85, s89
    v_mfma_f32_16x16x32_bf16 v[168:171], a[76:79], a[108:111], v[168:171]
    ds_read_b64 a[12:13], v78 offset:1664
    ds_read_b64 a[14:15], v78 offset:1672
    v_mfma_f32_16x16x32_bf16 v[160:163], a[64:67], a[112:115], v[160:163]
    v_mfma_f32_16x16x32_bf16 v[164:167], a[68:71], a[112:115], v[164:167]
    ds_read_b128 a[48:51], v79 offset:1664
    v_mfma_f32_16x16x32_bf16 v[168:171], a[72:75], a[112:115], v[168:171]
    v_mfma_f32_16x16x32_bf16 v[172:175], a[76:79], a[112:115], v[172:175]
    ds_read_b64 a[16:17], v78 offset:2176
    ds_read_b64 a[18:19], v78 offset:2184
    v_mfma_f32_16x16x32_bf16 v[160:163], a[80:83], a[96:99], v[160:163]
    v_mfma_f32_16x16x32_bf16 v[164:167], a[80:83], a[100:103], v[164:167]
    ds_read_b128 a[52:55], v79 offset:1152
    v_mfma_f32_16x16x32_bf16 v[168:171], a[80:83], a[104:107], v[168:171]
    v_mfma_f32_16x16x32_bf16 v[172:175], a[80:83], a[108:111], v[172:175]
    ds_read_b64 a[20:21], v78 offset:2688
    ds_read_b64 a[22:23], v78 offset:2696
    s_waitcnt lgkmcnt(15)
    v_mfma_f32_16x16x32_bf16 v[164:167], a[64:67], a[116:119], v[164:167]
    ds_read_b64 v[124:125], v203 offset:1536
    v_mfma_f32_16x16x32_bf16 v[168:171], a[68:71], a[116:119], v[168:171]
    ds_read_b128 a[56:59], v79 offset:640
    v_mfma_f32_16x16x32_bf16 v[172:175], a[72:75], a[116:119], v[172:175]
    ds_read_b64 v[126:127], v203 offset:1024
    v_mfma_f32_16x16x32_bf16 v[164:167], a[84:87], a[96:99], v[164:167]
    ds_read_b64 a[24:25], v78 offset:3200
    ds_read_b64 a[26:27], v78 offset:3208
    v_mfma_f32_16x16x32_bf16 v[168:171], a[84:87], a[100:103], v[168:171]
    ds_read_b64 v[128:129], v203 offset:512
    v_mfma_f32_16x16x32_bf16 v[172:175], a[84:87], a[104:107], v[172:175]
    ds_read_b128 a[60:63], v79 offset:128
    v_mfma_f32_16x16x32_bf16 v[168:171], a[64:67], a[120:123], v[168:171]
    ds_read_b64 v[130:131], v203 offset:0
    v_mfma_f32_16x16x32_bf16 v[172:175], a[68:71], a[120:123], v[172:175]
    ds_read_b64 a[28:29], v78 offset:3712
    ds_read_b64 a[30:31], v78 offset:3720
    v_mfma_f32_16x16x32_bf16 v[168:171], a[88:91], a[96:99], v[168:171]
    s_add_u32 m0, s84, 0
    s_add_u32 s89, s85, 0
    s_add_u32 s86, s85, 27648
    buffer_load_dwordx4 v7, s[48:51], s89 offen lds
    buffer_load_dwordx4 v6, s[48:51], s86 offen offset:1024 lds
    v_mfma_f32_16x16x32_bf16 v[172:175], a[88:91], a[100:103], v[172:175]
    s_lshl_b32 s82, s75, 16
    v_mfma_f32_16x16x32_bf16 v[172:175], a[64:67], a[124:127], v[172:175]
    s_and_b32 s101, s75, 0xffff0000
    v_mfma_f32_16x16x32_bf16 v[172:175], a[92:95], a[96:99], v[172:175]
    s_cmp_lt_u32 s76, 2
    s_cselect_b32 s82, s82, s101
    v_mfma_f32_16x16x32_bf16 v[144:147], a[0:3], a[32:35], v[144:147]
    s_waitcnt lgkmcnt(2)
    v_and_b32 v108, 0xffff0000, v125
    v_mfma_f32_16x16x32_bf16 v[148:151], a[0:3], a[36:39], v[148:151]
    ds_read_b128 a[96:99], v79 offset:3776
    v_mfma_f32_16x16x32_bf16 v[148:151], a[4:7], a[32:35], v[148:151]
    v_lshlrev_b32 v109, 16, v125
    v_mfma_f32_16x16x32_bf16 v[152:155], a[4:7], a[36:39], v[152:155]
    ds_read_b64 a[64:65], v78 offset:192
    ds_read_b64 a[66:67], v78 offset:200
    v_mfma_f32_16x16x32_bf16 v[152:155], a[0:3], a[40:43], v[152:155]
    v_and_b32 v110, 0xffff0000, v124
    v_mfma_f32_16x16x32_bf16 v[156:159], a[4:7], a[40:43], v[156:159]
    ds_read_b128 a[100:103], v79 offset:3264
    v_mfma_f32_16x16x32_bf16 v[152:155], a[8:11], a[32:35], v[152:155]
    v_lshlrev_b32 v111, 16, v124
    v_mfma_f32_16x16x32_bf16 v[156:159], a[8:11], a[36:39], v[156:159]
    ds_read_b64 a[68:69], v78 offset:704
    ds_read_b64 a[70:71], v78 offset:712
    v_mfma_f32_16x16x32_bf16 v[160:163], a[8:11], a[40:43], v[160:163]
    v_and_b32 v112, 0xffff0000, v127
    v_mfma_f32_16x16x32_bf16 v[156:159], a[0:3], a[44:47], v[156:159]
    ds_read_b128 a[104:107], v79 offset:2752
    v_mfma_f32_16x16x32_bf16 v[160:163], a[4:7], a[44:47], v[160:163]
    v_lshlrev_b32 v113, 16, v127
    v_mfma_f32_16x16x32_bf16 v[164:167], a[8:11], a[44:47], v[164:167]
    ds_read_b64 a[72:73], v78 offset:1216
    ds_read_b64 a[74:75], v78 offset:1224
    v_mfma_f32_16x16x32_bf16 v[156:159], a[12:15], a[32:35], v[156:159]
    v_and_b32 v114, 0xffff0000, v126
    v_mfma_f32_16x16x32_bf16 v[160:163], a[12:15], a[36:39], v[160:163]
    ds_read_b128 a[108:111], v79 offset:2240
    v_mfma_f32_16x16x32_bf16 v[164:167], a[12:15], a[40:43], v[164:167]
    s_add_u32 m0, s84, 2048
    s_add_u32 s89, s85, 57344
    s_add_u32 s86, s85, 84992
    buffer_load_dwordx4 v7, s[48:51], s89 offen lds
    buffer_load_dwordx4 v6, s[48:51], s86 offen offset:1024 lds
    v_mfma_f32_16x16x32_bf16 v[168:171], a[12:15], a[44:47], v[168:171]
    ds_read_b64 a[76:77], v78 offset:1728
    ds_read_b64 a[78:79], v78 offset:1736
    v_mfma_f32_16x16x32_bf16 v[160:163], a[0:3], a[48:51], v[160:163]
    v_lshlrev_b32 v115, 16, v126
    v_mfma_f32_16x16x32_bf16 v[164:167], a[4:7], a[48:51], v[164:167]
    ds_read_b128 a[112:115], v79 offset:1728
    v_mfma_f32_16x16x32_bf16 v[168:171], a[8:11], a[48:51], v[168:171]
    v_and_b32 v116, 0xffff0000, v129
    v_mfma_f32_16x16x32_bf16 v[172:175], a[12:15], a[48:51], v[172:175]
    ds_read_b64 a[80:81], v78 offset:2240
    ds_read_b64 a[82:83], v78 offset:2248
    v_mfma_f32_16x16x32_bf16 v[160:163], a[16:19], a[32:35], v[160:163]
    v_lshlrev_b32 v117, 16, v129
    v_mfma_f32_16x16x32_bf16 v[164:167], a[16:19], a[36:39], v[164:167]
    ds_read_b128 a[116:119], v79 offset:1216
    v_mfma_f32_16x16x32_bf16 v[168:171], a[16:19], a[40:43], v[168:171]
    v_and_b32 v118, 0xffff0000, v128
    v_mfma_f32_16x16x32_bf16 v[172:175], a[16:19], a[44:47], v[172:175]
    ds_read_b64 a[84:85], v78 offset:2752
    ds_read_b64 a[86:87], v78 offset:2760
    v_mfma_f32_16x16x32_bf16 v[164:167], a[0:3], a[52:55], v[164:167]
    v_lshlrev_b32 v119, 16, v128
    v_mfma_f32_16x16x32_bf16 v[168:171], a[4:7], a[52:55], v[168:171]
    ds_read_b128 a[120:123], v79 offset:704
    v_mfma_f32_16x16x32_bf16 v[172:175], a[8:11], a[52:55], v[172:175]
    v_and_b32 v120, 0xffff0000, v131
    v_mfma_f32_16x16x32_bf16 v[164:167], a[20:23], a[32:35], v[164:167]
    ds_read_b64 a[88:89], v78 offset:3264
    ds_read_b64 a[90:91], v78 offset:3272
    v_mfma_f32_16x16x32_bf16 v[168:171], a[20:23], a[36:39], v[168:171]
    v_lshlrev_b32 v121, 16, v131
    v_mfma_f32_16x16x32_bf16 v[172:175], a[20:23], a[40:43], v[172:175]
    ds_read_b128 a[124:127], v79 offset:192
    v_mfma_f32_16x16x32_bf16 v[168:171], a[0:3], a[56:59], v[168:171]
    v_and_b32 v122, 0xffff0000, v130
    v_mfma_f32_16x16x32_bf16 v[172:175], a[4:7], a[56:59], v[172:175]
    ds_read_b64 a[92:93], v78 offset:3776
    ds_read_b64 a[94:95], v78 offset:3784
    v_mfma_f32_16x16x32_bf16 v[168:171], a[24:27], a[32:35], v[168:171]
    s_add_u32 m0, s84, 65536
    s_add_u32 s89, s85, 0
    s_add_u32 s86, s85, 27648
    buffer_load_dwordx4 v7, s[52:55], s89 offen lds
    buffer_load_dwordx4 v6, s[52:55], s86 offen offset:1024 lds
    v_mfma_f32_16x16x32_bf16 v[172:175], a[24:27], a[36:39], v[172:175]
    v_lshlrev_b32 v123, 16, v130
    v_mfma_f32_16x16x32_bf16 v[172:175], a[0:3], a[60:63], v[172:175]
    v_mul_f32 v108, s82, v108
    s_waitcnt lgkmcnt(15)
    v_mfma_f32_16x16x32_bf16 v[172:175], a[28:31], a[32:35], v[172:175]
    v_mul_f32 v109, s82, v109
    v_mfma_f32_16x16x32_bf16 v[144:147], a[64:67], a[96:99], v[144:147]
    v_mul_f32 v110, s82, v110
    v_mul_f32 v111, s82, v111
    v_mfma_f32_16x16x32_bf16 v[148:151], a[64:67], a[100:103], v[148:151]
    v_mul_f32 v112, s82, v112
    v_mul_f32 v113, s82, v113
    v_mfma_f32_16x16x32_bf16 v[148:151], a[68:71], a[96:99], v[148:151]
    v_mul_f32 v114, s82, v114
    v_mul_f32 v115, s82, v115
    v_mfma_f32_16x16x32_bf16 v[152:155], a[68:71], a[100:103], v[152:155]
    v_mul_f32 v116, s82, v116
    v_mul_f32 v117, s82, v117
    v_mfma_f32_16x16x32_bf16 v[152:155], a[64:67], a[104:107], v[152:155]
    v_mul_f32 v118, s82, v118
    v_mul_f32 v119, s82, v119
    v_mfma_f32_16x16x32_bf16 v[156:159], a[68:71], a[104:107], v[156:159]
    v_mul_f32 v120, s82, v120
    v_mul_f32 v121, s82, v121
    v_mfma_f32_16x16x32_bf16 v[152:155], a[72:75], a[96:99], v[152:155]
    v_mul_f32 v122, s82, v122
    v_mul_f32 v123, s82, v123
    v_mfma_f32_16x16x32_bf16 v[156:159], a[72:75], a[100:103], v[156:159]
    v_mfma_f32_16x16x32_bf16 v[160:163], a[72:75], a[104:107], v[160:163]
    s_waitcnt lgkmcnt(14)
    v_mfma_f32_16x16x32_bf16 v[156:159], a[64:67], a[108:111], v[156:159]
    v_mfma_f32_16x16x32_bf16 v[160:163], a[68:71], a[108:111], v[160:163]
    v_mfma_f32_16x16x32_bf16 v[164:167], a[72:75], a[108:111], v[164:167]
    s_waitcnt lgkmcnt(12)
    v_mfma_f32_16x16x32_bf16 v[156:159], a[76:79], a[96:99], v[156:159]
    v_mfma_f32_16x16x32_bf16 v[160:163], a[76:79], a[100:103], v[160:163]
    v_mfma_f32_16x16x32_bf16 v[164:167], a[76:79], a[104:107], v[164:167]
    v_mfma_f32_16x16x32_bf16 v[168:171], a[76:79], a[108:111], v[168:171]
    s_waitcnt lgkmcnt(11)
    v_mfma_f32_16x16x32_bf16 v[160:163], a[64:67], a[112:115], v[160:163]
    s_add_u32 m0, s84, 67584
    s_add_u32 s89, s85, 57344
    s_add_u32 s86, s85, 84992
    buffer_load_dwordx4 v7, s[52:55], s89 offen lds
    buffer_load_dwordx4 v6, s[52:55], s86 offen offset:1024 lds
    s_add_u32 s84, s84, 16384
    s_add_u32 s85, s85, 458752
    s_cmp_ge_u32 s85, s29
    s_cselect_b32 s89, 1835008, 0
    s_sub_u32 s85, s85, s89
    v_mfma_f32_16x16x32_bf16 v[164:167], a[68:71], a[112:115], v[164:167]
    v_mfma_f32_16x16x32_bf16 v[168:171], a[72:75], a[112:115], v[168:171]
    v_mfma_f32_16x16x32_bf16 v[172:175], a[76:79], a[112:115], v[172:175]
    s_waitcnt lgkmcnt(9)
    v_mfma_f32_16x16x32_bf16 v[160:163], a[80:83], a[96:99], v[160:163]
    v_mfma_f32_16x16x32_bf16 v[164:167], a[80:83], a[100:103], v[164:167]
    v_mfma_f32_16x16x32_bf16 v[168:171], a[80:83], a[104:107], v[168:171]
    v_mfma_f32_16x16x32_bf16 v[172:175], a[80:83], a[108:111], v[172:175]
    s_waitcnt lgkmcnt(8)
    v_mfma_f32_16x16x32_bf16 v[164:167], a[64:67], a[116:119], v[164:167]
    v_mfma_f32_16x16x32_bf16 v[168:171], a[68:71], a[116:119], v[168:171]
    v_mfma_f32_16x16x32_bf16 v[172:175], a[72:75], a[116:119], v[172:175]
    s_waitcnt lgkmcnt(6)
    v_mfma_f32_16x16x32_bf16 v[164:167], a[84:87], a[96:99], v[164:167]
    v_mfma_f32_16x16x32_bf16 v[168:171], a[84:87], a[100:103], v[168:171]
    v_mfma_f32_16x16x32_bf16 v[172:175], a[84:87], a[104:107], v[172:175]
    s_waitcnt lgkmcnt(5)
    v_mfma_f32_16x16x32_bf16 v[168:171], a[64:67], a[120:123], v[168:171]
    v_mfma_f32_16x16x32_bf16 v[172:175], a[68:71], a[120:123], v[172:175]
    s_waitcnt lgkmcnt(3)
    v_mfma_f32_16x16x32_bf16 v[168:171], a[88:91], a[96:99], v[168:171]
    v_mfma_f32_16x16x32_bf16 v[172:175], a[88:91], a[100:103], v[172:175]
    s_waitcnt lgkmcnt(2)
    v_mfma_f32_16x16x32_bf16 v[172:175], a[64:67], a[124:127], v[172:175]
    s_waitcnt lgkmcnt(0)
    v_mfma_f32_16x16x32_bf16 v[172:175], a[92:95], a[96:99], v[172:175]
    s_and_b32 s83, s76, 1
    s_cmp_eq_u32 s83, 1
    s_cbranch_scc1 L_hf_22
    ds_write_b128 v200, v[160:163] offset:0
    ds_write_b128 v200, v[164:167] offset:1024
    ds_write_b128 v200, v[168:171] offset:2048
    s_nop 1
    ds_write_b128 v200, v[172:175] offset:3072
    v_pk_add_f32 v[108:109], v[108:109], v[144:145]
    v_pk_add_f32 v[110:111], v[110:111], v[146:147]
    v_pk_add_f32 v[112:113], v[112:113], v[148:149]
    v_pk_add_f32 v[114:115], v[114:115], v[150:151]
    v_pk_add_f32 v[116:117], v[116:117], v[152:153]
    v_pk_add_f32 v[118:119], v[118:119], v[154:155]
    v_pk_add_f32 v[120:121], v[120:121], v[156:157]
    v_pk_add_f32 v[122:123], v[122:123], v[158:159]
    s_branch L_hfd_23
L_hf_22:
    ds_write_b128 v200, v[144:147] offset:0
    ds_write_b128 v200, v[148:151] offset:1024
    ds_write_b128 v200, v[152:155] offset:2048
    ds_write_b128 v200, v[156:159] offset:3072
    v_pk_add_f32 v[108:109], v[108:109], v[160:161]
    v_pk_add_f32 v[110:111], v[110:111], v[162:163]
    v_pk_add_f32 v[112:113], v[112:113], v[164:165]
    v_pk_add_f32 v[114:115], v[114:115], v[166:167]
    v_pk_add_f32 v[116:117], v[116:117], v[168:169]
    v_pk_add_f32 v[118:119], v[118:119], v[170:171]
    v_pk_add_f32 v[120:121], v[120:121], v[172:173]
    v_pk_add_f32 v[122:123], v[122:123], v[174:175]
L_hfd_23:
    s_waitcnt lgkmcnt(0)
    s_barrier
    ds_read_b128 v[176:179], v201 offset:0
    ds_read_b128 v[180:183], v201 offset:1024
    ds_read_b128 v[184:187], v201 offset:2048
    ds_read_b128 v[188:191], v201 offset:3072
    s_waitcnt lgkmcnt(3)
    v_pk_add_f32 v[176:177], v[176:177], v[108:109]
    v_pk_add_f32 v[178:179], v[178:179], v[110:111]
    s_waitcnt lgkmcnt(2)
    v_pk_add_f32 v[180:181], v[180:181], v[112:113]
    v_pk_add_f32 v[182:183], v[182:183], v[114:115]
    s_waitcnt lgkmcnt(1)
    v_pk_add_f32 v[184:185], v[184:185], v[116:117]
    v_pk_add_f32 v[186:187], v[186:187], v[118:119]
    s_waitcnt lgkmcnt(0)
    v_pk_add_f32 v[188:189], v[188:189], v[120:121]
    v_pk_add_f32 v[190:191], v[190:191], v[122:123]
    v_cvt_pk_bf16_f32 v192, v176, v177
    v_cvt_pk_bf16_f32 v193, v178, v179
    v_cvt_pk_bf16_f32 v194, v180, v181
    v_cvt_pk_bf16_f32 v195, v182, v183
    s_nop 0
    v_permlane16_swap_b32 v192, v194
    v_permlane16_swap_b32 v193, v195
    buffer_store_dwordx4 v[192:195], v202, s[64:67], s18 offen offset:0 sc1
    v_cvt_pk_bf16_f32 v196, v184, v185
    v_cvt_pk_bf16_f32 v197, v186, v187
    v_cvt_pk_bf16_f32 v198, v188, v189
    v_cvt_pk_bf16_f32 v199, v190, v191
    s_nop 0
    v_permlane16_swap_b32 v196, v198
    v_permlane16_swap_b32 v197, v199
    buffer_store_dwordx4 v[196:199], v202, s[64:67], s18 offen offset:1024 sc1
    v_lshlrev_b32 v72, 3, v5
    buffer_load_dword v73, v72, s[92:95], 0 offen offset:0 sc1
    s_waitcnt vmcnt(24)
    v_lshlrev_b32 v144, 16, v40
    v_and_b32 v145, 0xffff0000, v40
    v_lshlrev_b32 v146, 16, v41
    v_and_b32 v147, 0xffff0000, v41
    v_lshlrev_b32 v148, 16, v42
    v_and_b32 v149, 0xffff0000, v42
    v_lshlrev_b32 v150, 16, v43
    v_and_b32 v151, 0xffff0000, v43
    v_lshlrev_b32 v168, 16, v44
    v_and_b32 v169, 0xffff0000, v44
    v_lshlrev_b32 v170, 16, v45
    v_and_b32 v171, 0xffff0000, v45
    v_lshlrev_b32 v172, 16, v46
    v_and_b32 v173, 0xffff0000, v46
    v_lshlrev_b32 v174, 16, v47
    v_and_b32 v175, 0xffff0000, v47
    s_and_b32 s83, s76, 1
    v_lshrrev_b32 v58, 3, v1
    v_and_b32 v59, 7, v1
    v_bfe_u32 v60, v1, 4, 1
    v_xor_b32 v59, v59, v60
    s_lshl_b32 s80, s83, 2
    v_xor_b32 v59, s80, v59
    v_lshlrev_b32 v59, 4, v59
    v_mul_u32_u24 v58, 4096, v58
    v_add_u32 v204, v58, v59
    v_xor_b32 v205, 32, v204
    v_add_u32 v205, 31744, v205
    v_lshrrev_b32 v58, 4, v1
    v_bfe_u32 v59, v1, 1, 1
    v_lshl_add_u32 v58, v58, 1, v59
    v_bfe_u32 v59, v1, 2, 2
    v_lshl_add_u32 v60, v58, 3, v59
    v_and_b32 v58, 3, v58
    v_lshrrev_b32 v59, 1, v59
    v_lshl_add_u32 v58, v58, 1, v59
    v_xor_b32 v58, s76, v58
    v_lshlrev_b32 v58, 4, v58
    v_lshl_add_u32 v206, v60, 7, v58
    v_and_b32 v58, 1, v1
    v_lshl_add_u32 v206, v58, 3, v206
    v_add_u32 v206, 147456, v206
    v_xor_b32 v207, 64, v206
    s_lshl_b32 s20, s78, 18
    s_lshl_b32 s89, s76, 16
    s_add_u32 s20, s20, s89
    s_lshl_b32 s89, s30, 9
    s_add_u32 s20, s20, s89
    s_lshl_b32 s89, s79, 7
    s_add_u32 s20, s20, s89
    s_add_u32 s20, s20, 0x1b00000
    s_lshl_b32 s24, s76, 11
    s_add_u32 s24, s24, 0x24000
    s_mul_i32 s23, s78, 10496
    s_add_u32 s23, s23, 0x862300
    s_lshl_b32 s17, s30, 11
    s_lshl_b32 s89, s79, 9
    s_add_u32 s17, s17, s89
    s_lshl_b32 s89, s76, 6
    s_add_u32 s17, s17, s89
    s_add_u32 s17, s17, 0x8a0000
    s_add_u32 m0, s84, 0
    s_add_u32 s89, s85, 0
    s_add_u32 s86, s85, 27648
    buffer_load_dwordx4 v7, s[48:51], s89 offen lds
    buffer_load_dwordx4 v6, s[48:51], s86 offen offset:1024 lds
    s_mov_b32 s100, 0x3f803f80
    s_waitcnt vmcnt(24)
    ds_read_b64_tr_b16 v[208:209], v132 offset:0
    ds_read_b64_tr_b16 v[210:211], v132 offset:512
    ds_read_b64_tr_b16 v[212:213], v133 offset:0
    ds_read_b64_tr_b16 v[214:215], v133 offset:512
    ds_read_b64_tr_b16 v[216:217], v134 offset:0
    ds_read_b64_tr_b16 v[218:219], v134 offset:512
    ds_read_b64_tr_b16 v[220:221], v135 offset:0
    ds_read_b64_tr_b16 v[222:223], v135 offset:512
    s_waitcnt lgkmcnt(0)
    s_waitcnt vmcnt(13)
    ds_read_b64_tr_b16 v[232:233], v136 offset:0
    ds_read_b64_tr_b16 v[234:235], v136 offset:512
    ds_read_b64_tr_b16 v[236:237], v137 offset:0
    ds_read_b64_tr_b16 v[238:239], v137 offset:512
    ds_read_b64_tr_b16 v[240:241], v138 offset:0
    ds_read_b64_tr_b16 v[242:243], v138 offset:512
    ds_read_b64_tr_b16 v[244:245], v139 offset:0
    ds_read_b64_tr_b16 v[246:247], v139 offset:512
    ds_write_b128 v140, v[208:211] offset:0
    v_dot2_f32_bf16 v224, v208, s100, 0
    v_dot2_f32_bf16 v224, v209, s100, v224
    v_dot2_f32_bf16 v224, v210, s100, v224
    v_dot2_f32_bf16 v224, v211, s100, v224
    ds_write_b128 v140, v[212:215] offset:1024
    v_dot2_f32_bf16 v225, v212, s100, 0
    v_dot2_f32_bf16 v225, v213, s100, v225
    v_dot2_f32_bf16 v225, v214, s100, v225
    v_dot2_f32_bf16 v225, v215, s100, v225
    ds_write_b128 v140, v[216:219] offset:2048
    v_dot2_f32_bf16 v226, v216, s100, 0
    v_dot2_f32_bf16 v226, v217, s100, v226
    v_dot2_f32_bf16 v226, v218, s100, v226
    v_dot2_f32_bf16 v226, v219, s100, v226
    ds_write_b128 v140, v[220:223] offset:3072
    v_dot2_f32_bf16 v227, v220, s100, 0
    v_dot2_f32_bf16 v227, v221, s100, v227
    v_dot2_f32_bf16 v227, v222, s100, v227
    v_dot2_f32_bf16 v227, v223, s100, v227
    s_waitcnt lgkmcnt(4)
    ds_write_b128 v141, v[232:235] offset:0
    v_dot2_f32_bf16 v228, v232, s100, 0
    v_dot2_f32_bf16 v228, v233, s100, v228
    v_dot2_f32_bf16 v228, v234, s100, v228
    v_dot2_f32_bf16 v228, v235, s100, v228
    ds_write_b128 v141, v[236:239] offset:1024
    v_dot2_f32_bf16 v229, v236, s100, 0
    v_dot2_f32_bf16 v229, v237, s100, v229
    v_dot2_f32_bf16 v229, v238, s100, v229
    v_dot2_f32_bf16 v229, v239, s100, v229
    ds_write_b128 v141, v[240:243] offset:2048
    v_dot2_f32_bf16 v230, v240, s100, 0
    v_dot2_f32_bf16 v230, v241, s100, v230
    v_dot2_f32_bf16 v230, v242, s100, v230
    v_dot2_f32_bf16 v230, v243, s100, v230
    ds_write_b128 v141, v[244:247] offset:3072
    v_dot2_f32_bf16 v231, v244, s100, 0
    v_dot2_f32_bf16 v231, v245, s100, v231
    v_dot2_f32_bf16 v231, v246, s100, v231
    v_dot2_f32_bf16 v231, v247, s100, v231
    s_waitcnt vmcnt(2)
    s_barrier
    s_cmp_lg_u32 s76, 1
    s_cbranch_scc1 L_noarr_24
    s_add_u32 s80, s28, 8704
    s_cmp_eq_u32 s16, 0
    s_cbranch_scc1 L_ps_25
    buffer_store_dword v23, off, s[64:67], s80
L_pb_26:
    s_cmp_lg_u32 s31, 0
    s_cbranch_scc1 L_noarr_24
    buffer_load_dword v16, v4, s[64:67], s80 offen offset:0 sc1
    s_waitcnt vmcnt(0)
    v_cmp_eq_u32 vcc, 0, v16
    s_cbranch_vccnz L_fs_27
L_fb_28:
    buffer_store_dword v23, off, s[64:67], s80 offset:256 sc1
L_noarr_24:
    s_add_u32 s81, s78, s30
    s_mov_b32 s82, s81
    s_cmp_ge_u32 s82, 7
    s_cselect_b32 s80, 7, 0
    s_sub_u32 s82, s82, s80
    s_cmp_ge_u32 s82, 7
    s_cselect_b32 s80, 7, 0
    s_sub_u32 s82, s82, s80
    s_lshl_b32 s81, s81, 12
    s_lshl_b32 s68, s82, 12
    s_and_b32 s32, s81, 0x7000
    s_add_u32 s81, s81, 4096
    s_and_b32 s33, s81, 0x7000
    s_add_u32 s81, s81, 4096
    s_add_u32 s80, s68, 4096
    s_cmp_lt_u32 s80, 28672
    s_cselect_b32 s69, s80, 0
    s_and_b32 s34, s81, 0x7000
    s_add_u32 s81, s81, 4096
    s_add_u32 s80, s69, 4096
    s_cmp_lt_u32 s80, 28672
    s_cselect_b32 s70, s80, 0
    s_and_b32 s35, s81, 0x7000
    s_add_u32 s81, s81, 4096
    s_add_u32 s80, s70, 4096
    s_cmp_lt_u32 s80, 28672
    s_cselect_b32 s71, s80, 0
    s_and_b32 s36, s81, 0x7000
    s_add_u32 s81, s81, 4096
    s_add_u32 s80, s71, 4096
    s_cmp_lt_u32 s80, 28672
    s_cselect_b32 s72, s80, 0
    s_and_b32 s37, s81, 0x7000
    s_add_u32 s81, s81, 4096
    s_add_u32 s80, s72, 4096
    s_cmp_lt_u32 s80, 28672
    s_cselect_b32 s73, s80, 0
    s_and_b32 s38, s81, 0x7000
    s_add_u32 s81, s81, 4096
    s_add_u32 s80, s73, 4096
    s_cmp_lt_u32 s80, 28672
    s_cselect_b32 s74, s80, 0
    s_and_b32 s39, s81, 0x7000
    s_mul_i32 s3, s76, 57344
    s_mul_i32 s89, s78, 229376
    s_add_u32 s3, s3, s89
    s_lshl_b32 s47, s76, 13
    s_add_u32 s47, s47, 0x20000
    s_lshl_b32 s4, s30, 18
    s_lshl_b32 s89, s79, 16
    s_add_u32 s4, s4, s89
    s_lshl_b32 s89, s78, 12
    s_add_u32 s4, s4, s89
    s_lshl_b32 s89, s76, 7
    s_add_u32 s4, s4, s89
    s_add_u32 s4, s4, 0x400000
    s_lshl_b32 s12, s88, 0
    s_lshl_b32 s89, s79, 9
    s_add_u32 s12, s12, s89
    s_lshl_b32 s89, s78, 4
    s_add_u32 s12, s12, s89
    s_lshl_b32 s89, s76, 2
    s_add_u32 s12, s12, s89
    s_add_u32 s12, s12, 0x200
    s_lshl_b32 s8, s30, 18
    s_lshl_b32 s89, s76, 16
    s_add_u32 s8, s8, s89
    s_add_u32 s8, s8, 0x400000
    s_lshl_b32 s9, s30, 14
    s_lshl_b32 s89, s76, 12
    s_add_u32 s9, s9, s89
    s_add_u32 s9, s9, 0x800000
    s_lshr_b32 s81, s31, 1
    s_mul_i32 s10, s30, 917504
    s_mul_i32 s89, s76, 229376
    s_add_u32 s10, s10, s89
    s_mul_i32 s89, s81, 7168
    s_add_u32 s10, s10, s89
    s_add_u32 s10, s10, 0x900000
    s_mul_i32 s11, s30, 917504
    s_mul_i32 s89, s79, 229376
    s_add_u32 s11, s11, s89
    s_mul_i32 s89, s76, 28672
    s_add_u32 s11, s11, s89
    s_add_u32 s11, s11, 0x900000
    s_lshl_b32 s13, s88, 0
    s_lshl_b32 s89, s76, 9
    s_add_u32 s13, s13, s89
    s_add_u32 s13, s13, 0x200
    s_lshl_b32 s26, s88, 0
    s_lshl_b32 s89, s76, 9
    s_add_u32 s26, s26, s89
    s_lshl_b32 s89, s31, 2
    s_add_u32 s26, s26, s89
    s_add_u32 s26, s26, 0x1200
    s_lshl_b32 s27, s88, 0
    s_lshl_b32 s89, s79, 9
    s_add_u32 s27, s27, s89
    s_lshl_b32 s89, s76, 5
    s_add_u32 s27, s27, s89
    s_add_u32 s27, s27, 0x1200
    s_mov_b32 s44, 0xffff
    s_mov_b32 s45, 0
    v_and_b32 v58, 15, v1
    v_lshrrev_b32 v59, 4, v1
    v_lshlrev_b32 v62, 9, v59
    v_lshl_add_u32 v0, v58, 4, v62
    v_lshl_add_u32 v22, v58, 3, v62
    v_and_b32 v60, 7, v1
    v_and_b32 v61, 4, v1
    v_lshl_add_u32 v60, v61, 1, v60
    v_xor_b32 v61, v59, v60
    v_lshlrev_b32 v61, 4, v61
    v_lshl_add_u32 v61, v58, 8, v61
    v_add_u32 v8, s47, v61
    v_lshrrev_b32 v58, 3, v1
    v_lshlrev_b32 v58, 1, v58
    v_xor_b32 v58, v58, v60
    v_lshlrev_b32 v58, 4, v58
    v_and_b32 v59, 7, v1
    v_lshl_add_u32 v58, v59, 8, v58
    s_lshl_b32 s81, s76, 11
    s_add_u32 s81, s81, 0x20000
    v_add_u32 v9, s81, v58
    v_xor_b32 v10, 16, v9
    s_add_u32 m0, s84, 2048
    s_add_u32 s89, s85, 57344
    s_add_u32 s86, s85, 84992
    buffer_load_dwordx4 v7, s[48:51], s89 offen lds
    buffer_load_dwordx4 v6, s[48:51], s86 offen offset:1024 lds
    s_add_u32 m0, s84, 65536
    s_add_u32 s89, s85, 0
    s_add_u32 s86, s85, 27648
    buffer_load_dwordx4 v7, s[52:55], s89 offen lds
    buffer_load_dwordx4 v6, s[52:55], s86 offen offset:1024 lds
    s_add_u32 m0, s84, 67584
    s_add_u32 s89, s85, 57344
    s_add_u32 s86, s85, 84992
    buffer_load_dwordx4 v7, s[52:55], s89 offen lds
    buffer_load_dwordx4 v6, s[52:55], s86 offen offset:1024 lds
    s_add_u32 s84, s84, 16384
    s_add_u32 s85, s85, 458752
    s_cmp_ge_u32 s85, s29
    s_cselect_b32 s89, 1835008, 0
    s_sub_u32 s85, s85, s89
    s_add_u32 m0, s84, 0
    s_add_u32 s89, s85, 0
    s_add_u32 s86, s85, 27648
    buffer_load_dwordx4 v7, s[48:51], s89 offen lds
    buffer_load_dwordx4 v6, s[48:51], s86 offen offset:1024 lds
    s_mov_b32 s100, 0x3f803f80
    ds_read_b64_tr_b16 v[208:209], v132 offset:16384
    ds_read_b64_tr_b16 v[210:211], v132 offset:16896
    ds_read_b64_tr_b16 v[212:213], v133 offset:16384
    ds_read_b64_tr_b16 v[214:215], v133 offset:16896
    ds_read_b64_tr_b16 v[216:217], v134 offset:16384
    ds_read_b64_tr_b16 v[218:219], v134 offset:16896
    ds_read_b64_tr_b16 v[220:221], v135 offset:16384
    ds_read_b64_tr_b16 v[222:223], v135 offset:16896
    s_waitcnt lgkmcnt(0)
    ds_read_b64_tr_b16 v[232:233], v136 offset:16384
    ds_read_b64_tr_b16 v[234:235], v136 offset:16896
    ds_read_b64_tr_b16 v[236:237], v137 offset:16384
    ds_read_b64_tr_b16 v[238:239], v137 offset:16896
    ds_read_b64_tr_b16 v[240:241], v138 offset:16384
    ds_read_b64_tr_b16 v[242:243], v138 offset:16896
    ds_read_b64_tr_b16 v[244:245], v139 offset:16384
    ds_read_b64_tr_b16 v[246:247], v139 offset:16896
    ds_write_b128 v140, v[208:211] offset:16384
    v_dot2_f32_bf16 v224, v208, s100, v224
    v_dot2_f32_bf16 v224, v209, s100, v224
    v_dot2_f32_bf16 v224, v210, s100, v224
    v_dot2_f32_bf16 v224, v211, s100, v224
    ds_write_b128 v140, v[212:215] offset:17408
    v_dot2_f32_bf16 v225, v212, s100, v225
    v_dot2_f32_bf16 v225, v213, s100, v225
    v_dot2_f32_bf16 v225, v214, s100, v225
    v_dot2_f32_bf16 v225, v215, s100, v225
    ds_write_b128 v140, v[216:219] offset:18432
    v_dot2_f32_bf16 v226, v216, s100, v226
    v_dot2_f32_bf16 v226, v217, s100, v226
    v_dot2_f32_bf16 v226, v218, s100, v226
    v_dot2_f32_bf16 v226, v219, s100, v226
    ds_write_b128 v140, v[220:223] offset:19456
    v_dot2_f32_bf16 v227, v220, s100, v227
    v_dot2_f32_bf16 v227, v221, s100, v227
    v_dot2_f32_bf16 v227, v222, s100, v227
    v_dot2_f32_bf16 v227, v223, s100, v227
    s_waitcnt lgkmcnt(4)
    ds_write_b128 v141, v[232:235] offset:16384
    v_dot2_f32_bf16 v228, v232, s100, v228
    v_dot2_f32_bf16 v228, v233, s100, v228
    v_dot2_f32_bf16 v228, v234, s100, v228
    v_dot2_f32_bf16 v228, v235, s100, v228
    ds_write_b128 v141, v[236:239] offset:17408
    v_dot2_f32_bf16 v229, v236, s100, v229
    v_dot2_f32_bf16 v229, v237, s100, v229
    v_dot2_f32_bf16 v229, v238, s100, v229
    v_dot2_f32_bf16 v229, v239, s100, v229
    ds_write_b128 v141, v[240:243] offset:18432
    v_dot2_f32_bf16 v230, v240, s100, v230
    v_dot2_f32_bf16 v230, v241, s100, v230
    v_dot2_f32_bf16 v230, v242, s100, v230
    v_dot2_f32_bf16 v230, v243, s100, v230
    ds_write_b128 v141, v[244:247] offset:19456
    v_dot2_f32_bf16 v231, v244, s100, v231
    v_dot2_f32_bf16 v231, v245, s100, v231
    v_dot2_f32_bf16 v231, v246, s100, v231
    v_dot2_f32_bf16 v231, v247, s100, v231
    s_cmp_lg_u32 s76, 1
    s_cbranch_scc1 L_nopoll_29
    v_cmp_eq_u32 vcc, 0, v73
    s_cbranch_vccnz L_fs_30
L_fb_31:
    s_add_u32 s80, s88, 8704
    v_add_u32 v72, s80, v4
    s_mov_b32 exec_lo, 0
    v_mov_b32 v72, s23
    s_mov_b32 exec_lo, -1
    s_mov_b32 s87, 0
    buffer_load_dword v16, v72, s[64:67], 0 offen offset:0 sc1
    s_waitcnt vmcnt(0)
    v_cmp_eq_u32 vcc, 0, v16
    s_cbranch_vccnz L_fs_32
L_fb_33:
L_nopoll_29:
    s_barrier
    s_mov_b32 m0, s24
    s_nop 0
    buffer_load_dwordx4 v204, s[64:67], s20 offen sc1 lds
    buffer_load_dwordx4 v205, s[64:67], s20 offen offset:1024 sc1 lds
    v_lshlrev_b32 v58, 1, v5
    buffer_load_dwordx2 v[18:19], v58, s[64:67], s17 offen offset:0 sc1
    buffer_load_dwordx2 v[56:57], v58, s[64:67], s17 offen offset:256 sc1
    s_add_u32 m0, s84, 2048
    s_add_u32 s89, s85, 57344
    s_add_u32 s86, s85, 84992
    buffer_load_dwordx4 v7, s[48:51], s89 offen lds
    buffer_load_dwordx4 v6, s[48:51], s86 offen offset:1024 lds
    s_add_u32 m0, s84, 65536
    s_add_u32 s89, s85, 0
    s_add_u32 s86, s85, 27648
    buffer_load_dwordx4 v7, s[52:55], s89 offen lds
    buffer_load_dwordx4 v6, s[52:55], s86 offen offset:1024 lds
    s_add_u32 m0, s84, 67584
    s_add_u32 s89, s85, 57344
    s_add_u32 s86, s85, 84992
    buffer_load_dwordx4 v7, s[52:55], s89 offen lds
    buffer_load_dwordx4 v6, s[52:55], s86 offen offset:1024 lds
    s_mov_b32 s100, 0x3f803f80
    s_waitcnt vmcnt(16)
    ds_read_b64_tr_b16 v[208:209], v132 offset:32768
    ds_read_b64_tr_b16 v[210:211], v132 offset:33280
    ds_read_b64_tr_b16 v[212:213], v133 offset:32768
    ds_read_b64_tr_b16 v[214:215], v133 offset:33280
    ds_read_b64_tr_b16 v[216:217], v134 offset:32768
    ds_read_b64_tr_b16 v[218:219], v134 offset:33280
    ds_read_b64_tr_b16 v[220:221], v135 offset:32768
    ds_read_b64_tr_b16 v[222:223], v135 offset:33280
    s_waitcnt lgkmcnt(0)
    ds_write_b128 v140, v[208:211] offset:32768
    v_dot2_f32_bf16 v224, v208, s100, v224
    v_dot2_f32_bf16 v224, v209, s100, v224
    v_dot2_f32_bf16 v224, v210, s100, v224
    v_dot2_f32_bf16 v224, v211, s100, v224
    ds_write_b128 v140, v[212:215] offset:33792
    v_dot2_f32_bf16 v225, v212, s100, v225
    v_dot2_f32_bf16 v225, v213, s100, v225
    v_dot2_f32_bf16 v225, v214, s100, v225
    v_dot2_f32_bf16 v225, v215, s100, v225
    ds_write_b128 v140, v[216:219] offset:34816
    v_dot2_f32_bf16 v226, v216, s100, v226
    v_dot2_f32_bf16 v226, v217, s100, v226
    v_dot2_f32_bf16 v226, v218, s100, v226
    v_dot2_f32_bf16 v226, v219, s100, v226
    ds_write_b128 v140, v[220:223] offset:35840
    v_dot2_f32_bf16 v227, v220, s100, v227
    v_dot2_f32_bf16 v227, v221, s100, v227
    v_dot2_f32_bf16 v227, v222, s100, v227
    v_dot2_f32_bf16 v227, v223, s100, v227
    s_waitcnt vmcnt(6)
    s_barrier
    ds_read_b64_tr_b16 v[48:49], v206 offset:0
    ds_read_b64_tr_b16 v[50:51], v206 offset:512
    ds_read_b64_tr_b16 v[52:53], v207 offset:0
    ds_read_b64_tr_b16 v[54:55], v207 offset:512
    v_mul_f32 v18, 0x3b000000, v18
    v_mul_f32 v56, 0x3b000000, v56
    v_mul_f32 v19, 0x3b000000, v19
    v_mul_f32 v57, 0x3b000000, v57
    v_fma_f32 v19, -v18, v18, v19
    v_fma_f32 v57, -v56, v56, v57
    v_max_f32 v19, 0, v19
    v_max_f32 v57, 0, v57
    v_add_f32 v19, 0x3727c5ac, v19
    v_add_f32 v57, 0x3727c5ac, v57
    v_rsq_f32 v19, v19
    v_rsq_f32 v57, v57
    v_mul_f32 v18, v18, v19
    v_mul_f32 v56, v56, v57
    s_waitcnt lgkmcnt(0)
    s_barrier
    v_lshlrev_b32 v152, 16, v48
    v_lshlrev_b32 v176, 16, v52
    v_and_b32 v153, 0xffff0000, v48
    v_and_b32 v177, 0xffff0000, v52
    v_lshlrev_b32 v154, 16, v49
    v_lshlrev_b32 v178, 16, v53
    v_and_b32 v155, 0xffff0000, v49
    v_and_b32 v179, 0xffff0000, v53
    v_lshlrev_b32 v156, 16, v50
    v_lshlrev_b32 v180, 16, v54
    v_and_b32 v157, 0xffff0000, v50
    v_and_b32 v181, 0xffff0000, v54
    v_lshlrev_b32 v158, 16, v51
    v_lshlrev_b32 v182, 16, v55
    v_and_b32 v159, 0xffff0000, v51
    v_and_b32 v183, 0xffff0000, v55
    v_pk_fma_f32 v[160:161], v[144:145], v[18:19], v[18:19] op_sel:[0,1,0] op_sel_hi:[1,1,0] neg_lo:[0,0,1] neg_hi:[0,0,1]
    v_pk_fma_f32 v[184:185], v[168:169], v[56:57], v[56:57] op_sel:[0,1,0] op_sel_hi:[1,1,0] neg_lo:[0,0,1] neg_hi:[0,0,1]
    v_pk_fma_f32 v[162:163], v[146:147], v[18:19], v[18:19] op_sel:[0,1,0] op_sel_hi:[1,1,0] neg_lo:[0,0,1] neg_hi:[0,0,1]
    v_pk_fma_f32 v[186:187], v[170:171], v[56:57], v[56:57] op_sel:[0,1,0] op_sel_hi:[1,1,0] neg_lo:[0,0,1] neg_hi:[0,0,1]
    v_pk_fma_f32 v[144:145], v[160:161], v[152:153], v[144:145]
    v_pk_fma_f32 v[168:169], v[184:185], v[176:177], v[168:169]
    v_pk_fma_f32 v[146:147], v[162:163], v[154:155], v[146:147]
    v_pk_fma_f32 v[170:171], v[186:187], v[178:179], v[170:171]
    v_pk_fma_f32 v[160:161], v[148:149], v[18:19], v[18:19] op_sel:[0,1,0] op_sel_hi:[1,1,0] neg_lo:[0,0,1] neg_hi:[0,0,1]
    v_pk_fma_f32 v[184:185], v[172:173], v[56:57], v[56:57] op_sel:[0,1,0] op_sel_hi:[1,1,0] neg_lo:[0,0,1] neg_hi:[0,0,1]
    v_pk_fma_f32 v[162:163], v[150:151], v[18:19], v[18:19] op_sel:[0,1,0] op_sel_hi:[1,1,0] neg_lo:[0,0,1] neg_hi:[0,0,1]
    v_pk_fma_f32 v[186:187], v[174:175], v[56:57], v[56:57] op_sel:[0,1,0] op_sel_hi:[1,1,0] neg_lo:[0,0,1] neg_hi:[0,0,1]
    v_pk_fma_f32 v[148:149], v[160:161], v[156:157], v[148:149]
    v_pk_fma_f32 v[172:173], v[184:185], v[180:181], v[172:173]
    v_pk_fma_f32 v[150:151], v[162:163], v[158:159], v[150:151]
    v_pk_fma_f32 v[174:175], v[186:187], v[182:183], v[174:175]
    v_cvt_pk_bf16_f32 v40, v144, v145
    v_cvt_pk_bf16_f32 v44, v168, v169
    v_cvt_pk_bf16_f32 v41, v146, v147
    v_cvt_pk_bf16_f32 v45, v170, v171
    v_cvt_pk_bf16_f32 v42, v148, v149
    v_cvt_pk_bf16_f32 v46, v172, v173
    v_cvt_pk_bf16_f32 v43, v150, v151
    v_cvt_pk_bf16_f32 v47, v174, v175
    s_add_u32 s80, s4, 0x0
    buffer_store_dwordx4 v[40:43], v12, s[64:67], s80 offen sc1
    s_add_u32 s81, s4, 0x8000
    buffer_store_dwordx4 v[44:47], v12, s[64:67], s81 offen sc1
    s_mov_b32 s100, 0x3f803f80
    s_mov_b32 s100, 0x3f803f80
    v_dot2_f32_bf16 v18, v40, s100, 0
    v_dot2_f32_bf16 v56, v44, s100, 0
    v_dot2_f32_bf16 v19, v40, v40, 0
    v_dot2_f32_bf16 v57, v44, v44, 0
    v_dot2_f32_bf16 v18, v41, s100, v18
    v_dot2_f32_bf16 v56, v45, s100, v56
    v_dot2_f32_bf16 v19, v41, v41, v19
    v_dot2_f32_bf16 v57, v45, v45, v57
    v_dot2_f32_bf16 v18, v42, s100, v18
    v_dot2_f32_bf16 v56, v46, s100, v56
    v_dot2_f32_bf16 v19, v42, v42, v19
    v_dot2_f32_bf16 v57, v46, v46, v57
    v_dot2_f32_bf16 v18, v43, s100, v18
    v_dot2_f32_bf16 v56, v47, s100, v56
    v_dot2_f32_bf16 v19, v43, v43, v19
    v_dot2_f32_bf16 v57, v47, v47, v57
    s_nop 2
    s_nop 2
    v_permlane32_swap_b32 v18, v19
    v_permlane32_swap_b32 v56, v57
    v_add_f32 v18, v18, v19
    v_add_f32 v56, v56, v57
    v_mov_b32 v160, v18
    v_mov_b32 v184, v56
    s_nop 0
    v_permlane16_swap_b32 v18, v160
    v_permlane16_swap_b32 v56, v184
    v_add_f32 v18, v18, v160
    v_add_f32 v56, v56, v184
    s_nop 0
    v_add_f32_dpp v18, v18, v18 row_ror:8 row_mask:0xf bank_mask:0xf
    v_add_f32_dpp v56, v56, v56 row_ror:8 row_mask:0xf bank_mask:0xf
    v_mov_b32 v19, v18
    v_mov_b32 v57, v56
    s_nop 0
    v_permlane32_swap_b32 v18, v19
    v_permlane32_swap_b32 v56, v57
    s_add_u32 s80, s5, 0x0
    s_mov_b64 exec, 0xff
    s_cmp_eq_u32 s16, 0
    s_cbranch_scc1 L_ps_34
    buffer_store_dwordx2 v[18:19], v17, s[64:67], s80 offen
L_pb_35:
    s_mov_b64 exec, -1
    s_add_u32 s81, s5, 0x800
    s_mov_b64 exec, 0xff
    s_cmp_eq_u32 s16, 0
    s_cbranch_scc1 L_ps_36
    buffer_store_dwordx2 v[56:57], v17, s[64:67], s81 offen
L_pb_37:
    s_mov_b64 exec, -1
    s_lshl_b32 s14, s68, 1
    s_add_u32 s14, s14, s3
    buffer_load_dwordx4 a[0:3], v2, s[64:67], s14 offen offset:0 sc1
    buffer_load_dwordx4 a[4:7], v2, s[64:67], s14 offen offset:1024 sc1
    buffer_load_dwordx4 a[8:11], v2, s[64:67], s14 offen offset:2048 sc1
    buffer_load_dwordx4 a[12:15], v2, s[64:67], s14 offen offset:3072 sc1
    s_add_u32 s14, s14, 4096
    buffer_load_dwordx4 a[16:19], v2, s[64:67], s14 offen offset:0 sc1
    buffer_load_dwordx4 a[20:23], v2, s[64:67], s14 offen offset:1024 sc1
    buffer_load_dwordx4 a[24:27], v2, s[64:67], s14 offen offset:2048 sc1
    buffer_load_dwordx4 a[28:31], v2, s[64:67], s14 offen offset:3072 sc1
    s_mov_b32 s100, 0x3f803f80
    ds_read_b64_tr_b16 v[232:233], v136 offset:32768
    ds_read_b64_tr_b16 v[234:235], v136 offset:33280
    ds_read_b64_tr_b16 v[236:237], v137 offset:32768
    ds_read_b64_tr_b16 v[238:239], v137 offset:33280
    ds_read_b64_tr_b16 v[240:241], v138 offset:32768
    ds_read_b64_tr_b16 v[242:243], v138 offset:33280
    ds_read_b64_tr_b16 v[244:245], v139 offset:32768
    ds_read_b64_tr_b16 v[246:247], v139 offset:33280
    s_waitcnt lgkmcnt(0)
    s_waitcnt vmcnt(16)
    ds_read_b64_tr_b16 v[208:209], v132 offset:49152
    ds_read_b64_tr_b16 v[210:211], v132 offset:49664
    ds_read_b64_tr_b16 v[212:213], v133 offset:49152
    ds_read_b64_tr_b16 v[214:215], v133 offset:49664
    ds_read_b64_tr_b16 v[216:217], v134 offset:49152
    ds_read_b64_tr_b16 v[218:219], v134 offset:49664
    ds_read_b64_tr_b16 v[220:221], v135 offset:49152
    ds_read_b64_tr_b16 v[222:223], v135 offset:49664
    ds_write_b128 v141, v[232:235] offset:32768
    v_dot2_f32_bf16 v228, v232, s100, v228
    v_dot2_f32_bf16 v228, v233, s100, v228
    v_dot2_f32_bf16 v228, v234, s100, v228
    v_dot2_f32_bf16 v228, v235, s100, v228
    ds_write_b128 v141, v[236:239] offset:33792
    v_dot2_f32_bf16 v229, v236, s100, v229
    v_dot2_f32_bf16 v229, v237, s100, v229
    v_dot2_f32_bf16 v229, v238, s100, v229
    v_dot2_f32_bf16 v229, v239, s100, v229
    ds_write_b128 v141, v[240:243] offset:34816
    v_dot2_f32_bf16 v230, v240, s100, v230
    v_dot2_f32_bf16 v230, v241, s100, v230
    v_dot2_f32_bf16 v230, v242, s100, v230
    v_dot2_f32_bf16 v230, v243, s100, v230
    ds_write_b128 v141, v[244:247] offset:35840
    v_dot2_f32_bf16 v231, v244, s100, v231
    v_dot2_f32_bf16 v231, v245, s100, v231
    v_dot2_f32_bf16 v231, v246, s100, v231
    v_dot2_f32_bf16 v231, v247, s100, v231
    s_waitcnt lgkmcnt(4)
    ds_write_b128 v140, v[208:211] offset:49152
    v_dot2_f32_bf16 v224, v208, s100, v224
    v_dot2_f32_bf16 v224, v209, s100, v224
    v_dot2_f32_bf16 v224, v210, s100, v224
    v_dot2_f32_bf16 v224, v211, s100, v224
    ds_write_b128 v140, v[212:215] offset:50176
    v_dot2_f32_bf16 v225, v212, s100, v225
    v_dot2_f32_bf16 v225, v213, s100, v225
    v_dot2_f32_bf16 v225, v214, s100, v225
    v_dot2_f32_bf16 v225, v215, s100, v225
    ds_write_b128 v140, v[216:219] offset:51200
    v_dot2_f32_bf16 v226, v216, s100, v226
    v_dot2_f32_bf16 v226, v217, s100, v226
    v_dot2_f32_bf16 v226, v218, s100, v226
    v_dot2_f32_bf16 v226, v219, s100, v226
    ds_write_b128 v140, v[220:223] offset:52224
    v_dot2_f32_bf16 v227, v220, s100, v227
    v_dot2_f32_bf16 v227, v221, s100, v227
    v_dot2_f32_bf16 v227, v222, s100, v227
    v_dot2_f32_bf16 v227, v223, s100, v227
    s_waitcnt vmcnt(10)
    s_cmp_eq_u32 s16, 0
    s_cbranch_scc1 L_ps_38
    buffer_store_dword v23, off, s[64:67], s12 offset:0
    buffer_store_dword v23, off, s[64:67], s12 offset:256
L_pb_39:
    s_lshl_b32 s14, s69, 1
    s_add_u32 s14, s14, s3
    buffer_load_dwordx4 a[32:35], v2, s[64:67], s14 offen offset:0 sc1
    buffer_load_dwordx4 a[36:39], v2, s[64:67], s14 offen offset:1024 sc1
    buffer_load_dwordx4 a[40:43], v2, s[64:67], s14 offen offset:2048 sc1
    buffer_load_dwordx4 a[44:47], v2, s[64:67], s14 offen offset:3072 sc1
    v_lshrrev_b32 v72, 5, v1
    v_lshl_add_u32 v72, v72, 8, v4
    s_mov_b32 s100, 0x3f803f80
    ds_read_b64_tr_b16 v[232:233], v136 offset:49152
    ds_read_b64_tr_b16 v[234:235], v136 offset:49664
    ds_read_b64_tr_b16 v[236:237], v137 offset:49152
    ds_read_b64_tr_b16 v[238:239], v137 offset:49664
    ds_read_b64_tr_b16 v[240:241], v138 offset:49152
    ds_read_b64_tr_b16 v[242:243], v138 offset:49664
    ds_read_b64_tr_b16 v[244:245], v139 offset:49152
    ds_read_b64_tr_b16 v[246:247], v139 offset:49664
    s_waitcnt lgkmcnt(0)
    ds_write_b128 v141, v[232:235] offset:49152
    v_dot2_f32_bf16 v228, v232, s100, v228
    v_dot2_f32_bf16 v228, v233, s100, v228
    v_dot2_f32_bf16 v228, v234, s100, v228
    v_dot2_f32_bf16 v228, v235, s100, v228
    ds_write_b128 v141, v[236:239] offset:50176
    v_dot2_f32_bf16 v229, v236, s100, v229
    v_dot2_f32_bf16 v229, v237, s100, v229
    v_dot2_f32_bf16 v229, v238, s100, v229
    v_dot2_f32_bf16 v229, v239, s100, v229
    ds_write_b128 v141, v[240:243] offset:51200
    v_dot2_f32_bf16 v230, v240, s100, v230
    v_dot2_f32_bf16 v230, v241, s100, v230
    v_dot2_f32_bf16 v230, v242, s100, v230
    v_dot2_f32_bf16 v230, v243, s100, v230
    ds_write_b128 v141, v[244:247] offset:52224
    v_dot2_f32_bf16 v231, v244, s100, v231
    v_dot2_f32_bf16 v231, v245, s100, v231
    v_dot2_f32_bf16 v231, v246, s100, v231
    v_dot2_f32_bf16 v231, v247, s100, v231
    v_permlane32_swap_b32 v224, v226
    v_permlane32_swap_b32 v225, v227
    v_permlane32_swap_b32 v228, v230
    v_permlane32_swap_b32 v229, v231
    v_add_f32 v224, v224, v226
    v_add_f32 v225, v225, v227
    v_add_f32 v228, v228, v230
    v_add_f32 v229, v229, v231
    v_add_u32 v57, 131072, v17
    v_add_u32 v56, s47, v17
    v_permlane16_swap_b32 v224, v225
    v_permlane16_swap_b32 v228, v229
    v_add_f32 v60, v224, v225
    v_add_f32 v61, v228, v229
    ds_write_b64 v56, v[60:61]
    v_mov_b32 v30, 0
    v_mov_b32 v31, 0
    v_mov_b32 v34, 0
    v_mov_b32 v35, 0
    s_waitcnt lgkmcnt(0)
    s_barrier
    ds_read_b64 v[208:209], v57 offset:0
    ds_read_b64 v[210:211], v57 offset:8192
    ds_read_b64 v[212:213], v57 offset:16384
    ds_read_b64 v[214:215], v57 offset:24576
    s_waitcnt lgkmcnt(0)
    s_barrier
    buffer_load_dword v16, v72, s[64:67], s13 offen offset:0 sc1
    s_waitcnt vmcnt(0)
    v_cmp_eq_u32 vcc, 0, v16
    s_cbranch_vccnz L_fs_40
L_fb_41:
    s_add_u32 s80, s8, 0x0
    v_add_u32 v78, s80, v0
    buffer_load_dwordx4 v[80:83], v78, s[64:67], s32 offen offset:0 sc1
    buffer_load_dwordx4 v[84:87], v78, s[64:67], s32 offen offset:256 sc1
    buffer_load_dwordx4 v[88:91], v78, s[64:67], s32 offen offset:2048 sc1
    buffer_load_dwordx4 v[92:95], v78, s[64:67], s32 offen offset:2304 sc1
    buffer_load_dwordx4 v[96:99], v78, s[64:67], s33 offen offset:0 sc1
    buffer_load_dwordx4 v[100:103], v78, s[64:67], s33 offen offset:256 sc1
    buffer_load_dwordx4 v[104:107], v78, s[64:67], s33 offen offset:2048 sc1
    buffer_load_dwordx4 v[108:111], v78, s[64:67], s33 offen offset:2304 sc1
    buffer_load_dwordx4 v[112:115], v78, s[64:67], s34 offen offset:0 sc1
    buffer_load_dwordx4 v[116:119], v78, s[64:67], s34 offen offset:256 sc1
    v_pk_add_f32 v[208:209], v[208:209], v[210:211]
    v_pk_add_f32 v[212:213], v[212:213], v[214:215]
    v_pk_add_f32 v[208:209], v[208:209], v[212:213] neg_lo:[1,1] neg_hi:[1,1]
    v_cvt_pk_bf16_f32 v28, v208, v208
    v_cvt_pk_bf16_f32 v32, v209, v209
    v_and_b32 v212, 0xffff0000, v28
    v_sub_f32 v208, v208, v212
    v_cvt_pk_bf16_f32 v29, v208, 0
    v_and_b32 v213, 0xffff0000, v32
    v_sub_f32 v209, v209, v213
    v_cvt_pk_bf16_f32 v33, v209, 0
    s_add_u32 s14, s14, 4096
    buffer_load_dwordx4 a[48:51], v2, s[64:67], s14 offen offset:0 sc1
    buffer_load_dwordx4 a[52:55], v2, s[64:67], s14 offen offset:1024 sc1
    buffer_load_dwordx4 a[56:59], v2, s[64:67], s14 offen offset:2048 sc1
    buffer_load_dwordx4 a[60:63], v2, s[64:67], s14 offen offset:3072 sc1
    s_cmp_eq_u32 s77, 1
    s_cbranch_scc0 L_even
    s_branch L_odd
L_even:
    ds_read_b128 a[224:227], v2 offset:0
    ds_read_b128 a[228:231], v3 offset:0
    ds_read_b128 a[232:235], v2 offset:1024
    ds_read_b128 a[236:239], v3 offset:1024
    ds_read_b128 a[240:243], v2 offset:2048
    ds_read_b128 a[244:247], v3 offset:2048
    ds_read_b128 a[248:251], v2 offset:3072
    ds_read_b128 a[252:255], v3 offset:3072
    s_waitcnt vmcnt(13) lgkmcnt(4)
    v_mfma_f32_16x16x32_bf16 v[144:147], a[224:227], v[80:83], 0
    buffer_load_dwordx4 v[120:123], v78, s[64:67], s34 offen offset:2048 sc1
    v_mfma_f32_16x16x32_bf16 v[148:151], a[228:231], v[80:83], 0
    s_waitcnt vmcnt(13)
    v_mfma_f32_16x16x32_bf16 v[152:155], a[224:227], v[84:87], 0
    v_mfma_f32_16x16x32_bf16 v[156:159], a[228:231], v[84:87], 0
    v_mfma_f32_16x16x32_bf16 v[160:163], a[232:235], v[80:83], 0
    buffer_load_dwordx4 v[124:127], v78, s[64:67], s34 offen offset:2304 sc1
    v_mfma_f32_16x16x32_bf16 v[164:167], a[236:239], v[80:83], 0
    v_mfma_f32_16x16x32_bf16 v[168:171], a[232:235], v[84:87], 0
    ds_read_b128 a[224:227], v2 offset:4096
    ds_read_b128 a[228:231], v3 offset:4096
    v_mfma_f32_16x16x32_bf16 v[172:175], a[236:239], v[84:87], 0
    s_waitcnt lgkmcnt(2)
    v_mfma_f32_16x16x32_bf16 v[176:179], a[240:243], v[80:83], 0
    buffer_load_dwordx4 v[128:131], v78, s[64:67], s35 offen offset:0 sc1
    v_mfma_f32_16x16x32_bf16 v[180:183], a[244:247], v[80:83], 0
    v_mfma_f32_16x16x32_bf16 v[184:187], a[240:243], v[84:87], 0
    ds_read_b128 a[232:235], v2 offset:5120
    ds_read_b128 a[236:239], v3 offset:5120
    v_mfma_f32_16x16x32_bf16 v[188:191], a[244:247], v[84:87], 0
    v_mfma_f32_16x16x32_bf16 v[192:195], a[248:251], v[80:83], 0
    buffer_load_dwordx4 v[132:135], v78, s[64:67], s35 offen offset:256 sc1
    v_mfma_f32_16x16x32_bf16 v[196:199], a[252:255], v[80:83], 0
    v_mfma_f32_16x16x32_bf16 v[200:203], a[248:251], v[84:87], 0
    ds_read_b128 a[240:243], v2 offset:6144
    ds_read_b128 a[244:247], v3 offset:6144
    v_mfma_f32_16x16x32_bf16 v[204:207], a[252:255], v[84:87], 0
    s_waitcnt vmcnt(14) lgkmcnt(2)
    v_mfma_f32_16x16x32_bf16 v[144:147], a[224:227], v[88:91], v[144:147]
    buffer_load_dwordx4 v[136:139], v78, s[64:67], s35 offen offset:2048 sc1
    v_mfma_f32_16x16x32_bf16 v[148:151], a[228:231], v[88:91], v[148:151]
    s_add_u32 s80, s8, 0x8000
    v_add_u32 v79, s80, v0
    v_mfma_f32_16x16x32_bf16 v[152:155], a[224:227], v[92:95], v[152:155]
    ds_read_b128 a[248:251], v2 offset:7168
    ds_read_b128 a[252:255], v3 offset:7168
    v_mfma_f32_16x16x32_bf16 v[156:159], a[228:231], v[92:95], v[156:159]
    v_mfma_f32_16x16x32_bf16 v[160:163], a[232:235], v[88:91], v[160:163]
    buffer_load_dwordx4 v[140:143], v78, s[64:67], s35 offen offset:2304 sc1
    v_mfma_f32_16x16x32_bf16 v[164:167], a[236:239], v[88:91], v[164:167]
    v_mfma_f32_16x16x32_bf16 v[168:171], a[232:235], v[92:95], v[168:171]
    ds_read_b128 a[224:227], v2 offset:8192
    ds_read_b128 a[228:231], v3 offset:8192
    v_mfma_f32_16x16x32_bf16 v[172:175], a[236:239], v[92:95], v[172:175]
    s_add_u32 s46, s9, 0x0
    buffer_load_dwordx2 v[64:65], v22, s[64:67], s46 offen offset:0 sc1
    s_waitcnt lgkmcnt(2)
    v_mfma_f32_16x16x32_bf16 v[176:179], a[240:243], v[88:91], v[176:179]
    buffer_load_dwordx4 v[80:83], v78, s[64:67], s36 offen offset:0 sc1
    v_mfma_f32_16x16x32_bf16 v[180:183], a[244:247], v[88:91], v[180:183]
    buffer_load_dwordx2 v[66:67], v22, s[64:67], s46 offen offset:256 sc1
    v_mfma_f32_16x16x32_bf16 v[184:187], a[240:243], v[92:95], v[184:187]
    ds_read_b128 a[232:235], v2 offset:9216
    ds_read_b128 a[236:239], v3 offset:9216
    v_mfma_f32_16x16x32_bf16 v[188:191], a[244:247], v[92:95], v[188:191]
    buffer_load_dwordx2 v[68:69], v22, s[64:67], s46 offen offset:128 sc1
    v_mfma_f32_16x16x32_bf16 v[192:195], a[248:251], v[88:91], v[192:195]
    buffer_load_dwordx4 v[84:87], v78, s[64:67], s36 offen offset:256 sc1
    v_mfma_f32_16x16x32_bf16 v[196:199], a[252:255], v[88:91], v[196:199]
    v_mfma_f32_16x16x32_bf16 v[200:203], a[248:251], v[92:95], v[200:203]
    ds_read_b128 a[240:243], v2 offset:10240
    ds_read_b128 a[244:247], v3 offset:10240
    v_mfma_f32_16x16x32_bf16 v[204:207], a[252:255], v[92:95], v[204:207]
    buffer_load_dwordx2 v[70:71], v22, s[64:67], s46 offen offset:384 sc1
    s_waitcnt vmcnt(20) lgkmcnt(2)
    v_mfma_f32_16x16x32_bf16 v[144:147], a[224:227], v[96:99], v[144:147]
    buffer_load_dwordx4 v[88:91], v78, s[64:67], s36 offen offset:2048 sc1
    v_mfma_f32_16x16x32_bf16 v[148:151], a[228:231], v[96:99], v[148:151]
    v_mfma_f32_16x16x32_bf16 v[152:155], a[224:227], v[100:103], v[152:155]
    ds_read_b128 a[248:251], v2 offset:11264
    ds_read_b128 a[252:255], v3 offset:11264
    v_mfma_f32_16x16x32_bf16 v[156:159], a[228:231], v[100:103], v[156:159]
    v_mfma_f32_16x16x32_bf16 v[160:163], a[232:235], v[96:99], v[160:163]
    buffer_load_dwordx4 v[92:95], v78, s[64:67], s36 offen offset:2304 sc1
    v_mfma_f32_16x16x32_bf16 v[164:167], a[236:239], v[96:99], v[164:167]
    v_mfma_f32_16x16x32_bf16 v[168:171], a[232:235], v[100:103], v[168:171]
    ds_read_b128 a[224:227], v2 offset:12288
    ds_read_b128 a[228:231], v3 offset:12288
    v_mfma_f32_16x16x32_bf16 v[172:175], a[236:239], v[100:103], v[172:175]
    s_waitcnt lgkmcnt(2)
    v_mfma_f32_16x16x32_bf16 v[176:179], a[240:243], v[96:99], v[176:179]
    v_mfma_f32_16x16x32_bf16 v[180:183], a[244:247], v[96:99], v[180:183]
    v_mfma_f32_16x16x32_bf16 v[184:187], a[240:243], v[100:103], v[184:187]
    ds_read_b128 a[232:235], v2 offset:13312
    ds_read_b128 a[236:239], v3 offset:13312
    v_mfma_f32_16x16x32_bf16 v[188:191], a[244:247], v[100:103], v[188:191]
    v_mfma_f32_16x16x32_bf16 v[192:195], a[248:251], v[96:99], v[192:195]
    v_mfma_f32_16x16x32_bf16 v[196:199], a[252:255], v[96:99], v[196:199]
    v_mfma_f32_16x16x32_bf16 v[200:203], a[248:251], v[100:103], v[200:203]
    ds_read_b128 a[240:243], v2 offset:14336
    ds_read_b128 a[244:247], v3 offset:14336
    v_mfma_f32_16x16x32_bf16 v[204:207], a[252:255], v[100:103], v[204:207]
    s_waitcnt vmcnt(20) lgkmcnt(2)
    v_mfma_f32_16x16x32_bf16 v[144:147], a[224:227], v[104:107], v[144:147]
    s_lshl_b32 s14, s70, 1
    s_add_u32 s14, s14, s3
    buffer_load_dwordx4 a[64:67], v2, s[64:67], s14 offen offset:0 sc1
    v_mfma_f32_16x16x32_bf16 v[148:151], a[228:231], v[104:107], v[148:151]
    v_mfma_f32_16x16x32_bf16 v[152:155], a[224:227], v[108:111], v[152:155]
    ds_read_b128 a[248:251], v2 offset:15360
    ds_read_b128 a[252:255], v3 offset:15360
    v_mfma_f32_16x16x32_bf16 v[156:159], a[228:231], v[108:111], v[156:159]
    v_mfma_f32_16x16x32_bf16 v[160:163], a[232:235], v[104:107], v[160:163]
    buffer_load_dwordx4 a[68:71], v2, s[64:67], s14 offen offset:1024 sc1
    v_mfma_f32_16x16x32_bf16 v[164:167], a[236:239], v[104:107], v[164:167]
    v_mfma_f32_16x16x32_bf16 v[168:171], a[232:235], v[108:111], v[168:171]
    ds_read_b128 a[224:227], v2 offset:16384
    ds_read_b128 a[228:231], v3 offset:16384
    v_mfma_f32_16x16x32_bf16 v[172:175], a[236:239], v[108:111], v[172:175]
    s_waitcnt lgkmcnt(2)
    v_mfma_f32_16x16x32_bf16 v[176:179], a[240:243], v[104:107], v[176:179]
    buffer_load_dwordx4 a[72:75], v2, s[64:67], s14 offen offset:2048 sc1
    v_mfma_f32_16x16x32_bf16 v[180:183], a[244:247], v[104:107], v[180:183]
    v_mfma_f32_16x16x32_bf16 v[184:187], a[240:243], v[108:111], v[184:187]
    ds_read_b128 a[232:235], v2 offset:17408
    ds_read_b128 a[236:239], v3 offset:17408
    v_mfma_f32_16x16x32_bf16 v[188:191], a[244:247], v[108:111], v[188:191]
    v_mfma_f32_16x16x32_bf16 v[192:195], a[248:251], v[104:107], v[192:195]
    buffer_load_dwordx4 a[76:79], v2, s[64:67], s14 offen offset:3072 sc1
    v_mfma_f32_16x16x32_bf16 v[196:199], a[252:255], v[104:107], v[196:199]
    v_mfma_f32_16x16x32_bf16 v[200:203], a[248:251], v[108:111], v[200:203]
    ds_read_b128 a[240:243], v2 offset:18432
    ds_read_b128 a[244:247], v3 offset:18432
    v_mfma_f32_16x16x32_bf16 v[204:207], a[252:255], v[108:111], v[204:207]
    s_waitcnt vmcnt(22) lgkmcnt(2)
    v_mfma_f32_16x16x32_bf16 v[144:147], a[224:227], v[112:115], v[144:147]
    buffer_load_dwordx4 v[96:99], v78, s[64:67], s37 offen offset:0 sc1
    v_mfma_f32_16x16x32_bf16 v[148:151], a[228:231], v[112:115], v[148:151]
    v_mfma_f32_16x16x32_bf16 v[152:155], a[224:227], v[116:119], v[152:155]
    ds_read_b128 a[248:251], v2 offset:19456
    ds_read_b128 a[252:255], v3 offset:19456
    v_mfma_f32_16x16x32_bf16 v[156:159], a[228:231], v[116:119], v[156:159]
    v_mfma_f32_16x16x32_bf16 v[160:163], a[232:235], v[112:115], v[160:163]
    buffer_load_dwordx4 v[100:103], v78, s[64:67], s37 offen offset:256 sc1
    v_mfma_f32_16x16x32_bf16 v[164:167], a[236:239], v[112:115], v[164:167]
    v_mfma_f32_16x16x32_bf16 v[168:171], a[232:235], v[116:119], v[168:171]
    ds_read_b128 a[224:227], v2 offset:20480
    ds_read_b128 a[228:231], v3 offset:20480
    v_mfma_f32_16x16x32_bf16 v[172:175], a[236:239], v[116:119], v[172:175]
    s_waitcnt lgkmcnt(2)
    v_mfma_f32_16x16x32_bf16 v[176:179], a[240:243], v[112:115], v[176:179]
    buffer_load_dwordx4 v[104:107], v78, s[64:67], s37 offen offset:2048 sc1
    v_mfma_f32_16x16x32_bf16 v[180:183], a[244:247], v[112:115], v[180:183]
    s_waitcnt vmcnt(9)
    v_min3_i32 v72, v65, v67, v69
    v_mfma_f32_16x16x32_bf16 v[184:187], a[240:243], v[116:119], v[184:187]
    ds_read_b128 a[232:235], v2 offset:21504
    ds_read_b128 a[236:239], v3 offset:21504
    v_mfma_f32_16x16x32_bf16 v[188:191], a[244:247], v[116:119], v[188:191]
    v_min_i32 v72, v72, v71
    v_mfma_f32_16x16x32_bf16 v[192:195], a[248:251], v[112:115], v[192:195]
    buffer_load_dwordx4 v[108:111], v78, s[64:67], s37 offen offset:2304 sc1
    v_mfma_f32_16x16x32_bf16 v[196:199], a[252:255], v[112:115], v[196:199]
    v_cmp_gt_i32 vcc, 0, v72
    s_cbranch_vccnz L_ts_42
L_tb_43:
    v_mfma_f32_16x16x32_bf16 v[200:203], a[248:251], v[116:119], v[200:203]
    ds_read_b128 a[240:243], v2 offset:22528
    ds_read_b128 a[244:247], v3 offset:22528
    v_mfma_f32_16x16x32_bf16 v[204:207], a[252:255], v[116:119], v[204:207]
    v_add_f32 v64, v64, v66
    s_waitcnt lgkmcnt(2)
    v_mfma_f32_16x16x32_bf16 v[144:147], a[224:227], v[120:123], v[144:147]
    buffer_load_dwordx4 v[112:115], v78, s[64:67], s38 offen offset:0 sc1
    v_mfma_f32_16x16x32_bf16 v[148:151], a[228:231], v[120:123], v[148:151]
    v_add_f32 v68, v68, v70
    v_add_f32 v65, v65, v67
    v_mfma_f32_16x16x32_bf16 v[152:155], a[224:227], v[124:127], v[152:155]
    ds_read_b128 a[248:251], v2 offset:23552
    ds_read_b128 a[252:255], v3 offset:23552
    v_mfma_f32_16x16x32_bf16 v[156:159], a[228:231], v[124:127], v[156:159]
    v_add_f32 v69, v69, v71
    v_permlane32_swap_b32 v64, v68
    v_mfma_f32_16x16x32_bf16 v[160:163], a[232:235], v[120:123], v[160:163]
    buffer_load_dwordx4 v[116:119], v78, s[64:67], s38 offen offset:256 sc1
    v_mfma_f32_16x16x32_bf16 v[164:167], a[236:239], v[120:123], v[164:167]
    v_add_f32 v64, v64, v68
    v_permlane32_swap_b32 v65, v69
    v_mfma_f32_16x16x32_bf16 v[168:171], a[232:235], v[124:127], v[168:171]
    ds_read_b128 a[224:227], v2 offset:24576
    ds_read_b128 a[228:231], v3 offset:24576
    v_mfma_f32_16x16x32_bf16 v[172:175], a[236:239], v[124:127], v[172:175]
    v_add_f32 v65, v65, v69
    s_waitcnt lgkmcnt(2)
    v_mfma_f32_16x16x32_bf16 v[176:179], a[240:243], v[120:123], v[176:179]
    v_permlane16_swap_b32 v64, v65
    v_add_f32 v64, v64, v65
    v_mfma_f32_16x16x32_bf16 v[180:183], a[244:247], v[120:123], v[180:183]
    s_add_u32 s14, s14, 4096
    buffer_load_dwordx4 a[80:83], v2, s[64:67], s14 offen offset:0 sc1
    v_mfma_f32_16x16x32_bf16 v[184:187], a[240:243], v[124:127], v[184:187]
    ds_read_b128 a[232:235], v2 offset:25600
    ds_read_b128 a[236:239], v3 offset:25600
    v_mfma_f32_16x16x32_bf16 v[188:191], a[244:247], v[124:127], v[188:191]
    v_mul_f32 v64, 0x3b000000, v64
    v_mov_b32 v65, v64
    v_mfma_f32_16x16x32_bf16 v[192:195], a[248:251], v[120:123], v[192:195]
    s_nop 0
    v_permlane16_swap_b32 v64, v65
    v_fma_f32 v65, -v64, v64, v65
    v_mfma_f32_16x16x32_bf16 v[196:199], a[252:255], v[120:123], v[196:199]
    buffer_load_dwordx4 a[84:87], v2, s[64:67], s14 offen offset:1024 sc1
    v_mfma_f32_16x16x32_bf16 v[200:203], a[248:251], v[124:127], v[200:203]
    ds_read_b128 a[240:243], v2 offset:26624
    ds_read_b128 a[244:247], v3 offset:26624
    v_mfma_f32_16x16x32_bf16 v[204:207], a[252:255], v[124:127], v[204:207]
    v_cvt_pk_bf16_f32 v37, v64, 0
    s_waitcnt lgkmcnt(2)
    v_mfma_f32_16x16x32_bf16 v[144:147], a[224:227], v[128:131], v[144:147]
    v_max_f32 v65, 0, v65
    v_lshlrev_b32 v67, 16, v37
    v_mfma_f32_16x16x32_bf16 v[148:151], a[228:231], v[128:131], v[148:151]
    buffer_load_dwordx4 a[88:91], v2, s[64:67], s14 offen offset:2048 sc1
    v_mfma_f32_16x16x32_bf16 v[152:155], a[224:227], v[132:135], v[152:155]
    ds_read_b128 a[248:251], v2 offset:27648
    ds_read_b128 a[252:255], v3 offset:27648
    v_mfma_f32_16x16x32_bf16 v[156:159], a[228:231], v[132:135], v[156:159]
    v_add_f32 v19, 0x3727c5ac, v65
    v_sub_f32 v67, v64, v67
    v_mfma_f32_16x16x32_bf16 v[160:163], a[232:235], v[128:131], v[160:163]
    v_rsq_f32 v18, v19
    v_mfma_f32_16x16x32_bf16 v[164:167], a[236:239], v[128:131], v[164:167]
    buffer_load_dwordx4 a[92:95], v2, s[64:67], s14 offen offset:3072 sc1
    v_mfma_f32_16x16x32_bf16 v[168:171], a[232:235], v[132:135], v[168:171]
    ds_read_b128 a[224:227], v2 offset:28672
    ds_read_b128 a[228:231], v3 offset:28672
    v_mfma_f32_16x16x32_bf16 v[172:175], a[236:239], v[132:135], v[172:175]
    v_cvt_pk_bf16_f32 v36, v64, v67
    s_waitcnt lgkmcnt(2)
    v_mfma_f32_16x16x32_bf16 v[176:179], a[240:243], v[128:131], v[176:179]
    v_mul_f32 v18, 0xbfb8aa3b, v18
    v_mov_b32 v21, v19
    v_mfma_f32_16x16x32_bf16 v[180:183], a[244:247], v[128:131], v[180:183]
    buffer_load_dwordx4 v[120:123], v78, s[64:67], s38 offen offset:2048 sc1
    v_mfma_f32_16x16x32_bf16 v[184:187], a[240:243], v[132:135], v[184:187]
    ds_read_b128 a[232:235], v2 offset:29696
    ds_read_b128 a[236:239], v3 offset:29696
    v_mfma_f32_16x16x32_bf16 v[188:191], a[244:247], v[132:135], v[188:191]
    v_mov_b32 v39, v37
    v_mov_b32 v38, v36
    v_mfma_f32_16x16x32_bf16 v[192:195], a[248:251], v[128:131], v[192:195]
    v_mov_b32 v20, v18
    v_permlane32_swap_b32 v19, v21
    v_mfma_f32_16x16x32_bf16 v[196:199], a[252:255], v[128:131], v[196:199]
    buffer_load_dwordx4 v[124:127], v78, s[64:67], s38 offen offset:2304 sc1
    v_mfma_f32_16x16x32_bf16 v[200:203], a[248:251], v[132:135], v[200:203]
    ds_read_b128 a[240:243], v2 offset:30720
    ds_read_b128 a[244:247], v3 offset:30720
    v_mfma_f32_16x16x32_bf16 v[204:207], a[252:255], v[132:135], v[204:207]
    v_permlane32_swap_b32 v37, v39
    s_waitcnt lgkmcnt(2)
    v_mfma_f32_16x16x32_bf16 v[144:147], a[224:227], v[136:139], v[144:147]
    v_permlane32_swap_b32 v36, v38
    v_permlane32_swap_b32 v18, v20
    v_mfma_f32_16x16x32_bf16 v[148:151], a[228:231], v[136:139], v[148:151]
    buffer_load_dwordx4 v[128:131], v78, s[64:67], s39 offen offset:0 sc1
    v_mfma_f32_16x16x32_bf16 v[152:155], a[224:227], v[140:143], v[152:155]
    ds_read_b128 a[248:251], v2 offset:31744
    ds_read_b128 a[252:255], v3 offset:31744
    v_mfma_f32_16x16x32_bf16 v[156:159], a[228:231], v[140:143], v[156:159]
    s_lshl_b64 s[40:41], s[44:45], 0
    v_cndmask_b32 v24, 0, v36, s[40:41]
    v_mfma_f32_16x16x32_bf16 v[160:163], a[232:235], v[136:139], v[160:163]
    v_cndmask_b32 v25, 0, v37, s[40:41]
    v_cndmask_b32 v26, 0, v38, s[40:41]
    v_mfma_f32_16x16x32_bf16 v[164:167], a[236:239], v[136:139], v[164:167]
    buffer_load_dwordx4 v[132:135], v78, s[64:67], s39 offen offset:256 sc1
    v_mfma_f32_16x16x32_bf16 v[168:171], a[232:235], v[140:143], v[168:171]
    ds_read_b128 a[224:227], v2 offset:32768
    ds_read_b128 a[228:231], v3 offset:32768
    v_mfma_f32_16x16x32_bf16 v[172:175], a[236:239], v[140:143], v[172:175]
    v_cndmask_b32 v27, 0, v39, s[40:41]
    s_waitcnt lgkmcnt(2)
    v_mfma_f32_16x16x32_bf16 v[176:179], a[240:243], v[136:139], v[176:179]
    v_mfma_f32_16x16x32_bf16 v[180:183], a[244:247], v[136:139], v[180:183]
    v_mfma_f32_16x16x32_bf16 v[184:187], a[240:243], v[140:143], v[184:187]
    ds_read_b128 a[232:235], v2 offset:33792
    ds_read_b128 a[236:239], v3 offset:33792
    v_mfma_f32_16x16x32_bf16 v[188:191], a[244:247], v[140:143], v[188:191]
    v_mfma_f32_16x16x32_bf16 v[192:195], a[248:251], v[136:139], v[192:195]
    v_mfma_f32_16x16x32_bf16 v[196:199], a[252:255], v[136:139], v[196:199]
    v_mfma_f32_16x16x32_bf16 v[200:203], a[248:251], v[140:143], v[200:203]
    ds_read_b128 a[240:243], v2 offset:34816
    ds_read_b128 a[244:247], v3 offset:34816
    v_mfma_f32_16x16x32_bf16 v[204:207], a[252:255], v[140:143], v[204:207]
    s_waitcnt lgkmcnt(2)
    v_mfma_f32_16x16x32_bf16 v[144:147], a[224:227], v[80:83], v[144:147]
    buffer_load_dwordx4 v[136:139], v78, s[64:67], s39 offen offset:2048 sc1
    v_mfma_f32_16x16x32_bf16 v[148:151], a[228:231], v[80:83], v[148:151]
    v_mfma_f32_16x16x32_bf16 v[152:155], a[224:227], v[84:87], v[152:155]
    ds_read_b128 a[248:251], v2 offset:35840
    ds_read_b128 a[252:255], v3 offset:35840
    v_mfma_f32_16x16x32_bf16 v[156:159], a[228:231], v[84:87], v[156:159]
    v_mfma_f32_16x16x32_bf16 v[160:163], a[232:235], v[80:83], v[160:163]
    s_lshl_b32 s14, s71, 1
    s_add_u32 s14, s14, s3
    buffer_load_dwordx4 a[96:99], v2, s[64:67], s14 offen offset:0 sc1
    v_mfma_f32_16x16x32_bf16 v[164:167], a[236:239], v[80:83], v[164:167]
    v_mfma_f32_16x16x32_bf16 v[168:171], a[232:235], v[84:87], v[168:171]
    ds_read_b128 a[224:227], v2 offset:36864
    ds_read_b128 a[228:231], v3 offset:36864
    v_mfma_f32_16x16x32_bf16 v[172:175], a[236:239], v[84:87], v[172:175]
    s_waitcnt lgkmcnt(2)
    v_mfma_f32_16x16x32_bf16 v[176:179], a[240:243], v[80:83], v[176:179]
    buffer_load_dwordx4 a[100:103], v2, s[64:67], s14 offen offset:1024 sc1
    v_mfma_f32_16x16x32_bf16 v[180:183], a[244:247], v[80:83], v[180:183]
    v_mfma_f32_16x16x32_bf16 v[184:187], a[240:243], v[84:87], v[184:187]
    ds_read_b128 a[232:235], v2 offset:37888
    ds_read_b128 a[236:239], v3 offset:37888
    v_mfma_f32_16x16x32_bf16 v[188:191], a[244:247], v[84:87], v[188:191]
    v_mfma_f32_16x16x32_bf16 v[192:195], a[248:251], v[80:83], v[192:195]
    buffer_load_dwordx4 a[104:107], v2, s[64:67], s14 offen offset:2048 sc1
    v_mfma_f32_16x16x32_bf16 v[196:199], a[252:255], v[80:83], v[196:199]
    v_mfma_f32_16x16x32_bf16 v[200:203], a[248:251], v[84:87], v[200:203]
    ds_read_b128 a[240:243], v2 offset:38912
    ds_read_b128 a[244:247], v3 offset:38912
    v_mfma_f32_16x16x32_bf16 v[204:207], a[252:255], v[84:87], v[204:207]
    s_waitcnt vmcnt(22) lgkmcnt(2)
    v_mfma_f32_16x16x32_bf16 v[144:147], a[224:227], v[88:91], v[144:147]
    buffer_load_dwordx4 a[108:111], v2, s[64:67], s14 offen offset:3072 sc1
    v_mfma_f32_16x16x32_bf16 v[148:151], a[228:231], v[88:91], v[148:151]
    v_mfma_f32_16x16x32_bf16 v[152:155], a[224:227], v[92:95], v[152:155]
    ds_read_b128 a[248:251], v2 offset:39936
    ds_read_b128 a[252:255], v3 offset:39936
    v_mfma_f32_16x16x32_bf16 v[156:159], a[228:231], v[92:95], v[156:159]
    v_mfma_f32_16x16x32_bf16 v[160:163], a[232:235], v[88:91], v[160:163]
    buffer_load_dwordx4 v[140:143], v78, s[64:67], s39 offen offset:2304 sc1
    v_mfma_f32_16x16x32_bf16 v[164:167], a[236:239], v[88:91], v[164:167]
    v_mfma_f32_16x16x32_bf16 v[168:171], a[232:235], v[92:95], v[168:171]
    ds_read_b128 a[224:227], v2 offset:40960
    ds_read_b128 a[228:231], v3 offset:40960
    v_mfma_f32_16x16x32_bf16 v[172:175], a[236:239], v[92:95], v[172:175]
    s_waitcnt lgkmcnt(2)
    v_mfma_f32_16x16x32_bf16 v[176:179], a[240:243], v[88:91], v[176:179]
    buffer_load_dwordx4 v[80:83], v79, s[64:67], s32 offen offset:0 sc1
    v_mfma_f32_16x16x32_bf16 v[180:183], a[244:247], v[88:91], v[180:183]
    v_mfma_f32_16x16x32_bf16 v[184:187], a[240:243], v[92:95], v[184:187]
    ds_read_b128 a[232:235], v2 offset:41984
    ds_read_b128 a[236:239], v3 offset:41984
    v_mfma_f32_16x16x32_bf16 v[188:191], a[244:247], v[92:95], v[188:191]
    v_mfma_f32_16x16x32_bf16 v[192:195], a[248:251], v[88:91], v[192:195]
    buffer_load_dwordx4 v[84:87], v79, s[64:67], s32 offen offset:256 sc1
    v_mfma_f32_16x16x32_bf16 v[196:199], a[252:255], v[88:91], v[196:199]
    v_mfma_f32_16x16x32_bf16 v[200:203], a[248:251], v[92:95], v[200:203]
    ds_read_b128 a[240:243], v2 offset:43008
    ds_read_b128 a[244:247], v3 offset:43008
    v_mfma_f32_16x16x32_bf16 v[204:207], a[252:255], v[92:95], v[204:207]
    s_waitcnt vmcnt(20) lgkmcnt(2)
    v_mfma_f32_16x16x32_bf16 v[144:147], a[224:227], v[96:99], v[144:147]
    buffer_load_dwordx4 v[88:91], v79, s[64:67], s32 offen offset:2048 sc1
    v_mfma_f32_16x16x32_bf16 v[148:151], a[228:231], v[96:99], v[148:151]
    v_mfma_f32_16x16x32_bf16 v[152:155], a[224:227], v[100:103], v[152:155]
    ds_read_b128 a[248:251], v2 offset:44032
    ds_read_b128 a[252:255], v3 offset:44032
    v_mfma_f32_16x16x32_bf16 v[156:159], a[228:231], v[100:103], v[156:159]
    v_mfma_f32_16x16x32_bf16 v[160:163], a[232:235], v[96:99], v[160:163]
    buffer_load_dwordx4 v[92:95], v79, s[64:67], s32 offen offset:2304 sc1
    v_mfma_f32_16x16x32_bf16 v[164:167], a[236:239], v[96:99], v[164:167]
    v_mfma_f32_16x16x32_bf16 v[168:171], a[232:235], v[100:103], v[168:171]
    ds_read_b128 a[224:227], v2 offset:45056
    ds_read_b128 a[228:231], v3 offset:45056
    v_mfma_f32_16x16x32_bf16 v[172:175], a[236:239], v[100:103], v[172:175]
    s_waitcnt lgkmcnt(2)
    v_mfma_f32_16x16x32_bf16 v[176:179], a[240:243], v[96:99], v[176:179]
    v_mfma_f32_16x16x32_bf16 v[180:183], a[244:247], v[96:99], v[180:183]
    v_mfma_f32_16x16x32_bf16 v[184:187], a[240:243], v[100:103], v[184:187]
    ds_read_b128 a[232:235], v2 offset:49152
    ds_read_b128 a[236:239], v3 offset:49152
    v_mfma_f32_16x16x32_bf16 v[188:191], a[244:247], v[100:103], v[188:191]
    v_mfma_f32_16x16x32_bf16 v[192:195], a[248:251], v[96:99], v[192:195]
    v_mfma_f32_16x16x32_bf16 v[196:199], a[252:255], v[96:99], v[196:199]
    s_add_u32 s14, s14, 4096
    buffer_load_dwordx4 a[112:115], v2, s[64:67], s14 offen offset:0 sc1
    v_mfma_f32_16x16x32_bf16 v[200:203], a[248:251], v[100:103], v[200:203]
    ds_read_b128 a[240:243], v2 offset:53248
    ds_read_b128 a[244:247], v3 offset:53248
    v_mfma_f32_16x16x32_bf16 v[204:207], a[252:255], v[100:103], v[204:207]
    s_waitcnt vmcnt(21) lgkmcnt(2)
    v_mfma_f32_16x16x32_bf16 v[144:147], a[224:227], v[104:107], v[144:147]
    v_mfma_f32_16x16x32_bf16 v[148:151], a[228:231], v[104:107], v[148:151]
    buffer_load_dwordx4 a[116:119], v2, s[64:67], s14 offen offset:1024 sc1
    v_mfma_f32_16x16x32_bf16 v[152:155], a[224:227], v[108:111], v[152:155]
    ds_read_b128 a[248:251], v2 offset:57344
    ds_read_b128 a[252:255], v3 offset:57344
    v_mfma_f32_16x16x32_bf16 v[156:159], a[228:231], v[108:111], v[156:159]
    s_waitcnt vmcnt(20)
    v_mfma_f32_16x16x32_bf16 v[144:147], a[232:235], v[112:115], v[144:147]
    v_mfma_f32_16x16x32_bf16 v[148:151], a[236:239], v[112:115], v[148:151]
    buffer_load_dwordx4 a[120:123], v2, s[64:67], s14 offen offset:2048 sc1
    v_mfma_f32_16x16x32_bf16 v[152:155], a[232:235], v[116:119], v[152:155]
    ds_read_b128 a[224:227], v2 offset:61440
    ds_read_b128 a[228:231], v3 offset:61440
    v_mfma_f32_16x16x32_bf16 v[156:159], a[236:239], v[116:119], v[156:159]
    s_waitcnt vmcnt(15) lgkmcnt(2)
    v_mfma_f32_16x16x32_bf16 v[144:147], a[240:243], v[120:123], v[144:147]
    v_mfma_f32_16x16x32_bf16 v[148:151], a[244:247], v[120:123], v[148:151]
    buffer_load_dwordx4 a[124:127], v2, s[64:67], s14 offen offset:3072 sc1
    v_mfma_f32_16x16x32_bf16 v[152:155], a[240:243], v[124:127], v[152:155]
    ds_read_b128 a[232:235], v2 offset:46080
    ds_read_b128 a[236:239], v3 offset:46080
    v_mfma_f32_16x16x32_bf16 v[156:159], a[244:247], v[124:127], v[156:159]
    s_waitcnt vmcnt(14)
    v_mfma_f32_16x16x32_bf16 v[144:147], a[248:251], v[128:131], v[144:147]
    v_mfma_f32_16x16x32_bf16 v[148:151], a[252:255], v[128:131], v[148:151]
    buffer_load_dwordx4 v[96:99], v79, s[64:67], s33 offen offset:0 sc1
    v_mfma_f32_16x16x32_bf16 v[152:155], a[248:251], v[132:135], v[152:155]
    ds_read_b128 a[240:243], v2 offset:50176
    ds_read_b128 a[244:247], v3 offset:50176
    v_mfma_f32_16x16x32_bf16 v[156:159], a[252:255], v[132:135], v[156:159]
    s_waitcnt vmcnt(9) lgkmcnt(2)
    v_mfma_f32_16x16x32_bf16 v[144:147], a[224:227], v[136:139], v[144:147]
    v_mfma_f32_16x16x32_bf16 v[148:151], a[228:231], v[136:139], v[148:151]
    buffer_load_dwordx4 v[100:103], v79, s[64:67], s33 offen offset:256 sc1
    v_mfma_f32_16x16x32_bf16 v[152:155], a[224:227], v[140:143], v[152:155]
    ds_read_b128 a[248:251], v2 offset:54272
    ds_read_b128 a[252:255], v3 offset:54272
    v_mfma_f32_16x16x32_bf16 v[156:159], a[228:231], v[140:143], v[156:159]
    v_mfma_f32_16x16x32_bf16 v[144:147], v[28:31], v[24:27], v[144:147]
    v_mfma_f32_16x16x32_bf16 v[148:151], v[32:35], v[24:27], v[148:151]
    v_mfma_f32_16x16x32_bf16 v[152:155], v[28:31], v[26:29], v[152:155]
    v_mfma_f32_16x16x32_bf16 v[156:159], v[32:35], v[26:29], v[156:159]
    v_mfma_f32_16x16x32_bf16 v[160:163], a[232:235], v[104:107], v[160:163]
    v_mfma_f32_16x16x32_bf16 v[164:167], a[236:239], v[104:107], v[164:167]
    s_lshl_b64 s[40:41], s[44:45], 16
    v_cndmask_b32 v24, 0, v36, s[40:41]
    v_cndmask_b32 v25, 0, v37, s[40:41]
    v_cndmask_b32 v26, 0, v38, s[40:41]
    v_mfma_f32_16x16x32_bf16 v[168:171], a[232:235], v[108:111], v[168:171]
    ds_read_b128 a[224:227], v2 offset:58368
    ds_read_b128 a[228:231], v3 offset:58368
    v_cndmask_b32 v27, 0, v39, s[40:41]
    v_mfma_f32_16x16x32_bf16 v[172:175], a[236:239], v[108:111], v[172:175]
    s_waitcnt lgkmcnt(2)
    v_mfma_f32_16x16x32_bf16 v[160:163], a[240:243], v[112:115], v[160:163]
    v_mfma_f32_16x16x32_bf16 v[164:167], a[244:247], v[112:115], v[164:167]
    v_mfma_f32_16x16x32_bf16 v[168:171], a[240:243], v[116:119], v[168:171]
    ds_read_b128 a[232:235], v2 offset:62464
    ds_read_b128 a[236:239], v3 offset:62464
    s_add_u32 s96, s10, 0x0
    v_mul_f32 v148, v144, v148
    v_mfma_f32_16x16x32_bf16 v[172:175], a[244:247], v[116:119], v[172:175]
    v_mul_f32 v144, v18, v144
    v_mul_f32 v149, v145, v149
    v_mul_f32 v145, v18, v145
    v_mul_f32 v150, v146, v150
    v_mfma_f32_16x16x32_bf16 v[160:163], a[248:251], v[120:123], v[160:163]
    v_exp_f32 v144, v144
    v_mul_f32 v146, v18, v146
    v_fma_f32 v144, v144, v19, v19
    v_mfma_f32_16x16x32_bf16 v[164:167], a[252:255], v[120:123], v[164:167]
    v_exp_f32 v145, v145
    v_mul_f32 v151, v147, v151
    v_mul_f32 v147, v18, v147
    v_mfma_f32_16x16x32_bf16 v[168:171], a[248:251], v[124:127], v[168:171]
    ds_read_b128 a[240:243], v2 offset:47104
    ds_read_b128 a[244:247], v3 offset:47104
    v_exp_f32 v146, v146
    v_mfma_f32_16x16x32_bf16 v[172:175], a[252:255], v[124:127], v[172:175]
    v_fma_f32 v145, v145, v19, v19
    v_rcp_f32 v144, v144
    s_waitcnt lgkmcnt(2)
    v_mfma_f32_16x16x32_bf16 v[160:163], a[224:227], v[128:131], v[160:163]
    v_mul_f32 v156, v152, v156
    v_mul_f32 v152, v20, v152
    v_exp_f32 v147, v147
    v_mfma_f32_16x16x32_bf16 v[164:167], a[228:231], v[128:131], v[164:167]
    v_fma_f32 v146, v146, v19, v19
    v_rcp_f32 v145, v145
    v_mul_f32 v148, v148, v144
    v_mfma_f32_16x16x32_bf16 v[168:171], a[224:227], v[132:135], v[168:171]
    ds_read_b128 a[248:251], v2 offset:51200
    ds_read_b128 a[252:255], v3 offset:51200
    v_mul_f32 v157, v153, v157
    v_mul_f32 v153, v20, v153
    v_mfma_f32_16x16x32_bf16 v[172:175], a[228:231], v[132:135], v[172:175]
    s_lshl_b32 s14, s72, 1
    s_add_u32 s14, s14, s3
    buffer_load_dwordx4 a[128:131], v2, s[64:67], s14 offen offset:0 sc1
    v_exp_f32 v152, v152
    v_mfma_f32_16x16x32_bf16 v[160:163], a[232:235], v[136:139], v[160:163]
    v_fma_f32 v147, v147, v19, v19
    v_rcp_f32 v146, v146
    v_mul_f32 v149, v149, v145
    v_mfma_f32_16x16x32_bf16 v[164:167], a[236:239], v[136:139], v[164:167]
    v_mul_f32 v158, v154, v158
    v_mul_f32 v154, v20, v154
    v_exp_f32 v153, v153
    v_mfma_f32_16x16x32_bf16 v[168:171], a[232:235], v[140:143], v[168:171]
    ds_read_b128 a[224:227], v2 offset:55296
    ds_read_b128 a[228:231], v3 offset:55296
    v_fma_f32 v152, v152, v21, v21
    v_mul_f32 v150, v150, v146
    v_mfma_f32_16x16x32_bf16 v[172:175], a[236:239], v[140:143], v[172:175]
    v_rcp_f32 v147, v147
    v_cvt_pk_bf16_f32 v144, v148, v149
    v_mfma_f32_16x16x32_bf16 v[160:163], v[28:31], v[24:27], v[160:163]
    buffer_load_dwordx4 a[132:135], v2, s[64:67], s14 offen offset:1024 sc1
    v_mul_f32 v159, v155, v159
    v_mul_f32 v155, v20, v155
    v_mfma_f32_16x16x32_bf16 v[164:167], v[32:35], v[24:27], v[164:167]
    v_exp_f32 v154, v154
    v_fma_f32 v153, v153, v21, v21
    v_mul_f32 v151, v151, v147
    v_mfma_f32_16x16x32_bf16 v[168:171], v[28:31], v[26:29], v[168:171]
    v_rcp_f32 v152, v152
    v_exp_f32 v155, v155
    v_mfma_f32_16x16x32_bf16 v[172:175], v[32:35], v[26:29], v[172:175]
    v_fma_f32 v154, v154, v21, v21
    v_rcp_f32 v153, v153
    v_mul_f32 v156, v156, v152
    s_waitcnt lgkmcnt(2)
    v_mfma_f32_16x16x32_bf16 v[176:179], a[240:243], v[104:107], v[176:179]
    buffer_load_dwordx4 a[136:139], v2, s[64:67], s14 offen offset:2048 sc1
    v_cvt_pk_bf16_f32 v145, v150, v151
    v_fma_f32 v155, v155, v21, v21
    v_mfma_f32_16x16x32_bf16 v[180:183], a[244:247], v[104:107], v[180:183]
    s_lshl_b64 s[40:41], s[44:45], 32
    v_cndmask_b32 v24, 0, v36, s[40:41]
    v_cndmask_b32 v25, 0, v37, s[40:41]
    v_cndmask_b32 v26, 0, v38, s[40:41]
    v_mfma_f32_16x16x32_bf16 v[184:187], a[240:243], v[108:111], v[184:187]
    ds_read_b128 a[232:235], v2 offset:59392
    ds_read_b128 a[236:239], v3 offset:59392
    v_cndmask_b32 v27, 0, v39, s[40:41]
    v_mul_f32 v157, v157, v153
    v_mfma_f32_16x16x32_bf16 v[188:191], a[244:247], v[108:111], v[188:191]
    v_rcp_f32 v154, v154
    v_rcp_f32 v155, v155
    v_mfma_f32_16x16x32_bf16 v[176:179], a[248:251], v[112:115], v[176:179]
    buffer_load_dwordx4 a[140:143], v2, s[64:67], s14 offen offset:3072 sc1
    v_mul_f32 v158, v158, v154
    v_cvt_pk_bf16_f32 v146, v156, v157
    v_mfma_f32_16x16x32_bf16 v[180:183], a[252:255], v[112:115], v[180:183]
    v_mul_f32 v159, v159, v155
    v_cvt_pk_bf16_f32 v147, v158, v159
    v_permlane16_swap_b32 v144, v146
    s_nop 0
    v_permlane16_swap_b32 v145, v147
    v_mfma_f32_16x16x32_bf16 v[184:187], a[248:251], v[116:119], v[184:187]
    ds_read_b128 a[240:243], v2 offset:63488
    ds_read_b128 a[244:247], v3 offset:63488
    v_mfma_f32_16x16x32_bf16 v[188:191], a[252:255], v[116:119], v[188:191]
    buffer_store_dwordx4 v[144:147], v2, s[64:67], s96 offen sc1
    s_waitcnt lgkmcnt(2)
    v_mfma_f32_16x16x32_bf16 v[176:179], a[224:227], v[120:123], v[176:179]
    s_add_u32 s97, s10, 0x400
    v_mul_f32 v164, v160, v164
    v_mul_f32 v160, v18, v160
    v_mul_f32 v165, v161, v165
    v_mfma_f32_16x16x32_bf16 v[180:183], a[228:231], v[120:123], v[180:183]
    v_mul_f32 v161, v18, v161
    v_exp_f32 v160, v160
    v_mul_f32 v166, v162, v166
    v_mfma_f32_16x16x32_bf16 v[184:187], a[224:227], v[124:127], v[184:187]
    ds_read_b128 a[248:251], v2 offset:48128
    ds_read_b128 a[252:255], v3 offset:48128
    v_mul_f32 v162, v18, v162
    v_fma_f32 v160, v160, v19, v19
    v_mfma_f32_16x16x32_bf16 v[188:191], a[228:231], v[124:127], v[188:191]
    v_exp_f32 v161, v161
    v_mul_f32 v167, v163, v167
    v_mul_f32 v163, v18, v163
    v_mfma_f32_16x16x32_bf16 v[176:179], a[232:235], v[128:131], v[176:179]
    v_exp_f32 v162, v162
    v_fma_f32 v161, v161, v19, v19
    v_mul_f32 v172, v168, v172
    v_mfma_f32_16x16x32_bf16 v[180:183], a[236:239], v[128:131], v[180:183]
    v_rcp_f32 v160, v160
    v_mul_f32 v168, v20, v168
    v_fma_f32 v162, v162, v19, v19
    v_mfma_f32_16x16x32_bf16 v[184:187], a[232:235], v[132:135], v[184:187]
    ds_read_b128 a[224:227], v2 offset:52224
    ds_read_b128 a[228:231], v3 offset:52224
    v_exp_f32 v163, v163
    v_mfma_f32_16x16x32_bf16 v[188:191], a[236:239], v[132:135], v[188:191]
    v_rcp_f32 v161, v161
    v_mul_f32 v164, v164, v160
    s_waitcnt lgkmcnt(2)
    v_mfma_f32_16x16x32_bf16 v[176:179], a[240:243], v[136:139], v[176:179]
    v_mul_f32 v173, v169, v173
    v_mul_f32 v169, v20, v169
    v_exp_f32 v168, v168
    v_mfma_f32_16x16x32_bf16 v[180:183], a[244:247], v[136:139], v[180:183]
    v_fma_f32 v163, v163, v19, v19
    v_rcp_f32 v162, v162
    v_mul_f32 v165, v165, v161
    v_mfma_f32_16x16x32_bf16 v[184:187], a[240:243], v[140:143], v[184:187]
    ds_read_b128 a[232:235], v2 offset:56320
    ds_read_b128 a[236:239], v3 offset:56320
    v_mul_f32 v174, v170, v174
    v_mul_f32 v170, v20, v170
    v_mfma_f32_16x16x32_bf16 v[188:191], a[244:247], v[140:143], v[188:191]
    v_exp_f32 v169, v169
    v_fma_f32 v168, v168, v21, v21
    v_mul_f32 v166, v166, v162
    v_mfma_f32_16x16x32_bf16 v[176:179], v[28:31], v[24:27], v[176:179]
    v_rcp_f32 v163, v163
    v_cvt_pk_bf16_f32 v160, v164, v165
    v_mul_f32 v175, v171, v175
    v_mfma_f32_16x16x32_bf16 v[180:183], v[32:35], v[24:27], v[180:183]
    v_mul_f32 v171, v20, v171
    v_exp_f32 v170, v170
    v_fma_f32 v169, v169, v21, v21
    v_mfma_f32_16x16x32_bf16 v[184:187], v[28:31], v[26:29], v[184:187]
    v_rcp_f32 v168, v168
    v_mul_f32 v167, v167, v163
    v_fma_f32 v170, v170, v21, v21
    v_mfma_f32_16x16x32_bf16 v[188:191], v[32:35], v[26:29], v[188:191]
    v_exp_f32 v171, v171
    v_rcp_f32 v169, v169
    v_mfma_f32_16x16x32_bf16 v[192:195], a[248:251], v[104:107], v[192:195]
    v_mul_f32 v172, v172, v168
    v_cvt_pk_bf16_f32 v161, v166, v167
    v_fma_f32 v171, v171, v21, v21
    v_mul_f32 v173, v173, v169
    v_mfma_f32_16x16x32_bf16 v[196:199], a[252:255], v[104:107], v[196:199]
    s_lshl_b64 s[40:41], s[44:45], 48
    v_cndmask_b32 v24, 0, v36, s[40:41]
    v_cndmask_b32 v25, 0, v37, s[40:41]
    v_cndmask_b32 v26, 0, v38, s[40:41]
    v_mfma_f32_16x16x32_bf16 v[200:203], a[248:251], v[108:111], v[200:203]
    ds_read_b128 a[240:243], v2 offset:60416
    ds_read_b128 a[244:247], v3 offset:60416
    v_cndmask_b32 v27, 0, v39, s[40:41]
    v_mfma_f32_16x16x32_bf16 v[204:207], a[252:255], v[108:111], v[204:207]
    v_rcp_f32 v170, v170
    s_nop 0
    v_mul_f32 v174, v174, v170
    s_waitcnt lgkmcnt(2)
    v_mfma_f32_16x16x32_bf16 v[192:195], a[224:227], v[112:115], v[192:195]
    buffer_load_dwordx4 v[104:107], v79, s[64:67], s33 offen offset:2048 sc1
    v_rcp_f32 v171, v171
    v_mfma_f32_16x16x32_bf16 v[196:199], a[228:231], v[112:115], v[196:199]
    v_cvt_pk_bf16_f32 v162, v172, v173
    v_mul_f32 v175, v175, v171
    v_cvt_pk_bf16_f32 v163, v174, v175
    v_permlane16_swap_b32 v160, v162
    v_mfma_f32_16x16x32_bf16 v[200:203], a[224:227], v[116:119], v[200:203]
    ds_read_b128 a[248:251], v2 offset:64512
    ds_read_b128 a[252:255], v3 offset:64512
    v_permlane16_swap_b32 v161, v163
    v_mfma_f32_16x16x32_bf16 v[204:207], a[228:231], v[116:119], v[204:207]
    buffer_store_dwordx4 v[160:163], v2, s[64:67], s97 offen sc1
    v_mfma_f32_16x16x32_bf16 v[192:195], a[232:235], v[120:123], v[192:195]
    buffer_load_dwordx4 v[108:111], v79, s[64:67], s33 offen offset:2304 sc1
    s_add_u32 s98, s10, 0x800
    v_mul_f32 v180, v176, v180
    v_mfma_f32_16x16x32_bf16 v[196:199], a[236:239], v[120:123], v[196:199]
    v_mul_f32 v176, v18, v176
    v_mul_f32 v181, v177, v181
    v_mul_f32 v177, v18, v177
    v_mul_f32 v182, v178, v182
    v_mfma_f32_16x16x32_bf16 v[200:203], a[232:235], v[124:127], v[200:203]
    ds_read_b128 a[224:227], v2 offset:0
    ds_read_b128 a[228:231], v3 offset:0
    v_exp_f32 v176, v176
    v_mfma_f32_16x16x32_bf16 v[204:207], a[236:239], v[124:127], v[204:207]
    v_mul_f32 v178, v18, v178
    v_exp_f32 v177, v177
    s_waitcnt lgkmcnt(2)
    v_mfma_f32_16x16x32_bf16 v[192:195], a[240:243], v[128:131], v[192:195]
    s_add_u32 s14, s14, 4096
    buffer_load_dwordx4 a[144:147], v2, s[64:67], s14 offen offset:0 sc1
    v_fma_f32 v176, v176, v19, v19
    v_mul_f32 v183, v179, v183
    v_mfma_f32_16x16x32_bf16 v[196:199], a[244:247], v[128:131], v[196:199]
    v_mul_f32 v179, v18, v179
    v_exp_f32 v178, v178
    v_fma_f32 v177, v177, v19, v19
    v_mfma_f32_16x16x32_bf16 v[200:203], a[240:243], v[132:135], v[200:203]
    ds_read_b128 a[232:235], v2 offset:1024
    ds_read_b128 a[236:239], v3 offset:1024
    v_rcp_f32 v176, v176
    v_mfma_f32_16x16x32_bf16 v[204:207], a[244:247], v[132:135], v[204:207]
    v_mul_f32 v188, v184, v188
    v_mul_f32 v184, v20, v184
    v_exp_f32 v179, v179
    v_mfma_f32_16x16x32_bf16 v[192:195], a[248:251], v[136:139], v[192:195]
    buffer_load_dwordx4 a[148:151], v2, s[64:67], s14 offen offset:1024 sc1
    v_fma_f32 v178, v178, v19, v19
    v_mul_f32 v180, v180, v176
    v_mfma_f32_16x16x32_bf16 v[196:199], a[252:255], v[136:139], v[196:199]
    v_rcp_f32 v177, v177
    v_mul_f32 v189, v185, v189
    v_mul_f32 v185, v20, v185
    v_mfma_f32_16x16x32_bf16 v[200:203], a[248:251], v[140:143], v[200:203]
    ds_read_b128 a[240:243], v2 offset:2048
    ds_read_b128 a[244:247], v3 offset:2048
    v_exp_f32 v184, v184
    v_mfma_f32_16x16x32_bf16 v[204:207], a[252:255], v[140:143], v[204:207]
    v_fma_f32 v179, v179, v19, v19
    v_rcp_f32 v178, v178
    v_mfma_f32_16x16x32_bf16 v[192:195], v[28:31], v[24:27], v[192:195]
    buffer_load_dwordx4 a[152:155], v2, s[64:67], s14 offen offset:2048 sc1
    v_mul_f32 v181, v181, v177
    v_mul_f32 v190, v186, v190
    v_mfma_f32_16x16x32_bf16 v[196:199], v[32:35], v[24:27], v[196:199]
    v_mul_f32 v186, v20, v186
    v_exp_f32 v185, v185
    v_fma_f32 v184, v184, v21, v21
    v_mfma_f32_16x16x32_bf16 v[200:203], v[28:31], v[26:29], v[200:203]
    v_rcp_f32 v179, v179
    v_mul_f32 v182, v182, v178
    v_cvt_pk_bf16_f32 v176, v180, v181
    v_mfma_f32_16x16x32_bf16 v[204:207], v[32:35], v[26:29], v[204:207]
    v_mul_f32 v191, v187, v191
    v_mul_f32 v187, v20, v187
    v_exp_f32 v186, v186
    ds_read_b128 a[248:251], v2 offset:4096
    ds_read_b128 a[252:255], v3 offset:4096
    s_waitcnt vmcnt(20) lgkmcnt(4)
    v_mfma_f32_16x16x32_bf16 v[208:211], a[224:227], v[80:83], 0
    buffer_load_dwordx4 a[156:159], v2, s[64:67], s14 offen offset:3072 sc1
    s_add_u32 s46, s9, 0x800
    buffer_load_dwordx2 v[64:65], v22, s[64:67], s46 offen offset:0 sc1
    v_mfma_f32_16x16x32_bf16 v[212:215], a[228:231], v[80:83], 0
    v_fma_f32 v185, v185, v21, v21
    v_rcp_f32 v184, v184
    v_mul_f32 v183, v183, v179
    s_waitcnt vmcnt(21)
    v_mfma_f32_16x16x32_bf16 v[216:219], a[224:227], v[84:87], 0
    buffer_load_dwordx2 v[66:67], v22, s[64:67], s46 offen offset:256 sc1
    v_fma_f32 v186, v186, v21, v21
    v_mfma_f32_16x16x32_bf16 v[220:223], a[228:231], v[84:87], 0
    v_exp_f32 v187, v187
    v_rcp_f32 v185, v185
    v_mfma_f32_16x16x32_bf16 v[224:227], a[232:235], v[80:83], 0
    buffer_load_dwordx4 v[112:115], v79, s[64:67], s34 offen offset:0 sc1
    v_mul_f32 v188, v188, v184
    v_cvt_pk_bf16_f32 v177, v182, v183
    v_mfma_f32_16x16x32_bf16 v[228:231], a[236:239], v[80:83], 0
    buffer_load_dwordx2 v[68:69], v22, s[64:67], s46 offen offset:128 sc1
    v_fma_f32 v187, v187, v21, v21
    v_mfma_f32_16x16x32_bf16 v[232:235], a[232:235], v[84:87], 0
    ds_read_b128 a[224:227], v2 offset:5120
    ds_read_b128 a[228:231], v3 offset:5120
    v_rcp_f32 v186, v186
    v_mfma_f32_16x16x32_bf16 v[236:239], a[236:239], v[84:87], 0
    buffer_load_dwordx2 v[70:71], v22, s[64:67], s46 offen offset:384 sc1
    s_waitcnt lgkmcnt(2)
    v_mfma_f32_16x16x32_bf16 v[240:243], a[240:243], v[80:83], 0
    buffer_load_dwordx4 v[116:119], v79, s[64:67], s34 offen offset:256 sc1
    v_mul_f32 v189, v189, v185
    v_mul_f32 v190, v190, v186
    v_mfma_f32_16x16x32_bf16 v[244:247], a[244:247], v[80:83], 0
    v_rcp_f32 v187, v187
    v_cvt_pk_bf16_f32 v178, v188, v189
    v_mul_f32 v191, v191, v187
    v_mfma_f32_16x16x32_bf16 v[248:251], a[240:243], v[84:87], 0
    ds_read_b128 a[232:235], v2 offset:6144
    ds_read_b128 a[236:239], v3 offset:6144
    v_cvt_pk_bf16_f32 v179, v190, v191
    v_permlane16_swap_b32 v176, v178
    v_mfma_f32_16x16x32_bf16 v[252:255], a[244:247], v[84:87], 0
    v_permlane16_swap_b32 v177, v179
    s_waitcnt vmcnt(24)
    v_mfma_f32_16x16x32_bf16 v[208:211], a[248:251], v[88:91], v[208:211]
    buffer_load_dwordx4 v[120:123], v79, s[64:67], s34 offen offset:2048 sc1
    buffer_store_dwordx4 v[176:179], v2, s[64:67], s98 offen sc1
    v_mfma_f32_16x16x32_bf16 v[212:215], a[252:255], v[88:91], v[212:215]
    s_add_u32 s99, s10, 0xc00
    v_mul_f32 v196, v192, v196
    v_mul_f32 v192, v18, v192
    v_mul_f32 v197, v193, v197
    v_mfma_f32_16x16x32_bf16 v[216:219], a[248:251], v[92:95], v[216:219]
    ds_read_b128 a[240:243], v2 offset:8192
    ds_read_b128 a[244:247], v3 offset:8192
    v_mul_f32 v193, v18, v193
    v_mul_f32 v198, v194, v198
    v_mfma_f32_16x16x32_bf16 v[220:223], a[252:255], v[92:95], v[220:223]
    v_exp_f32 v192, v192
    v_mul_f32 v194, v18, v194
    s_waitcnt lgkmcnt(2)
    v_mfma_f32_16x16x32_bf16 v[224:227], a[224:227], v[88:91], v[224:227]
    buffer_load_dwordx4 v[124:127], v79, s[64:67], s34 offen offset:2304 sc1
    v_exp_f32 v193, v193
    v_mfma_f32_16x16x32_bf16 v[228:231], a[228:231], v[88:91], v[228:231]
    v_fma_f32 v192, v192, v19, v19
    v_mul_f32 v199, v195, v199
    v_mul_f32 v195, v18, v195
    v_fma_f32 v193, v193, v19, v19
    v_mfma_f32_16x16x32_bf16 v[232:235], a[224:227], v[92:95], v[232:235]
    ds_read_b128 a[248:251], v2 offset:9216
    ds_read_b128 a[252:255], v3 offset:9216
    v_exp_f32 v194, v194
    v_mfma_f32_16x16x32_bf16 v[236:239], a[228:231], v[92:95], v[236:239]
    v_rcp_f32 v192, v192
    v_mul_f32 v204, v200, v204
    v_mul_f32 v200, v20, v200
    v_mfma_f32_16x16x32_bf16 v[240:243], a[232:235], v[88:91], v[240:243]
    buffer_load_dwordx4 v[128:131], v79, s[64:67], s35 offen offset:0 sc1
    v_exp_f32 v195, v195
    v_mfma_f32_16x16x32_bf16 v[244:247], a[236:239], v[88:91], v[244:247]
    v_fma_f32 v194, v194, v19, v19
    v_rcp_f32 v193, v193
    v_mul_f32 v196, v196, v192
    v_mfma_f32_16x16x32_bf16 v[248:251], a[232:235], v[92:95], v[248:251]
    ds_read_b128 a[224:227], v2 offset:10240
    ds_read_b128 a[228:231], v3 offset:10240
    v_mul_f32 v205, v201, v205
    v_mul_f32 v201, v20, v201
    v_mfma_f32_16x16x32_bf16 v[252:255], a[236:239], v[92:95], v[252:255]
    v_exp_f32 v200, v200
    v_fma_f32 v195, v195, v19, v19
    s_waitcnt vmcnt(22) lgkmcnt(2)
    v_mfma_f32_16x16x32_bf16 v[208:211], a[240:243], v[96:99], v[208:211]
    buffer_load_dwordx4 v[132:135], v79, s[64:67], s35 offen offset:256 sc1
    v_rcp_f32 v194, v194
    v_mfma_f32_16x16x32_bf16 v[212:215], a[244:247], v[96:99], v[212:215]
    v_mul_f32 v197, v197, v193
    v_mul_f32 v206, v202, v206
    v_mul_f32 v202, v20, v202
    v_fma_f32 v200, v200, v21, v21
    v_mfma_f32_16x16x32_bf16 v[216:219], a[240:243], v[100:103], v[216:219]
    ds_read_b128 a[232:235], v2 offset:12288
    ds_read_b128 a[236:239], v3 offset:12288
    v_exp_f32 v201, v201
    v_mfma_f32_16x16x32_bf16 v[220:223], a[244:247], v[100:103], v[220:223]
    v_rcp_f32 v195, v195
    v_mul_f32 v198, v198, v194
    v_cvt_pk_bf16_f32 v192, v196, v197
    v_mfma_f32_16x16x32_bf16 v[224:227], a[248:251], v[96:99], v[224:227]
    s_lshl_b32 s14, s73, 1
    s_add_u32 s14, s14, s3
    buffer_load_dwordx4 a[160:163], v2, s[64:67], s14 offen offset:0 sc1
    v_mul_f32 v207, v203, v207
    v_mul_f32 v203, v20, v203
    v_mfma_f32_16x16x32_bf16 v[228:231], a[252:255], v[96:99], v[228:231]
    v_exp_f32 v202, v202
    v_fma_f32 v201, v201, v21, v21
    v_mul_f32 v199, v199, v195
    v_mfma_f32_16x16x32_bf16 v[232:235], a[248:251], v[100:103], v[232:235]
    ds_read_b128 a[240:243], v2 offset:13312
    ds_read_b128 a[244:247], v3 offset:13312
    v_rcp_f32 v200, v200
    v_mfma_f32_16x16x32_bf16 v[236:239], a[252:255], v[100:103], v[236:239]
    v_exp_f32 v203, v203
    v_fma_f32 v202, v202, v21, v21
    s_waitcnt lgkmcnt(2)
    v_mfma_f32_16x16x32_bf16 v[240:243], a[224:227], v[96:99], v[240:243]
    buffer_load_dwordx4 a[164:167], v2, s[64:67], s14 offen offset:1024 sc1
    v_rcp_f32 v201, v201
    v_mfma_f32_16x16x32_bf16 v[244:247], a[228:231], v[96:99], v[244:247]
    v_mul_f32 v204, v204, v200
    v_cvt_pk_bf16_f32 v193, v198, v199
    v_fma_f32 v203, v203, v21, v21
    v_mul_f32 v205, v205, v201
    v_mfma_f32_16x16x32_bf16 v[248:251], a[224:227], v[100:103], v[248:251]
    ds_read_b128 a[248:251], v2 offset:14336
    ds_read_b128 a[252:255], v3 offset:14336
    v_rcp_f32 v202, v202
    v_mfma_f32_16x16x32_bf16 v[252:255], a[228:231], v[100:103], v[252:255]
    v_rcp_f32 v203, v203
    v_mul_f32 v206, v206, v202
    v_cvt_pk_bf16_f32 v194, v204, v205
    s_waitcnt vmcnt(17)
    v_mfma_f32_16x16x32_bf16 v[208:211], a[232:235], v[104:107], v[208:211]
    buffer_load_dwordx4 a[168:171], v2, s[64:67], s14 offen offset:2048 sc1
    v_mul_f32 v207, v207, v203
    v_cvt_pk_bf16_f32 v195, v206, v207
    v_mfma_f32_16x16x32_bf16 v[212:215], a[236:239], v[104:107], v[212:215]
    v_permlane16_swap_b32 v192, v194
    v_permlane16_swap_b32 v193, v195
    v_mfma_f32_16x16x32_bf16 v[216:219], a[232:235], v[108:111], v[216:219]
    ds_read_b128 a[224:227], v2 offset:16384
    ds_read_b128 a[228:231], v3 offset:16384
    buffer_store_dwordx4 v[192:195], v2, s[64:67], s99 offen sc1
    v_mfma_f32_16x16x32_bf16 v[220:223], a[236:239], v[108:111], v[220:223]
    s_waitcnt lgkmcnt(2)
    v_mfma_f32_16x16x32_bf16 v[224:227], a[240:243], v[104:107], v[224:227]
    buffer_load_dwordx4 a[172:175], v2, s[64:67], s14 offen offset:3072 sc1
    v_mfma_f32_16x16x32_bf16 v[228:231], a[244:247], v[104:107], v[228:231]
    v_mfma_f32_16x16x32_bf16 v[232:235], a[240:243], v[108:111], v[232:235]
    ds_read_b128 a[232:235], v2 offset:17408
    ds_read_b128 a[236:239], v3 offset:17408
    v_mfma_f32_16x16x32_bf16 v[236:239], a[244:247], v[108:111], v[236:239]
    v_mfma_f32_16x16x32_bf16 v[240:243], a[248:251], v[104:107], v[240:243]
    buffer_load_dwordx4 v[136:139], v79, s[64:67], s35 offen offset:2048 sc1
    v_mfma_f32_16x16x32_bf16 v[244:247], a[252:255], v[104:107], v[244:247]
    v_mfma_f32_16x16x32_bf16 v[248:251], a[248:251], v[108:111], v[248:251]
    ds_read_b128 a[240:243], v2 offset:18432
    ds_read_b128 a[244:247], v3 offset:18432
    v_mfma_f32_16x16x32_bf16 v[252:255], a[252:255], v[108:111], v[252:255]
    s_waitcnt vmcnt(11) lgkmcnt(2)
    v_mfma_f32_16x16x32_bf16 v[208:211], a[224:227], v[112:115], v[208:211]
    buffer_load_dwordx4 v[140:143], v79, s[64:67], s35 offen offset:2304 sc1
    v_mfma_f32_16x16x32_bf16 v[212:215], a[228:231], v[112:115], v[212:215]
    v_min3_i32 v72, v65, v67, v69
    v_mfma_f32_16x16x32_bf16 v[216:219], a[224:227], v[116:119], v[216:219]
    ds_read_b128 a[248:251], v2 offset:20480
    ds_read_b128 a[252:255], v3 offset:20480
    v_min_i32 v72, v72, v71
    v_mfma_f32_16x16x32_bf16 v[220:223], a[228:231], v[116:119], v[220:223]
    v_cmp_gt_i32 vcc, 0, v72
    s_cbranch_vccnz L_ts_44
L_tb_45:
    v_mfma_f32_16x16x32_bf16 v[224:227], a[232:235], v[112:115], v[224:227]
    buffer_load_dwordx4 v[80:83], v79, s[64:67], s36 offen offset:0 sc1
    v_add_f32 v64, v64, v66
    v_mfma_f32_16x16x32_bf16 v[228:231], a[236:239], v[112:115], v[228:231]
    v_add_f32 v68, v68, v70
    v_add_f32 v65, v65, v67
    v_mfma_f32_16x16x32_bf16 v[232:235], a[232:235], v[116:119], v[232:235]
    ds_read_b128 a[224:227], v2 offset:21504
    ds_read_b128 a[228:231], v3 offset:21504
    v_add_f32 v69, v69, v71
    v_mfma_f32_16x16x32_bf16 v[236:239], a[236:239], v[116:119], v[236:239]
    v_permlane32_swap_b32 v64, v68
    s_waitcnt lgkmcnt(2)
    v_mfma_f32_16x16x32_bf16 v[240:243], a[240:243], v[112:115], v[240:243]
    buffer_load_dwordx4 v[84:87], v79, s[64:67], s36 offen offset:256 sc1
    v_add_f32 v64, v64, v68
    v_mfma_f32_16x16x32_bf16 v[244:247], a[244:247], v[112:115], v[244:247]
    v_permlane32_swap_b32 v65, v69
    v_add_f32 v65, v65, v69
    v_mfma_f32_16x16x32_bf16 v[248:251], a[240:243], v[116:119], v[248:251]
    ds_read_b128 a[232:235], v2 offset:22528
    ds_read_b128 a[236:239], v3 offset:22528
    v_permlane16_swap_b32 v64, v65
    v_mfma_f32_16x16x32_bf16 v[252:255], a[244:247], v[116:119], v[252:255]
    v_add_f32 v64, v64, v65
    v_mul_f32 v64, 0x3b000000, v64
    s_waitcnt vmcnt(11)
    v_mfma_f32_16x16x32_bf16 v[208:211], a[248:251], v[120:123], v[208:211]
    buffer_load_dwordx4 v[88:91], v79, s[64:67], s36 offen offset:2048 sc1
    v_mov_b32 v65, v64
    v_mfma_f32_16x16x32_bf16 v[212:215], a[252:255], v[120:123], v[212:215]
    s_nop 0
    v_permlane16_swap_b32 v64, v65
    v_fma_f32 v65, -v64, v64, v65
    v_mfma_f32_16x16x32_bf16 v[216:219], a[248:251], v[124:127], v[216:219]
    ds_read_b128 a[240:243], v2 offset:24576
    ds_read_b128 a[244:247], v3 offset:24576
    v_cvt_pk_bf16_f32 v37, v64, 0
    v_mfma_f32_16x16x32_bf16 v[220:223], a[252:255], v[124:127], v[220:223]
    v_max_f32 v65, 0, v65
    s_waitcnt lgkmcnt(2)
    v_mfma_f32_16x16x32_bf16 v[224:227], a[224:227], v[120:123], v[224:227]
    buffer_load_dwordx4 v[92:95], v79, s[64:67], s36 offen offset:2304 sc1
    v_lshlrev_b32 v67, 16, v37
    v_mfma_f32_16x16x32_bf16 v[228:231], a[228:231], v[120:123], v[228:231]
    v_add_f32 v57, 0x3727c5ac, v65
    v_sub_f32 v67, v64, v67
    v_mfma_f32_16x16x32_bf16 v[232:235], a[224:227], v[124:127], v[232:235]
    ds_read_b128 a[248:251], v2 offset:25600
    ds_read_b128 a[252:255], v3 offset:25600
    v_cvt_pk_bf16_f32 v36, v64, v67
    v_mfma_f32_16x16x32_bf16 v[236:239], a[228:231], v[124:127], v[236:239]
    v_rsq_f32 v56, v57
    v_mfma_f32_16x16x32_bf16 v[240:243], a[232:235], v[120:123], v[240:243]
    buffer_load_dwordx4 v[96:99], v79, s[64:67], s37 offen offset:0 sc1
    v_mul_f32 v56, 0xbfb8aa3b, v56
    v_mfma_f32_16x16x32_bf16 v[244:247], a[236:239], v[120:123], v[244:247]
    v_mov_b32 v59, v57
    v_mov_b32 v39, v37
    v_mfma_f32_16x16x32_bf16 v[248:251], a[232:235], v[124:127], v[248:251]
    ds_read_b128 a[224:227], v2 offset:26624
    ds_read_b128 a[228:231], v3 offset:26624
    v_mov_b32 v38, v36
    v_mfma_f32_16x16x32_bf16 v[252:255], a[236:239], v[124:127], v[252:255]
    v_mov_b32 v58, v56
    s_waitcnt vmcnt(12) lgkmcnt(2)
    v_mfma_f32_16x16x32_bf16 v[208:211], a[240:243], v[128:131], v[208:211]
    s_add_u32 s14, s14, 4096
    buffer_load_dwordx4 a[176:179], v2, s[64:67], s14 offen offset:0 sc1
    v_permlane32_swap_b32 v57, v59
    v_mfma_f32_16x16x32_bf16 v[212:215], a[244:247], v[128:131], v[212:215]
    v_permlane32_swap_b32 v37, v39
    v_permlane32_swap_b32 v36, v38
    v_mfma_f32_16x16x32_bf16 v[216:219], a[240:243], v[132:135], v[216:219]
    ds_read_b128 a[232:235], v2 offset:28672
    ds_read_b128 a[236:239], v3 offset:28672
    v_permlane32_swap_b32 v56, v58
    v_mfma_f32_16x16x32_bf16 v[220:223], a[244:247], v[132:135], v[220:223]
    s_lshl_b64 s[40:41], s[44:45], 0
    v_cndmask_b32 v24, 0, v36, s[40:41]
    s_waitcnt vmcnt(9)
    s_cmp_eq_u32 s16, 0
    s_cbranch_scc1 L_ps_46
    buffer_store_dword v23, off, s[64:67], s26 offset:0
L_pb_47:
    v_mfma_f32_16x16x32_bf16 v[224:227], a[248:251], v[128:131], v[224:227]
    buffer_load_dwordx4 a[180:183], v2, s[64:67], s14 offen offset:1024 sc1
    v_cndmask_b32 v25, 0, v37, s[40:41]
    v_mfma_f32_16x16x32_bf16 v[228:231], a[252:255], v[128:131], v[228:231]
    v_cndmask_b32 v26, 0, v38, s[40:41]
    v_cndmask_b32 v27, 0, v39, s[40:41]
    v_mfma_f32_16x16x32_bf16 v[232:235], a[248:251], v[132:135], v[232:235]
    ds_read_b128 a[240:243], v2 offset:29696
    ds_read_b128 a[244:247], v3 offset:29696
    v_mfma_f32_16x16x32_bf16 v[236:239], a[252:255], v[132:135], v[236:239]
    s_waitcnt lgkmcnt(2)
    v_mfma_f32_16x16x32_bf16 v[240:243], a[224:227], v[128:131], v[240:243]
    buffer_load_dwordx4 a[184:187], v2, s[64:67], s14 offen offset:2048 sc1
    v_mfma_f32_16x16x32_bf16 v[244:247], a[228:231], v[128:131], v[244:247]
    v_mfma_f32_16x16x32_bf16 v[248:251], a[224:227], v[132:135], v[248:251]
    ds_read_b128 a[248:251], v2 offset:30720
    ds_read_b128 a[252:255], v3 offset:30720
    v_mfma_f32_16x16x32_bf16 v[252:255], a[228:231], v[132:135], v[252:255]
    s_waitcnt vmcnt(9)
    v_mfma_f32_16x16x32_bf16 v[208:211], a[232:235], v[136:139], v[208:211]
    buffer_load_dwordx4 a[188:191], v2, s[64:67], s14 offen offset:3072 sc1
    v_mfma_f32_16x16x32_bf16 v[212:215], a[236:239], v[136:139], v[212:215]
    v_mfma_f32_16x16x32_bf16 v[216:219], a[232:235], v[140:143], v[216:219]
    ds_read_b128 a[224:227], v2 offset:32768
    ds_read_b128 a[228:231], v3 offset:32768
    v_mfma_f32_16x16x32_bf16 v[220:223], a[236:239], v[140:143], v[220:223]
    s_waitcnt lgkmcnt(2)
    v_mfma_f32_16x16x32_bf16 v[224:227], a[240:243], v[136:139], v[224:227]
    buffer_load_dwordx4 v[100:103], v79, s[64:67], s37 offen offset:256 sc1
    v_mfma_f32_16x16x32_bf16 v[228:231], a[244:247], v[136:139], v[228:231]
    v_mfma_f32_16x16x32_bf16 v[232:235], a[240:243], v[140:143], v[232:235]
    ds_read_b128 a[232:235], v2 offset:33792
    ds_read_b128 a[236:239], v3 offset:33792
    v_mfma_f32_16x16x32_bf16 v[236:239], a[244:247], v[140:143], v[236:239]
    v_mfma_f32_16x16x32_bf16 v[240:243], a[248:251], v[136:139], v[240:243]
    buffer_load_dwordx4 v[104:107], v79, s[64:67], s37 offen offset:2048 sc1
    v_mfma_f32_16x16x32_bf16 v[244:247], a[252:255], v[136:139], v[244:247]
    v_mfma_f32_16x16x32_bf16 v[248:251], a[248:251], v[140:143], v[248:251]
    ds_read_b128 a[240:243], v2 offset:34816
    ds_read_b128 a[244:247], v3 offset:34816
    v_mfma_f32_16x16x32_bf16 v[252:255], a[252:255], v[140:143], v[252:255]
    s_waitcnt vmcnt(10) lgkmcnt(2)
    v_mfma_f32_16x16x32_bf16 v[208:211], a[224:227], v[80:83], v[208:211]
    buffer_load_dwordx4 v[108:111], v79, s[64:67], s37 offen offset:2304 sc1
    v_mfma_f32_16x16x32_bf16 v[212:215], a[228:231], v[80:83], v[212:215]
    v_mfma_f32_16x16x32_bf16 v[216:219], a[224:227], v[84:87], v[216:219]
    ds_read_b128 a[248:251], v2 offset:36864
    ds_read_b128 a[252:255], v3 offset:36864
    v_mfma_f32_16x16x32_bf16 v[220:223], a[228:231], v[84:87], v[220:223]
    v_mfma_f32_16x16x32_bf16 v[224:227], a[232:235], v[80:83], v[224:227]
    buffer_load_dwordx4 v[112:115], v79, s[64:67], s38 offen offset:0 sc1
    v_mfma_f32_16x16x32_bf16 v[228:231], a[236:239], v[80:83], v[228:231]
    v_mfma_f32_16x16x32_bf16 v[232:235], a[232:235], v[84:87], v[232:235]
    ds_read_b128 a[224:227], v2 offset:37888
    ds_read_b128 a[228:231], v3 offset:37888
    v_mfma_f32_16x16x32_bf16 v[236:239], a[236:239], v[84:87], v[236:239]
    s_waitcnt lgkmcnt(2)
    v_mfma_f32_16x16x32_bf16 v[240:243], a[240:243], v[80:83], v[240:243]
    buffer_load_dwordx4 v[116:119], v79, s[64:67], s38 offen offset:256 sc1
    v_mfma_f32_16x16x32_bf16 v[244:247], a[244:247], v[80:83], v[244:247]
    v_mfma_f32_16x16x32_bf16 v[248:251], a[240:243], v[84:87], v[248:251]
    ds_read_b128 a[232:235], v2 offset:38912
    ds_read_b128 a[236:239], v3 offset:38912
    v_mfma_f32_16x16x32_bf16 v[252:255], a[244:247], v[84:87], v[252:255]
    s_waitcnt vmcnt(11)
    v_mfma_f32_16x16x32_bf16 v[208:211], a[248:251], v[88:91], v[208:211]
    buffer_load_dwordx4 v[120:123], v79, s[64:67], s38 offen offset:2048 sc1
    v_mfma_f32_16x16x32_bf16 v[212:215], a[252:255], v[88:91], v[212:215]
    v_mfma_f32_16x16x32_bf16 v[216:219], a[248:251], v[92:95], v[216:219]
    ds_read_b128 a[240:243], v2 offset:40960
    ds_read_b128 a[244:247], v3 offset:40960
    v_mfma_f32_16x16x32_bf16 v[220:223], a[252:255], v[92:95], v[220:223]
    s_waitcnt lgkmcnt(2)
    v_mfma_f32_16x16x32_bf16 v[224:227], a[224:227], v[88:91], v[224:227]
    s_lshl_b32 s14, s74, 1
    s_add_u32 s14, s14, s3
    buffer_load_dwordx4 a[192:195], v2, s[64:67], s14 offen offset:0 sc1
    v_mfma_f32_16x16x32_bf16 v[228:231], a[228:231], v[88:91], v[228:231]
    v_mfma_f32_16x16x32_bf16 v[232:235], a[224:227], v[92:95], v[232:235]
    ds_read_b128 a[248:251], v2 offset:41984
    ds_read_b128 a[252:255], v3 offset:41984
    v_mfma_f32_16x16x32_bf16 v[236:239], a[228:231], v[92:95], v[236:239]
    v_mfma_f32_16x16x32_bf16 v[240:243], a[232:235], v[88:91], v[240:243]
    buffer_load_dwordx4 a[196:199], v2, s[64:67], s14 offen offset:1024 sc1
    v_mfma_f32_16x16x32_bf16 v[244:247], a[236:239], v[88:91], v[244:247]
    v_mfma_f32_16x16x32_bf16 v[248:251], a[232:235], v[92:95], v[248:251]
    ds_read_b128 a[224:227], v2 offset:43008
    ds_read_b128 a[228:231], v3 offset:43008
    v_mfma_f32_16x16x32_bf16 v[252:255], a[236:239], v[92:95], v[252:255]
    s_waitcnt vmcnt(7) lgkmcnt(2)
    v_mfma_f32_16x16x32_bf16 v[208:211], a[240:243], v[96:99], v[208:211]
    buffer_load_dwordx4 a[200:203], v2, s[64:67], s14 offen offset:2048 sc1
    v_mfma_f32_16x16x32_bf16 v[212:215], a[244:247], v[96:99], v[212:215]
    v_mfma_f32_16x16x32_bf16 v[216:219], a[240:243], v[100:103], v[216:219]
    ds_read_b128 a[232:235], v2 offset:45056
    ds_read_b128 a[236:239], v3 offset:45056
    v_mfma_f32_16x16x32_bf16 v[220:223], a[244:247], v[100:103], v[220:223]
    v_mfma_f32_16x16x32_bf16 v[224:227], a[248:251], v[96:99], v[224:227]
    buffer_load_dwordx4 a[204:207], v2, s[64:67], s14 offen offset:3072 sc1
    v_mfma_f32_16x16x32_bf16 v[228:231], a[252:255], v[96:99], v[228:231]
    v_mfma_f32_16x16x32_bf16 v[232:235], a[248:251], v[100:103], v[232:235]
    ds_read_b128 a[240:243], v2 offset:49152
    ds_read_b128 a[244:247], v3 offset:49152
    v_mfma_f32_16x16x32_bf16 v[236:239], a[252:255], v[100:103], v[236:239]
    s_waitcnt lgkmcnt(2)
    v_mfma_f32_16x16x32_bf16 v[240:243], a[224:227], v[96:99], v[240:243]
    buffer_load_dwordx4 v[124:127], v79, s[64:67], s38 offen offset:2304 sc1
    v_mfma_f32_16x16x32_bf16 v[244:247], a[228:231], v[96:99], v[244:247]
    v_mfma_f32_16x16x32_bf16 v[248:251], a[224:227], v[100:103], v[248:251]
    ds_read_b128 a[248:251], v2 offset:53248
    ds_read_b128 a[252:255], v3 offset:53248
    v_mfma_f32_16x16x32_bf16 v[252:255], a[228:231], v[100:103], v[252:255]
    s_waitcnt vmcnt(8)
    v_mfma_f32_16x16x32_bf16 v[208:211], a[232:235], v[104:107], v[208:211]
    buffer_load_dwordx4 v[128:131], v79, s[64:67], s39 offen offset:0 sc1
    v_mfma_f32_16x16x32_bf16 v[212:215], a[236:239], v[104:107], v[212:215]
    v_mfma_f32_16x16x32_bf16 v[216:219], a[232:235], v[108:111], v[216:219]
    ds_read_b128 a[224:227], v2 offset:57344
    ds_read_b128 a[228:231], v3 offset:57344
    v_mfma_f32_16x16x32_bf16 v[220:223], a[236:239], v[108:111], v[220:223]
    s_waitcnt vmcnt(7) lgkmcnt(2)
    v_mfma_f32_16x16x32_bf16 v[208:211], a[240:243], v[112:115], v[208:211]
    buffer_load_dwordx4 v[132:135], v79, s[64:67], s39 offen offset:256 sc1
    v_mfma_f32_16x16x32_bf16 v[212:215], a[244:247], v[112:115], v[212:215]
    buffer_load_dword v16, v5, s[64:67], s27 offen offset:0 sc1
    v_mfma_f32_16x16x32_bf16 v[216:219], a[240:243], v[116:119], v[216:219]
    ds_read_b128 a[232:235], v2 offset:61440
    ds_read_b128 a[236:239], v3 offset:61440
    v_mfma_f32_16x16x32_bf16 v[220:223], a[244:247], v[116:119], v[220:223]
    s_waitcnt vmcnt(3)
    v_mfma_f32_16x16x32_bf16 v[208:211], a[248:251], v[120:123], v[208:211]
    buffer_load_dwordx4 v[136:139], v79, s[64:67], s39 offen offset:2048 sc1
    v_mfma_f32_16x16x32_bf16 v[212:215], a[252:255], v[120:123], v[212:215]
    v_mfma_f32_16x16x32_bf16 v[216:219], a[248:251], v[124:127], v[216:219]
    ds_read_b128 a[240:243], v2 offset:46080
    ds_read_b128 a[244:247], v3 offset:46080
    v_mfma_f32_16x16x32_bf16 v[220:223], a[252:255], v[124:127], v[220:223]
    s_waitcnt vmcnt(2) lgkmcnt(2)
    v_mfma_f32_16x16x32_bf16 v[208:211], a[224:227], v[128:131], v[208:211]
    buffer_load_dwordx4 v[140:143], v79, s[64:67], s39 offen offset:2304 sc1
    v_mfma_f32_16x16x32_bf16 v[212:215], a[228:231], v[128:131], v[212:215]
    v_mfma_f32_16x16x32_bf16 v[216:219], a[224:227], v[132:135], v[216:219]
    ds_read_b128 a[248:251], v2 offset:50176
    ds_read_b128 a[252:255], v3 offset:50176
    v_mfma_f32_16x16x32_bf16 v[220:223], a[228:231], v[132:135], v[220:223]
    s_waitcnt vmcnt(0)
    v_mfma_f32_16x16x32_bf16 v[208:211], a[232:235], v[136:139], v[208:211]
    v_mfma_f32_16x16x32_bf16 v[212:215], a[236:239], v[136:139], v[212:215]
    v_mfma_f32_16x16x32_bf16 v[216:219], a[232:235], v[140:143], v[216:219]
    ds_read_b128 a[224:227], v2 offset:54272
    ds_read_b128 a[228:231], v3 offset:54272
    v_mfma_f32_16x16x32_bf16 v[220:223], a[236:239], v[140:143], v[220:223]
    v_mfma_f32_16x16x32_bf16 v[208:211], v[28:31], v[24:27], v[208:211]
    v_mfma_f32_16x16x32_bf16 v[212:215], v[32:35], v[24:27], v[212:215]
    s_add_u32 s14, s14, 4096
    buffer_load_dwordx4 a[208:211], v2, s[64:67], s14 offen offset:0 sc1
    v_mfma_f32_16x16x32_bf16 v[216:219], v[28:31], v[26:29], v[216:219]
    v_mfma_f32_16x16x32_bf16 v[220:223], v[32:35], v[26:29], v[220:223]
    s_waitcnt lgkmcnt(2)
    v_mfma_f32_16x16x32_bf16 v[224:227], a[240:243], v[104:107], v[224:227]
    v_mfma_f32_16x16x32_bf16 v[228:231], a[244:247], v[104:107], v[228:231]
    buffer_load_dwordx4 a[212:215], v2, s[64:67], s14 offen offset:1024 sc1
    v_mfma_f32_16x16x32_bf16 v[232:235], a[240:243], v[108:111], v[232:235]
    ds_read_b128 a[232:235], v2 offset:58368
    ds_read_b128 a[236:239], v3 offset:58368
    v_mfma_f32_16x16x32_bf16 v[236:239], a[244:247], v[108:111], v[236:239]
    s_lshl_b64 s[40:41], s[44:45], 16
    v_cndmask_b32 v24, 0, v36, s[40:41]
    v_mfma_f32_16x16x32_bf16 v[224:227], a[248:251], v[112:115], v[224:227]
    v_cndmask_b32 v25, 0, v37, s[40:41]
    v_cndmask_b32 v26, 0, v38, s[40:41]
    v_mfma_f32_16x16x32_bf16 v[228:231], a[252:255], v[112:115], v[228:231]
    buffer_load_dwordx4 a[216:219], v2, s[64:67], s14 offen offset:2048 sc1
    v_mfma_f32_16x16x32_bf16 v[232:235], a[248:251], v[116:119], v[232:235]
    ds_read_b128 a[240:243], v2 offset:62464
    ds_read_b128 a[244:247], v3 offset:62464
    v_mfma_f32_16x16x32_bf16 v[236:239], a[252:255], v[116:119], v[236:239]
    v_cndmask_b32 v27, 0, v39, s[40:41]
    s_waitcnt lgkmcnt(2)
    v_mfma_f32_16x16x32_bf16 v[224:227], a[224:227], v[120:123], v[224:227]
    s_add_u32 s96, s10, 0x1c000
    v_mul_f32 v212, v208, v212
    v_mfma_f32_16x16x32_bf16 v[228:231], a[228:231], v[120:123], v[228:231]
    buffer_load_dwordx4 a[220:223], v2, s[64:67], s14 offen offset:3072 sc1
    v_mfma_f32_16x16x32_bf16 v[232:235], a[224:227], v[124:127], v[232:235]
    ds_read_b128 a[248:251], v2 offset:47104
    ds_read_b128 a[252:255], v3 offset:47104
    v_mfma_f32_16x16x32_bf16 v[236:239], a[228:231], v[124:127], v[236:239]
    v_mul_f32 v208, v56, v208
    v_mul_f32 v213, v209, v213
    v_mfma_f32_16x16x32_bf16 v[224:227], a[232:235], v[128:131], v[224:227]
    v_mul_f32 v209, v56, v209
    v_mul_f32 v214, v210, v214
    v_mfma_f32_16x16x32_bf16 v[228:231], a[236:239], v[128:131], v[228:231]
    v_cmp_eq_u32 vcc, 0, v16
    s_cbranch_vccnz L_fs_48
L_fb_49:
    s_add_u32 s80, s11, 0x0
    v_add_u32 v78, s80, v0
    buffer_load_dwordx4 v[80:83], v78, s[64:67], s68 offen offset:0 sc1
    v_mfma_f32_16x16x32_bf16 v[232:235], a[232:235], v[132:135], v[232:235]
    ds_read_b128 a[224:227], v2 offset:51200
    ds_read_b128 a[228:231], v3 offset:51200
    v_mfma_f32_16x16x32_bf16 v[236:239], a[236:239], v[132:135], v[236:239]
    v_mul_f32 v210, v56, v210
    s_waitcnt lgkmcnt(2)
    v_mfma_f32_16x16x32_bf16 v[224:227], a[240:243], v[136:139], v[224:227]
    v_exp_f32 v208, v208
    v_mfma_f32_16x16x32_bf16 v[228:231], a[244:247], v[136:139], v[228:231]
    buffer_load_dwordx4 v[84:87], v78, s[64:67], s68 offen offset:256 sc1
    v_mfma_f32_16x16x32_bf16 v[232:235], a[240:243], v[140:143], v[232:235]
    ds_read_b128 a[232:235], v2 offset:55296
    ds_read_b128 a[236:239], v3 offset:55296
    v_mfma_f32_16x16x32_bf16 v[236:239], a[244:247], v[140:143], v[236:239]
    v_exp_f32 v209, v209
    v_mfma_f32_16x16x32_bf16 v[224:227], v[28:31], v[24:27], v[224:227]
    v_fma_f32 v208, v208, v57, v57
    v_mul_f32 v215, v211, v215
    v_mfma_f32_16x16x32_bf16 v[228:231], v[32:35], v[24:27], v[228:231]
    buffer_load_dwordx4 v[88:91], v78, s[64:67], s68 offen offset:2048 sc1
    v_mfma_f32_16x16x32_bf16 v[232:235], v[28:31], v[26:29], v[232:235]
    v_mul_f32 v211, v56, v211
    v_fma_f32 v209, v209, v57, v57
    v_mfma_f32_16x16x32_bf16 v[236:239], v[32:35], v[26:29], v[236:239]
    v_exp_f32 v210, v210
    v_mfma_f32_16x16x32_bf16 v[240:243], a[248:251], v[104:107], v[240:243]
    v_rcp_f32 v208, v208
    v_mfma_f32_16x16x32_bf16 v[244:247], a[252:255], v[104:107], v[244:247]
    buffer_load_dwordx4 v[92:95], v78, s[64:67], s68 offen offset:2304 sc1
    v_mfma_f32_16x16x32_bf16 v[248:251], a[248:251], v[108:111], v[248:251]
    ds_read_b128 a[240:243], v2 offset:59392
    ds_read_b128 a[244:247], v3 offset:59392
    v_mfma_f32_16x16x32_bf16 v[252:255], a[252:255], v[108:111], v[252:255]
    s_lshl_b64 s[40:41], s[44:45], 32
    s_waitcnt lgkmcnt(2)
    v_mfma_f32_16x16x32_bf16 v[240:243], a[224:227], v[112:115], v[240:243]
    v_cndmask_b32 v24, 0, v36, s[40:41]
    v_cndmask_b32 v25, 0, v37, s[40:41]
    v_mfma_f32_16x16x32_bf16 v[244:247], a[228:231], v[112:115], v[244:247]
    buffer_load_dwordx4 v[96:99], v78, s[64:67], s69 offen offset:0 sc1
    v_mfma_f32_16x16x32_bf16 v[248:251], a[224:227], v[116:119], v[248:251]
    ds_read_b128 a[248:251], v2 offset:63488
    ds_read_b128 a[252:255], v3 offset:63488
    v_mfma_f32_16x16x32_bf16 v[252:255], a[228:231], v[116:119], v[252:255]
    v_cndmask_b32 v26, 0, v38, s[40:41]
    v_cndmask_b32 v27, 0, v39, s[40:41]
    v_mfma_f32_16x16x32_bf16 v[240:243], a[232:235], v[120:123], v[240:243]
    v_mul_f32 v220, v216, v220
    v_mul_f32 v216, v58, v216
    v_mfma_f32_16x16x32_bf16 v[244:247], a[236:239], v[120:123], v[244:247]
    buffer_load_dwordx4 v[100:103], v78, s[64:67], s69 offen offset:256 sc1
    v_mfma_f32_16x16x32_bf16 v[248:251], a[232:235], v[124:127], v[248:251]
    v_exp_f32 v211, v211
    v_mfma_f32_16x16x32_bf16 v[252:255], a[236:239], v[124:127], v[252:255]
    v_fma_f32 v210, v210, v57, v57
    s_waitcnt lgkmcnt(0)
    v_mfma_f32_16x16x32_bf16 v[240:243], a[240:243], v[128:131], v[240:243]
    v_rcp_f32 v209, v209
    v_mfma_f32_16x16x32_bf16 v[244:247], a[244:247], v[128:131], v[244:247]
    buffer_load_dwordx4 v[104:107], v78, s[64:67], s69 offen offset:2048 sc1
    v_mfma_f32_16x16x32_bf16 v[248:251], a[240:243], v[132:135], v[248:251]
    v_mul_f32 v212, v212, v208
    v_mul_f32 v221, v217, v221
    v_mfma_f32_16x16x32_bf16 v[252:255], a[244:247], v[132:135], v[252:255]
    v_mul_f32 v217, v58, v217
    v_fma_f32 v211, v211, v57, v57
    v_mfma_f32_16x16x32_bf16 v[240:243], a[248:251], v[136:139], v[240:243]
    v_exp_f32 v216, v216
    v_mfma_f32_16x16x32_bf16 v[244:247], a[252:255], v[136:139], v[244:247]
    buffer_load_dwordx4 v[108:111], v78, s[64:67], s69 offen offset:2304 sc1
    v_mfma_f32_16x16x32_bf16 v[248:251], a[248:251], v[140:143], v[248:251]
    v_rcp_f32 v210, v210
    v_mfma_f32_16x16x32_bf16 v[252:255], a[252:255], v[140:143], v[252:255]
    v_mul_f32 v213, v213, v209
    v_mfma_f32_16x16x32_bf16 v[240:243], v[28:31], v[24:27], v[240:243]
    v_mul_f32 v222, v218, v222
    v_mul_f32 v218, v58, v218
    v_mfma_f32_16x16x32_bf16 v[244:247], v[32:35], v[24:27], v[244:247]
    buffer_load_dwordx4 v[112:115], v78, s[64:67], s70 offen offset:0 sc1
    v_mfma_f32_16x16x32_bf16 v[248:251], v[28:31], v[26:29], v[248:251]
    v_exp_f32 v217, v217
    v_mfma_f32_16x16x32_bf16 v[252:255], v[32:35], v[26:29], v[252:255]
    v_fma_f32 v216, v216, v59, v59
    v_mul_f32 v214, v214, v210
    v_rcp_f32 v211, v211
    v_cvt_pk_bf16_f32 v208, v212, v213
    v_mul_f32 v223, v219, v223
    v_mul_f32 v219, v58, v219
    v_exp_f32 v218, v218
    v_fma_f32 v217, v217, v59, v59
    v_rcp_f32 v216, v216
    v_mul_f32 v215, v215, v211
    v_exp_f32 v219, v219
    v_fma_f32 v218, v218, v59, v59
    v_rcp_f32 v217, v217
    v_mul_f32 v220, v220, v216
    v_cvt_pk_bf16_f32 v209, v214, v215
    v_fma_f32 v219, v219, v59, v59
    v_rcp_f32 v218, v218
    v_mul_f32 v221, v221, v217
    v_rcp_f32 v219, v219
    v_mul_f32 v222, v222, v218
    v_cvt_pk_bf16_f32 v210, v220, v221
    v_mul_f32 v223, v223, v219
    v_cvt_pk_bf16_f32 v211, v222, v223
    v_permlane16_swap_b32 v208, v210
    s_nop 0
    v_permlane16_swap_b32 v209, v211
    buffer_store_dwordx4 v[208:211], v2, s[64:67], s96 offen sc1
    s_add_u32 s97, s10, 0x1c400
    v_pk_mul_f32 v[228:229], v[224:225], v[228:229]
    v_pk_mul_f32 v[224:225], v[224:225], v[56:57] op_sel_hi:[1,0]
    v_pk_mul_f32 v[230:231], v[226:227], v[230:231]
    v_pk_mul_f32 v[226:227], v[226:227], v[56:57] op_sel_hi:[1,0]
    v_pk_mul_f32 v[236:237], v[232:233], v[236:237]
    v_pk_mul_f32 v[232:233], v[232:233], v[58:59] op_sel_hi:[1,0]
    v_pk_mul_f32 v[238:239], v[234:235], v[238:239]
    v_pk_mul_f32 v[234:235], v[234:235], v[58:59] op_sel_hi:[1,0]
    buffer_load_dwordx4 v[116:119], v78, s[64:67], s70 offen offset:256 sc1
    v_exp_f32 v224, v224
    v_exp_f32 v225, v225
    v_exp_f32 v226, v226
    v_exp_f32 v227, v227
    v_exp_f32 v232, v232
    v_exp_f32 v233, v233
    buffer_load_dwordx4 v[120:123], v78, s[64:67], s70 offen offset:2048 sc1
    v_exp_f32 v234, v234
    v_exp_f32 v235, v235
    v_pk_fma_f32 v[224:225], v[224:225], v[56:57], v[56:57] op_sel:[0,1,1] op_sel_hi:[1,1,1]
    v_pk_fma_f32 v[226:227], v[226:227], v[56:57], v[56:57] op_sel:[0,1,1] op_sel_hi:[1,1,1]
    v_pk_fma_f32 v[232:233], v[232:233], v[58:59], v[58:59] op_sel:[0,1,1] op_sel_hi:[1,1,1]
    v_pk_fma_f32 v[234:235], v[234:235], v[58:59], v[58:59] op_sel:[0,1,1] op_sel_hi:[1,1,1]
    v_rcp_f32 v224, v224
    v_rcp_f32 v225, v225
    v_rcp_f32 v226, v226
    v_rcp_f32 v227, v227
    buffer_load_dwordx4 v[124:127], v78, s[64:67], s70 offen offset:2304 sc1
    v_rcp_f32 v232, v232
    v_rcp_f32 v233, v233
    v_rcp_f32 v234, v234
    v_rcp_f32 v235, v235
    v_pk_mul_f32 v[228:229], v[228:229], v[224:225]
    v_pk_mul_f32 v[230:231], v[230:231], v[226:227]
    v_pk_mul_f32 v[236:237], v[236:237], v[232:233]
    v_pk_mul_f32 v[238:239], v[238:239], v[234:235]
    v_cvt_pk_bf16_f32 v224, v228, v229
    v_cvt_pk_bf16_f32 v225, v230, v231
    v_cvt_pk_bf16_f32 v226, v236, v237
    v_cvt_pk_bf16_f32 v227, v238, v239
    s_nop 0
    v_permlane16_swap_b32 v224, v226
    v_permlane16_swap_b32 v225, v227
    buffer_store_dwordx4 v[224:227], v2, s[64:67], s97 offen sc1
    s_add_u32 s98, s10, 0x1c800
    v_pk_mul_f32 v[244:245], v[240:241], v[244:245]
    v_pk_mul_f32 v[240:241], v[240:241], v[56:57] op_sel_hi:[1,0]
    v_pk_mul_f32 v[246:247], v[242:243], v[246:247]
    v_pk_mul_f32 v[242:243], v[242:243], v[56:57] op_sel_hi:[1,0]
    v_pk_mul_f32 v[252:253], v[248:249], v[252:253]
    v_pk_mul_f32 v[248:249], v[248:249], v[58:59] op_sel_hi:[1,0]
    v_pk_mul_f32 v[254:255], v[250:251], v[254:255]
    v_pk_mul_f32 v[250:251], v[250:251], v[58:59] op_sel_hi:[1,0]
    buffer_load_dwordx4 v[128:131], v78, s[64:67], s71 offen offset:0 sc1
    v_exp_f32 v240, v240
    v_exp_f32 v241, v241
    v_exp_f32 v242, v242
    v_exp_f32 v243, v243
    v_exp_f32 v248, v248
    v_exp_f32 v249, v249
    buffer_load_dwordx4 v[132:135], v78, s[64:67], s71 offen offset:256 sc1
    v_exp_f32 v250, v250
    v_exp_f32 v251, v251
    v_pk_fma_f32 v[240:241], v[240:241], v[56:57], v[56:57] op_sel:[0,1,1] op_sel_hi:[1,1,1]
    v_pk_fma_f32 v[242:243], v[242:243], v[56:57], v[56:57] op_sel:[0,1,1] op_sel_hi:[1,1,1]
    v_pk_fma_f32 v[248:249], v[248:249], v[58:59], v[58:59] op_sel:[0,1,1] op_sel_hi:[1,1,1]
    v_pk_fma_f32 v[250:251], v[250:251], v[58:59], v[58:59] op_sel:[0,1,1] op_sel_hi:[1,1,1]
    v_rcp_f32 v240, v240
    v_rcp_f32 v241, v241
    v_rcp_f32 v242, v242
    v_rcp_f32 v243, v243
    buffer_load_dwordx4 v[136:139], v78, s[64:67], s71 offen offset:2048 sc1
    v_rcp_f32 v248, v248
    v_rcp_f32 v249, v249
    v_rcp_f32 v250, v250
    v_rcp_f32 v251, v251
    v_pk_mul_f32 v[244:245], v[244:245], v[240:241]
    v_pk_mul_f32 v[246:247], v[246:247], v[242:243]
    v_pk_mul_f32 v[252:253], v[252:253], v[248:249]
    v_pk_mul_f32 v[254:255], v[254:255], v[250:251]
    v_cvt_pk_bf16_f32 v240, v244, v245
    v_cvt_pk_bf16_f32 v241, v246, v247
    v_cvt_pk_bf16_f32 v242, v252, v253
    v_cvt_pk_bf16_f32 v243, v254, v255
    s_nop 0
    v_permlane16_swap_b32 v240, v242
    v_permlane16_swap_b32 v241, v243
    buffer_store_dwordx4 v[240:243], v2, s[64:67], s98 offen sc1
    s_waitcnt lgkmcnt(0)
    s_waitcnt vmcnt(17)
    v_mfma_f32_16x16x32_bf16 v[144:147], a[0:3], v[80:83], 0
    buffer_load_dwordx4 v[140:143], v78, s[64:67], s71 offen offset:2304 sc1
    v_mfma_f32_16x16x32_bf16 v[148:151], a[4:7], v[80:83], 0
    v_mfma_f32_16x16x32_bf16 v[152:155], a[8:11], v[80:83], 0
    v_mfma_f32_16x16x32_bf16 v[156:159], a[12:15], v[80:83], 0
    s_waitcnt vmcnt(17)
    v_mfma_f32_16x16x32_bf16 v[160:163], a[0:3], v[84:87], 0
    buffer_load_dwordx4 v[80:83], v78, s[64:67], s72 offen offset:0 sc1
    v_mfma_f32_16x16x32_bf16 v[164:167], a[4:7], v[84:87], 0
    v_mfma_f32_16x16x32_bf16 v[168:171], a[8:11], v[84:87], 0
    v_mfma_f32_16x16x32_bf16 v[172:175], a[12:15], v[84:87], 0
    s_waitcnt vmcnt(17)
    v_mfma_f32_16x16x32_bf16 v[144:147], a[16:19], v[88:91], v[144:147]
    buffer_load_dwordx4 v[84:87], v78, s[64:67], s72 offen offset:256 sc1
    v_mfma_f32_16x16x32_bf16 v[148:151], a[20:23], v[88:91], v[148:151]
    v_mfma_f32_16x16x32_bf16 v[152:155], a[24:27], v[88:91], v[152:155]
    v_mfma_f32_16x16x32_bf16 v[156:159], a[28:31], v[88:91], v[156:159]
    s_waitcnt vmcnt(17)
    v_mfma_f32_16x16x32_bf16 v[160:163], a[16:19], v[92:95], v[160:163]
    buffer_load_dwordx4 v[88:91], v78, s[64:67], s72 offen offset:2048 sc1
    v_mfma_f32_16x16x32_bf16 v[164:167], a[20:23], v[92:95], v[164:167]
    v_mfma_f32_16x16x32_bf16 v[168:171], a[24:27], v[92:95], v[168:171]
    v_mfma_f32_16x16x32_bf16 v[172:175], a[28:31], v[92:95], v[172:175]
    s_waitcnt vmcnt(17)
    v_mfma_f32_16x16x32_bf16 v[144:147], a[32:35], v[96:99], v[144:147]
    buffer_load_dwordx4 v[92:95], v78, s[64:67], s72 offen offset:2304 sc1
    v_mfma_f32_16x16x32_bf16 v[148:151], a[36:39], v[96:99], v[148:151]
    v_mfma_f32_16x16x32_bf16 v[152:155], a[40:43], v[96:99], v[152:155]
    v_mfma_f32_16x16x32_bf16 v[156:159], a[44:47], v[96:99], v[156:159]
    s_waitcnt vmcnt(17)
    v_mfma_f32_16x16x32_bf16 v[160:163], a[32:35], v[100:103], v[160:163]
    buffer_load_dwordx4 v[96:99], v78, s[64:67], s73 offen offset:0 sc1
    v_mfma_f32_16x16x32_bf16 v[164:167], a[36:39], v[100:103], v[164:167]
    v_mfma_f32_16x16x32_bf16 v[168:171], a[40:43], v[100:103], v[168:171]
    v_mfma_f32_16x16x32_bf16 v[172:175], a[44:47], v[100:103], v[172:175]
    s_waitcnt vmcnt(17)
    v_mfma_f32_16x16x32_bf16 v[144:147], a[48:51], v[104:107], v[144:147]
    buffer_load_dwordx4 v[100:103], v78, s[64:67], s73 offen offset:256 sc1
    v_mfma_f32_16x16x32_bf16 v[148:151], a[52:55], v[104:107], v[148:151]
    v_mfma_f32_16x16x32_bf16 v[152:155], a[56:59], v[104:107], v[152:155]
    v_mfma_f32_16x16x32_bf16 v[156:159], a[60:63], v[104:107], v[156:159]
    s_waitcnt vmcnt(17)
    v_mfma_f32_16x16x32_bf16 v[160:163], a[48:51], v[108:111], v[160:163]
    buffer_load_dwordx4 v[104:107], v78, s[64:67], s73 offen offset:2048 sc1
    v_mfma_f32_16x16x32_bf16 v[164:167], a[52:55], v[108:111], v[164:167]
    v_mfma_f32_16x16x32_bf16 v[168:171], a[56:59], v[108:111], v[168:171]
    v_mfma_f32_16x16x32_bf16 v[172:175], a[60:63], v[108:111], v[172:175]
    s_waitcnt vmcnt(17)
    v_mfma_f32_16x16x32_bf16 v[144:147], a[64:67], v[112:115], v[144:147]
    buffer_load_dwordx4 v[108:111], v78, s[64:67], s73 offen offset:2304 sc1
    v_mfma_f32_16x16x32_bf16 v[148:151], a[68:71], v[112:115], v[148:151]
    v_mfma_f32_16x16x32_bf16 v[152:155], a[72:75], v[112:115], v[152:155]
    v_mfma_f32_16x16x32_bf16 v[156:159], a[76:79], v[112:115], v[156:159]
    s_waitcnt vmcnt(16)
    v_mfma_f32_16x16x32_bf16 v[160:163], a[64:67], v[116:119], v[160:163]
    buffer_load_dwordx4 v[112:115], v78, s[64:67], s74 offen offset:0 sc1
    v_mfma_f32_16x16x32_bf16 v[164:167], a[68:71], v[116:119], v[164:167]
    v_mfma_f32_16x16x32_bf16 v[168:171], a[72:75], v[116:119], v[168:171]
    v_mfma_f32_16x16x32_bf16 v[172:175], a[76:79], v[116:119], v[172:175]
    s_waitcnt vmcnt(16)
    v_mfma_f32_16x16x32_bf16 v[144:147], a[80:83], v[120:123], v[144:147]
    buffer_load_dwordx4 v[116:119], v78, s[64:67], s74 offen offset:256 sc1
    v_mfma_f32_16x16x32_bf16 v[148:151], a[84:87], v[120:123], v[148:151]
    v_mfma_f32_16x16x32_bf16 v[152:155], a[88:91], v[120:123], v[152:155]
    v_mfma_f32_16x16x32_bf16 v[156:159], a[92:95], v[120:123], v[156:159]
    s_waitcnt vmcnt(11)
    s_cmp_eq_u32 s16, 0
    s_cbranch_scc1 L_ps_50
    buffer_store_dword v23, off, s[64:67], s26 offset:256
L_pb_51:
    s_add_u32 s80, s10, 0x1c000
    v_lshlrev_b32 v16, 3, v2
    s_mov_b64 exec, 0xffffff
    buffer_load_dword v16, v16, s[64:67], s80 offen sc1
    s_mov_b64 exec, -1
    v_mfma_f32_16x16x32_bf16 v[160:163], a[80:83], v[124:127], v[160:163]
    buffer_load_dwordx4 v[120:123], v78, s[64:67], s74 offen offset:2048 sc1
    v_mfma_f32_16x16x32_bf16 v[164:167], a[84:87], v[124:127], v[164:167]
    v_mfma_f32_16x16x32_bf16 v[168:171], a[88:91], v[124:127], v[168:171]
    v_mfma_f32_16x16x32_bf16 v[172:175], a[92:95], v[124:127], v[172:175]
    v_mfma_f32_16x16x32_bf16 v[144:147], a[96:99], v[128:131], v[144:147]
    buffer_load_dwordx4 v[124:127], v78, s[64:67], s74 offen offset:2304 sc1
    v_mfma_f32_16x16x32_bf16 v[148:151], a[100:103], v[128:131], v[148:151]
    v_mfma_f32_16x16x32_bf16 v[152:155], a[104:107], v[128:131], v[152:155]
    v_mfma_f32_16x16x32_bf16 v[156:159], a[108:111], v[128:131], v[156:159]
    v_mfma_f32_16x16x32_bf16 v[160:163], a[96:99], v[132:135], v[160:163]
    v_mfma_f32_16x16x32_bf16 v[164:167], a[100:103], v[132:135], v[164:167]
    v_mfma_f32_16x16x32_bf16 v[168:171], a[104:107], v[132:135], v[168:171]
    v_mfma_f32_16x16x32_bf16 v[172:175], a[108:111], v[132:135], v[172:175]
    v_mfma_f32_16x16x32_bf16 v[144:147], a[112:115], v[136:139], v[144:147]
    v_mfma_f32_16x16x32_bf16 v[148:151], a[116:119], v[136:139], v[148:151]
    v_mfma_f32_16x16x32_bf16 v[152:155], a[120:123], v[136:139], v[152:155]
    v_mfma_f32_16x16x32_bf16 v[156:159], a[124:127], v[136:139], v[156:159]
    s_waitcnt vmcnt(14)
    v_mfma_f32_16x16x32_bf16 v[160:163], a[112:115], v[140:143], v[160:163]
    v_mfma_f32_16x16x32_bf16 v[164:167], a[116:119], v[140:143], v[164:167]
    v_mfma_f32_16x16x32_bf16 v[168:171], a[120:123], v[140:143], v[168:171]
    v_mfma_f32_16x16x32_bf16 v[172:175], a[124:127], v[140:143], v[172:175]
    s_waitcnt vmcnt(13)
    v_mfma_f32_16x16x32_bf16 v[144:147], a[128:131], v[80:83], v[144:147]
    v_mfma_f32_16x16x32_bf16 v[148:151], a[132:135], v[80:83], v[148:151]
    v_mfma_f32_16x16x32_bf16 v[152:155], a[136:139], v[80:83], v[152:155]
    v_mfma_f32_16x16x32_bf16 v[156:159], a[140:143], v[80:83], v[156:159]
    s_waitcnt vmcnt(12)
    v_mfma_f32_16x16x32_bf16 v[160:163], a[128:131], v[84:87], v[160:163]
    v_mfma_f32_16x16x32_bf16 v[164:167], a[132:135], v[84:87], v[164:167]
    v_mfma_f32_16x16x32_bf16 v[168:171], a[136:139], v[84:87], v[168:171]
    v_mfma_f32_16x16x32_bf16 v[172:175], a[140:143], v[84:87], v[172:175]
    s_waitcnt vmcnt(11)
    v_mfma_f32_16x16x32_bf16 v[144:147], a[144:147], v[88:91], v[144:147]
    v_mfma_f32_16x16x32_bf16 v[148:151], a[148:151], v[88:91], v[148:151]
    v_mfma_f32_16x16x32_bf16 v[152:155], a[152:155], v[88:91], v[152:155]
    v_mfma_f32_16x16x32_bf16 v[156:159], a[156:159], v[88:91], v[156:159]
    s_waitcnt vmcnt(10)
    v_mfma_f32_16x16x32_bf16 v[160:163], a[144:147], v[92:95], v[160:163]
    v_mfma_f32_16x16x32_bf16 v[164:167], a[148:151], v[92:95], v[164:167]
    v_mfma_f32_16x16x32_bf16 v[168:171], a[152:155], v[92:95], v[168:171]
    v_mfma_f32_16x16x32_bf16 v[172:175], a[156:159], v[92:95], v[172:175]
    s_waitcnt vmcnt(9)
    v_mfma_f32_16x16x32_bf16 v[144:147], a[160:163], v[96:99], v[144:147]
    v_mfma_f32_16x16x32_bf16 v[148:151], a[164:167], v[96:99], v[148:151]
    v_mfma_f32_16x16x32_bf16 v[152:155], a[168:171], v[96:99], v[152:155]
    v_mfma_f32_16x16x32_bf16 v[156:159], a[172:175], v[96:99], v[156:159]
    s_waitcnt vmcnt(8)
    v_mfma_f32_16x16x32_bf16 v[160:163], a[160:163], v[100:103], v[160:163]
    v_mfma_f32_16x16x32_bf16 v[164:167], a[164:167], v[100:103], v[164:167]
    v_mfma_f32_16x16x32_bf16 v[168:171], a[168:171], v[100:103], v[168:171]
    v_mfma_f32_16x16x32_bf16 v[172:175], a[172:175], v[100:103], v[172:175]
    s_waitcnt vmcnt(7)
    v_mfma_f32_16x16x32_bf16 v[144:147], a[176:179], v[104:107], v[144:147]
    v_mfma_f32_16x16x32_bf16 v[148:151], a[180:183], v[104:107], v[148:151]
    v_mfma_f32_16x16x32_bf16 v[152:155], a[184:187], v[104:107], v[152:155]
    v_mfma_f32_16x16x32_bf16 v[156:159], a[188:191], v[104:107], v[156:159]
    s_waitcnt vmcnt(6)
    v_mfma_f32_16x16x32_bf16 v[160:163], a[176:179], v[108:111], v[160:163]
    v_mfma_f32_16x16x32_bf16 v[164:167], a[180:183], v[108:111], v[164:167]
    buffer_load_dword v16, v5, s[64:67], s27 offen offset:256 sc1
    v_mfma_f32_16x16x32_bf16 v[168:171], a[184:187], v[108:111], v[168:171]
    v_mfma_f32_16x16x32_bf16 v[172:175], a[188:191], v[108:111], v[172:175]
    s_waitcnt vmcnt(6)
    v_mfma_f32_16x16x32_bf16 v[144:147], a[192:195], v[112:115], v[144:147]
    v_mfma_f32_16x16x32_bf16 v[148:151], a[196:199], v[112:115], v[148:151]
    v_mfma_f32_16x16x32_bf16 v[152:155], a[200:203], v[112:115], v[152:155]
    v_mfma_f32_16x16x32_bf16 v[156:159], a[204:207], v[112:115], v[156:159]
    s_waitcnt vmcnt(2)
    v_mfma_f32_16x16x32_bf16 v[144:147], a[208:211], v[120:123], v[144:147]
    v_xor_b32 v73, 64, v8
    v_xor_b32 v74, 128, v8
    v_xor_b32 v75, 192, v8
    v_mfma_f32_16x16x32_bf16 v[148:151], a[212:215], v[120:123], v[148:151]
    v_mfma_f32_16x16x32_bf16 v[152:155], a[216:219], v[120:123], v[152:155]
    v_mfma_f32_16x16x32_bf16 v[156:159], a[220:223], v[120:123], v[156:159]
    v_mfma_f32_16x16x32_bf16 v[160:163], a[192:195], v[116:119], v[160:163]
    v_mfma_f32_16x16x32_bf16 v[164:167], a[196:199], v[116:119], v[164:167]
    v_mfma_f32_16x16x32_bf16 v[168:171], a[200:203], v[116:119], v[168:171]
    ds_write_b128 v8, v[144:147]
    v_mfma_f32_16x16x32_bf16 v[172:175], a[204:207], v[116:119], v[172:175]
    s_nop 0
    ds_write_b128 v73, v[148:151]
    s_waitcnt vmcnt(1)
    v_mfma_f32_16x16x32_bf16 v[160:163], a[208:211], v[124:127], v[160:163]
    ds_write_b128 v74, v[152:155]
    v_mfma_f32_16x16x32_bf16 v[164:167], a[212:215], v[124:127], v[164:167]
    s_waitcnt vmcnt(0)
    v_cmp_eq_u32 vcc, 0, v16
    s_cbranch_vccnz L_fs_52
L_fb_53:
    s_add_u32 s80, s11, 0x1c000
    v_add_u32 v79, s80, v0
    ds_write_b128 v75, v[156:159]
    v_mfma_f32_16x16x32_bf16 v[168:171], a[216:219], v[124:127], v[168:171]
    buffer_load_dwordx4 v[128:131], v79, s[64:67], s68 offen offset:0 sc1
    v_mfma_f32_16x16x32_bf16 v[172:175], a[220:223], v[124:127], v[172:175]
    buffer_load_dwordx4 v[132:135], v79, s[64:67], s68 offen offset:256 sc1
    buffer_load_dwordx4 v[136:139], v79, s[64:67], s68 offen offset:2048 sc1
    ds_write_b128 v8, v[160:163] offset:4096
    ds_write_b128 v73, v[164:167] offset:4096
    s_nop 1
    ds_write_b128 v74, v[168:171] offset:4096
    s_nop 0
    ds_write_b128 v75, v[172:175] offset:4096
    buffer_load_dwordx4 v[140:143], v79, s[64:67], s68 offen offset:2304 sc1
    buffer_load_dwordx4 v[80:83], v79, s[64:67], s69 offen offset:0 sc1
    v_lshlrev_b32 v240, 16, v40
    v_and_b32 v241, 0xffff0000, v40
    v_lshlrev_b32 v242, 16, v41
    v_and_b32 v243, 0xffff0000, v41
    v_lshlrev_b32 v244, 16, v42
    v_and_b32 v245, 0xffff0000, v42
    v_lshlrev_b32 v246, 16, v43
    v_and_b32 v247, 0xffff0000, v43
    s_waitcnt lgkmcnt(0)
    s_barrier
    ds_read_b128 v[208:211], v9 offset:0
    ds_read_b128 v[212:215], v10 offset:0
    ds_read_b128 v[216:219], v9 offset:8192
    ds_read_b128 v[220:223], v10 offset:8192
    ds_read_b128 v[224:227], v9 offset:16384
    ds_read_b128 v[228:231], v10 offset:16384
    ds_read_b128 v[232:235], v9 offset:24576
    ds_read_b128 v[236:239], v10 offset:24576
    buffer_load_dwordx4 v[84:87], v79, s[64:67], s69 offen offset:256 sc1
    buffer_load_dwordx4 v[88:91], v79, s[64:67], s69 offen offset:2048 sc1
    s_waitcnt lgkmcnt(7)
    v_pk_add_f32 v[240:241], v[240:241], v[208:209]
    v_pk_add_f32 v[242:243], v[242:243], v[210:211]
    s_waitcnt lgkmcnt(6)
    v_pk_add_f32 v[244:245], v[244:245], v[212:213]
    v_pk_add_f32 v[246:247], v[246:247], v[214:215]
    s_waitcnt lgkmcnt(5)
    v_pk_add_f32 v[240:241], v[240:241], v[216:217]
    v_pk_add_f32 v[242:243], v[242:243], v[218:219]
    s_waitcnt lgkmcnt(4)
    v_pk_add_f32 v[244:245], v[244:245], v[220:221]
    v_pk_add_f32 v[246:247], v[246:247], v[222:223]
    s_waitcnt lgkmcnt(3)
    v_pk_add_f32 v[240:241], v[240:241], v[224:225]
    v_pk_add_f32 v[242:243], v[242:243], v[226:227]
    s_waitcnt lgkmcnt(2)
    v_pk_add_f32 v[244:245], v[244:245], v[228:229]
    v_pk_add_f32 v[246:247], v[246:247], v[230:231]
    s_waitcnt lgkmcnt(1)
    v_pk_add_f32 v[240:241], v[240:241], v[232:233]
    v_pk_add_f32 v[242:243], v[242:243], v[234:235]
    buffer_load_dwordx4 v[92:95], v79, s[64:67], s69 offen offset:2304 sc1
    buffer_load_dwordx4 v[96:99], v79, s[64:67], s70 offen offset:0 sc1
    s_waitcnt lgkmcnt(0)
    v_pk_add_f32 v[244:245], v[244:245], v[236:237]
    v_pk_add_f32 v[246:247], v[246:247], v[238:239]
    v_pk_add_f32 v[76:77], v[240:241], v[242:243]
    v_pk_mul_f32 v[18:19], v[240:241], v[240:241]
    v_pk_add_f32 v[76:77], v[76:77], v[244:245]
    v_pk_fma_f32 v[18:19], v[242:243], v[242:243], v[18:19]
    v_pk_add_f32 v[76:77], v[76:77], v[246:247]
    v_pk_fma_f32 v[18:19], v[244:245], v[244:245], v[18:19]
    v_pk_fma_f32 v[18:19], v[246:247], v[246:247], v[18:19]
    v_add_f32 v19, v18, v19
    v_add_f32 v18, v76, v77
    s_nop 1
    v_permlane32_swap_b32 v18, v19
    v_add_f32 v18, v18, v19
    v_mov_b32 v76, v18
    s_nop 1
    v_permlane16_swap_b32 v18, v76
    v_add_f32 v18, v18, v76
    s_nop 1
    v_add_f32_dpp v18, v18, v18 row_ror:8 row_mask:0xf bank_mask:0xf
    v_mov_b32 v19, v18
    s_nop 1
    v_permlane32_swap_b32 v18, v19
    s_mov_b64 exec, 0xff
    s_cmp_eq_u32 s16, 0
    s_cbranch_scc1 L_ps_54
    buffer_store_dwordx2 v[18:19], v17, s[64:67], s25 offen offset:0
L_pb_55:
    s_mov_b64 exec, -1
    s_waitcnt vmcnt(9)
    v_mfma_f32_16x16x32_bf16 v[144:147], a[0:3], v[128:131], 0
    buffer_load_dwordx4 v[100:103], v79, s[64:67], s70 offen offset:256 sc1
    v_mfma_f32_16x16x32_bf16 v[148:151], a[4:7], v[128:131], 0
    s_barrier
    v_mfma_f32_16x16x32_bf16 v[152:155], a[8:11], v[128:131], 0
    v_mfma_f32_16x16x32_bf16 v[156:159], a[12:15], v[128:131], 0
    s_waitcnt vmcnt(9)
    v_mfma_f32_16x16x32_bf16 v[160:163], a[0:3], v[132:135], 0
    buffer_load_dwordx4 v[104:107], v79, s[64:67], s70 offen offset:2048 sc1
    v_mfma_f32_16x16x32_bf16 v[164:167], a[4:7], v[132:135], 0
    v_mfma_f32_16x16x32_bf16 v[168:171], a[8:11], v[132:135], 0
    v_mfma_f32_16x16x32_bf16 v[172:175], a[12:15], v[132:135], 0
    s_waitcnt vmcnt(9)
    v_mfma_f32_16x16x32_bf16 v[144:147], a[16:19], v[136:139], v[144:147]
    buffer_load_dwordx4 v[108:111], v79, s[64:67], s70 offen offset:2304 sc1
    v_mfma_f32_16x16x32_bf16 v[148:151], a[20:23], v[136:139], v[148:151]
    v_mfma_f32_16x16x32_bf16 v[152:155], a[24:27], v[136:139], v[152:155]
    v_mfma_f32_16x16x32_bf16 v[156:159], a[28:31], v[136:139], v[156:159]
    s_waitcnt vmcnt(9)
    v_mfma_f32_16x16x32_bf16 v[160:163], a[16:19], v[140:143], v[160:163]
    buffer_load_dwordx4 v[112:115], v79, s[64:67], s71 offen offset:0 sc1
    v_mfma_f32_16x16x32_bf16 v[164:167], a[20:23], v[140:143], v[164:167]
    v_mfma_f32_16x16x32_bf16 v[168:171], a[24:27], v[140:143], v[168:171]
    v_mfma_f32_16x16x32_bf16 v[172:175], a[28:31], v[140:143], v[172:175]
    s_waitcnt vmcnt(9)
    v_mfma_f32_16x16x32_bf16 v[144:147], a[32:35], v[80:83], v[144:147]
    buffer_load_dwordx4 v[116:119], v79, s[64:67], s71 offen offset:256 sc1
    v_mfma_f32_16x16x32_bf16 v[148:151], a[36:39], v[80:83], v[148:151]
    v_mfma_f32_16x16x32_bf16 v[152:155], a[40:43], v[80:83], v[152:155]
    v_mfma_f32_16x16x32_bf16 v[156:159], a[44:47], v[80:83], v[156:159]
    s_waitcnt vmcnt(9)
    v_mfma_f32_16x16x32_bf16 v[160:163], a[32:35], v[84:87], v[160:163]
    buffer_load_dwordx4 v[120:123], v79, s[64:67], s71 offen offset:2048 sc1
    v_mfma_f32_16x16x32_bf16 v[164:167], a[36:39], v[84:87], v[164:167]
    v_mfma_f32_16x16x32_bf16 v[168:171], a[40:43], v[84:87], v[168:171]
    v_mfma_f32_16x16x32_bf16 v[172:175], a[44:47], v[84:87], v[172:175]
    buffer_load_dwordx2 v[18:19], v17, s[64:67], s6 offen offset:0 sc1
    s_waitcnt vmcnt(10)
    v_mfma_f32_16x16x32_bf16 v[144:147], a[48:51], v[88:91], v[144:147]
    buffer_load_dwordx4 v[124:127], v79, s[64:67], s71 offen offset:2304 sc1
    v_mfma_f32_16x16x32_bf16 v[148:151], a[52:55], v[88:91], v[148:151]
    v_mfma_f32_16x16x32_bf16 v[152:155], a[56:59], v[88:91], v[152:155]
    v_mfma_f32_16x16x32_bf16 v[156:159], a[60:63], v[88:91], v[156:159]
    s_waitcnt vmcnt(10)
    v_mfma_f32_16x16x32_bf16 v[160:163], a[48:51], v[92:95], v[160:163]
    buffer_load_dwordx4 v[128:131], v79, s[64:67], s72 offen offset:0 sc1
    v_mfma_f32_16x16x32_bf16 v[164:167], a[52:55], v[92:95], v[164:167]
    v_mfma_f32_16x16x32_bf16 v[168:171], a[56:59], v[92:95], v[168:171]
    v_mfma_f32_16x16x32_bf16 v[172:175], a[60:63], v[92:95], v[172:175]
    s_waitcnt vmcnt(10)
    v_mfma_f32_16x16x32_bf16 v[144:147], a[64:67], v[96:99], v[144:147]
    buffer_load_dwordx4 v[132:135], v79, s[64:67], s72 offen offset:256 sc1
    v_mfma_f32_16x16x32_bf16 v[148:151], a[68:71], v[96:99], v[148:151]
    v_mfma_f32_16x16x32_bf16 v[152:155], a[72:75], v[96:99], v[152:155]
    v_mfma_f32_16x16x32_bf16 v[156:159], a[76:79], v[96:99], v[156:159]
    s_waitcnt vmcnt(9)
    v_mfma_f32_16x16x32_bf16 v[160:163], a[64:67], v[100:103], v[160:163]
    buffer_load_dwordx4 v[136:139], v79, s[64:67], s72 offen offset:2048 sc1
    v_mfma_f32_16x16x32_bf16 v[164:167], a[68:71], v[100:103], v[164:167]
    v_mfma_f32_16x16x32_bf16 v[168:171], a[72:75], v[100:103], v[168:171]
    v_mfma_f32_16x16x32_bf16 v[172:175], a[76:79], v[100:103], v[172:175]
    s_waitcnt vmcnt(9)
    v_mfma_f32_16x16x32_bf16 v[144:147], a[80:83], v[104:107], v[144:147]
    buffer_load_dwordx4 v[140:143], v79, s[64:67], s72 offen offset:2304 sc1
    v_mfma_f32_16x16x32_bf16 v[148:151], a[84:87], v[104:107], v[148:151]
    v_mfma_f32_16x16x32_bf16 v[152:155], a[88:91], v[104:107], v[152:155]
    v_mfma_f32_16x16x32_bf16 v[156:159], a[92:95], v[104:107], v[156:159]
    s_waitcnt vmcnt(9)
    v_mfma_f32_16x16x32_bf16 v[160:163], a[80:83], v[108:111], v[160:163]
    buffer_load_dwordx4 v[80:83], v79, s[64:67], s73 offen offset:0 sc1
    v_mfma_f32_16x16x32_bf16 v[164:167], a[84:87], v[108:111], v[164:167]
    v_mfma_f32_16x16x32_bf16 v[168:171], a[88:91], v[108:111], v[168:171]
    v_mfma_f32_16x16x32_bf16 v[172:175], a[92:95], v[108:111], v[172:175]
    s_waitcnt vmcnt(9)
    v_mfma_f32_16x16x32_bf16 v[144:147], a[96:99], v[112:115], v[144:147]
    buffer_load_dwordx4 v[84:87], v79, s[64:67], s73 offen offset:256 sc1
    v_mfma_f32_16x16x32_bf16 v[148:151], a[100:103], v[112:115], v[148:151]
    v_mfma_f32_16x16x32_bf16 v[152:155], a[104:107], v[112:115], v[152:155]
    v_mfma_f32_16x16x32_bf16 v[156:159], a[108:111], v[112:115], v[156:159]
    s_waitcnt vmcnt(9)
    v_mfma_f32_16x16x32_bf16 v[160:163], a[96:99], v[116:119], v[160:163]
    buffer_load_dwordx4 v[88:91], v79, s[64:67], s73 offen offset:2048 sc1
    v_mfma_f32_16x16x32_bf16 v[164:167], a[100:103], v[116:119], v[164:167]
    v_mfma_f32_16x16x32_bf16 v[168:171], a[104:107], v[116:119], v[168:171]
    v_mfma_f32_16x16x32_bf16 v[172:175], a[108:111], v[116:119], v[172:175]
    s_waitcnt vmcnt(9)
    v_mfma_f32_16x16x32_bf16 v[144:147], a[112:115], v[120:123], v[144:147]
    buffer_load_dwordx4 v[92:95], v79, s[64:67], s73 offen offset:2304 sc1
    v_mfma_f32_16x16x32_bf16 v[148:151], a[116:119], v[120:123], v[148:151]
    v_mfma_f32_16x16x32_bf16 v[152:155], a[120:123], v[120:123], v[152:155]
    v_mfma_f32_16x16x32_bf16 v[156:159], a[124:127], v[120:123], v[156:159]
    s_waitcnt vmcnt(9)
    v_cmp_eq_u32 vcc, 0xbf800000, v19
    s_cbranch_vccnz L_ss_56
L_sb_57:
    s_waitcnt vmcnt(8)
    v_mfma_f32_16x16x32_bf16 v[160:163], a[112:115], v[124:127], v[160:163]
    buffer_load_dwordx4 v[96:99], v79, s[64:67], s74 offen offset:0 sc1
    v_mfma_f32_16x16x32_bf16 v[164:167], a[116:119], v[124:127], v[164:167]
    v_permlane32_swap_b32 v18, v19
    v_add_f32 v18, v18, v19
    v_mfma_f32_16x16x32_bf16 v[168:171], a[120:123], v[124:127], v[168:171]
    v_mov_b32 v76, v18
    s_nop 1
    v_permlane16_swap_b32 v18, v76
    v_mfma_f32_16x16x32_bf16 v[172:175], a[124:127], v[124:127], v[172:175]
    v_add_f32 v18, v18, v76
    s_waitcnt vmcnt(8)
    v_mfma_f32_16x16x32_bf16 v[144:147], a[128:131], v[128:131], v[144:147]
    buffer_load_dwordx4 v[100:103], v79, s[64:67], s74 offen offset:256 sc1
    v_mfma_f32_16x16x32_bf16 v[148:151], a[132:135], v[128:131], v[148:151]
    v_add_f32_dpp v18, v18, v18 row_ror:8 row_mask:0xf bank_mask:0xf
    v_mov_b32 v19, v18
    v_mfma_f32_16x16x32_bf16 v[152:155], a[136:139], v[128:131], v[152:155]
    s_nop 0
    v_permlane32_swap_b32 v18, v19
    v_mul_f32 v18, 0x3b000000, v18
    v_mfma_f32_16x16x32_bf16 v[156:159], a[140:143], v[128:131], v[156:159]
    v_mul_f32 v19, 0x3b000000, v19
    s_waitcnt vmcnt(8)
    v_mfma_f32_16x16x32_bf16 v[160:163], a[128:131], v[132:135], v[160:163]
    buffer_load_dwordx4 v[104:107], v79, s[64:67], s74 offen offset:2048 sc1
    v_mfma_f32_16x16x32_bf16 v[164:167], a[132:135], v[132:135], v[164:167]
    v_lshlrev_b32 v248, 16, v48
    v_and_b32 v249, 0xffff0000, v48
    v_mfma_f32_16x16x32_bf16 v[168:171], a[136:139], v[132:135], v[168:171]
    v_fma_f32 v19, -v18, v18, v19
    v_lshlrev_b32 v250, 16, v49
    v_mfma_f32_16x16x32_bf16 v[172:175], a[140:143], v[132:135], v[172:175]
    v_and_b32 v251, 0xffff0000, v49
    s_waitcnt vmcnt(8)
    v_mfma_f32_16x16x32_bf16 v[144:147], a[144:147], v[136:139], v[144:147]
    buffer_load_dwordx4 v[108:111], v79, s[64:67], s74 offen offset:2304 sc1
    v_mfma_f32_16x16x32_bf16 v[148:151], a[148:151], v[136:139], v[148:151]
    v_max_f32 v19, 0, v19
    v_lshlrev_b32 v252, 16, v50
    v_mfma_f32_16x16x32_bf16 v[152:155], a[152:155], v[136:139], v[152:155]
    v_and_b32 v253, 0xffff0000, v50
    v_add_f32 v19, 0x3727c5ac, v19
    v_mfma_f32_16x16x32_bf16 v[156:159], a[156:159], v[136:139], v[156:159]
    v_lshlrev_b32 v254, 16, v51
    s_waitcnt vmcnt(8)
    v_mfma_f32_16x16x32_bf16 v[160:163], a[144:147], v[140:143], v[160:163]
    v_rsq_f32 v19, v19
    v_mfma_f32_16x16x32_bf16 v[164:167], a[148:151], v[140:143], v[164:167]
    v_and_b32 v255, 0xffff0000, v51
    v_mul_f32 v18, v18, v19
    v_mfma_f32_16x16x32_bf16 v[168:171], a[152:155], v[140:143], v[168:171]
    v_fma_f32 v76, v240, v19, -v18
    v_fma_f32 v77, v241, v19, -v18
    v_mfma_f32_16x16x32_bf16 v[172:175], a[156:159], v[140:143], v[172:175]
    v_fmac_f32 v240, v76, v248
    s_waitcnt vmcnt(7)
    v_mfma_f32_16x16x32_bf16 v[144:147], a[160:163], v[80:83], v[144:147]
    v_fmac_f32 v241, v77, v249
    v_fma_f32 v76, v242, v19, -v18
    v_mfma_f32_16x16x32_bf16 v[148:151], a[164:167], v[80:83], v[148:151]
    v_fma_f32 v77, v243, v19, -v18
    v_fmac_f32 v242, v76, v250
    v_mfma_f32_16x16x32_bf16 v[152:155], a[168:171], v[80:83], v[152:155]
    v_fmac_f32 v243, v77, v251
    v_fma_f32 v76, v244, v19, -v18
    v_mfma_f32_16x16x32_bf16 v[156:159], a[172:175], v[80:83], v[156:159]
    v_fma_f32 v77, v245, v19, -v18
    s_waitcnt vmcnt(6)
    v_mfma_f32_16x16x32_bf16 v[160:163], a[160:163], v[84:87], v[160:163]
    v_fmac_f32 v244, v76, v252
    v_fmac_f32 v245, v77, v253
    v_mfma_f32_16x16x32_bf16 v[164:167], a[164:167], v[84:87], v[164:167]
    v_fma_f32 v76, v246, v19, -v18
    v_fma_f32 v77, v247, v19, -v18
    v_mfma_f32_16x16x32_bf16 v[168:171], a[168:171], v[84:87], v[168:171]
    v_fmac_f32 v246, v76, v254
    v_fmac_f32 v247, v77, v255
    v_mfma_f32_16x16x32_bf16 v[172:175], a[172:175], v[84:87], v[172:175]
    v_cvt_pk_bf16_f32 v40, v240, v241
    s_waitcnt vmcnt(5)
    v_mfma_f32_16x16x32_bf16 v[144:147], a[176:179], v[88:91], v[144:147]
    v_cvt_pk_bf16_f32 v41, v242, v243
    v_cvt_pk_bf16_f32 v42, v244, v245
    v_mfma_f32_16x16x32_bf16 v[148:151], a[180:183], v[88:91], v[148:151]
    v_cvt_pk_bf16_f32 v43, v246, v247
    v_mfma_f32_16x16x32_bf16 v[152:155], a[184:187], v[88:91], v[152:155]
    s_add_u32 s80, s4, 0x200000
    buffer_store_dwordx4 v[40:43], v12, s[64:67], s80 offen sc1
    v_mfma_f32_16x16x32_bf16 v[156:159], a[188:191], v[88:91], v[156:159]
    v_lshlrev_b32 v240, 16, v40
    s_waitcnt vmcnt(5)
    v_mfma_f32_16x16x32_bf16 v[160:163], a[176:179], v[92:95], v[160:163]
    v_and_b32 v241, 0xffff0000, v40
    v_lshlrev_b32 v242, 16, v41
    v_mfma_f32_16x16x32_bf16 v[164:167], a[180:183], v[92:95], v[164:167]
    v_and_b32 v243, 0xffff0000, v41
    v_lshlrev_b32 v244, 16, v42
    v_mfma_f32_16x16x32_bf16 v[168:171], a[184:187], v[92:95], v[168:171]
    v_and_b32 v245, 0xffff0000, v42
    v_lshlrev_b32 v246, 16, v43
    v_mfma_f32_16x16x32_bf16 v[172:175], a[188:191], v[92:95], v[172:175]
    v_and_b32 v247, 0xffff0000, v43
    s_waitcnt vmcnt(4)
    v_mfma_f32_16x16x32_bf16 v[144:147], a[192:195], v[96:99], v[144:147]
    v_add_f32 v18, v240, v241
    v_mul_f32 v19, v240, v240
    v_mfma_f32_16x16x32_bf16 v[148:151], a[196:199], v[96:99], v[148:151]
    v_fmac_f32 v19, v241, v241
    v_add_f32 v18, v18, v242
    v_mfma_f32_16x16x32_bf16 v[152:155], a[200:203], v[96:99], v[152:155]
    v_fmac_f32 v19, v242, v242
    v_add_f32 v18, v18, v243
    v_mfma_f32_16x16x32_bf16 v[156:159], a[204:207], v[96:99], v[156:159]
    v_fmac_f32 v19, v243, v243
    s_waitcnt vmcnt(2)
    v_mfma_f32_16x16x32_bf16 v[144:147], a[208:211], v[104:107], v[144:147]
    v_xor_b32 v73, 64, v8
    v_xor_b32 v74, 128, v8
    v_xor_b32 v75, 192, v8
    v_mfma_f32_16x16x32_bf16 v[148:151], a[212:215], v[104:107], v[148:151]
    v_add_f32 v18, v18, v244
    v_fmac_f32 v19, v244, v244
    v_mfma_f32_16x16x32_bf16 v[152:155], a[216:219], v[104:107], v[152:155]
    v_add_f32 v18, v18, v245
    v_fmac_f32 v19, v245, v245
    v_mfma_f32_16x16x32_bf16 v[156:159], a[220:223], v[104:107], v[156:159]
    v_add_f32 v18, v18, v246
    v_mfma_f32_16x16x32_bf16 v[160:163], a[192:195], v[100:103], v[160:163]
    v_fmac_f32 v19, v246, v246
    v_add_f32 v18, v18, v247
    v_mfma_f32_16x16x32_bf16 v[164:167], a[196:199], v[100:103], v[164:167]
    v_fmac_f32 v19, v247, v247
    s_nop 1
    v_permlane32_swap_b32 v18, v19
    v_mfma_f32_16x16x32_bf16 v[168:171], a[200:203], v[100:103], v[168:171]
    ds_write_b128 v8, v[144:147]
    v_mfma_f32_16x16x32_bf16 v[172:175], a[204:207], v[100:103], v[172:175]
    ds_write_b128 v73, v[148:151]
    s_waitcnt vmcnt(1)
    v_mfma_f32_16x16x32_bf16 v[160:163], a[208:211], v[108:111], v[160:163]
    ds_write_b128 v74, v[152:155]
    v_mfma_f32_16x16x32_bf16 v[164:167], a[212:215], v[108:111], v[164:167]
    ds_write_b128 v75, v[156:159]
    v_mfma_f32_16x16x32_bf16 v[168:171], a[216:219], v[108:111], v[168:171]
    v_add_f32 v18, v18, v19
    v_mov_b32 v76, v18
    v_mfma_f32_16x16x32_bf16 v[172:175], a[220:223], v[108:111], v[172:175]
    s_nop 0
    v_permlane16_swap_b32 v18, v76
    v_add_f32 v18, v18, v76
    s_nop 1
    v_add_f32_dpp v18, v18, v18 row_ror:8 row_mask:0xf bank_mask:0xf
    v_mov_b32 v19, v18
    s_nop 1
    v_permlane32_swap_b32 v18, v19
    s_add_u32 s80, s5, 0x20000
    s_mov_b64 exec, 0xff
    s_cmp_eq_u32 s16, 0
    s_cbranch_scc1 L_ps_58
    buffer_store_dwordx2 v[18:19], v17, s[64:67], s80 offen
L_pb_59:
    s_mov_b64 exec, -1
    s_waitcnt vmcnt(1)
    s_cmp_eq_u32 s16, 0
    s_cbranch_scc1 L_ps_60
    buffer_store_dword v23, off, s[64:67], s12 offset:2048
L_pb_61:
    ds_write_b128 v8, v[160:163] offset:4096
    ds_write_b128 v73, v[164:167] offset:4096
    ds_write_b128 v74, v[168:171] offset:4096
    ds_write_b128 v75, v[172:175] offset:4096
    v_lshlrev_b32 v240, 16, v44
    v_and_b32 v241, 0xffff0000, v44
    v_lshlrev_b32 v242, 16, v45
    v_and_b32 v243, 0xffff0000, v45
    v_lshlrev_b32 v244, 16, v46
    v_and_b32 v245, 0xffff0000, v46
    v_lshlrev_b32 v246, 16, v47
    v_and_b32 v247, 0xffff0000, v47
    s_waitcnt lgkmcnt(0)
    s_barrier
    ds_read_b128 v[208:211], v9 offset:0
    ds_read_b128 v[212:215], v10 offset:0
    ds_read_b128 v[216:219], v9 offset:8192
    ds_read_b128 v[220:223], v10 offset:8192
    ds_read_b128 v[224:227], v9 offset:16384
    ds_read_b128 v[228:231], v10 offset:16384
    ds_read_b128 v[232:235], v9 offset:24576
    ds_read_b128 v[236:239], v10 offset:24576
    buffer_load_dword v16, v4, s[64:67], s13 offen offset:2048 sc1
    s_waitcnt lgkmcnt(7)
    v_pk_add_f32 v[240:241], v[240:241], v[208:209]
    v_pk_add_f32 v[242:243], v[242:243], v[210:211]
    s_waitcnt lgkmcnt(6)
    v_pk_add_f32 v[244:245], v[244:245], v[212:213]
    v_pk_add_f32 v[246:247], v[246:247], v[214:215]
    s_waitcnt lgkmcnt(5)
    v_pk_add_f32 v[240:241], v[240:241], v[216:217]
    v_pk_add_f32 v[242:243], v[242:243], v[218:219]
    s_waitcnt lgkmcnt(4)
    v_pk_add_f32 v[244:245], v[244:245], v[220:221]
    v_pk_add_f32 v[246:247], v[246:247], v[222:223]
    s_waitcnt lgkmcnt(3)
    v_pk_add_f32 v[240:241], v[240:241], v[224:225]
    v_pk_add_f32 v[242:243], v[242:243], v[226:227]
    s_waitcnt lgkmcnt(2)
    v_pk_add_f32 v[244:245], v[244:245], v[228:229]
    v_pk_add_f32 v[246:247], v[246:247], v[230:231]
    s_waitcnt lgkmcnt(1)
    v_pk_add_f32 v[240:241], v[240:241], v[232:233]
    v_pk_add_f32 v[242:243], v[242:243], v[234:235]
    s_waitcnt lgkmcnt(0)
    v_pk_add_f32 v[244:245], v[244:245], v[236:237]
    v_pk_add_f32 v[246:247], v[246:247], v[238:239]
    v_pk_add_f32 v[76:77], v[240:241], v[242:243]
    v_pk_mul_f32 v[56:57], v[240:241], v[240:241]
    v_pk_add_f32 v[76:77], v[76:77], v[244:245]
    v_pk_fma_f32 v[56:57], v[242:243], v[242:243], v[56:57]
    v_pk_add_f32 v[76:77], v[76:77], v[246:247]
    v_pk_fma_f32 v[56:57], v[244:245], v[244:245], v[56:57]
    v_pk_fma_f32 v[56:57], v[246:247], v[246:247], v[56:57]
    v_add_f32 v57, v56, v57
    v_add_f32 v56, v76, v77
    s_nop 1
    v_permlane32_swap_b32 v56, v57
    v_add_f32 v56, v56, v57
    v_mov_b32 v76, v56
    s_nop 1
    v_permlane16_swap_b32 v56, v76
    v_add_f32 v56, v56, v76
    s_nop 1
    v_add_f32_dpp v56, v56, v56 row_ror:8 row_mask:0xf bank_mask:0xf
    v_mov_b32 v57, v56
    s_nop 1
    v_permlane32_swap_b32 v56, v57
    s_mov_b64 exec, 0xff
    s_cmp_eq_u32 s16, 0
    s_cbranch_scc1 L_ps_62
    buffer_store_dwordx2 v[56:57], v17, s[64:67], s25 offen offset:2048
L_pb_63:
    s_mov_b64 exec, -1
    s_barrier
    s_waitcnt vmcnt(1)
    v_cmp_eq_u32 vcc, 0, v16
    s_cbranch_vccnz L_fs_64
L_fb_65:
    s_add_u32 s80, s8, 0x200000
    v_add_u32 v78, s80, v0
    buffer_load_dwordx4 v[112:115], v78, s[64:67], s32 offen offset:0 sc1
    buffer_load_dwordx4 v[116:119], v78, s[64:67], s32 offen offset:256 sc1
    buffer_load_dwordx4 v[120:123], v78, s[64:67], s32 offen offset:2048 sc1
    buffer_load_dwordx4 v[124:127], v78, s[64:67], s32 offen offset:2304 sc1
    buffer_load_dwordx4 v[128:131], v78, s[64:67], s33 offen offset:0 sc1
    ds_read_b128 a[224:227], v2 offset:0
    ds_read_b128 a[228:231], v3 offset:0
    ds_read_b128 a[232:235], v2 offset:1024
    ds_read_b128 a[236:239], v3 offset:1024
    ds_read_b128 a[240:243], v2 offset:2048
    ds_read_b128 a[244:247], v3 offset:2048
    ds_read_b128 a[248:251], v2 offset:3072
    ds_read_b128 a[252:255], v3 offset:3072
    s_waitcnt vmcnt(4) lgkmcnt(4)
    v_mfma_f32_16x16x32_bf16 v[144:147], a[224:227], v[112:115], 0
    buffer_load_dwordx4 v[132:135], v78, s[64:67], s33 offen offset:256 sc1
    v_mfma_f32_16x16x32_bf16 v[148:151], a[228:231], v[112:115], 0
    s_waitcnt vmcnt(4)
    v_mfma_f32_16x16x32_bf16 v[152:155], a[224:227], v[116:119], 0
    v_mfma_f32_16x16x32_bf16 v[156:159], a[228:231], v[116:119], 0
    v_mfma_f32_16x16x32_bf16 v[160:163], a[232:235], v[112:115], 0
    buffer_load_dwordx4 v[136:139], v78, s[64:67], s33 offen offset:2048 sc1
    buffer_load_dwordx2 v[56:57], v17, s[64:67], s6 offen offset:2048 sc1
    v_mfma_f32_16x16x32_bf16 v[164:167], a[236:239], v[112:115], 0
    v_mfma_f32_16x16x32_bf16 v[168:171], a[232:235], v[116:119], 0
    ds_read_b128 a[224:227], v2 offset:4096
    ds_read_b128 a[228:231], v3 offset:4096
    v_mfma_f32_16x16x32_bf16 v[172:175], a[236:239], v[116:119], 0
    s_waitcnt lgkmcnt(2)
    v_mfma_f32_16x16x32_bf16 v[176:179], a[240:243], v[112:115], 0
    buffer_load_dwordx4 v[140:143], v78, s[64:67], s33 offen offset:2304 sc1
    v_mfma_f32_16x16x32_bf16 v[180:183], a[244:247], v[112:115], 0
    v_mfma_f32_16x16x32_bf16 v[184:187], a[240:243], v[116:119], 0
    ds_read_b128 a[232:235], v2 offset:5120
    ds_read_b128 a[236:239], v3 offset:5120
    v_mfma_f32_16x16x32_bf16 v[188:191], a[244:247], v[116:119], 0
    v_mfma_f32_16x16x32_bf16 v[192:195], a[248:251], v[112:115], 0
    buffer_load_dwordx4 v[80:83], v78, s[64:67], s34 offen offset:0 sc1
    v_mfma_f32_16x16x32_bf16 v[196:199], a[252:255], v[112:115], 0
    v_mfma_f32_16x16x32_bf16 v[200:203], a[248:251], v[116:119], 0
    ds_read_b128 a[240:243], v2 offset:6144
    ds_read_b128 a[244:247], v3 offset:6144
    v_mfma_f32_16x16x32_bf16 v[204:207], a[252:255], v[116:119], 0
    s_waitcnt vmcnt(6) lgkmcnt(2)
    v_mfma_f32_16x16x32_bf16 v[144:147], a[224:227], v[120:123], v[144:147]
    buffer_load_dwordx4 v[84:87], v78, s[64:67], s34 offen offset:256 sc1
    v_mfma_f32_16x16x32_bf16 v[148:151], a[228:231], v[120:123], v[148:151]
    v_mfma_f32_16x16x32_bf16 v[152:155], a[224:227], v[124:127], v[152:155]
    ds_read_b128 a[248:251], v2 offset:7168
    ds_read_b128 a[252:255], v3 offset:7168
    v_mfma_f32_16x16x32_bf16 v[156:159], a[228:231], v[124:127], v[156:159]
    v_mfma_f32_16x16x32_bf16 v[160:163], a[232:235], v[120:123], v[160:163]
    buffer_load_dwordx4 v[88:91], v78, s[64:67], s34 offen offset:2048 sc1
    v_mfma_f32_16x16x32_bf16 v[164:167], a[236:239], v[120:123], v[164:167]
    v_mfma_f32_16x16x32_bf16 v[168:171], a[232:235], v[124:127], v[168:171]
    ds_read_b128 a[224:227], v2 offset:8192
    ds_read_b128 a[228:231], v3 offset:8192
    v_mfma_f32_16x16x32_bf16 v[172:175], a[236:239], v[124:127], v[172:175]
    s_add_u32 s46, s9, 0x20000
    buffer_load_dwordx2 v[64:65], v22, s[64:67], s46 offen offset:0 sc1
    s_waitcnt lgkmcnt(2)
    v_mfma_f32_16x16x32_bf16 v[176:179], a[240:243], v[120:123], v[176:179]
    buffer_load_dwordx4 v[92:95], v78, s[64:67], s34 offen offset:2304 sc1
    v_mfma_f32_16x16x32_bf16 v[180:183], a[244:247], v[120:123], v[180:183]
    buffer_load_dwordx2 v[66:67], v22, s[64:67], s46 offen offset:256 sc1
    v_mfma_f32_16x16x32_bf16 v[184:187], a[240:243], v[124:127], v[184:187]
    ds_read_b128 a[232:235], v2 offset:9216
    ds_read_b128 a[236:239], v3 offset:9216
    v_mfma_f32_16x16x32_bf16 v[188:191], a[244:247], v[124:127], v[188:191]
    buffer_load_dwordx2 v[68:69], v22, s[64:67], s46 offen offset:128 sc1
    v_mfma_f32_16x16x32_bf16 v[192:195], a[248:251], v[120:123], v[192:195]
    buffer_load_dwordx4 v[96:99], v78, s[64:67], s35 offen offset:0 sc1
    v_mfma_f32_16x16x32_bf16 v[196:199], a[252:255], v[120:123], v[196:199]
    buffer_load_dwordx2 v[70:71], v22, s[64:67], s46 offen offset:384 sc1
    v_mfma_f32_16x16x32_bf16 v[200:203], a[248:251], v[124:127], v[200:203]
    ds_read_b128 a[240:243], v2 offset:10240
    ds_read_b128 a[244:247], v3 offset:10240
    v_mfma_f32_16x16x32_bf16 v[204:207], a[252:255], v[124:127], v[204:207]
    s_waitcnt vmcnt(12) lgkmcnt(2)
    v_mfma_f32_16x16x32_bf16 v[144:147], a[224:227], v[128:131], v[144:147]
    buffer_load_dwordx4 v[100:103], v78, s[64:67], s35 offen offset:256 sc1
    v_mfma_f32_16x16x32_bf16 v[148:151], a[228:231], v[128:131], v[148:151]
    v_mfma_f32_16x16x32_bf16 v[152:155], a[224:227], v[132:135], v[152:155]
    ds_read_b128 a[248:251], v2 offset:11264
    ds_read_b128 a[252:255], v3 offset:11264
    v_mfma_f32_16x16x32_bf16 v[156:159], a[228:231], v[132:135], v[156:159]
    v_mfma_f32_16x16x32_bf16 v[160:163], a[232:235], v[128:131], v[160:163]
    buffer_load_dwordx4 v[104:107], v78, s[64:67], s35 offen offset:2048 sc1
    s_waitcnt vmcnt(12)
    v_cmp_eq_u32 vcc, 0xbf800000, v57
    s_cbranch_vccnz L_ss_66
L_sb_67:
    v_mfma_f32_16x16x32_bf16 v[164:167], a[236:239], v[128:131], v[164:167]
    v_permlane32_swap_b32 v56, v57
    v_add_f32 v56, v56, v57
    v_mov_b32 v76, v56
    s_nop 1
    v_permlane16_swap_b32 v56, v76
    v_mfma_f32_16x16x32_bf16 v[168:171], a[232:235], v[132:135], v[168:171]
    ds_read_b128 a[224:227], v2 offset:12288
    ds_read_b128 a[228:231], v3 offset:12288
    v_add_f32 v56, v56, v76
    s_nop 1
    v_add_f32_dpp v56, v56, v56 row_ror:8 row_mask:0xf bank_mask:0xf
    v_mfma_f32_16x16x32_bf16 v[172:175], a[236:239], v[132:135], v[172:175]
    v_mov_b32 v57, v56
    s_nop 1
    v_permlane32_swap_b32 v56, v57
    v_mul_f32 v56, 0x3b000000, v56
    s_waitcnt lgkmcnt(2)
    v_mfma_f32_16x16x32_bf16 v[176:179], a[240:243], v[128:131], v[176:179]
    buffer_load_dwordx4 v[108:111], v78, s[64:67], s35 offen offset:2304 sc1
    v_mul_f32 v57, 0x3b000000, v57
    v_lshlrev_b32 v248, 16, v52
    v_mfma_f32_16x16x32_bf16 v[180:183], a[244:247], v[128:131], v[180:183]
    v_and_b32 v249, 0xffff0000, v52
    v_fma_f32 v57, -v56, v56, v57
    v_lshlrev_b32 v250, 16, v53
    v_and_b32 v251, 0xffff0000, v53
    v_mfma_f32_16x16x32_bf16 v[184:187], a[240:243], v[132:135], v[184:187]
    ds_read_b128 a[232:235], v2 offset:13312
    ds_read_b128 a[236:239], v3 offset:13312
    v_max_f32 v57, 0, v57
    v_lshlrev_b32 v252, 16, v54
    v_mfma_f32_16x16x32_bf16 v[188:191], a[244:247], v[132:135], v[188:191]
    v_and_b32 v253, 0xffff0000, v54
    v_add_f32 v57, 0x3727c5ac, v57
    v_rsq_f32 v57, v57
    v_mfma_f32_16x16x32_bf16 v[192:195], a[248:251], v[128:131], v[192:195]
    buffer_load_dwordx4 v[112:115], v78, s[64:67], s36 offen offset:0 sc1
    v_lshlrev_b32 v254, 16, v55
    v_and_b32 v255, 0xffff0000, v55
    v_mfma_f32_16x16x32_bf16 v[196:199], a[252:255], v[128:131], v[196:199]
    v_mul_f32 v56, v56, v57
    v_fma_f32 v76, v240, v57, -v56
    v_fma_f32 v77, v241, v57, -v56
    v_fmac_f32 v240, v76, v248
    v_mfma_f32_16x16x32_bf16 v[200:203], a[248:251], v[132:135], v[200:203]
    ds_read_b128 a[240:243], v2 offset:14336
    ds_read_b128 a[244:247], v3 offset:14336
    v_fmac_f32 v241, v77, v249
    v_fma_f32 v76, v242, v57, -v56
    v_mfma_f32_16x16x32_bf16 v[204:207], a[252:255], v[132:135], v[204:207]
    v_fma_f32 v77, v243, v57, -v56
    v_fmac_f32 v242, v76, v250
    v_fmac_f32 v243, v77, v251
    s_waitcnt vmcnt(13) lgkmcnt(2)
    v_mfma_f32_16x16x32_bf16 v[144:147], a[224:227], v[136:139], v[144:147]
    buffer_load_dwordx4 v[116:119], v78, s[64:67], s36 offen offset:256 sc1
    v_fma_f32 v76, v244, v57, -v56
    v_fma_f32 v77, v245, v57, -v56
    v_mfma_f32_16x16x32_bf16 v[148:151], a[228:231], v[136:139], v[148:151]
    v_fmac_f32 v244, v76, v252
    v_fmac_f32 v245, v77, v253
    v_fma_f32 v76, v246, v57, -v56
    v_fma_f32 v77, v247, v57, -v56
    v_mfma_f32_16x16x32_bf16 v[152:155], a[224:227], v[140:143], v[152:155]
    ds_read_b128 a[248:251], v2 offset:15360
    ds_read_b128 a[252:255], v3 offset:15360
    v_fmac_f32 v246, v76, v254
    v_fmac_f32 v247, v77, v255
    v_mfma_f32_16x16x32_bf16 v[156:159], a[228:231], v[140:143], v[156:159]
    v_cvt_pk_bf16_f32 v44, v240, v241
    v_cvt_pk_bf16_f32 v45, v242, v243
    v_cvt_pk_bf16_f32 v46, v244, v245
    v_cvt_pk_bf16_f32 v47, v246, v247
    v_mfma_f32_16x16x32_bf16 v[160:163], a[232:235], v[136:139], v[160:163]
    buffer_load_dwordx4 v[120:123], v78, s[64:67], s36 offen offset:2048 sc1
    v_mfma_f32_16x16x32_bf16 v[164:167], a[236:239], v[136:139], v[164:167]
    s_add_u32 s81, s4, 0x208000
    buffer_store_dwordx4 v[44:47], v12, s[64:67], s81 offen sc1
    v_mfma_f32_16x16x32_bf16 v[168:171], a[232:235], v[140:143], v[168:171]
    ds_read_b128 a[224:227], v2 offset:16384
    ds_read_b128 a[228:231], v3 offset:16384
    v_lshlrev_b32 v240, 16, v44
    v_and_b32 v241, 0xffff0000, v44
    v_mfma_f32_16x16x32_bf16 v[172:175], a[236:239], v[140:143], v[172:175]
    v_lshlrev_b32 v242, 16, v45
    v_and_b32 v243, 0xffff0000, v45
    v_lshlrev_b32 v244, 16, v46
    s_waitcnt lgkmcnt(2)
    v_mfma_f32_16x16x32_bf16 v[176:179], a[240:243], v[136:139], v[176:179]
    buffer_load_dwordx4 v[124:127], v78, s[64:67], s36 offen offset:2304 sc1
    v_and_b32 v245, 0xffff0000, v46
    v_lshlrev_b32 v246, 16, v47
    v_mfma_f32_16x16x32_bf16 v[180:183], a[244:247], v[136:139], v[180:183]
    v_and_b32 v247, 0xffff0000, v47
    v_add_f32 v56, v240, v241
    v_mul_f32 v57, v240, v240
    v_fmac_f32 v57, v241, v241
    v_mfma_f32_16x16x32_bf16 v[184:187], a[240:243], v[140:143], v[184:187]
    ds_read_b128 a[232:235], v2 offset:17408
    ds_read_b128 a[236:239], v3 offset:17408
    v_add_f32 v56, v56, v242
    v_fmac_f32 v57, v242, v242
    v_mfma_f32_16x16x32_bf16 v[188:191], a[244:247], v[140:143], v[188:191]
    v_add_f32 v56, v56, v243
    v_fmac_f32 v57, v243, v243
    v_add_f32 v56, v56, v244
    v_fmac_f32 v57, v244, v244
    v_mfma_f32_16x16x32_bf16 v[192:195], a[248:251], v[136:139], v[192:195]
    buffer_load_dwordx4 v[128:131], v78, s[64:67], s37 offen offset:0 sc1
    v_add_f32 v56, v56, v245
    v_fmac_f32 v57, v245, v245
    v_mfma_f32_16x16x32_bf16 v[196:199], a[252:255], v[136:139], v[196:199]
    v_add_f32 v56, v56, v246
    v_fmac_f32 v57, v246, v246
    v_add_f32 v56, v56, v247
    v_fmac_f32 v57, v247, v247
    v_mfma_f32_16x16x32_bf16 v[200:203], a[248:251], v[140:143], v[200:203]
    ds_read_b128 a[240:243], v2 offset:18432
    ds_read_b128 a[244:247], v3 offset:18432
    v_permlane32_swap_b32 v56, v57
    v_add_f32 v56, v56, v57
    v_mfma_f32_16x16x32_bf16 v[204:207], a[252:255], v[140:143], v[204:207]
    v_mov_b32 v76, v56
    s_nop 1
    v_permlane16_swap_b32 v56, v76
    v_add_f32 v56, v56, v76
    s_waitcnt vmcnt(16) lgkmcnt(2)
    v_mfma_f32_16x16x32_bf16 v[144:147], a[224:227], v[80:83], v[144:147]
    buffer_load_dwordx4 v[132:135], v78, s[64:67], s37 offen offset:256 sc1
    v_add_f32_dpp v56, v56, v56 row_ror:8 row_mask:0xf bank_mask:0xf
    v_mov_b32 v57, v56
    v_mfma_f32_16x16x32_bf16 v[148:151], a[228:231], v[80:83], v[148:151]
    s_nop 0
    v_permlane32_swap_b32 v56, v57
    s_add_u32 s81, s5, 0x20800
    s_mov_b64 exec, 0xff
    s_cmp_eq_u32 s16, 0
    s_cbranch_scc1 L_ps_68
    buffer_store_dwordx2 v[56:57], v17, s[64:67], s81 offen
L_pb_69:
    s_mov_b64 exec, -1
    v_mfma_f32_16x16x32_bf16 v[152:155], a[224:227], v[84:87], v[152:155]
    ds_read_b128 a[248:251], v2 offset:19456
    ds_read_b128 a[252:255], v3 offset:19456
    v_mfma_f32_16x16x32_bf16 v[156:159], a[228:231], v[84:87], v[156:159]
    v_mfma_f32_16x16x32_bf16 v[160:163], a[232:235], v[80:83], v[160:163]
    buffer_load_dwordx4 v[136:139], v78, s[64:67], s37 offen offset:2048 sc1
    v_mfma_f32_16x16x32_bf16 v[164:167], a[236:239], v[80:83], v[164:167]
    s_waitcnt vmcnt(12)
    v_min3_i32 v72, v65, v67, v69
    v_mfma_f32_16x16x32_bf16 v[168:171], a[232:235], v[84:87], v[168:171]
    ds_read_b128 a[224:227], v2 offset:20480
    ds_read_b128 a[228:231], v3 offset:20480
    v_mfma_f32_16x16x32_bf16 v[172:175], a[236:239], v[84:87], v[172:175]
    v_min_i32 v72, v72, v71
    s_waitcnt lgkmcnt(2)
    v_mfma_f32_16x16x32_bf16 v[176:179], a[240:243], v[80:83], v[176:179]
    buffer_load_dwordx4 v[140:143], v78, s[64:67], s37 offen offset:2304 sc1
    v_mfma_f32_16x16x32_bf16 v[180:183], a[244:247], v[80:83], v[180:183]
    v_cmp_gt_i32 vcc, 0, v72
    s_cbranch_vccnz L_ts_70
L_tb_71:
    v_mfma_f32_16x16x32_bf16 v[184:187], a[240:243], v[84:87], v[184:187]
    ds_read_b128 a[232:235], v2 offset:21504
    ds_read_b128 a[236:239], v3 offset:21504
    v_mfma_f32_16x16x32_bf16 v[188:191], a[244:247], v[84:87], v[188:191]
    v_add_f32 v64, v64, v66
    v_add_f32 v68, v68, v70
    v_mfma_f32_16x16x32_bf16 v[192:195], a[248:251], v[80:83], v[192:195]
    v_add_f32 v65, v65, v67
    v_add_f32 v69, v69, v71
    v_mfma_f32_16x16x32_bf16 v[196:199], a[252:255], v[80:83], v[196:199]
    v_permlane32_swap_b32 v64, v68
    v_add_f32 v64, v64, v68
    v_mfma_f32_16x16x32_bf16 v[200:203], a[248:251], v[84:87], v[200:203]
    ds_read_b128 a[240:243], v2 offset:22528
    ds_read_b128 a[244:247], v3 offset:22528
    v_mfma_f32_16x16x32_bf16 v[204:207], a[252:255], v[84:87], v[204:207]
    v_permlane32_swap_b32 v65, v69
    s_waitcnt lgkmcnt(2)
    v_mfma_f32_16x16x32_bf16 v[144:147], a[224:227], v[88:91], v[144:147]
    buffer_load_dwordx4 v[80:83], v78, s[64:67], s38 offen offset:0 sc1
    v_mfma_f32_16x16x32_bf16 v[148:151], a[228:231], v[88:91], v[148:151]
    v_add_f32 v65, v65, v69
    s_nop 1
    v_permlane16_swap_b32 v64, v65
    v_mfma_f32_16x16x32_bf16 v[152:155], a[224:227], v[92:95], v[152:155]
    ds_read_b128 a[248:251], v2 offset:23552
    ds_read_b128 a[252:255], v3 offset:23552
    v_mfma_f32_16x16x32_bf16 v[156:159], a[228:231], v[92:95], v[156:159]
    v_add_f32 v64, v64, v65
    v_mul_f32 v64, 0x3b000000, v64
    v_mfma_f32_16x16x32_bf16 v[160:163], a[232:235], v[88:91], v[160:163]
    buffer_load_dwordx4 v[84:87], v78, s[64:67], s38 offen offset:256 sc1
    v_mfma_f32_16x16x32_bf16 v[164:167], a[236:239], v[88:91], v[164:167]
    v_mov_b32 v65, v64
    s_nop 1
    v_permlane16_swap_b32 v64, v65
    v_mfma_f32_16x16x32_bf16 v[168:171], a[232:235], v[92:95], v[168:171]
    ds_read_b128 a[224:227], v2 offset:24576
    ds_read_b128 a[228:231], v3 offset:24576
    v_mfma_f32_16x16x32_bf16 v[172:175], a[236:239], v[92:95], v[172:175]
    v_fma_f32 v65, -v64, v64, v65
    s_waitcnt lgkmcnt(2)
    v_mfma_f32_16x16x32_bf16 v[176:179], a[240:243], v[88:91], v[176:179]
    v_cvt_pk_bf16_f32 v37, v64, 0
    v_max_f32 v65, 0, v65
    v_mfma_f32_16x16x32_bf16 v[180:183], a[244:247], v[88:91], v[180:183]
    v_lshlrev_b32 v67, 16, v37
    v_add_f32 v19, 0x3727c5ac, v65
    v_mfma_f32_16x16x32_bf16 v[184:187], a[240:243], v[92:95], v[184:187]
    ds_read_b128 a[232:235], v2 offset:25600
    ds_read_b128 a[236:239], v3 offset:25600
    v_mfma_f32_16x16x32_bf16 v[188:191], a[244:247], v[92:95], v[188:191]
    v_sub_f32 v67, v64, v67
    v_cvt_pk_bf16_f32 v36, v64, v67
    v_mfma_f32_16x16x32_bf16 v[192:195], a[248:251], v[88:91], v[192:195]
    v_rsq_f32 v18, v19
    v_mfma_f32_16x16x32_bf16 v[196:199], a[252:255], v[88:91], v[196:199]
    v_mul_f32 v18, 0xbfb8aa3b, v18
    v_mov_b32 v21, v19
    v_mfma_f32_16x16x32_bf16 v[200:203], a[248:251], v[92:95], v[200:203]
    ds_read_b128 a[240:243], v2 offset:26624
    ds_read_b128 a[244:247], v3 offset:26624
    v_mfma_f32_16x16x32_bf16 v[204:207], a[252:255], v[92:95], v[204:207]
    v_mov_b32 v39, v37
    s_waitcnt vmcnt(14) lgkmcnt(2)
    v_mfma_f32_16x16x32_bf16 v[144:147], a[224:227], v[96:99], v[144:147]
    buffer_load_dwordx4 v[88:91], v78, s[64:67], s38 offen offset:2048 sc1
    v_mfma_f32_16x16x32_bf16 v[148:151], a[228:231], v[96:99], v[148:151]
    s_waitcnt vmcnt(9)
    s_cmp_eq_u32 s16, 0
    s_cbranch_scc1 L_ps_72
    buffer_store_dword v23, off, s[64:67], s12 offset:2304
L_pb_73:
    v_mfma_f32_16x16x32_bf16 v[152:155], a[224:227], v[100:103], v[152:155]
    ds_read_b128 a[248:251], v2 offset:27648
    ds_read_b128 a[252:255], v3 offset:27648
    v_mfma_f32_16x16x32_bf16 v[156:159], a[228:231], v[100:103], v[156:159]
    v_mov_b32 v38, v36
    v_mov_b32 v20, v18
    v_mfma_f32_16x16x32_bf16 v[160:163], a[232:235], v[96:99], v[160:163]
    buffer_load_dwordx4 v[92:95], v78, s[64:67], s38 offen offset:2304 sc1
    v_mfma_f32_16x16x32_bf16 v[164:167], a[236:239], v[96:99], v[164:167]
    v_permlane32_swap_b32 v19, v21
    v_permlane32_swap_b32 v37, v39
    v_mfma_f32_16x16x32_bf16 v[168:171], a[232:235], v[100:103], v[168:171]
    ds_read_b128 a[224:227], v2 offset:28672
    ds_read_b128 a[228:231], v3 offset:28672
    v_mfma_f32_16x16x32_bf16 v[172:175], a[236:239], v[100:103], v[172:175]
    v_permlane32_swap_b32 v36, v38
    s_waitcnt lgkmcnt(2)
    v_mfma_f32_16x16x32_bf16 v[176:179], a[240:243], v[96:99], v[176:179]
    v_permlane32_swap_b32 v18, v20
    s_lshl_b64 s[40:41], s[44:45], 0
    v_mfma_f32_16x16x32_bf16 v[180:183], a[244:247], v[96:99], v[180:183]
    v_cndmask_b32 v24, 0, v36, s[40:41]
    v_cndmask_b32 v25, 0, v37, s[40:41]
    v_mfma_f32_16x16x32_bf16 v[184:187], a[240:243], v[100:103], v[184:187]
    ds_read_b128 a[232:235], v2 offset:29696
    ds_read_b128 a[236:239], v3 offset:29696
    v_mfma_f32_16x16x32_bf16 v[188:191], a[244:247], v[100:103], v[188:191]
    v_cndmask_b32 v26, 0, v38, s[40:41]
    v_cndmask_b32 v27, 0, v39, s[40:41]
    v_mfma_f32_16x16x32_bf16 v[192:195], a[248:251], v[96:99], v[192:195]
    v_mfma_f32_16x16x32_bf16 v[196:199], a[252:255], v[96:99], v[196:199]
    v_mfma_f32_16x16x32_bf16 v[200:203], a[248:251], v[100:103], v[200:203]
    ds_read_b128 a[240:243], v2 offset:30720
    ds_read_b128 a[244:247], v3 offset:30720
    v_mfma_f32_16x16x32_bf16 v[204:207], a[252:255], v[100:103], v[204:207]
    s_waitcnt lgkmcnt(2)
    v_mfma_f32_16x16x32_bf16 v[144:147], a[224:227], v[104:107], v[144:147]
    buffer_load_dwordx4 v[96:99], v78, s[64:67], s39 offen offset:0 sc1
    v_mfma_f32_16x16x32_bf16 v[148:151], a[228:231], v[104:107], v[148:151]
    v_mfma_f32_16x16x32_bf16 v[152:155], a[224:227], v[108:111], v[152:155]
    ds_read_b128 a[248:251], v2 offset:31744
    ds_read_b128 a[252:255], v3 offset:31744
    v_mfma_f32_16x16x32_bf16 v[156:159], a[228:231], v[108:111], v[156:159]
    v_mfma_f32_16x16x32_bf16 v[160:163], a[232:235], v[104:107], v[160:163]
    buffer_load_dwordx4 v[100:103], v78, s[64:67], s39 offen offset:256 sc1
    v_mfma_f32_16x16x32_bf16 v[164:167], a[236:239], v[104:107], v[164:167]
    v_mfma_f32_16x16x32_bf16 v[168:171], a[232:235], v[108:111], v[168:171]
    ds_read_b128 a[224:227], v2 offset:32768
    ds_read_b128 a[228:231], v3 offset:32768
    v_mfma_f32_16x16x32_bf16 v[172:175], a[236:239], v[108:111], v[172:175]
    s_waitcnt lgkmcnt(2)
    v_mfma_f32_16x16x32_bf16 v[176:179], a[240:243], v[104:107], v[176:179]
    v_mfma_f32_16x16x32_bf16 v[180:183], a[244:247], v[104:107], v[180:183]
    v_mfma_f32_16x16x32_bf16 v[184:187], a[240:243], v[108:111], v[184:187]
    ds_read_b128 a[232:235], v2 offset:33792
    ds_read_b128 a[236:239], v3 offset:33792
    v_mfma_f32_16x16x32_bf16 v[188:191], a[244:247], v[108:111], v[188:191]
    v_mfma_f32_16x16x32_bf16 v[192:195], a[248:251], v[104:107], v[192:195]
    v_mfma_f32_16x16x32_bf16 v[196:199], a[252:255], v[104:107], v[196:199]
    v_mfma_f32_16x16x32_bf16 v[200:203], a[248:251], v[108:111], v[200:203]
    ds_read_b128 a[240:243], v2 offset:34816
    ds_read_b128 a[244:247], v3 offset:34816
    v_mfma_f32_16x16x32_bf16 v[204:207], a[252:255], v[108:111], v[204:207]
    s_waitcnt lgkmcnt(2)
    v_mfma_f32_16x16x32_bf16 v[144:147], a[224:227], v[112:115], v[144:147]
    buffer_load_dwordx4 v[104:107], v78, s[64:67], s39 offen offset:2048 sc1
    v_mfma_f32_16x16x32_bf16 v[148:151], a[228:231], v[112:115], v[148:151]
    v_mfma_f32_16x16x32_bf16 v[152:155], a[224:227], v[116:119], v[152:155]
    ds_read_b128 a[248:251], v2 offset:35840
    ds_read_b128 a[252:255], v3 offset:35840
    v_mfma_f32_16x16x32_bf16 v[156:159], a[228:231], v[116:119], v[156:159]
    v_mfma_f32_16x16x32_bf16 v[160:163], a[232:235], v[112:115], v[160:163]
    buffer_load_dwordx4 v[108:111], v78, s[64:67], s39 offen offset:2304 sc1
    v_mfma_f32_16x16x32_bf16 v[164:167], a[236:239], v[112:115], v[164:167]
    v_mfma_f32_16x16x32_bf16 v[168:171], a[232:235], v[116:119], v[168:171]
    ds_read_b128 a[224:227], v2 offset:36864
    ds_read_b128 a[228:231], v3 offset:36864
    v_mfma_f32_16x16x32_bf16 v[172:175], a[236:239], v[116:119], v[172:175]
    s_waitcnt lgkmcnt(2)
    v_mfma_f32_16x16x32_bf16 v[176:179], a[240:243], v[112:115], v[176:179]
    v_mfma_f32_16x16x32_bf16 v[180:183], a[244:247], v[112:115], v[180:183]
    v_mfma_f32_16x16x32_bf16 v[184:187], a[240:243], v[116:119], v[184:187]
    ds_read_b128 a[232:235], v2 offset:37888
    ds_read_b128 a[236:239], v3 offset:37888
    v_mfma_f32_16x16x32_bf16 v[188:191], a[244:247], v[116:119], v[188:191]
    v_mfma_f32_16x16x32_bf16 v[192:195], a[248:251], v[112:115], v[192:195]
    v_mfma_f32_16x16x32_bf16 v[196:199], a[252:255], v[112:115], v[196:199]
    v_mfma_f32_16x16x32_bf16 v[200:203], a[248:251], v[116:119], v[200:203]
    ds_read_b128 a[240:243], v2 offset:38912
    ds_read_b128 a[244:247], v3 offset:38912
    v_mfma_f32_16x16x32_bf16 v[204:207], a[252:255], v[116:119], v[204:207]
    s_waitcnt vmcnt(14) lgkmcnt(2)
    v_mfma_f32_16x16x32_bf16 v[144:147], a[224:227], v[120:123], v[144:147]
    v_mfma_f32_16x16x32_bf16 v[148:151], a[228:231], v[120:123], v[148:151]
    v_mfma_f32_16x16x32_bf16 v[152:155], a[224:227], v[124:127], v[152:155]
    ds_read_b128 a[248:251], v2 offset:39936
    ds_read_b128 a[252:255], v3 offset:39936
    v_mfma_f32_16x16x32_bf16 v[156:159], a[228:231], v[124:127], v[156:159]
    v_mfma_f32_16x16x32_bf16 v[160:163], a[232:235], v[120:123], v[160:163]
    v_mfma_f32_16x16x32_bf16 v[164:167], a[236:239], v[120:123], v[164:167]
    buffer_load_dword v16, v4, s[64:67], s13 offen offset:2304 sc1
    v_mfma_f32_16x16x32_bf16 v[168:171], a[232:235], v[124:127], v[168:171]
    ds_read_b128 a[224:227], v2 offset:40960
    ds_read_b128 a[228:231], v3 offset:40960
    v_mfma_f32_16x16x32_bf16 v[172:175], a[236:239], v[124:127], v[172:175]
    s_waitcnt lgkmcnt(2)
    v_mfma_f32_16x16x32_bf16 v[176:179], a[240:243], v[120:123], v[176:179]
    v_mfma_f32_16x16x32_bf16 v[180:183], a[244:247], v[120:123], v[180:183]
    v_mfma_f32_16x16x32_bf16 v[184:187], a[240:243], v[124:127], v[184:187]
    ds_read_b128 a[232:235], v2 offset:41984
    ds_read_b128 a[236:239], v3 offset:41984
    v_mfma_f32_16x16x32_bf16 v[188:191], a[244:247], v[124:127], v[188:191]
    v_mfma_f32_16x16x32_bf16 v[192:195], a[248:251], v[120:123], v[192:195]
    v_mfma_f32_16x16x32_bf16 v[196:199], a[252:255], v[120:123], v[196:199]
    v_mfma_f32_16x16x32_bf16 v[200:203], a[248:251], v[124:127], v[200:203]
    ds_read_b128 a[240:243], v2 offset:43008
    ds_read_b128 a[244:247], v3 offset:43008
    v_mfma_f32_16x16x32_bf16 v[204:207], a[252:255], v[124:127], v[204:207]
    s_waitcnt vmcnt(13) lgkmcnt(2)
    v_mfma_f32_16x16x32_bf16 v[144:147], a[224:227], v[128:131], v[144:147]
    v_mfma_f32_16x16x32_bf16 v[148:151], a[228:231], v[128:131], v[148:151]
    v_mfma_f32_16x16x32_bf16 v[152:155], a[224:227], v[132:135], v[152:155]
    ds_read_b128 a[248:251], v2 offset:44032
    ds_read_b128 a[252:255], v3 offset:44032
    v_mfma_f32_16x16x32_bf16 v[156:159], a[228:231], v[132:135], v[156:159]
    v_mfma_f32_16x16x32_bf16 v[160:163], a[232:235], v[128:131], v[160:163]
    v_mfma_f32_16x16x32_bf16 v[164:167], a[236:239], v[128:131], v[164:167]
    v_mfma_f32_16x16x32_bf16 v[168:171], a[232:235], v[132:135], v[168:171]
    ds_read_b128 a[224:227], v2 offset:45056
    ds_read_b128 a[228:231], v3 offset:45056
    v_mfma_f32_16x16x32_bf16 v[172:175], a[236:239], v[132:135], v[172:175]
    s_waitcnt lgkmcnt(2)
    v_mfma_f32_16x16x32_bf16 v[176:179], a[240:243], v[128:131], v[176:179]
    v_mfma_f32_16x16x32_bf16 v[180:183], a[244:247], v[128:131], v[180:183]
    s_waitcnt vmcnt(0)
    v_cmp_eq_u32 vcc, 0, v16
    s_cbranch_vccnz L_fs_74
L_fb_75:
    s_add_u32 s80, s8, 0x208000
    v_add_u32 v79, s80, v0
    buffer_load_dwordx4 v[112:115], v79, s[64:67], s32 offen offset:0 sc1
    v_mfma_f32_16x16x32_bf16 v[184:187], a[240:243], v[132:135], v[184:187]
    ds_read_b128 a[232:235], v2 offset:49152
    ds_read_b128 a[236:239], v3 offset:49152
    v_mfma_f32_16x16x32_bf16 v[188:191], a[244:247], v[132:135], v[188:191]
    v_mfma_f32_16x16x32_bf16 v[192:195], a[248:251], v[128:131], v[192:195]
    v_mfma_f32_16x16x32_bf16 v[196:199], a[252:255], v[128:131], v[196:199]
    buffer_load_dwordx4 v[116:119], v79, s[64:67], s32 offen offset:256 sc1
    v_mfma_f32_16x16x32_bf16 v[200:203], a[248:251], v[132:135], v[200:203]
    ds_read_b128 a[240:243], v2 offset:53248
    ds_read_b128 a[244:247], v3 offset:53248
    v_mfma_f32_16x16x32_bf16 v[204:207], a[252:255], v[132:135], v[204:207]
    s_waitcnt lgkmcnt(2)
    v_mfma_f32_16x16x32_bf16 v[144:147], a[224:227], v[136:139], v[144:147]
    v_mfma_f32_16x16x32_bf16 v[148:151], a[228:231], v[136:139], v[148:151]
    buffer_load_dwordx4 v[120:123], v79, s[64:67], s32 offen offset:2048 sc1
    v_mfma_f32_16x16x32_bf16 v[152:155], a[224:227], v[140:143], v[152:155]
    ds_read_b128 a[248:251], v2 offset:57344
    ds_read_b128 a[252:255], v3 offset:57344
    v_mfma_f32_16x16x32_bf16 v[156:159], a[228:231], v[140:143], v[156:159]
    v_mfma_f32_16x16x32_bf16 v[144:147], a[232:235], v[80:83], v[144:147]
    v_mfma_f32_16x16x32_bf16 v[148:151], a[236:239], v[80:83], v[148:151]
    buffer_load_dwordx4 v[124:127], v79, s[64:67], s32 offen offset:2304 sc1
    v_mfma_f32_16x16x32_bf16 v[152:155], a[232:235], v[84:87], v[152:155]
    ds_read_b128 a[224:227], v2 offset:61440
    ds_read_b128 a[228:231], v3 offset:61440
    v_mfma_f32_16x16x32_bf16 v[156:159], a[236:239], v[84:87], v[156:159]
    s_waitcnt lgkmcnt(2)
    v_mfma_f32_16x16x32_bf16 v[144:147], a[240:243], v[88:91], v[144:147]
    v_mfma_f32_16x16x32_bf16 v[148:151], a[244:247], v[88:91], v[148:151]
    buffer_load_dwordx4 v[128:131], v79, s[64:67], s33 offen offset:0 sc1
    v_mfma_f32_16x16x32_bf16 v[152:155], a[240:243], v[92:95], v[152:155]
    ds_read_b128 a[232:235], v2 offset:46080
    ds_read_b128 a[236:239], v3 offset:46080
    v_mfma_f32_16x16x32_bf16 v[156:159], a[244:247], v[92:95], v[156:159]
    v_mfma_f32_16x16x32_bf16 v[144:147], a[248:251], v[96:99], v[144:147]
    v_mfma_f32_16x16x32_bf16 v[148:151], a[252:255], v[96:99], v[148:151]
    buffer_load_dwordx4 v[132:135], v79, s[64:67], s33 offen offset:256 sc1
    v_mfma_f32_16x16x32_bf16 v[152:155], a[248:251], v[100:103], v[152:155]
    ds_read_b128 a[240:243], v2 offset:50176
    ds_read_b128 a[244:247], v3 offset:50176
    v_mfma_f32_16x16x32_bf16 v[156:159], a[252:255], v[100:103], v[156:159]
    s_waitcnt lgkmcnt(2)
    v_mfma_f32_16x16x32_bf16 v[144:147], a[224:227], v[104:107], v[144:147]
    v_mfma_f32_16x16x32_bf16 v[148:151], a[228:231], v[104:107], v[148:151]
    v_mfma_f32_16x16x32_bf16 v[152:155], a[224:227], v[108:111], v[152:155]
    ds_read_b128 a[248:251], v2 offset:54272
    ds_read_b128 a[252:255], v3 offset:54272
    v_mfma_f32_16x16x32_bf16 v[156:159], a[228:231], v[108:111], v[156:159]
    v_mfma_f32_16x16x32_bf16 v[144:147], v[28:31], v[24:27], v[144:147]
    v_mfma_f32_16x16x32_bf16 v[148:151], v[32:35], v[24:27], v[148:151]
    v_mfma_f32_16x16x32_bf16 v[152:155], v[28:31], v[26:29], v[152:155]
    v_mfma_f32_16x16x32_bf16 v[156:159], v[32:35], v[26:29], v[156:159]
    v_mfma_f32_16x16x32_bf16 v[160:163], a[232:235], v[136:139], v[160:163]
    v_mfma_f32_16x16x32_bf16 v[164:167], a[236:239], v[136:139], v[164:167]
    s_lshl_b64 s[40:41], s[44:45], 16
    v_cndmask_b32 v24, 0, v36, s[40:41]
    v_cndmask_b32 v25, 0, v37, s[40:41]
    v_cndmask_b32 v26, 0, v38, s[40:41]
    v_mfma_f32_16x16x32_bf16 v[168:171], a[232:235], v[140:143], v[168:171]
    ds_read_b128 a[224:227], v2 offset:58368
    ds_read_b128 a[228:231], v3 offset:58368
    v_cndmask_b32 v27, 0, v39, s[40:41]
    v_mfma_f32_16x16x32_bf16 v[172:175], a[236:239], v[140:143], v[172:175]
    s_waitcnt lgkmcnt(2)
    v_mfma_f32_16x16x32_bf16 v[160:163], a[240:243], v[80:83], v[160:163]
    v_mfma_f32_16x16x32_bf16 v[164:167], a[244:247], v[80:83], v[164:167]
    v_mfma_f32_16x16x32_bf16 v[168:171], a[240:243], v[84:87], v[168:171]
    ds_read_b128 a[232:235], v2 offset:62464
    ds_read_b128 a[236:239], v3 offset:62464
    v_mfma_f32_16x16x32_bf16 v[172:175], a[244:247], v[84:87], v[172:175]
    s_add_u32 s96, s10, 0x700000
    v_mul_f32 v148, v144, v148
    v_mul_f32 v144, v18, v144
    v_mul_f32 v149, v145, v149
    v_mfma_f32_16x16x32_bf16 v[160:163], a[248:251], v[88:91], v[160:163]
    v_mul_f32 v145, v18, v145
    v_exp_f32 v144, v144
    v_mfma_f32_16x16x32_bf16 v[164:167], a[252:255], v[88:91], v[164:167]
    v_mul_f32 v150, v146, v150
    v_mul_f32 v146, v18, v146
    v_exp_f32 v145, v145
    v_mfma_f32_16x16x32_bf16 v[168:171], a[248:251], v[92:95], v[168:171]
    ds_read_b128 a[240:243], v2 offset:47104
    ds_read_b128 a[244:247], v3 offset:47104
    v_fma_f32 v144, v144, v19, v19
    v_mfma_f32_16x16x32_bf16 v[172:175], a[252:255], v[92:95], v[172:175]
    v_mul_f32 v151, v147, v151
    v_mul_f32 v147, v18, v147
    v_fma_f32 v145, v145, v19, v19
    s_waitcnt lgkmcnt(2)
    v_mfma_f32_16x16x32_bf16 v[160:163], a[224:227], v[96:99], v[160:163]
    v_exp_f32 v146, v146
    v_mul_f32 v156, v152, v156
    v_mfma_f32_16x16x32_bf16 v[164:167], a[228:231], v[96:99], v[164:167]
    v_rcp_f32 v144, v144
    v_mul_f32 v152, v20, v152
    v_fma_f32 v146, v146, v19, v19
    v_mfma_f32_16x16x32_bf16 v[168:171], a[224:227], v[100:103], v[168:171]
    ds_read_b128 a[248:251], v2 offset:51200
    ds_read_b128 a[252:255], v3 offset:51200
    v_mfma_f32_16x16x32_bf16 v[172:175], a[228:231], v[100:103], v[172:175]
    v_exp_f32 v147, v147
    v_rcp_f32 v145, v145
    v_mfma_f32_16x16x32_bf16 v[160:163], a[232:235], v[104:107], v[160:163]
    v_mul_f32 v148, v148, v144
    v_mul_f32 v157, v153, v157
    v_mul_f32 v153, v20, v153
    v_mfma_f32_16x16x32_bf16 v[164:167], a[236:239], v[104:107], v[164:167]
    v_exp_f32 v152, v152
    v_fma_f32 v147, v147, v19, v19
    v_mul_f32 v149, v149, v145
    v_mfma_f32_16x16x32_bf16 v[168:171], a[232:235], v[108:111], v[168:171]
    ds_read_b128 a[224:227], v2 offset:55296
    ds_read_b128 a[228:231], v3 offset:55296
    v_mul_f32 v158, v154, v158
    v_mfma_f32_16x16x32_bf16 v[172:175], a[236:239], v[108:111], v[172:175]
    v_rcp_f32 v146, v146
    v_mul_f32 v154, v20, v154
    v_mfma_f32_16x16x32_bf16 v[160:163], v[28:31], v[24:27], v[160:163]
    v_exp_f32 v153, v153
    v_fma_f32 v152, v152, v21, v21
    v_mfma_f32_16x16x32_bf16 v[164:167], v[32:35], v[24:27], v[164:167]
    v_rcp_f32 v147, v147
    v_mul_f32 v150, v150, v146
    v_cvt_pk_bf16_f32 v144, v148, v149
    v_mfma_f32_16x16x32_bf16 v[168:171], v[28:31], v[26:29], v[168:171]
    v_mul_f32 v159, v155, v159
    v_mul_f32 v155, v20, v155
    v_fma_f32 v153, v153, v21, v21
    v_mfma_f32_16x16x32_bf16 v[172:175], v[32:35], v[26:29], v[172:175]
    v_exp_f32 v154, v154
    v_rcp_f32 v152, v152
    s_waitcnt lgkmcnt(2)
    v_mfma_f32_16x16x32_bf16 v[176:179], a[240:243], v[136:139], v[176:179]
    v_mul_f32 v151, v151, v147
    v_exp_f32 v155, v155
    v_mfma_f32_16x16x32_bf16 v[180:183], a[244:247], v[136:139], v[180:183]
    s_lshl_b64 s[40:41], s[44:45], 32
    v_cndmask_b32 v24, 0, v36, s[40:41]
    v_cndmask_b32 v25, 0, v37, s[40:41]
    v_cndmask_b32 v26, 0, v38, s[40:41]
    v_mfma_f32_16x16x32_bf16 v[184:187], a[240:243], v[140:143], v[184:187]
    ds_read_b128 a[232:235], v2 offset:59392
    ds_read_b128 a[236:239], v3 offset:59392
    v_cndmask_b32 v27, 0, v39, s[40:41]
    v_mfma_f32_16x16x32_bf16 v[188:191], a[244:247], v[140:143], v[188:191]
    v_fma_f32 v154, v154, v21, v21
    v_rcp_f32 v153, v153
    v_mul_f32 v156, v156, v152
    v_mfma_f32_16x16x32_bf16 v[176:179], a[248:251], v[80:83], v[176:179]
    v_cvt_pk_bf16_f32 v145, v150, v151
    v_fma_f32 v155, v155, v21, v21
    v_mul_f32 v157, v157, v153
    v_mfma_f32_16x16x32_bf16 v[180:183], a[252:255], v[80:83], v[180:183]
    v_rcp_f32 v154, v154
    v_rcp_f32 v155, v155
    v_mfma_f32_16x16x32_bf16 v[184:187], a[248:251], v[84:87], v[184:187]
    ds_read_b128 a[240:243], v2 offset:63488
    ds_read_b128 a[244:247], v3 offset:63488
    v_mul_f32 v158, v158, v154
    v_mfma_f32_16x16x32_bf16 v[188:191], a[252:255], v[84:87], v[188:191]
    v_cvt_pk_bf16_f32 v146, v156, v157
    v_mul_f32 v159, v159, v155
    v_cvt_pk_bf16_f32 v147, v158, v159
    s_waitcnt lgkmcnt(2)
    v_mfma_f32_16x16x32_bf16 v[176:179], a[224:227], v[88:91], v[176:179]
    v_permlane16_swap_b32 v144, v146
    v_permlane16_swap_b32 v145, v147
    v_mfma_f32_16x16x32_bf16 v[180:183], a[228:231], v[88:91], v[180:183]
    buffer_store_dwordx4 v[144:147], v2, s[64:67], s96 offen sc1
    v_mfma_f32_16x16x32_bf16 v[184:187], a[224:227], v[92:95], v[184:187]
    ds_read_b128 a[248:251], v2 offset:48128
    ds_read_b128 a[252:255], v3 offset:48128
    v_mfma_f32_16x16x32_bf16 v[188:191], a[228:231], v[92:95], v[188:191]
    s_add_u32 s97, s10, 0x700400
    v_mul_f32 v164, v160, v164
    v_mul_f32 v160, v18, v160
    v_mul_f32 v165, v161, v165
    v_mfma_f32_16x16x32_bf16 v[176:179], a[232:235], v[96:99], v[176:179]
    v_mul_f32 v161, v18, v161
    v_exp_f32 v160, v160
    v_mfma_f32_16x16x32_bf16 v[180:183], a[236:239], v[96:99], v[180:183]
    v_mul_f32 v166, v162, v166
    v_mul_f32 v162, v18, v162
    v_exp_f32 v161, v161
    v_mfma_f32_16x16x32_bf16 v[184:187], a[232:235], v[100:103], v[184:187]
    ds_read_b128 a[224:227], v2 offset:52224
    ds_read_b128 a[228:231], v3 offset:52224
    v_fma_f32 v160, v160, v19, v19
    v_mfma_f32_16x16x32_bf16 v[188:191], a[236:239], v[100:103], v[188:191]
    v_mul_f32 v167, v163, v167
    v_mul_f32 v163, v18, v163
    v_fma_f32 v161, v161, v19, v19
    s_waitcnt lgkmcnt(2)
    v_mfma_f32_16x16x32_bf16 v[176:179], a[240:243], v[104:107], v[176:179]
    v_exp_f32 v162, v162
    v_mul_f32 v172, v168, v172
    v_mfma_f32_16x16x32_bf16 v[180:183], a[244:247], v[104:107], v[180:183]
    v_rcp_f32 v160, v160
    v_mul_f32 v168, v20, v168
    v_fma_f32 v162, v162, v19, v19
    v_mfma_f32_16x16x32_bf16 v[184:187], a[240:243], v[108:111], v[184:187]
    ds_read_b128 a[232:235], v2 offset:56320
    ds_read_b128 a[236:239], v3 offset:56320
    v_mfma_f32_16x16x32_bf16 v[188:191], a[244:247], v[108:111], v[188:191]
    v_exp_f32 v163, v163
    v_rcp_f32 v161, v161
    v_mfma_f32_16x16x32_bf16 v[176:179], v[28:31], v[24:27], v[176:179]
    v_mul_f32 v164, v164, v160
    v_mul_f32 v173, v169, v173
    v_mul_f32 v169, v20, v169
    v_mfma_f32_16x16x32_bf16 v[180:183], v[32:35], v[24:27], v[180:183]
    v_exp_f32 v168, v168
    v_fma_f32 v163, v163, v19, v19
    v_mul_f32 v165, v165, v161
    v_mfma_f32_16x16x32_bf16 v[184:187], v[28:31], v[26:29], v[184:187]
    v_rcp_f32 v162, v162
    v_mul_f32 v174, v170, v174
    v_mfma_f32_16x16x32_bf16 v[188:191], v[32:35], v[26:29], v[188:191]
    v_mul_f32 v170, v20, v170
    v_exp_f32 v169, v169
    v_fma_f32 v168, v168, v21, v21
    v_mfma_f32_16x16x32_bf16 v[192:195], a[248:251], v[136:139], v[192:195]
    v_rcp_f32 v163, v163
    v_mul_f32 v166, v166, v162
    v_mfma_f32_16x16x32_bf16 v[196:199], a[252:255], v[136:139], v[196:199]
    s_lshl_b64 s[40:41], s[44:45], 48
    v_cndmask_b32 v24, 0, v36, s[40:41]
    v_cndmask_b32 v25, 0, v37, s[40:41]
    v_cndmask_b32 v26, 0, v38, s[40:41]
    v_mfma_f32_16x16x32_bf16 v[200:203], a[248:251], v[140:143], v[200:203]
    ds_read_b128 a[240:243], v2 offset:60416
    ds_read_b128 a[244:247], v3 offset:60416
    v_cndmask_b32 v27, 0, v39, s[40:41]
    v_mfma_f32_16x16x32_bf16 v[204:207], a[252:255], v[140:143], v[204:207]
    v_cvt_pk_bf16_f32 v160, v164, v165
    v_mul_f32 v175, v171, v175
    v_mul_f32 v171, v20, v171
    s_waitcnt lgkmcnt(2)
    v_mfma_f32_16x16x32_bf16 v[192:195], a[224:227], v[80:83], v[192:195]
    buffer_load_dwordx4 v[136:139], v79, s[64:67], s33 offen offset:2048 sc1
    v_fma_f32 v169, v169, v21, v21
    v_mfma_f32_16x16x32_bf16 v[196:199], a[228:231], v[80:83], v[196:199]
    v_exp_f32 v170, v170
    v_rcp_f32 v168, v168
    v_mfma_f32_16x16x32_bf16 v[200:203], a[224:227], v[84:87], v[200:203]
    ds_read_b128 a[248:251], v2 offset:64512
    ds_read_b128 a[252:255], v3 offset:64512
    v_mul_f32 v167, v167, v163
    v_mfma_f32_16x16x32_bf16 v[204:207], a[228:231], v[84:87], v[204:207]
    v_exp_f32 v171, v171
    v_fma_f32 v170, v170, v21, v21
    v_mul_f32 v172, v172, v168
    v_mfma_f32_16x16x32_bf16 v[192:195], a[232:235], v[88:91], v[192:195]
    buffer_load_dwordx4 v[140:143], v79, s[64:67], s33 offen offset:2304 sc1
    v_cvt_pk_bf16_f32 v161, v166, v167
    v_mfma_f32_16x16x32_bf16 v[196:199], a[236:239], v[88:91], v[196:199]
    v_rcp_f32 v169, v169
    v_fma_f32 v171, v171, v21, v21
    v_mul_f32 v173, v173, v169
    v_mfma_f32_16x16x32_bf16 v[200:203], a[232:235], v[92:95], v[200:203]
    ds_read_b128 a[224:227], v2 offset:0
    ds_read_b128 a[228:231], v3 offset:0
    v_mfma_f32_16x16x32_bf16 v[204:207], a[236:239], v[92:95], v[204:207]
    v_rcp_f32 v170, v170
    s_nop 0
    v_mul_f32 v174, v174, v170
    s_waitcnt lgkmcnt(2)
    v_mfma_f32_16x16x32_bf16 v[192:195], a[240:243], v[96:99], v[192:195]
    buffer_load_dwordx4 v[80:83], v79, s[64:67], s34 offen offset:0 sc1
    v_cvt_pk_bf16_f32 v162, v172, v173
    v_mfma_f32_16x16x32_bf16 v[196:199], a[244:247], v[96:99], v[196:199]
    v_rcp_f32 v171, v171
    s_nop 0
    v_mul_f32 v175, v175, v171
    v_cvt_pk_bf16_f32 v163, v174, v175
    v_mfma_f32_16x16x32_bf16 v[200:203], a[240:243], v[100:103], v[200:203]
    ds_read_b128 a[232:235], v2 offset:1024
    ds_read_b128 a[236:239], v3 offset:1024
    v_permlane16_swap_b32 v160, v162
    v_mfma_f32_16x16x32_bf16 v[204:207], a[244:247], v[100:103], v[204:207]
    v_permlane16_swap_b32 v161, v163
    buffer_store_dwordx4 v[160:163], v2, s[64:67], s97 offen sc1
    v_mfma_f32_16x16x32_bf16 v[192:195], a[248:251], v[104:107], v[192:195]
    buffer_load_dwordx4 v[84:87], v79, s[64:67], s34 offen offset:256 sc1
    v_mfma_f32_16x16x32_bf16 v[196:199], a[252:255], v[104:107], v[196:199]
    s_add_u32 s98, s10, 0x700800
    v_mul_f32 v180, v176, v180
    v_mul_f32 v176, v18, v176
    v_mul_f32 v181, v177, v181
    v_mfma_f32_16x16x32_bf16 v[200:203], a[248:251], v[108:111], v[200:203]
    ds_read_b128 a[240:243], v2 offset:2048
    ds_read_b128 a[244:247], v3 offset:2048
    v_mul_f32 v177, v18, v177
    v_mfma_f32_16x16x32_bf16 v[204:207], a[252:255], v[108:111], v[204:207]
    v_exp_f32 v176, v176
    v_mul_f32 v182, v178, v182
    v_mfma_f32_16x16x32_bf16 v[192:195], v[28:31], v[24:27], v[192:195]
    buffer_load_dwordx4 v[88:91], v79, s[64:67], s34 offen offset:2048 sc1
    v_mul_f32 v178, v18, v178
    v_mfma_f32_16x16x32_bf16 v[196:199], v[32:35], v[24:27], v[196:199]
    v_exp_f32 v177, v177
    v_fma_f32 v176, v176, v19, v19
    v_mul_f32 v183, v179, v183
    v_mfma_f32_16x16x32_bf16 v[200:203], v[28:31], v[26:29], v[200:203]
    v_mul_f32 v179, v18, v179
    v_exp_f32 v178, v178
    v_mfma_f32_16x16x32_bf16 v[204:207], v[32:35], v[26:29], v[204:207]
    v_fma_f32 v177, v177, v19, v19
    v_rcp_f32 v176, v176
    v_mul_f32 v188, v184, v188
    ds_read_b128 a[248:251], v2 offset:4096
    ds_read_b128 a[252:255], v3 offset:4096
    s_waitcnt vmcnt(12) lgkmcnt(4)
    v_mfma_f32_16x16x32_bf16 v[208:211], a[224:227], v[112:115], 0
    buffer_load_dwordx4 v[92:95], v79, s[64:67], s34 offen offset:2304 sc1
    v_mul_f32 v184, v20, v184
    v_mfma_f32_16x16x32_bf16 v[212:215], a[228:231], v[112:115], 0
    s_add_u32 s46, s9, 0x20800
    buffer_load_dwordx2 v[64:65], v22, s[64:67], s46 offen offset:0 sc1
    v_fma_f32 v178, v178, v19, v19
    s_waitcnt vmcnt(13)
    v_mfma_f32_16x16x32_bf16 v[216:219], a[224:227], v[116:119], 0
    v_exp_f32 v179, v179
    v_mul_f32 v180, v180, v176
    v_mfma_f32_16x16x32_bf16 v[220:223], a[228:231], v[116:119], 0
    buffer_load_dwordx2 v[66:67], v22, s[64:67], s46 offen offset:256 sc1
    v_mul_f32 v189, v185, v189
    v_mfma_f32_16x16x32_bf16 v[224:227], a[232:235], v[112:115], 0
    buffer_load_dwordx4 v[96:99], v79, s[64:67], s35 offen offset:0 sc1
    v_mul_f32 v185, v20, v185
    v_mfma_f32_16x16x32_bf16 v[228:231], a[236:239], v[112:115], 0
    buffer_load_dwordx2 v[68:69], v22, s[64:67], s46 offen offset:128 sc1
    v_mfma_f32_16x16x32_bf16 v[232:235], a[232:235], v[116:119], 0
    ds_read_b128 a[224:227], v2 offset:5120
    ds_read_b128 a[228:231], v3 offset:5120
    v_mfma_f32_16x16x32_bf16 v[236:239], a[236:239], v[116:119], 0
    buffer_load_dwordx2 v[70:71], v22, s[64:67], s46 offen offset:384 sc1
    s_waitcnt lgkmcnt(2)
    v_mfma_f32_16x16x32_bf16 v[240:243], a[240:243], v[112:115], 0
    buffer_load_dwordx4 v[100:103], v79, s[64:67], s35 offen offset:256 sc1
    v_mfma_f32_16x16x32_bf16 v[244:247], a[244:247], v[112:115], 0
    v_rcp_f32 v177, v177
    v_exp_f32 v184, v184
    v_mfma_f32_16x16x32_bf16 v[248:251], a[240:243], v[116:119], 0
    ds_read_b128 a[232:235], v2 offset:6144
    ds_read_b128 a[236:239], v3 offset:6144
    v_fma_f32 v179, v179, v19, v19
    v_mfma_f32_16x16x32_bf16 v[252:255], a[244:247], v[116:119], 0
    v_rcp_f32 v178, v178
    v_mul_f32 v181, v181, v177
    v_mul_f32 v190, v186, v190
    s_waitcnt vmcnt(16)
    v_mfma_f32_16x16x32_bf16 v[208:211], a[248:251], v[120:123], v[208:211]
    buffer_load_dwordx4 v[104:107], v79, s[64:67], s35 offen offset:2048 sc1
    v_mul_f32 v186, v20, v186
    v_mfma_f32_16x16x32_bf16 v[212:215], a[252:255], v[120:123], v[212:215]
    v_exp_f32 v185, v185
    v_fma_f32 v184, v184, v21, v21
    v_mul_f32 v182, v182, v178
    v_mfma_f32_16x16x32_bf16 v[216:219], a[248:251], v[124:127], v[216:219]
    ds_read_b128 a[240:243], v2 offset:8192
    ds_read_b128 a[244:247], v3 offset:8192
    v_cvt_pk_bf16_f32 v176, v180, v181
    v_mfma_f32_16x16x32_bf16 v[220:223], a[252:255], v[124:127], v[220:223]
    v_rcp_f32 v179, v179
    v_mul_f32 v191, v187, v191
    s_waitcnt lgkmcnt(2)
    v_mfma_f32_16x16x32_bf16 v[224:227], a[224:227], v[120:123], v[224:227]
    buffer_load_dwordx4 v[108:111], v79, s[64:67], s35 offen offset:2304 sc1
    v_mul_f32 v187, v20, v187
    v_mfma_f32_16x16x32_bf16 v[228:231], a[228:231], v[120:123], v[228:231]
    v_exp_f32 v186, v186
    v_fma_f32 v185, v185, v21, v21
    v_mul_f32 v183, v183, v179
    v_mfma_f32_16x16x32_bf16 v[232:235], a[224:227], v[124:127], v[232:235]
    ds_read_b128 a[248:251], v2 offset:9216
    ds_read_b128 a[252:255], v3 offset:9216
    v_mfma_f32_16x16x32_bf16 v[236:239], a[228:231], v[124:127], v[236:239]
    v_rcp_f32 v184, v184
    v_exp_f32 v187, v187
    v_mfma_f32_16x16x32_bf16 v[240:243], a[232:235], v[120:123], v[240:243]
    buffer_load_dwordx4 v[112:115], v79, s[64:67], s36 offen offset:0 sc1
    v_fma_f32 v186, v186, v21, v21
    v_mfma_f32_16x16x32_bf16 v[244:247], a[236:239], v[120:123], v[244:247]
    v_rcp_f32 v185, v185
    v_mul_f32 v188, v188, v184
    v_cvt_pk_bf16_f32 v177, v182, v183
    v_mfma_f32_16x16x32_bf16 v[248:251], a[232:235], v[124:127], v[248:251]
    ds_read_b128 a[224:227], v2 offset:10240
    ds_read_b128 a[228:231], v3 offset:10240
    v_fma_f32 v187, v187, v21, v21
    v_mfma_f32_16x16x32_bf16 v[252:255], a[236:239], v[124:127], v[252:255]
    v_rcp_f32 v186, v186
    v_mul_f32 v189, v189, v185
    s_waitcnt vmcnt(17) lgkmcnt(2)
    v_mfma_f32_16x16x32_bf16 v[208:211], a[240:243], v[128:131], v[208:211]
    buffer_load_dwordx4 v[116:119], v79, s[64:67], s36 offen offset:256 sc1
    v_mul_f32 v190, v190, v186
    v_mfma_f32_16x16x32_bf16 v[212:215], a[244:247], v[128:131], v[212:215]
    v_rcp_f32 v187, v187
    v_cvt_pk_bf16_f32 v178, v188, v189
    v_mul_f32 v191, v191, v187
    v_mfma_f32_16x16x32_bf16 v[216:219], a[240:243], v[132:135], v[216:219]
    ds_read_b128 a[232:235], v2 offset:12288
    ds_read_b128 a[236:239], v3 offset:12288
    v_cvt_pk_bf16_f32 v179, v190, v191
    v_mfma_f32_16x16x32_bf16 v[220:223], a[244:247], v[132:135], v[220:223]
    v_permlane16_swap_b32 v176, v178
    v_permlane16_swap_b32 v177, v179
    v_mfma_f32_16x16x32_bf16 v[224:227], a[248:251], v[128:131], v[224:227]
    buffer_load_dwordx4 v[120:123], v79, s[64:67], s36 offen offset:2048 sc1
    buffer_store_dwordx4 v[176:179], v2, s[64:67], s98 offen sc1
    v_mfma_f32_16x16x32_bf16 v[228:231], a[252:255], v[128:131], v[228:231]
    s_add_u32 s99, s10, 0x700c00
    v_mul_f32 v196, v192, v196
    v_mul_f32 v192, v18, v192
    v_mul_f32 v197, v193, v197
    v_mfma_f32_16x16x32_bf16 v[232:235], a[248:251], v[132:135], v[232:235]
    ds_read_b128 a[240:243], v2 offset:13312
    ds_read_b128 a[244:247], v3 offset:13312
    v_mul_f32 v193, v18, v193
    v_mfma_f32_16x16x32_bf16 v[236:239], a[252:255], v[132:135], v[236:239]
    v_exp_f32 v192, v192
    v_mul_f32 v198, v194, v198
    s_waitcnt lgkmcnt(2)
    v_mfma_f32_16x16x32_bf16 v[240:243], a[224:227], v[128:131], v[240:243]
    buffer_load_dwordx4 v[124:127], v79, s[64:67], s36 offen offset:2304 sc1
    v_mul_f32 v194, v18, v194
    v_mfma_f32_16x16x32_bf16 v[244:247], a[228:231], v[128:131], v[244:247]
    v_exp_f32 v193, v193
    v_fma_f32 v192, v192, v19, v19
    v_mul_f32 v199, v195, v199
    v_mfma_f32_16x16x32_bf16 v[248:251], a[224:227], v[132:135], v[248:251]
    ds_read_b128 a[248:251], v2 offset:14336
    ds_read_b128 a[252:255], v3 offset:14336
    v_mul_f32 v195, v18, v195
    v_mfma_f32_16x16x32_bf16 v[252:255], a[228:231], v[132:135], v[252:255]
    v_exp_f32 v194, v194
    v_fma_f32 v193, v193, v19, v19
    v_mul_f32 v204, v200, v204
    s_waitcnt vmcnt(18)
    v_mfma_f32_16x16x32_bf16 v[208:211], a[232:235], v[136:139], v[208:211]
    buffer_load_dwordx4 v[128:131], v79, s[64:67], s37 offen offset:0 sc1
    v_mul_f32 v200, v20, v200
    v_mfma_f32_16x16x32_bf16 v[212:215], a[236:239], v[136:139], v[212:215]
    v_rcp_f32 v192, v192
    v_exp_f32 v195, v195
    v_mfma_f32_16x16x32_bf16 v[216:219], a[232:235], v[140:143], v[216:219]
    ds_read_b128 a[224:227], v2 offset:16384
    ds_read_b128 a[228:231], v3 offset:16384
    v_fma_f32 v194, v194, v19, v19
    v_mfma_f32_16x16x32_bf16 v[220:223], a[236:239], v[140:143], v[220:223]
    v_rcp_f32 v193, v193
    v_mul_f32 v196, v196, v192
    s_waitcnt lgkmcnt(2)
    v_mfma_f32_16x16x32_bf16 v[224:227], a[240:243], v[136:139], v[224:227]
    buffer_load_dwordx4 v[132:135], v79, s[64:67], s37 offen offset:256 sc1
    v_mul_f32 v205, v201, v205
    v_mfma_f32_16x16x32_bf16 v[228:231], a[244:247], v[136:139], v[228:231]
    v_mul_f32 v201, v20, v201
    v_exp_f32 v200, v200
    v_fma_f32 v195, v195, v19, v19
    v_mfma_f32_16x16x32_bf16 v[232:235], a[240:243], v[140:143], v[232:235]
    ds_read_b128 a[232:235], v2 offset:17408
    ds_read_b128 a[236:239], v3 offset:17408
    v_mul_f32 v197, v197, v193
    v_mfma_f32_16x16x32_bf16 v[236:239], a[244:247], v[140:143], v[236:239]
    v_rcp_f32 v194, v194
    v_mul_f32 v206, v202, v206
    v_mul_f32 v202, v20, v202
    v_mfma_f32_16x16x32_bf16 v[240:243], a[248:251], v[136:139], v[240:243]
    v_exp_f32 v201, v201
    v_fma_f32 v200, v200, v21, v21
    v_mfma_f32_16x16x32_bf16 v[244:247], a[252:255], v[136:139], v[244:247]
    v_rcp_f32 v195, v195
    v_mul_f32 v198, v198, v194
    v_cvt_pk_bf16_f32 v192, v196, v197
    v_mfma_f32_16x16x32_bf16 v[248:251], a[248:251], v[140:143], v[248:251]
    ds_read_b128 a[240:243], v2 offset:18432
    ds_read_b128 a[244:247], v3 offset:18432
    v_mul_f32 v207, v203, v207
    v_mfma_f32_16x16x32_bf16 v[252:255], a[252:255], v[140:143], v[252:255]
    v_mul_f32 v203, v20, v203
    v_exp_f32 v202, v202
    s_waitcnt vmcnt(17) lgkmcnt(2)
    v_mfma_f32_16x16x32_bf16 v[208:211], a[224:227], v[80:83], v[208:211]
    buffer_load_dwordx4 v[136:139], v79, s[64:67], s37 offen offset:2048 sc1
    v_fma_f32 v201, v201, v21, v21
    v_mfma_f32_16x16x32_bf16 v[212:215], a[228:231], v[80:83], v[212:215]
    v_rcp_f32 v200, v200
    v_mul_f32 v199, v199, v195
    v_fma_f32 v202, v202, v21, v21
    v_mfma_f32_16x16x32_bf16 v[216:219], a[224:227], v[84:87], v[216:219]
    ds_read_b128 a[248:251], v2 offset:20480
    ds_read_b128 a[252:255], v3 offset:20480
    v_mfma_f32_16x16x32_bf16 v[220:223], a[228:231], v[84:87], v[220:223]
    v_exp_f32 v203, v203
    v_rcp_f32 v201, v201
    v_mfma_f32_16x16x32_bf16 v[224:227], a[232:235], v[80:83], v[224:227]
    buffer_load_dwordx4 v[140:143], v79, s[64:67], s37 offen offset:2304 sc1
    v_mul_f32 v204, v204, v200
    v_mfma_f32_16x16x32_bf16 v[228:231], a[236:239], v[80:83], v[228:231]
    v_cvt_pk_bf16_f32 v193, v198, v199
    v_fma_f32 v203, v203, v21, v21
    v_rcp_f32 v202, v202
    v_mfma_f32_16x16x32_bf16 v[232:235], a[232:235], v[84:87], v[232:235]
    ds_read_b128 a[224:227], v2 offset:21504
    ds_read_b128 a[228:231], v3 offset:21504
    v_mul_f32 v205, v205, v201
    v_mfma_f32_16x16x32_bf16 v[236:239], a[236:239], v[84:87], v[236:239]
    v_rcp_f32 v203, v203
    v_mul_f32 v206, v206, v202
    s_waitcnt lgkmcnt(2)
    v_mfma_f32_16x16x32_bf16 v[240:243], a[240:243], v[80:83], v[240:243]
    v_cvt_pk_bf16_f32 v194, v204, v205
    v_mul_f32 v207, v207, v203
    v_cvt_pk_bf16_f32 v195, v206, v207
    v_mfma_f32_16x16x32_bf16 v[244:247], a[244:247], v[80:83], v[244:247]
    v_permlane16_swap_b32 v192, v194
    v_permlane16_swap_b32 v193, v195
    v_mfma_f32_16x16x32_bf16 v[248:251], a[240:243], v[84:87], v[248:251]
    ds_read_b128 a[232:235], v2 offset:22528
    ds_read_b128 a[236:239], v3 offset:22528
    buffer_store_dwordx4 v[192:195], v2, s[64:67], s99 offen sc1
    v_mfma_f32_16x16x32_bf16 v[252:255], a[244:247], v[84:87], v[252:255]
    buffer_load_dwordx4 v[80:83], v79, s[64:67], s38 offen offset:0 sc1
    s_waitcnt vmcnt(19)
    v_mfma_f32_16x16x32_bf16 v[208:211], a[248:251], v[88:91], v[208:211]
    s_waitcnt vmcnt(14)
    v_min3_i32 v72, v65, v67, v69
    v_mfma_f32_16x16x32_bf16 v[212:215], a[252:255], v[88:91], v[212:215]
    v_min_i32 v72, v72, v71
    v_cmp_gt_i32 vcc, 0, v72
    s_cbranch_vccnz L_ts_76
L_tb_77:
    v_mfma_f32_16x16x32_bf16 v[216:219], a[248:251], v[92:95], v[216:219]
    ds_read_b128 a[240:243], v2 offset:24576
    ds_read_b128 a[244:247], v3 offset:24576
    v_mfma_f32_16x16x32_bf16 v[220:223], a[252:255], v[92:95], v[220:223]
    v_add_f32 v64, v64, v66
    v_add_f32 v68, v68, v70
    s_waitcnt lgkmcnt(2)
    v_mfma_f32_16x16x32_bf16 v[224:227], a[224:227], v[88:91], v[224:227]
    buffer_load_dwordx4 v[84:87], v79, s[64:67], s38 offen offset:256 sc1
    v_mfma_f32_16x16x32_bf16 v[228:231], a[228:231], v[88:91], v[228:231]
    v_add_f32 v65, v65, v67
    v_add_f32 v69, v69, v71
    v_permlane32_swap_b32 v64, v68
    v_mfma_f32_16x16x32_bf16 v[232:235], a[224:227], v[92:95], v[232:235]
    ds_read_b128 a[248:251], v2 offset:25600
    ds_read_b128 a[252:255], v3 offset:25600
    v_mfma_f32_16x16x32_bf16 v[236:239], a[228:231], v[92:95], v[236:239]
    v_add_f32 v64, v64, v68
    v_permlane32_swap_b32 v65, v69
    v_add_f32 v65, v65, v69
    v_mfma_f32_16x16x32_bf16 v[240:243], a[232:235], v[88:91], v[240:243]
    s_nop 0
    v_permlane16_swap_b32 v64, v65
    v_add_f32 v64, v64, v65
    v_mfma_f32_16x16x32_bf16 v[244:247], a[236:239], v[88:91], v[244:247]
    v_mul_f32 v64, 0x3b000000, v64
    v_mov_b32 v65, v64
    s_nop 1
    v_permlane16_swap_b32 v64, v65
    v_mfma_f32_16x16x32_bf16 v[248:251], a[232:235], v[92:95], v[248:251]
    ds_read_b128 a[224:227], v2 offset:26624
    ds_read_b128 a[228:231], v3 offset:26624
    v_mfma_f32_16x16x32_bf16 v[252:255], a[236:239], v[92:95], v[252:255]
    v_fma_f32 v65, -v64, v64, v65
    v_cvt_pk_bf16_f32 v37, v64, 0
    s_waitcnt vmcnt(14) lgkmcnt(2)
    v_mfma_f32_16x16x32_bf16 v[208:211], a[240:243], v[96:99], v[208:211]
    buffer_load_dwordx4 v[88:91], v79, s[64:67], s38 offen offset:2048 sc1
    v_mfma_f32_16x16x32_bf16 v[212:215], a[244:247], v[96:99], v[212:215]
    v_max_f32 v65, 0, v65
    v_lshlrev_b32 v67, 16, v37
    v_add_f32 v57, 0x3727c5ac, v65
    v_mfma_f32_16x16x32_bf16 v[216:219], a[240:243], v[100:103], v[216:219]
    ds_read_b128 a[232:235], v2 offset:28672
    ds_read_b128 a[236:239], v3 offset:28672
    v_mfma_f32_16x16x32_bf16 v[220:223], a[244:247], v[100:103], v[220:223]
    v_sub_f32 v67, v64, v67
    v_rsq_f32 v56, v57
    v_mfma_f32_16x16x32_bf16 v[224:227], a[248:251], v[96:99], v[224:227]
    buffer_load_dwordx4 v[92:95], v79, s[64:67], s38 offen offset:2304 sc1
    v_mfma_f32_16x16x32_bf16 v[228:231], a[252:255], v[96:99], v[228:231]
    v_cvt_pk_bf16_f32 v36, v64, v67
    v_mul_f32 v56, 0xbfb8aa3b, v56
    v_mov_b32 v59, v57
    v_mfma_f32_16x16x32_bf16 v[232:235], a[248:251], v[100:103], v[232:235]
    ds_read_b128 a[240:243], v2 offset:29696
    ds_read_b128 a[244:247], v3 offset:29696
    v_mfma_f32_16x16x32_bf16 v[236:239], a[252:255], v[100:103], v[236:239]
    v_mov_b32 v39, v37
    v_mov_b32 v38, v36
    s_waitcnt lgkmcnt(2)
    v_mfma_f32_16x16x32_bf16 v[240:243], a[224:227], v[96:99], v[240:243]
    v_mov_b32 v58, v56
    v_permlane32_swap_b32 v57, v59
    v_mfma_f32_16x16x32_bf16 v[244:247], a[228:231], v[96:99], v[244:247]
    v_permlane32_swap_b32 v37, v39
    v_permlane32_swap_b32 v36, v38
    v_permlane32_swap_b32 v56, v58
    v_mfma_f32_16x16x32_bf16 v[248:251], a[224:227], v[100:103], v[248:251]
    ds_read_b128 a[248:251], v2 offset:30720
    ds_read_b128 a[252:255], v3 offset:30720
    v_mfma_f32_16x16x32_bf16 v[252:255], a[228:231], v[100:103], v[252:255]
    buffer_load_dwordx4 v[96:99], v79, s[64:67], s39 offen offset:0 sc1
    s_lshl_b64 s[40:41], s[44:45], 0
    s_waitcnt vmcnt(15)
    v_mfma_f32_16x16x32_bf16 v[208:211], a[232:235], v[104:107], v[208:211]
    v_cndmask_b32 v24, 0, v36, s[40:41]
    v_cndmask_b32 v25, 0, v37, s[40:41]
    v_mfma_f32_16x16x32_bf16 v[212:215], a[236:239], v[104:107], v[212:215]
    v_cndmask_b32 v26, 0, v38, s[40:41]
    v_cndmask_b32 v27, 0, v39, s[40:41]
    v_mfma_f32_16x16x32_bf16 v[216:219], a[232:235], v[108:111], v[216:219]
    ds_read_b128 a[224:227], v2 offset:32768
    ds_read_b128 a[228:231], v3 offset:32768
    v_mfma_f32_16x16x32_bf16 v[220:223], a[236:239], v[108:111], v[220:223]
    s_waitcnt lgkmcnt(2)
    v_mfma_f32_16x16x32_bf16 v[224:227], a[240:243], v[104:107], v[224:227]
    buffer_load_dwordx4 v[100:103], v79, s[64:67], s39 offen offset:256 sc1
    v_mfma_f32_16x16x32_bf16 v[228:231], a[244:247], v[104:107], v[228:231]
    v_mfma_f32_16x16x32_bf16 v[232:235], a[240:243], v[108:111], v[232:235]
    ds_read_b128 a[232:235], v2 offset:33792
    ds_read_b128 a[236:239], v3 offset:33792
    v_mfma_f32_16x16x32_bf16 v[236:239], a[244:247], v[108:111], v[236:239]
    v_mfma_f32_16x16x32_bf16 v[240:243], a[248:251], v[104:107], v[240:243]
    v_mfma_f32_16x16x32_bf16 v[244:247], a[252:255], v[104:107], v[244:247]
    v_mfma_f32_16x16x32_bf16 v[248:251], a[248:251], v[108:111], v[248:251]
    ds_read_b128 a[240:243], v2 offset:34816
    ds_read_b128 a[244:247], v3 offset:34816
    v_mfma_f32_16x16x32_bf16 v[252:255], a[252:255], v[108:111], v[252:255]
    s_waitcnt vmcnt(6)
    s_cmp_eq_u32 s16, 0
    s_cbranch_scc1 L_ps_78
    buffer_store_dword v23, off, s[64:67], s26 offset:2048
L_pb_79:
    s_waitcnt lgkmcnt(2)
    v_mfma_f32_16x16x32_bf16 v[208:211], a[224:227], v[112:115], v[208:211]
    buffer_load_dwordx4 v[104:107], v79, s[64:67], s39 offen offset:2048 sc1
    v_mfma_f32_16x16x32_bf16 v[212:215], a[228:231], v[112:115], v[212:215]
    v_mfma_f32_16x16x32_bf16 v[216:219], a[224:227], v[116:119], v[216:219]
    ds_read_b128 a[248:251], v2 offset:36864
    ds_read_b128 a[252:255], v3 offset:36864
    v_mfma_f32_16x16x32_bf16 v[220:223], a[228:231], v[116:119], v[220:223]
    v_mfma_f32_16x16x32_bf16 v[224:227], a[232:235], v[112:115], v[224:227]
    buffer_load_dwordx4 v[108:111], v79, s[64:67], s39 offen offset:2304 sc1
    v_mfma_f32_16x16x32_bf16 v[228:231], a[236:239], v[112:115], v[228:231]
    v_mfma_f32_16x16x32_bf16 v[232:235], a[232:235], v[116:119], v[232:235]
    ds_read_b128 a[224:227], v2 offset:37888
    ds_read_b128 a[228:231], v3 offset:37888
    v_mfma_f32_16x16x32_bf16 v[236:239], a[236:239], v[116:119], v[236:239]
    s_waitcnt lgkmcnt(2)
    v_mfma_f32_16x16x32_bf16 v[240:243], a[240:243], v[112:115], v[240:243]
    v_mfma_f32_16x16x32_bf16 v[244:247], a[244:247], v[112:115], v[244:247]
    v_mfma_f32_16x16x32_bf16 v[248:251], a[240:243], v[116:119], v[248:251]
    ds_read_b128 a[232:235], v2 offset:38912
    ds_read_b128 a[236:239], v3 offset:38912
    v_mfma_f32_16x16x32_bf16 v[252:255], a[244:247], v[116:119], v[252:255]
    v_mfma_f32_16x16x32_bf16 v[208:211], a[248:251], v[120:123], v[208:211]
    v_mfma_f32_16x16x32_bf16 v[212:215], a[252:255], v[120:123], v[212:215]
    v_mfma_f32_16x16x32_bf16 v[216:219], a[248:251], v[124:127], v[216:219]
    ds_read_b128 a[240:243], v2 offset:40960
    ds_read_b128 a[244:247], v3 offset:40960
    v_mfma_f32_16x16x32_bf16 v[220:223], a[252:255], v[124:127], v[220:223]
    s_waitcnt lgkmcnt(2)
    v_mfma_f32_16x16x32_bf16 v[224:227], a[224:227], v[120:123], v[224:227]
    v_mfma_f32_16x16x32_bf16 v[228:231], a[228:231], v[120:123], v[228:231]
    v_mfma_f32_16x16x32_bf16 v[232:235], a[224:227], v[124:127], v[232:235]
    ds_read_b128 a[248:251], v2 offset:41984
    ds_read_b128 a[252:255], v3 offset:41984
    v_mfma_f32_16x16x32_bf16 v[236:239], a[228:231], v[124:127], v[236:239]
    v_mfma_f32_16x16x32_bf16 v[240:243], a[232:235], v[120:123], v[240:243]
    v_mfma_f32_16x16x32_bf16 v[244:247], a[236:239], v[120:123], v[244:247]
    v_mfma_f32_16x16x32_bf16 v[248:251], a[232:235], v[124:127], v[248:251]
    ds_read_b128 a[224:227], v2 offset:43008
    ds_read_b128 a[228:231], v3 offset:43008
    v_mfma_f32_16x16x32_bf16 v[252:255], a[236:239], v[124:127], v[252:255]
    s_waitcnt lgkmcnt(2)
    v_mfma_f32_16x16x32_bf16 v[208:211], a[240:243], v[128:131], v[208:211]
    v_mfma_f32_16x16x32_bf16 v[212:215], a[244:247], v[128:131], v[212:215]
    v_mfma_f32_16x16x32_bf16 v[216:219], a[240:243], v[132:135], v[216:219]
    ds_read_b128 a[232:235], v2 offset:45056
    ds_read_b128 a[236:239], v3 offset:45056
    v_mfma_f32_16x16x32_bf16 v[220:223], a[244:247], v[132:135], v[220:223]
    v_mfma_f32_16x16x32_bf16 v[224:227], a[248:251], v[128:131], v[224:227]
    v_mfma_f32_16x16x32_bf16 v[228:231], a[252:255], v[128:131], v[228:231]
    v_mfma_f32_16x16x32_bf16 v[232:235], a[248:251], v[132:135], v[232:235]
    ds_read_b128 a[240:243], v2 offset:49152
    ds_read_b128 a[244:247], v3 offset:49152
    v_mfma_f32_16x16x32_bf16 v[236:239], a[252:255], v[132:135], v[236:239]
    s_waitcnt lgkmcnt(2)
    v_mfma_f32_16x16x32_bf16 v[240:243], a[224:227], v[128:131], v[240:243]
    v_mfma_f32_16x16x32_bf16 v[244:247], a[228:231], v[128:131], v[244:247]
    v_mfma_f32_16x16x32_bf16 v[248:251], a[224:227], v[132:135], v[248:251]
    ds_read_b128 a[248:251], v2 offset:53248
    ds_read_b128 a[252:255], v3 offset:53248
    v_mfma_f32_16x16x32_bf16 v[252:255], a[228:231], v[132:135], v[252:255]
    v_mfma_f32_16x16x32_bf16 v[208:211], a[232:235], v[136:139], v[208:211]
    v_mfma_f32_16x16x32_bf16 v[212:215], a[236:239], v[136:139], v[212:215]
    v_mfma_f32_16x16x32_bf16 v[216:219], a[232:235], v[140:143], v[216:219]
    ds_read_b128 a[224:227], v2 offset:57344
    ds_read_b128 a[228:231], v3 offset:57344
    v_mfma_f32_16x16x32_bf16 v[220:223], a[236:239], v[140:143], v[220:223]
    s_waitcnt vmcnt(7) lgkmcnt(2)
    v_mfma_f32_16x16x32_bf16 v[208:211], a[240:243], v[80:83], v[208:211]
    v_mfma_f32_16x16x32_bf16 v[212:215], a[244:247], v[80:83], v[212:215]
    v_mfma_f32_16x16x32_bf16 v[216:219], a[240:243], v[84:87], v[216:219]
    ds_read_b128 a[232:235], v2 offset:61440
    ds_read_b128 a[236:239], v3 offset:61440
    v_mfma_f32_16x16x32_bf16 v[220:223], a[244:247], v[84:87], v[220:223]
    s_waitcnt vmcnt(5)
    v_mfma_f32_16x16x32_bf16 v[208:211], a[248:251], v[88:91], v[208:211]
    v_mfma_f32_16x16x32_bf16 v[212:215], a[252:255], v[88:91], v[212:215]
    buffer_load_dword v16, v5, s[64:67], s27 offen offset:2048 sc1
    v_mfma_f32_16x16x32_bf16 v[216:219], a[248:251], v[92:95], v[216:219]
    ds_read_b128 a[240:243], v2 offset:46080
    ds_read_b128 a[244:247], v3 offset:46080
    v_mfma_f32_16x16x32_bf16 v[220:223], a[252:255], v[92:95], v[220:223]
    s_waitcnt vmcnt(4) lgkmcnt(2)
    v_mfma_f32_16x16x32_bf16 v[208:211], a[224:227], v[96:99], v[208:211]
    v_mfma_f32_16x16x32_bf16 v[212:215], a[228:231], v[96:99], v[212:215]
    v_mfma_f32_16x16x32_bf16 v[216:219], a[224:227], v[100:103], v[216:219]
    ds_read_b128 a[248:251], v2 offset:50176
    ds_read_b128 a[252:255], v3 offset:50176
    v_mfma_f32_16x16x32_bf16 v[220:223], a[228:231], v[100:103], v[220:223]
    s_waitcnt vmcnt(1)
    v_mfma_f32_16x16x32_bf16 v[208:211], a[232:235], v[104:107], v[208:211]
    v_mfma_f32_16x16x32_bf16 v[212:215], a[236:239], v[104:107], v[212:215]
    v_mfma_f32_16x16x32_bf16 v[216:219], a[232:235], v[108:111], v[216:219]
    ds_read_b128 a[224:227], v2 offset:54272
    ds_read_b128 a[228:231], v3 offset:54272
    v_mfma_f32_16x16x32_bf16 v[220:223], a[236:239], v[108:111], v[220:223]
    v_mfma_f32_16x16x32_bf16 v[208:211], v[28:31], v[24:27], v[208:211]
    v_mfma_f32_16x16x32_bf16 v[212:215], v[32:35], v[24:27], v[212:215]
    v_mfma_f32_16x16x32_bf16 v[216:219], v[28:31], v[26:29], v[216:219]
    v_mfma_f32_16x16x32_bf16 v[220:223], v[32:35], v[26:29], v[220:223]
    s_waitcnt lgkmcnt(2)
    v_mfma_f32_16x16x32_bf16 v[224:227], a[240:243], v[136:139], v[224:227]
    v_mfma_f32_16x16x32_bf16 v[228:231], a[244:247], v[136:139], v[228:231]
    s_lshl_b64 s[40:41], s[44:45], 16
    v_cndmask_b32 v24, 0, v36, s[40:41]
    v_mfma_f32_16x16x32_bf16 v[232:235], a[240:243], v[140:143], v[232:235]
    ds_read_b128 a[232:235], v2 offset:58368
    ds_read_b128 a[236:239], v3 offset:58368
    v_mfma_f32_16x16x32_bf16 v[236:239], a[244:247], v[140:143], v[236:239]
    v_cndmask_b32 v25, 0, v37, s[40:41]
    v_cndmask_b32 v26, 0, v38, s[40:41]
    v_mfma_f32_16x16x32_bf16 v[224:227], a[248:251], v[80:83], v[224:227]
    v_cndmask_b32 v27, 0, v39, s[40:41]
    v_mfma_f32_16x16x32_bf16 v[228:231], a[252:255], v[80:83], v[228:231]
    s_waitcnt vmcnt(0)
    v_cmp_eq_u32 vcc, 0, v16
    s_cbranch_vccnz L_fs_80
L_fb_81:
    s_add_u32 s80, s11, 0x700000
    v_add_u32 v78, s80, v0
    buffer_load_dwordx4 v[112:115], v78, s[64:67], s68 offen offset:0 sc1
    v_mfma_f32_16x16x32_bf16 v[232:235], a[248:251], v[84:87], v[232:235]
    ds_read_b128 a[240:243], v2 offset:62464
    ds_read_b128 a[244:247], v3 offset:62464
    v_mfma_f32_16x16x32_bf16 v[236:239], a[252:255], v[84:87], v[236:239]
    s_waitcnt lgkmcnt(2)
    v_mfma_f32_16x16x32_bf16 v[224:227], a[224:227], v[88:91], v[224:227]
    s_add_u32 s96, s10, 0x71c000
    v_mul_f32 v212, v208, v212
    v_mfma_f32_16x16x32_bf16 v[228:231], a[228:231], v[88:91], v[228:231]
    buffer_load_dwordx4 v[116:119], v78, s[64:67], s68 offen offset:256 sc1
    v_mfma_f32_16x16x32_bf16 v[232:235], a[224:227], v[92:95], v[232:235]
    ds_read_b128 a[248:251], v2 offset:47104
    ds_read_b128 a[252:255], v3 offset:47104
    v_mfma_f32_16x16x32_bf16 v[236:239], a[228:231], v[92:95], v[236:239]
    v_mul_f32 v208, v56, v208
    v_mul_f32 v213, v209, v213
    v_mfma_f32_16x16x32_bf16 v[224:227], a[232:235], v[96:99], v[224:227]
    v_mul_f32 v209, v56, v209
    v_mul_f32 v214, v210, v214
    v_mfma_f32_16x16x32_bf16 v[228:231], a[236:239], v[96:99], v[228:231]
    buffer_load_dwordx4 v[120:123], v78, s[64:67], s68 offen offset:2048 sc1
    v_mfma_f32_16x16x32_bf16 v[232:235], a[232:235], v[100:103], v[232:235]
    ds_read_b128 a[224:227], v2 offset:51200
    ds_read_b128 a[228:231], v3 offset:51200
    v_mfma_f32_16x16x32_bf16 v[236:239], a[236:239], v[100:103], v[236:239]
    v_mul_f32 v210, v56, v210
    s_waitcnt lgkmcnt(2)
    v_mfma_f32_16x16x32_bf16 v[224:227], a[240:243], v[104:107], v[224:227]
    v_exp_f32 v208, v208
    v_mfma_f32_16x16x32_bf16 v[228:231], a[244:247], v[104:107], v[228:231]
    buffer_load_dwordx4 v[124:127], v78, s[64:67], s68 offen offset:2304 sc1
    v_mfma_f32_16x16x32_bf16 v[232:235], a[240:243], v[108:111], v[232:235]
    ds_read_b128 a[232:235], v2 offset:55296
    ds_read_b128 a[236:239], v3 offset:55296
    v_mfma_f32_16x16x32_bf16 v[236:239], a[244:247], v[108:111], v[236:239]
    v_exp_f32 v209, v209
    v_mfma_f32_16x16x32_bf16 v[224:227], v[28:31], v[24:27], v[224:227]
    v_fma_f32 v208, v208, v57, v57
    v_mul_f32 v215, v211, v215
    v_mfma_f32_16x16x32_bf16 v[228:231], v[32:35], v[24:27], v[228:231]
    buffer_load_dwordx4 v[128:131], v78, s[64:67], s69 offen offset:0 sc1
    v_mfma_f32_16x16x32_bf16 v[232:235], v[28:31], v[26:29], v[232:235]
    v_mul_f32 v211, v56, v211
    v_fma_f32 v209, v209, v57, v57
    v_mfma_f32_16x16x32_bf16 v[236:239], v[32:35], v[26:29], v[236:239]
    v_exp_f32 v210, v210
    v_mfma_f32_16x16x32_bf16 v[240:243], a[248:251], v[136:139], v[240:243]
    v_rcp_f32 v208, v208
    v_mfma_f32_16x16x32_bf16 v[244:247], a[252:255], v[136:139], v[244:247]
    buffer_load_dwordx4 v[132:135], v78, s[64:67], s69 offen offset:256 sc1
    v_mfma_f32_16x16x32_bf16 v[248:251], a[248:251], v[140:143], v[248:251]
    ds_read_b128 a[240:243], v2 offset:59392
    ds_read_b128 a[244:247], v3 offset:59392
    v_mfma_f32_16x16x32_bf16 v[252:255], a[252:255], v[140:143], v[252:255]
    s_lshl_b64 s[40:41], s[44:45], 32
    s_waitcnt lgkmcnt(2)
    v_mfma_f32_16x16x32_bf16 v[240:243], a[224:227], v[80:83], v[240:243]
    v_cndmask_b32 v24, 0, v36, s[40:41]
    v_cndmask_b32 v25, 0, v37, s[40:41]
    v_mfma_f32_16x16x32_bf16 v[244:247], a[228:231], v[80:83], v[244:247]
    buffer_load_dwordx4 v[136:139], v78, s[64:67], s69 offen offset:2048 sc1
    v_mfma_f32_16x16x32_bf16 v[248:251], a[224:227], v[84:87], v[248:251]
    ds_read_b128 a[248:251], v2 offset:63488
    ds_read_b128 a[252:255], v3 offset:63488
    v_mfma_f32_16x16x32_bf16 v[252:255], a[228:231], v[84:87], v[252:255]
    v_cndmask_b32 v26, 0, v38, s[40:41]
    v_cndmask_b32 v27, 0, v39, s[40:41]
    v_mfma_f32_16x16x32_bf16 v[240:243], a[232:235], v[88:91], v[240:243]
    v_mul_f32 v220, v216, v220
    v_mul_f32 v216, v58, v216
    v_mfma_f32_16x16x32_bf16 v[244:247], a[236:239], v[88:91], v[244:247]
    buffer_load_dwordx4 v[140:143], v78, s[64:67], s69 offen offset:2304 sc1
    v_mfma_f32_16x16x32_bf16 v[248:251], a[232:235], v[92:95], v[248:251]
    v_exp_f32 v211, v211
    v_mfma_f32_16x16x32_bf16 v[252:255], a[236:239], v[92:95], v[252:255]
    v_fma_f32 v210, v210, v57, v57
    s_waitcnt lgkmcnt(0)
    v_mfma_f32_16x16x32_bf16 v[240:243], a[240:243], v[96:99], v[240:243]
    v_rcp_f32 v209, v209
    v_mfma_f32_16x16x32_bf16 v[244:247], a[244:247], v[96:99], v[244:247]
    buffer_load_dwordx4 v[80:83], v78, s[64:67], s70 offen offset:0 sc1
    v_mfma_f32_16x16x32_bf16 v[248:251], a[240:243], v[100:103], v[248:251]
    v_mul_f32 v212, v212, v208
    v_mul_f32 v221, v217, v221
    v_mfma_f32_16x16x32_bf16 v[252:255], a[244:247], v[100:103], v[252:255]
    v_mul_f32 v217, v58, v217
    v_fma_f32 v211, v211, v57, v57
    v_mfma_f32_16x16x32_bf16 v[240:243], a[248:251], v[104:107], v[240:243]
    v_exp_f32 v216, v216
    v_mfma_f32_16x16x32_bf16 v[244:247], a[252:255], v[104:107], v[244:247]
    buffer_load_dwordx4 v[84:87], v78, s[64:67], s70 offen offset:256 sc1
    v_mfma_f32_16x16x32_bf16 v[248:251], a[248:251], v[108:111], v[248:251]
    v_rcp_f32 v210, v210
    v_mfma_f32_16x16x32_bf16 v[252:255], a[252:255], v[108:111], v[252:255]
    v_mul_f32 v213, v213, v209
    v_mfma_f32_16x16x32_bf16 v[240:243], v[28:31], v[24:27], v[240:243]
    v_mul_f32 v222, v218, v222
    v_mul_f32 v218, v58, v218
    v_mfma_f32_16x16x32_bf16 v[244:247], v[32:35], v[24:27], v[244:247]
    buffer_load_dwordx4 v[88:91], v78, s[64:67], s70 offen offset:2048 sc1
    v_mfma_f32_16x16x32_bf16 v[248:251], v[28:31], v[26:29], v[248:251]
    v_exp_f32 v217, v217
    v_mfma_f32_16x16x32_bf16 v[252:255], v[32:35], v[26:29], v[252:255]
    v_fma_f32 v216, v216, v59, v59
    v_mul_f32 v214, v214, v210
    v_rcp_f32 v211, v211
    v_cvt_pk_bf16_f32 v208, v212, v213
    v_mul_f32 v223, v219, v223
    v_mul_f32 v219, v58, v219
    v_exp_f32 v218, v218
    v_fma_f32 v217, v217, v59, v59
    v_rcp_f32 v216, v216
    v_mul_f32 v215, v215, v211
    v_exp_f32 v219, v219
    v_fma_f32 v218, v218, v59, v59
    v_rcp_f32 v217, v217
    v_mul_f32 v220, v220, v216
    v_cvt_pk_bf16_f32 v209, v214, v215
    v_fma_f32 v219, v219, v59, v59
    v_rcp_f32 v218, v218
    v_mul_f32 v221, v221, v217
    v_rcp_f32 v219, v219
    v_mul_f32 v222, v222, v218
    v_cvt_pk_bf16_f32 v210, v220, v221
    v_mul_f32 v223, v223, v219
    v_cvt_pk_bf16_f32 v211, v222, v223
    v_permlane16_swap_b32 v208, v210
    s_nop 0
    v_permlane16_swap_b32 v209, v211
    buffer_store_dwordx4 v[208:211], v2, s[64:67], s96 offen sc1
    s_add_u32 s97, s10, 0x71c400
    v_pk_mul_f32 v[228:229], v[224:225], v[228:229]
    v_pk_mul_f32 v[224:225], v[224:225], v[56:57] op_sel_hi:[1,0]
    v_pk_mul_f32 v[230:231], v[226:227], v[230:231]
    v_pk_mul_f32 v[226:227], v[226:227], v[56:57] op_sel_hi:[1,0]
    v_pk_mul_f32 v[236:237], v[232:233], v[236:237]
    v_pk_mul_f32 v[232:233], v[232:233], v[58:59] op_sel_hi:[1,0]
    v_pk_mul_f32 v[238:239], v[234:235], v[238:239]
    v_pk_mul_f32 v[234:235], v[234:235], v[58:59] op_sel_hi:[1,0]
    buffer_load_dwordx4 v[92:95], v78, s[64:67], s70 offen offset:2304 sc1
    v_exp_f32 v224, v224
    v_exp_f32 v225, v225
    v_exp_f32 v226, v226
    v_exp_f32 v227, v227
    v_exp_f32 v232, v232
    v_exp_f32 v233, v233
    buffer_load_dwordx4 v[96:99], v78, s[64:67], s71 offen offset:0 sc1
    v_exp_f32 v234, v234
    v_exp_f32 v235, v235
    v_pk_fma_f32 v[224:225], v[224:225], v[56:57], v[56:57] op_sel:[0,1,1] op_sel_hi:[1,1,1]
    v_pk_fma_f32 v[226:227], v[226:227], v[56:57], v[56:57] op_sel:[0,1,1] op_sel_hi:[1,1,1]
    v_pk_fma_f32 v[232:233], v[232:233], v[58:59], v[58:59] op_sel:[0,1,1] op_sel_hi:[1,1,1]
    v_pk_fma_f32 v[234:235], v[234:235], v[58:59], v[58:59] op_sel:[0,1,1] op_sel_hi:[1,1,1]
    v_rcp_f32 v224, v224
    v_rcp_f32 v225, v225
    v_rcp_f32 v226, v226
    v_rcp_f32 v227, v227
    buffer_load_dwordx4 v[100:103], v78, s[64:67], s71 offen offset:256 sc1
    v_rcp_f32 v232, v232
    v_rcp_f32 v233, v233
    v_rcp_f32 v234, v234
    v_rcp_f32 v235, v235
    v_pk_mul_f32 v[228:229], v[228:229], v[224:225]
    v_pk_mul_f32 v[230:231], v[230:231], v[226:227]
    v_pk_mul_f32 v[236:237], v[236:237], v[232:233]
    v_pk_mul_f32 v[238:239], v[238:239], v[234:235]
    v_cvt_pk_bf16_f32 v224, v228, v229
    v_cvt_pk_bf16_f32 v225, v230, v231
    v_cvt_pk_bf16_f32 v226, v236, v237
    v_cvt_pk_bf16_f32 v227, v238, v239
    s_nop 0
    v_permlane16_swap_b32 v224, v226
    v_permlane16_swap_b32 v225, v227
    buffer_store_dwordx4 v[224:227], v2, s[64:67], s97 offen sc1
    s_add_u32 s98, s10, 0x71c800
    v_pk_mul_f32 v[244:245], v[240:241], v[244:245]
    v_pk_mul_f32 v[240:241], v[240:241], v[56:57] op_sel_hi:[1,0]
    v_pk_mul_f32 v[246:247], v[242:243], v[246:247]
    v_pk_mul_f32 v[242:243], v[242:243], v[56:57] op_sel_hi:[1,0]
    v_pk_mul_f32 v[252:253], v[248:249], v[252:253]
    v_pk_mul_f32 v[248:249], v[248:249], v[58:59] op_sel_hi:[1,0]
    v_pk_mul_f32 v[254:255], v[250:251], v[254:255]
    v_pk_mul_f32 v[250:251], v[250:251], v[58:59] op_sel_hi:[1,0]
    buffer_load_dwordx4 v[104:107], v78, s[64:67], s71 offen offset:2048 sc1
    v_exp_f32 v240, v240
    v_exp_f32 v241, v241
    v_exp_f32 v242, v242
    v_exp_f32 v243, v243
    v_exp_f32 v248, v248
    v_exp_f32 v249, v249
    buffer_load_dwordx4 v[108:111], v78, s[64:67], s71 offen offset:2304 sc1
    v_exp_f32 v250, v250
    v_exp_f32 v251, v251
    v_pk_fma_f32 v[240:241], v[240:241], v[56:57], v[56:57] op_sel:[0,1,1] op_sel_hi:[1,1,1]
    v_pk_fma_f32 v[242:243], v[242:243], v[56:57], v[56:57] op_sel:[0,1,1] op_sel_hi:[1,1,1]
    v_pk_fma_f32 v[248:249], v[248:249], v[58:59], v[58:59] op_sel:[0,1,1] op_sel_hi:[1,1,1]
    v_pk_fma_f32 v[250:251], v[250:251], v[58:59], v[58:59] op_sel:[0,1,1] op_sel_hi:[1,1,1]
    v_rcp_f32 v240, v240
    v_rcp_f32 v241, v241
    v_rcp_f32 v242, v242
    v_rcp_f32 v243, v243
    v_rcp_f32 v248, v248
    v_rcp_f32 v249, v249
    v_rcp_f32 v250, v250
    v_rcp_f32 v251, v251
    v_pk_mul_f32 v[244:245], v[244:245], v[240:241]
    v_pk_mul_f32 v[246:247], v[246:247], v[242:243]
    v_pk_mul_f32 v[252:253], v[252:253], v[248:249]
    v_pk_mul_f32 v[254:255], v[254:255], v[250:251]
    v_cvt_pk_bf16_f32 v240, v244, v245
    v_cvt_pk_bf16_f32 v241, v246, v247
    v_cvt_pk_bf16_f32 v242, v252, v253
    v_cvt_pk_bf16_f32 v243, v254, v255
    s_nop 0
    v_permlane16_swap_b32 v240, v242
    v_permlane16_swap_b32 v241, v243
    buffer_store_dwordx4 v[240:243], v2, s[64:67], s98 offen sc1
    s_waitcnt lgkmcnt(0)
    s_waitcnt vmcnt(18)
    v_mfma_f32_16x16x32_bf16 v[144:147], a[0:3], v[112:115], 0
    v_mfma_f32_16x16x32_bf16 v[148:151], a[4:7], v[112:115], 0
    v_mfma_f32_16x16x32_bf16 v[152:155], a[8:11], v[112:115], 0
    v_mfma_f32_16x16x32_bf16 v[156:159], a[12:15], v[112:115], 0
    s_waitcnt vmcnt(17)
    v_mfma_f32_16x16x32_bf16 v[160:163], a[0:3], v[116:119], 0
    buffer_load_dwordx4 v[112:115], v78, s[64:67], s72 offen offset:0 sc1
    v_mfma_f32_16x16x32_bf16 v[164:167], a[4:7], v[116:119], 0
    v_mfma_f32_16x16x32_bf16 v[168:171], a[8:11], v[116:119], 0
    v_mfma_f32_16x16x32_bf16 v[172:175], a[12:15], v[116:119], 0
    s_waitcnt vmcnt(17)
    v_mfma_f32_16x16x32_bf16 v[144:147], a[16:19], v[120:123], v[144:147]
    buffer_load_dwordx4 v[116:119], v78, s[64:67], s72 offen offset:256 sc1
    v_mfma_f32_16x16x32_bf16 v[148:151], a[20:23], v[120:123], v[148:151]
    v_mfma_f32_16x16x32_bf16 v[152:155], a[24:27], v[120:123], v[152:155]
    v_mfma_f32_16x16x32_bf16 v[156:159], a[28:31], v[120:123], v[156:159]
    s_waitcnt vmcnt(17)
    v_mfma_f32_16x16x32_bf16 v[160:163], a[16:19], v[124:127], v[160:163]
    buffer_load_dwordx4 v[120:123], v78, s[64:67], s72 offen offset:2048 sc1
    v_mfma_f32_16x16x32_bf16 v[164:167], a[20:23], v[124:127], v[164:167]
    v_mfma_f32_16x16x32_bf16 v[168:171], a[24:27], v[124:127], v[168:171]
    v_mfma_f32_16x16x32_bf16 v[172:175], a[28:31], v[124:127], v[172:175]
    s_waitcnt vmcnt(17)
    v_mfma_f32_16x16x32_bf16 v[144:147], a[32:35], v[128:131], v[144:147]
    buffer_load_dwordx4 v[124:127], v78, s[64:67], s72 offen offset:2304 sc1
    v_mfma_f32_16x16x32_bf16 v[148:151], a[36:39], v[128:131], v[148:151]
    v_mfma_f32_16x16x32_bf16 v[152:155], a[40:43], v[128:131], v[152:155]
    v_mfma_f32_16x16x32_bf16 v[156:159], a[44:47], v[128:131], v[156:159]
    s_waitcnt vmcnt(17)
    v_mfma_f32_16x16x32_bf16 v[160:163], a[32:35], v[132:135], v[160:163]
    buffer_load_dwordx4 v[128:131], v78, s[64:67], s73 offen offset:0 sc1
    v_mfma_f32_16x16x32_bf16 v[164:167], a[36:39], v[132:135], v[164:167]
    v_mfma_f32_16x16x32_bf16 v[168:171], a[40:43], v[132:135], v[168:171]
    v_mfma_f32_16x16x32_bf16 v[172:175], a[44:47], v[132:135], v[172:175]
    s_waitcnt vmcnt(17)
    v_mfma_f32_16x16x32_bf16 v[144:147], a[48:51], v[136:139], v[144:147]
    buffer_load_dwordx4 v[132:135], v78, s[64:67], s73 offen offset:256 sc1
    v_mfma_f32_16x16x32_bf16 v[148:151], a[52:55], v[136:139], v[148:151]
    v_mfma_f32_16x16x32_bf16 v[152:155], a[56:59], v[136:139], v[152:155]
    v_mfma_f32_16x16x32_bf16 v[156:159], a[60:63], v[136:139], v[156:159]
    s_waitcnt vmcnt(17)
    v_mfma_f32_16x16x32_bf16 v[160:163], a[48:51], v[140:143], v[160:163]
    buffer_load_dwordx4 v[136:139], v78, s[64:67], s73 offen offset:2048 sc1
    v_mfma_f32_16x16x32_bf16 v[164:167], a[52:55], v[140:143], v[164:167]
    v_mfma_f32_16x16x32_bf16 v[168:171], a[56:59], v[140:143], v[168:171]
    v_mfma_f32_16x16x32_bf16 v[172:175], a[60:63], v[140:143], v[172:175]
    s_waitcnt vmcnt(17)
    v_mfma_f32_16x16x32_bf16 v[144:147], a[64:67], v[80:83], v[144:147]
    buffer_load_dwordx4 v[140:143], v78, s[64:67], s73 offen offset:2304 sc1
    v_mfma_f32_16x16x32_bf16 v[148:151], a[68:71], v[80:83], v[148:151]
    v_mfma_f32_16x16x32_bf16 v[152:155], a[72:75], v[80:83], v[152:155]
    v_mfma_f32_16x16x32_bf16 v[156:159], a[76:79], v[80:83], v[156:159]
    s_waitcnt vmcnt(17)
    v_mfma_f32_16x16x32_bf16 v[160:163], a[64:67], v[84:87], v[160:163]
    buffer_load_dwordx4 v[80:83], v78, s[64:67], s74 offen offset:0 sc1
    v_mfma_f32_16x16x32_bf16 v[164:167], a[68:71], v[84:87], v[164:167]
    v_mfma_f32_16x16x32_bf16 v[168:171], a[72:75], v[84:87], v[168:171]
    v_mfma_f32_16x16x32_bf16 v[172:175], a[76:79], v[84:87], v[172:175]
    s_waitcnt vmcnt(17)
    v_mfma_f32_16x16x32_bf16 v[144:147], a[80:83], v[88:91], v[144:147]
    buffer_load_dwordx4 v[84:87], v78, s[64:67], s74 offen offset:256 sc1
    v_mfma_f32_16x16x32_bf16 v[148:151], a[84:87], v[88:91], v[148:151]
    v_mfma_f32_16x16x32_bf16 v[152:155], a[88:91], v[88:91], v[152:155]
    v_mfma_f32_16x16x32_bf16 v[156:159], a[92:95], v[88:91], v[156:159]
    s_waitcnt vmcnt(10)
    s_cmp_eq_u32 s16, 0
    s_cbranch_scc1 L_ps_82
    buffer_store_dword v23, off, s[64:67], s26 offset:2304
L_pb_83:
    s_add_u32 s80, s10, 0x71c000
    v_lshlrev_b32 v16, 3, v2
    s_mov_b64 exec, 0xffffff
    buffer_load_dword v16, v16, s[64:67], s80 offen sc1
    s_mov_b64 exec, -1
    v_mfma_f32_16x16x32_bf16 v[160:163], a[80:83], v[92:95], v[160:163]
    buffer_load_dwordx4 v[88:91], v78, s[64:67], s74 offen offset:2048 sc1
    v_mfma_f32_16x16x32_bf16 v[164:167], a[84:87], v[92:95], v[164:167]
    v_mfma_f32_16x16x32_bf16 v[168:171], a[88:91], v[92:95], v[168:171]
    v_mfma_f32_16x16x32_bf16 v[172:175], a[92:95], v[92:95], v[172:175]
    v_mfma_f32_16x16x32_bf16 v[144:147], a[96:99], v[96:99], v[144:147]
    buffer_load_dwordx4 v[92:95], v78, s[64:67], s74 offen offset:2304 sc1
    v_mfma_f32_16x16x32_bf16 v[148:151], a[100:103], v[96:99], v[148:151]
    v_mfma_f32_16x16x32_bf16 v[152:155], a[104:107], v[96:99], v[152:155]
    v_mfma_f32_16x16x32_bf16 v[156:159], a[108:111], v[96:99], v[156:159]
    v_mfma_f32_16x16x32_bf16 v[160:163], a[96:99], v[100:103], v[160:163]
    v_mfma_f32_16x16x32_bf16 v[164:167], a[100:103], v[100:103], v[164:167]
    v_mfma_f32_16x16x32_bf16 v[168:171], a[104:107], v[100:103], v[168:171]
    v_mfma_f32_16x16x32_bf16 v[172:175], a[108:111], v[100:103], v[172:175]
    v_mfma_f32_16x16x32_bf16 v[144:147], a[112:115], v[104:107], v[144:147]
    v_mfma_f32_16x16x32_bf16 v[148:151], a[116:119], v[104:107], v[148:151]
    v_mfma_f32_16x16x32_bf16 v[152:155], a[120:123], v[104:107], v[152:155]
    v_mfma_f32_16x16x32_bf16 v[156:159], a[124:127], v[104:107], v[156:159]
    v_mfma_f32_16x16x32_bf16 v[160:163], a[112:115], v[108:111], v[160:163]
    v_mfma_f32_16x16x32_bf16 v[164:167], a[116:119], v[108:111], v[164:167]
    v_mfma_f32_16x16x32_bf16 v[168:171], a[120:123], v[108:111], v[168:171]
    v_mfma_f32_16x16x32_bf16 v[172:175], a[124:127], v[108:111], v[172:175]
    s_waitcnt vmcnt(13)
    v_mfma_f32_16x16x32_bf16 v[144:147], a[128:131], v[112:115], v[144:147]
    v_mfma_f32_16x16x32_bf16 v[148:151], a[132:135], v[112:115], v[148:151]
    v_mfma_f32_16x16x32_bf16 v[152:155], a[136:139], v[112:115], v[152:155]
    v_mfma_f32_16x16x32_bf16 v[156:159], a[140:143], v[112:115], v[156:159]
    s_waitcnt vmcnt(12)
    v_mfma_f32_16x16x32_bf16 v[160:163], a[128:131], v[116:119], v[160:163]
    v_mfma_f32_16x16x32_bf16 v[164:167], a[132:135], v[116:119], v[164:167]
    v_mfma_f32_16x16x32_bf16 v[168:171], a[136:139], v[116:119], v[168:171]
    v_mfma_f32_16x16x32_bf16 v[172:175], a[140:143], v[116:119], v[172:175]
    s_waitcnt vmcnt(11)
    v_mfma_f32_16x16x32_bf16 v[144:147], a[144:147], v[120:123], v[144:147]
    v_mfma_f32_16x16x32_bf16 v[148:151], a[148:151], v[120:123], v[148:151]
    v_mfma_f32_16x16x32_bf16 v[152:155], a[152:155], v[120:123], v[152:155]
    v_mfma_f32_16x16x32_bf16 v[156:159], a[156:159], v[120:123], v[156:159]
    s_waitcnt vmcnt(10)
    v_mfma_f32_16x16x32_bf16 v[160:163], a[144:147], v[124:127], v[160:163]
    v_mfma_f32_16x16x32_bf16 v[164:167], a[148:151], v[124:127], v[164:167]
    v_mfma_f32_16x16x32_bf16 v[168:171], a[152:155], v[124:127], v[168:171]
    v_mfma_f32_16x16x32_bf16 v[172:175], a[156:159], v[124:127], v[172:175]
    s_waitcnt vmcnt(9)
    v_mfma_f32_16x16x32_bf16 v[144:147], a[160:163], v[128:131], v[144:147]
    v_mfma_f32_16x16x32_bf16 v[148:151], a[164:167], v[128:131], v[148:151]
    buffer_load_dword v16, v5, s[64:67], s27 offen offset:2304 sc1
    v_mfma_f32_16x16x32_bf16 v[152:155], a[168:171], v[128:131], v[152:155]
    v_mfma_f32_16x16x32_bf16 v[156:159], a[172:175], v[128:131], v[156:159]
    s_waitcnt vmcnt(9)
    v_mfma_f32_16x16x32_bf16 v[160:163], a[160:163], v[132:135], v[160:163]
    v_mfma_f32_16x16x32_bf16 v[164:167], a[164:167], v[132:135], v[164:167]
    v_mfma_f32_16x16x32_bf16 v[168:171], a[168:171], v[132:135], v[168:171]
    v_mfma_f32_16x16x32_bf16 v[172:175], a[172:175], v[132:135], v[172:175]
    s_waitcnt vmcnt(8)
    v_mfma_f32_16x16x32_bf16 v[144:147], a[176:179], v[136:139], v[144:147]
    v_mfma_f32_16x16x32_bf16 v[148:151], a[180:183], v[136:139], v[148:151]
    v_mfma_f32_16x16x32_bf16 v[152:155], a[184:187], v[136:139], v[152:155]
    v_mfma_f32_16x16x32_bf16 v[156:159], a[188:191], v[136:139], v[156:159]
    s_waitcnt vmcnt(7)
    v_mfma_f32_16x16x32_bf16 v[160:163], a[176:179], v[140:143], v[160:163]
    v_mfma_f32_16x16x32_bf16 v[164:167], a[180:183], v[140:143], v[164:167]
    v_mfma_f32_16x16x32_bf16 v[168:171], a[184:187], v[140:143], v[168:171]
    v_mfma_f32_16x16x32_bf16 v[172:175], a[188:191], v[140:143], v[172:175]
    s_waitcnt vmcnt(6)
    v_mfma_f32_16x16x32_bf16 v[144:147], a[192:195], v[80:83], v[144:147]
    v_mfma_f32_16x16x32_bf16 v[148:151], a[196:199], v[80:83], v[148:151]
    s_waitcnt vmcnt(0)
    v_cmp_eq_u32 vcc, 0, v16
    s_cbranch_vccnz L_fs_84
L_fb_85:
    s_add_u32 s80, s11, 0x71c000
    v_add_u32 v79, s80, v0
    v_mfma_f32_16x16x32_bf16 v[152:155], a[200:203], v[80:83], v[152:155]
    buffer_load_dwordx4 v[96:99], v79, s[64:67], s68 offen offset:0 sc1
    v_mfma_f32_16x16x32_bf16 v[156:159], a[204:207], v[80:83], v[156:159]
    v_mfma_f32_16x16x32_bf16 v[144:147], a[208:211], v[88:91], v[144:147]
    buffer_load_dwordx4 v[100:103], v79, s[64:67], s68 offen offset:256 sc1
    v_xor_b32 v73, 64, v8
    v_xor_b32 v74, 128, v8
    v_xor_b32 v75, 192, v8
    v_mfma_f32_16x16x32_bf16 v[148:151], a[212:215], v[88:91], v[148:151]
    v_mfma_f32_16x16x32_bf16 v[152:155], a[216:219], v[88:91], v[152:155]
    buffer_load_dwordx4 v[104:107], v79, s[64:67], s68 offen offset:2048 sc1
    v_mfma_f32_16x16x32_bf16 v[156:159], a[220:223], v[88:91], v[156:159]
    v_mfma_f32_16x16x32_bf16 v[160:163], a[192:195], v[84:87], v[160:163]
    buffer_load_dwordx4 v[108:111], v79, s[64:67], s68 offen offset:2304 sc1
    v_mfma_f32_16x16x32_bf16 v[164:167], a[196:199], v[84:87], v[164:167]
    v_mfma_f32_16x16x32_bf16 v[168:171], a[200:203], v[84:87], v[168:171]
    buffer_load_dwordx4 v[112:115], v79, s[64:67], s69 offen offset:0 sc1
    ds_write_b128 v8, v[144:147]
    v_mfma_f32_16x16x32_bf16 v[172:175], a[204:207], v[84:87], v[172:175]
    ds_write_b128 v73, v[148:151]
    v_mfma_f32_16x16x32_bf16 v[160:163], a[208:211], v[92:95], v[160:163]
    buffer_load_dwordx4 v[116:119], v79, s[64:67], s69 offen offset:256 sc1
    ds_write_b128 v74, v[152:155]
    v_mfma_f32_16x16x32_bf16 v[164:167], a[212:215], v[92:95], v[164:167]
    ds_write_b128 v75, v[156:159]
    v_mfma_f32_16x16x32_bf16 v[168:171], a[216:219], v[92:95], v[168:171]
    buffer_load_dwordx4 v[120:123], v79, s[64:67], s69 offen offset:2048 sc1
    v_mfma_f32_16x16x32_bf16 v[172:175], a[220:223], v[92:95], v[172:175]
    buffer_load_dwordx4 v[124:127], v79, s[64:67], s69 offen offset:2304 sc1
    buffer_load_dwordx4 v[128:131], v79, s[64:67], s70 offen offset:0 sc1
    ds_write_b128 v8, v[160:163] offset:4096
    s_nop 0
    ds_write_b128 v73, v[164:167] offset:4096
    s_nop 0
    ds_write_b128 v74, v[168:171] offset:4096
    s_nop 0
    ds_write_b128 v75, v[172:175] offset:4096
    buffer_load_dwordx4 v[132:135], v79, s[64:67], s70 offen offset:256 sc1
    buffer_load_dwordx4 v[136:139], v79, s[64:67], s70 offen offset:2048 sc1
    s_waitcnt lgkmcnt(0)
    s_barrier
    s_waitcnt vmcnt(10)
    v_mfma_f32_16x16x32_bf16 v[144:147], a[0:3], v[96:99], 0
    buffer_load_dwordx4 v[140:143], v79, s[64:67], s70 offen offset:2304 sc1
    v_mfma_f32_16x16x32_bf16 v[148:151], a[4:7], v[96:99], 0
    ds_read_b128 v[208:211], v9 offset:0
    ds_read_b128 v[212:215], v10 offset:0
    v_mfma_f32_16x16x32_bf16 v[152:155], a[8:11], v[96:99], 0
    buffer_load_dwordx4 v[80:83], v79, s[64:67], s71 offen offset:0 sc1
    v_mfma_f32_16x16x32_bf16 v[156:159], a[12:15], v[96:99], 0
    ds_read_b128 v[216:219], v9 offset:8192
    s_waitcnt vmcnt(11)
    v_mfma_f32_16x16x32_bf16 v[160:163], a[0:3], v[100:103], 0
    buffer_load_dwordx4 v[84:87], v79, s[64:67], s71 offen offset:256 sc1
    v_mfma_f32_16x16x32_bf16 v[164:167], a[4:7], v[100:103], 0
    ds_read_b128 v[220:223], v10 offset:8192
    ds_read_b128 v[224:227], v9 offset:16384
    v_mfma_f32_16x16x32_bf16 v[168:171], a[8:11], v[100:103], 0
    buffer_load_dwordx4 v[88:91], v79, s[64:67], s71 offen offset:2048 sc1
    v_mfma_f32_16x16x32_bf16 v[172:175], a[12:15], v[100:103], 0
    ds_read_b128 v[228:231], v10 offset:16384
    s_waitcnt vmcnt(12)
    v_mfma_f32_16x16x32_bf16 v[144:147], a[16:19], v[104:107], v[144:147]
    buffer_load_dwordx4 v[92:95], v79, s[64:67], s71 offen offset:2304 sc1
    v_mfma_f32_16x16x32_bf16 v[148:151], a[20:23], v[104:107], v[148:151]
    ds_read_b128 v[232:235], v9 offset:24576
    ds_read_b128 v[236:239], v10 offset:24576
    v_mfma_f32_16x16x32_bf16 v[152:155], a[24:27], v[104:107], v[152:155]
    buffer_load_dwordx4 v[96:99], v79, s[64:67], s72 offen offset:0 sc1
    v_mfma_f32_16x16x32_bf16 v[156:159], a[28:31], v[104:107], v[156:159]
    v_lshlrev_b32 v240, 16, v40
    s_waitcnt vmcnt(13)
    v_mfma_f32_16x16x32_bf16 v[160:163], a[16:19], v[108:111], v[160:163]
    buffer_load_dwordx4 v[100:103], v79, s[64:67], s72 offen offset:256 sc1
    v_mfma_f32_16x16x32_bf16 v[164:167], a[20:23], v[108:111], v[164:167]
    v_and_b32 v241, 0xffff0000, v40
    v_lshlrev_b32 v242, 16, v41
    v_mfma_f32_16x16x32_bf16 v[168:171], a[24:27], v[108:111], v[168:171]
    buffer_load_dwordx4 v[104:107], v79, s[64:67], s72 offen offset:2048 sc1
    v_mfma_f32_16x16x32_bf16 v[172:175], a[28:31], v[108:111], v[172:175]
    v_and_b32 v243, 0xffff0000, v41
    s_waitcnt vmcnt(14)
    v_mfma_f32_16x16x32_bf16 v[144:147], a[32:35], v[112:115], v[144:147]
    buffer_load_dwordx4 v[108:111], v79, s[64:67], s72 offen offset:2304 sc1
    v_mfma_f32_16x16x32_bf16 v[148:151], a[36:39], v[112:115], v[148:151]
    v_lshlrev_b32 v244, 16, v42
    v_and_b32 v245, 0xffff0000, v42
    v_mfma_f32_16x16x32_bf16 v[152:155], a[40:43], v[112:115], v[152:155]
    v_lshlrev_b32 v246, 16, v43
    v_and_b32 v247, 0xffff0000, v43
    v_mfma_f32_16x16x32_bf16 v[156:159], a[44:47], v[112:115], v[156:159]
    s_waitcnt vmcnt(14)
    v_mfma_f32_16x16x32_bf16 v[160:163], a[32:35], v[116:119], v[160:163]
    buffer_load_dwordx4 v[112:115], v79, s[64:67], s73 offen offset:0 sc1
    v_mfma_f32_16x16x32_bf16 v[164:167], a[36:39], v[116:119], v[164:167]
    s_waitcnt lgkmcnt(7)
    v_add_f32 v240, v240, v208
    v_mfma_f32_16x16x32_bf16 v[168:171], a[40:43], v[116:119], v[168:171]
    v_add_f32 v241, v241, v209
    v_add_f32 v242, v242, v210
    v_mfma_f32_16x16x32_bf16 v[172:175], a[44:47], v[116:119], v[172:175]
    v_add_f32 v243, v243, v211
    s_waitcnt vmcnt(14)
    v_mfma_f32_16x16x32_bf16 v[144:147], a[48:51], v[120:123], v[144:147]
    buffer_load_dwordx4 v[116:119], v79, s[64:67], s73 offen offset:256 sc1
    v_mfma_f32_16x16x32_bf16 v[148:151], a[52:55], v[120:123], v[148:151]
    s_waitcnt lgkmcnt(6)
    v_add_f32 v244, v244, v212
    v_mfma_f32_16x16x32_bf16 v[152:155], a[56:59], v[120:123], v[152:155]
    v_add_f32 v245, v245, v213
    v_add_f32 v246, v246, v214
    v_mfma_f32_16x16x32_bf16 v[156:159], a[60:63], v[120:123], v[156:159]
    v_add_f32 v247, v247, v215
    s_waitcnt vmcnt(14)
    v_mfma_f32_16x16x32_bf16 v[160:163], a[48:51], v[124:127], v[160:163]
    buffer_load_dwordx4 v[120:123], v79, s[64:67], s73 offen offset:2048 sc1
    v_mfma_f32_16x16x32_bf16 v[164:167], a[52:55], v[124:127], v[164:167]
    s_waitcnt lgkmcnt(5)
    v_add_f32 v240, v240, v216
    v_mfma_f32_16x16x32_bf16 v[168:171], a[56:59], v[124:127], v[168:171]
    v_add_f32 v241, v241, v217
    v_add_f32 v242, v242, v218
    v_mfma_f32_16x16x32_bf16 v[172:175], a[60:63], v[124:127], v[172:175]
    v_add_f32 v243, v243, v219
    s_waitcnt vmcnt(14)
    v_mfma_f32_16x16x32_bf16 v[144:147], a[64:67], v[128:131], v[144:147]
    buffer_load_dwordx4 v[124:127], v79, s[64:67], s73 offen offset:2304 sc1
    v_mfma_f32_16x16x32_bf16 v[148:151], a[68:71], v[128:131], v[148:151]
    s_waitcnt lgkmcnt(4)
    v_add_f32 v244, v244, v220
    v_mfma_f32_16x16x32_bf16 v[152:155], a[72:75], v[128:131], v[152:155]
    v_add_f32 v245, v245, v221
    v_add_f32 v246, v246, v222
    v_mfma_f32_16x16x32_bf16 v[156:159], a[76:79], v[128:131], v[156:159]
    v_add_f32 v247, v247, v223
    s_waitcnt vmcnt(14)
    v_mfma_f32_16x16x32_bf16 v[160:163], a[64:67], v[132:135], v[160:163]
    buffer_load_dwordx4 v[128:131], v79, s[64:67], s74 offen offset:0 sc1
    v_mfma_f32_16x16x32_bf16 v[164:167], a[68:71], v[132:135], v[164:167]
    s_waitcnt lgkmcnt(3)
    v_add_f32 v240, v240, v224
    v_mfma_f32_16x16x32_bf16 v[168:171], a[72:75], v[132:135], v[168:171]
    v_add_f32 v241, v241, v225
    v_add_f32 v242, v242, v226
    v_mfma_f32_16x16x32_bf16 v[172:175], a[76:79], v[132:135], v[172:175]
    v_add_f32 v243, v243, v227
    s_waitcnt vmcnt(14)
    v_mfma_f32_16x16x32_bf16 v[144:147], a[80:83], v[136:139], v[144:147]
    buffer_load_dwordx4 v[132:135], v79, s[64:67], s74 offen offset:256 sc1
    v_mfma_f32_16x16x32_bf16 v[148:151], a[84:87], v[136:139], v[148:151]
    s_waitcnt lgkmcnt(2)
    v_add_f32 v244, v244, v228
    v_mfma_f32_16x16x32_bf16 v[152:155], a[88:91], v[136:139], v[152:155]
    v_add_f32 v245, v245, v229
    v_add_f32 v246, v246, v230
    v_mfma_f32_16x16x32_bf16 v[156:159], a[92:95], v[136:139], v[156:159]
    v_add_f32 v247, v247, v231
    s_waitcnt vmcnt(14)
    v_mfma_f32_16x16x32_bf16 v[160:163], a[80:83], v[140:143], v[160:163]
    buffer_load_dwordx4 v[136:139], v79, s[64:67], s74 offen offset:2048 sc1
    v_mfma_f32_16x16x32_bf16 v[164:167], a[84:87], v[140:143], v[164:167]
    s_waitcnt lgkmcnt(1)
    v_add_f32 v240, v240, v232
    v_mfma_f32_16x16x32_bf16 v[168:171], a[88:91], v[140:143], v[168:171]
    v_add_f32 v241, v241, v233
    v_add_f32 v242, v242, v234
    v_mfma_f32_16x16x32_bf16 v[172:175], a[92:95], v[140:143], v[172:175]
    v_add_f32 v243, v243, v235
    s_waitcnt vmcnt(14)
    v_mfma_f32_16x16x32_bf16 v[144:147], a[96:99], v[80:83], v[144:147]
    buffer_load_dwordx4 v[140:143], v79, s[64:67], s74 offen offset:2304 sc1
    v_mfma_f32_16x16x32_bf16 v[148:151], a[100:103], v[80:83], v[148:151]
    s_waitcnt lgkmcnt(0)
    v_add_f32 v244, v244, v236
    v_mfma_f32_16x16x32_bf16 v[152:155], a[104:107], v[80:83], v[152:155]
    v_add_f32 v245, v245, v237
    v_add_f32 v246, v246, v238
    v_mfma_f32_16x16x32_bf16 v[156:159], a[108:111], v[80:83], v[156:159]
    v_add_f32 v247, v247, v239
    s_waitcnt vmcnt(14)
    v_mfma_f32_16x16x32_bf16 v[160:163], a[96:99], v[84:87], v[160:163]
    s_barrier
    v_cvt_pk_bf16_f32 v40, v240, v241
    v_mfma_f32_16x16x32_bf16 v[164:167], a[100:103], v[84:87], v[164:167]
    v_cvt_pk_bf16_f32 v41, v242, v243
    v_cvt_pk_bf16_f32 v42, v244, v245
    v_mfma_f32_16x16x32_bf16 v[168:171], a[104:107], v[84:87], v[168:171]
    v_cvt_pk_bf16_f32 v43, v246, v247
    v_mfma_f32_16x16x32_bf16 v[172:175], a[108:111], v[84:87], v[172:175]
    s_waitcnt vmcnt(13)
    v_mfma_f32_16x16x32_bf16 v[144:147], a[112:115], v[88:91], v[144:147]
    s_add_u32 s80, s7, 0
    buffer_store_dwordx4 v[40:43], v13, s[60:63], s80 offen
    v_mfma_f32_16x16x32_bf16 v[148:151], a[116:119], v[88:91], v[148:151]
    v_mfma_f32_16x16x32_bf16 v[152:155], a[120:123], v[88:91], v[152:155]
    v_mfma_f32_16x16x32_bf16 v[156:159], a[124:127], v[88:91], v[156:159]
    s_waitcnt vmcnt(13)
    v_mfma_f32_16x16x32_bf16 v[160:163], a[112:115], v[92:95], v[160:163]
    v_mfma_f32_16x16x32_bf16 v[164:167], a[116:119], v[92:95], v[164:167]
    v_mfma_f32_16x16x32_bf16 v[168:171], a[120:123], v[92:95], v[168:171]
    v_mfma_f32_16x16x32_bf16 v[172:175], a[124:127], v[92:95], v[172:175]
    s_waitcnt vmcnt(12)
    v_mfma_f32_16x16x32_bf16 v[144:147], a[128:131], v[96:99], v[144:147]
    v_mfma_f32_16x16x32_bf16 v[148:151], a[132:135], v[96:99], v[148:151]
    v_mfma_f32_16x16x32_bf16 v[152:155], a[136:139], v[96:99], v[152:155]
    v_mfma_f32_16x16x32_bf16 v[156:159], a[140:143], v[96:99], v[156:159]
    s_waitcnt vmcnt(11)
    v_mfma_f32_16x16x32_bf16 v[160:163], a[128:131], v[100:103], v[160:163]
    v_mfma_f32_16x16x32_bf16 v[164:167], a[132:135], v[100:103], v[164:167]
    v_mfma_f32_16x16x32_bf16 v[168:171], a[136:139], v[100:103], v[168:171]
    v_mfma_f32_16x16x32_bf16 v[172:175], a[140:143], v[100:103], v[172:175]
    s_waitcnt vmcnt(10)
    v_mfma_f32_16x16x32_bf16 v[144:147], a[144:147], v[104:107], v[144:147]
    v_mfma_f32_16x16x32_bf16 v[148:151], a[148:151], v[104:107], v[148:151]
    v_mfma_f32_16x16x32_bf16 v[152:155], a[152:155], v[104:107], v[152:155]
    v_mfma_f32_16x16x32_bf16 v[156:159], a[156:159], v[104:107], v[156:159]
    s_waitcnt vmcnt(9)
    v_mfma_f32_16x16x32_bf16 v[160:163], a[144:147], v[108:111], v[160:163]
    v_mfma_f32_16x16x32_bf16 v[164:167], a[148:151], v[108:111], v[164:167]
    v_mfma_f32_16x16x32_bf16 v[168:171], a[152:155], v[108:111], v[168:171]
    v_mfma_f32_16x16x32_bf16 v[172:175], a[156:159], v[108:111], v[172:175]
    s_waitcnt vmcnt(8)
    v_mfma_f32_16x16x32_bf16 v[144:147], a[160:163], v[112:115], v[144:147]
    v_mfma_f32_16x16x32_bf16 v[148:151], a[164:167], v[112:115], v[148:151]
    v_mfma_f32_16x16x32_bf16 v[152:155], a[168:171], v[112:115], v[152:155]
    v_mfma_f32_16x16x32_bf16 v[156:159], a[172:175], v[112:115], v[156:159]
    s_waitcnt vmcnt(7)
    v_mfma_f32_16x16x32_bf16 v[160:163], a[160:163], v[116:119], v[160:163]
    v_mfma_f32_16x16x32_bf16 v[164:167], a[164:167], v[116:119], v[164:167]
    v_mfma_f32_16x16x32_bf16 v[168:171], a[168:171], v[116:119], v[168:171]
    v_mfma_f32_16x16x32_bf16 v[172:175], a[172:175], v[116:119], v[172:175]
    s_waitcnt vmcnt(6)
    v_mfma_f32_16x16x32_bf16 v[144:147], a[176:179], v[120:123], v[144:147]
    v_mfma_f32_16x16x32_bf16 v[148:151], a[180:183], v[120:123], v[148:151]
    v_mfma_f32_16x16x32_bf16 v[152:155], a[184:187], v[120:123], v[152:155]
    v_mfma_f32_16x16x32_bf16 v[156:159], a[188:191], v[120:123], v[156:159]
    s_waitcnt vmcnt(5)
    v_mfma_f32_16x16x32_bf16 v[160:163], a[176:179], v[124:127], v[160:163]
    v_mfma_f32_16x16x32_bf16 v[164:167], a[180:183], v[124:127], v[164:167]
    v_mfma_f32_16x16x32_bf16 v[168:171], a[184:187], v[124:127], v[168:171]
    v_mfma_f32_16x16x32_bf16 v[172:175], a[188:191], v[124:127], v[172:175]
    s_waitcnt vmcnt(4)
    v_mfma_f32_16x16x32_bf16 v[144:147], a[192:195], v[128:131], v[144:147]
    v_mfma_f32_16x16x32_bf16 v[148:151], a[196:199], v[128:131], v[148:151]
    v_mfma_f32_16x16x32_bf16 v[152:155], a[200:203], v[128:131], v[152:155]
    v_mfma_f32_16x16x32_bf16 v[156:159], a[204:207], v[128:131], v[156:159]
    s_waitcnt vmcnt(2)
    v_mfma_f32_16x16x32_bf16 v[144:147], a[208:211], v[136:139], v[144:147]
    v_xor_b32 v73, 64, v8
    v_xor_b32 v74, 128, v8
    v_xor_b32 v75, 192, v8
    v_mfma_f32_16x16x32_bf16 v[148:151], a[212:215], v[136:139], v[148:151]
    v_mfma_f32_16x16x32_bf16 v[152:155], a[216:219], v[136:139], v[152:155]
    v_mfma_f32_16x16x32_bf16 v[156:159], a[220:223], v[136:139], v[156:159]
    v_mfma_f32_16x16x32_bf16 v[160:163], a[192:195], v[132:135], v[160:163]
    v_mfma_f32_16x16x32_bf16 v[164:167], a[196:199], v[132:135], v[164:167]
    v_mfma_f32_16x16x32_bf16 v[168:171], a[200:203], v[132:135], v[168:171]
    ds_write_b128 v8, v[144:147]
    v_mfma_f32_16x16x32_bf16 v[172:175], a[204:207], v[132:135], v[172:175]
    s_nop 0
    ds_write_b128 v73, v[148:151]
    s_waitcnt vmcnt(1)
    v_mfma_f32_16x16x32_bf16 v[160:163], a[208:211], v[140:143], v[160:163]
    ds_write_b128 v74, v[152:155]
    v_mfma_f32_16x16x32_bf16 v[164:167], a[212:215], v[140:143], v[164:167]
    ds_write_b128 v75, v[156:159]
    v_mfma_f32_16x16x32_bf16 v[168:171], a[216:219], v[140:143], v[168:171]
    v_mfma_f32_16x16x32_bf16 v[172:175], a[220:223], v[140:143], v[172:175]
    s_nop 2
    ds_write_b128 v8, v[160:163] offset:4096
    s_nop 0
    ds_write_b128 v73, v[164:167] offset:4096
    s_nop 0
    ds_write_b128 v74, v[168:171] offset:4096
    ds_write_b128 v75, v[172:175] offset:4096
    v_lshlrev_b32 v240, 16, v44
    v_and_b32 v241, 0xffff0000, v44
    v_lshlrev_b32 v242, 16, v45
    v_and_b32 v243, 0xffff0000, v45
    v_lshlrev_b32 v244, 16, v46
    v_and_b32 v245, 0xffff0000, v46
    v_lshlrev_b32 v246, 16, v47
    v_and_b32 v247, 0xffff0000, v47
    s_waitcnt lgkmcnt(0)
    s_barrier
    ds_read_b128 v[208:211], v9 offset:0
    ds_read_b128 v[212:215], v10 offset:0
    ds_read_b128 v[216:219], v9 offset:8192
    ds_read_b128 v[220:223], v10 offset:8192
    ds_read_b128 v[224:227], v9 offset:16384
    ds_read_b128 v[228:231], v10 offset:16384
    ds_read_b128 v[232:235], v9 offset:24576
    ds_read_b128 v[236:239], v10 offset:24576
    s_waitcnt lgkmcnt(7)
    v_pk_add_f32 v[240:241], v[240:241], v[208:209]
    v_pk_add_f32 v[242:243], v[242:243], v[210:211]
    s_waitcnt lgkmcnt(6)
    v_pk_add_f32 v[244:245], v[244:245], v[212:213]
    v_pk_add_f32 v[246:247], v[246:247], v[214:215]
    s_waitcnt lgkmcnt(5)
    v_pk_add_f32 v[240:241], v[240:241], v[216:217]
    v_pk_add_f32 v[242:243], v[242:243], v[218:219]
    s_waitcnt lgkmcnt(4)
    v_pk_add_f32 v[244:245], v[244:245], v[220:221]
    v_pk_add_f32 v[246:247], v[246:247], v[222:223]
    s_waitcnt lgkmcnt(3)
    v_pk_add_f32 v[240:241], v[240:241], v[224:225]
    v_pk_add_f32 v[242:243], v[242:243], v[226:227]
    s_waitcnt lgkmcnt(2)
    v_pk_add_f32 v[244:245], v[244:245], v[228:229]
    v_pk_add_f32 v[246:247], v[246:247], v[230:231]
    s_waitcnt lgkmcnt(1)
    v_pk_add_f32 v[240:241], v[240:241], v[232:233]
    v_pk_add_f32 v[242:243], v[242:243], v[234:235]
    s_waitcnt lgkmcnt(0)
    v_pk_add_f32 v[244:245], v[244:245], v[236:237]
    v_pk_add_f32 v[246:247], v[246:247], v[238:239]
    v_cvt_pk_bf16_f32 v44, v240, v241
    v_cvt_pk_bf16_f32 v45, v242, v243
    v_cvt_pk_bf16_f32 v46, v244, v245
    v_cvt_pk_bf16_f32 v47, v246, v247
    s_add_u32 s80, s7, 32768
    buffer_store_dwordx4 v[44:47], v13, s[60:63], s80 offen
    s_branch L_end
L_c1s_11:
    v_cmp_eq_u32 vcc, 0, v16
    s_cbranch_vccz L_c1m_86
    s_add_u32 s87, s87, 1
    s_cmp_lt_u32 s87, 64
    s_cbranch_scc1 L_c1l_10
    s_cmp_lg_u32 s87, 64
    s_cbranch_scc1 L_c1g_87
    buffer_store_dword v23, off, s[64:67], s28 offset:256 sc1
L_c1g_87:
    buffer_load_dword v16, v4, s[64:67], s88 offen offset:256 sc1
    s_waitcnt vmcnt(0)
    v_cmp_eq_u32 vcc, 0, v16
    s_cbranch_vccz L_c1q_88
    s_cmp_lt_u32 s87, 0x200000
    s_cbranch_scc1 L_c1l_10
    s_branch L_end
L_c1m_86:
    buffer_store_dword v23, off, s[64:67], s28 offset:256 sc1
L_c1q_88:
    v_mov_b32 v58, 0
    s_branch L_c1d_12
L_ps_13:
    buffer_store_dword v104, v92, s[64:67], s80 offen sc1
    s_branch L_pb_14
L_ps_16:
    buffer_store_dwordx2 v[106:107], v17, s[64:67], s80 offen offset:0 sc1
    buffer_store_dwordx2 v[106:107], v17, s[64:67], s80 offen offset:2048 sc1
    s_branch L_pb_17
L_ps_18:
    buffer_store_dwordx2 v[106:107], v17, s[64:67], s80 offen offset:0 sc1
    buffer_store_dwordx2 v[106:107], v17, s[64:67], s80 offen offset:2048 sc1
    s_branch L_pb_19
L_ps_20:
    buffer_store_dwordx2 v[106:107], v17, s[64:67], s80 offen offset:0 sc1
    buffer_store_dwordx2 v[106:107], v17, s[64:67], s80 offen offset:2048 sc1
    s_branch L_pb_21
L_ps_25:
    buffer_store_dword v23, off, s[64:67], s80 sc1
    s_branch L_pb_26
L_fs_27:
    s_mov_b32 s87, 0
L_fl_89:
    buffer_load_dword v16, v4, s[64:67], s80 offen offset:0 sc1
    s_waitcnt vmcnt(0)
    v_cmp_eq_u32 vcc, 0, v16
    s_cbranch_vccz L_fb_28
    s_add_u32 s87, s87, 1
    s_cmp_lt_u32 s87, 0x200000
    s_cbranch_scc1 L_fl_89
    s_branch L_end
L_fs_30:
    s_mov_b32 s87, 0
L_fl_90:
    buffer_load_dword v73, v72, s[92:95], 0 offen offset:0 sc1
    s_waitcnt vmcnt(0)
    v_cmp_eq_u32 vcc, 0, v73
    s_cbranch_vccz L_fb_31
    s_add_u32 s87, s87, 1
    s_cmp_lt_u32 s87, 0x200000
    s_cbranch_scc1 L_fl_90
    s_branch L_end
L_fs_32:
    s_mov_b32 s87, 0
L_fl_91:
    buffer_load_dword v16, v72, s[64:67], 0 offen offset:0 sc1
    s_waitcnt vmcnt(0)
    v_cmp_eq_u32 vcc, 0, v16
    s_cbranch_vccz L_fb_33
    s_add_u32 s87, s87, 1
    s_cmp_lt_u32 s87, 0x200000
    s_cbranch_scc1 L_fl_91
    s_branch L_end
L_ps_34:
    buffer_store_dwordx2 v[18:19], v17, s[64:67], s80 offen sc1
    s_branch L_pb_35
L_ps_36:
    buffer_store_dwordx2 v[56:57], v17, s[64:67], s81 offen sc1
    s_branch L_pb_37
L_ps_38:
    buffer_store_dword v23, off, s[64:67], s12 offset:0 sc1
    buffer_store_dword v23, off, s[64:67], s12 offset:256 sc1
    s_branch L_pb_39
L_fs_40:
    s_mov_b32 s87, 0
L_fl_92:
    buffer_load_dword v16, v72, s[64:67], s13 offen offset:0 sc1
    s_waitcnt vmcnt(0)
    v_cmp_eq_u32 vcc, 0, v16
    s_cbranch_vccz L_fb_41
    s_add_u32 s87, s87, 1
    s_cmp_lt_u32 s87, 0x200000
    s_cbranch_scc1 L_fl_92
    s_branch L_end
L_ts_42:
    s_mov_b32 s87, 0
L_tl_93:
    s_add_u32 s46, s9, 0x0
    buffer_load_dwordx2 v[64:65], v22, s[64:67], s46 offen offset:0 sc1
    buffer_load_dwordx2 v[66:67], v22, s[64:67], s46 offen offset:256 sc1
    buffer_load_dwordx2 v[68:69], v22, s[64:67], s46 offen offset:128 sc1
    buffer_load_dwordx2 v[70:71], v22, s[64:67], s46 offen offset:384 sc1
    s_waitcnt vmcnt(0)
    v_xor_b32 v72, 0xbf800000, v65
    v_xor_b32 v73, 0xbf800000, v67
    v_min_u32 v72, v72, v73
    v_xor_b32 v73, 0xbf800000, v69
    v_min_u32 v72, v72, v73
    v_xor_b32 v73, 0xbf800000, v71
    v_min_u32 v72, v72, v73
    v_cmp_eq_u32 vcc, 0, v72
    s_cbranch_vccz L_tb_43
    s_add_u32 s87, s87, 1
    s_cmp_lt_u32 s87, 0x200000
    s_cbranch_scc1 L_tl_93
    s_branch L_end
L_ts_44:
    s_mov_b32 s87, 0
L_tl_94:
    s_add_u32 s46, s9, 0x800
    buffer_load_dwordx2 v[64:65], v22, s[64:67], s46 offen offset:0 sc1
    buffer_load_dwordx2 v[66:67], v22, s[64:67], s46 offen offset:256 sc1
    buffer_load_dwordx2 v[68:69], v22, s[64:67], s46 offen offset:128 sc1
    buffer_load_dwordx2 v[70:71], v22, s[64:67], s46 offen offset:384 sc1
    s_waitcnt vmcnt(0)
    v_xor_b32 v72, 0xbf800000, v65
    v_xor_b32 v73, 0xbf800000, v67
    v_min_u32 v72, v72, v73
    v_xor_b32 v73, 0xbf800000, v69
    v_min_u32 v72, v72, v73
    v_xor_b32 v73, 0xbf800000, v71
    v_min_u32 v72, v72, v73
    v_cmp_eq_u32 vcc, 0, v72
    s_cbranch_vccz L_tb_45
    s_add_u32 s87, s87, 1
    s_cmp_lt_u32 s87, 0x200000
    s_cbranch_scc1 L_tl_94
    s_branch L_end
L_ps_46:
    buffer_store_dword v23, off, s[64:67], s26 offset:0 sc1
    s_branch L_pb_47
L_fs_48:
    s_mov_b32 s87, 0
L_fl_95:
    buffer_load_dword v16, v5, s[64:67], s27 offen offset:0 sc1
    s_waitcnt vmcnt(0)
    v_cmp_eq_u32 vcc, 0, v16
    s_cbranch_vccz L_fb_49
    s_add_u32 s87, s87, 1
    s_cmp_lt_u32 s87, 0x200000
    s_cbranch_scc1 L_fl_95
    s_branch L_end
L_ps_50:
    buffer_store_dword v23, off, s[64:67], s26 offset:256 sc1
    s_branch L_pb_51
L_fs_52:
    s_mov_b32 s87, 0
L_fl_96:
    buffer_load_dword v16, v5, s[64:67], s27 offen offset:256 sc1
    s_waitcnt vmcnt(0)
    v_cmp_eq_u32 vcc, 0, v16
    s_cbranch_vccz L_fb_53
    s_add_u32 s87, s87, 1
    s_cmp_lt_u32 s87, 0x200000
    s_cbranch_scc1 L_fl_96
    s_branch L_end
L_ps_54:
    buffer_store_dwordx2 v[18:19], v17, s[64:67], s25 offen offset:0 sc1
    s_branch L_pb_55
L_ss_56:
    s_mov_b32 s87, 0
L_sl_97:
    buffer_load_dwordx2 v[18:19], v17, s[64:67], s6 offen offset:0 sc1
    s_waitcnt vmcnt(0)
    v_cmp_eq_u32 vcc, 0xbf800000, v19
    s_cbranch_vccz L_sb_57
    s_add_u32 s87, s87, 1
    s_cmp_lt_u32 s87, 0x200000
    s_cbranch_scc1 L_sl_97
    s_branch L_end
L_ps_58:
    buffer_store_dwordx2 v[18:19], v17, s[64:67], s80 offen sc1
    s_branch L_pb_59
L_ps_60:
    buffer_store_dword v23, off, s[64:67], s12 offset:2048 sc1
    s_branch L_pb_61
L_ps_62:
    buffer_store_dwordx2 v[56:57], v17, s[64:67], s25 offen offset:2048 sc1
    s_branch L_pb_63
L_fs_64:
    s_mov_b32 s87, 0
L_fl_98:
    buffer_load_dword v16, v4, s[64:67], s13 offen offset:2048 sc1
    s_waitcnt vmcnt(0)
    v_cmp_eq_u32 vcc, 0, v16
    s_cbranch_vccz L_fb_65
    s_add_u32 s87, s87, 1
    s_cmp_lt_u32 s87, 0x200000
    s_cbranch_scc1 L_fl_98
    s_branch L_end
L_ss_66:
    s_mov_b32 s87, 0
L_sl_99:
    buffer_load_dwordx2 v[56:57], v17, s[64:67], s6 offen offset:2048 sc1
    s_waitcnt vmcnt(0)
    v_cmp_eq_u32 vcc, 0xbf800000, v57
    s_cbranch_vccz L_sb_67
    s_add_u32 s87, s87, 1
    s_cmp_lt_u32 s87, 0x200000
    s_cbranch_scc1 L_sl_99
    s_branch L_end
L_ps_68:
    buffer_store_dwordx2 v[56:57], v17, s[64:67], s81 offen sc1
    s_branch L_pb_69
L_ts_70:
    s_mov_b32 s87, 0
L_tl_100:
    s_add_u32 s46, s9, 0x20000
    buffer_load_dwordx2 v[64:65], v22, s[64:67], s46 offen offset:0 sc1
    buffer_load_dwordx2 v[66:67], v22, s[64:67], s46 offen offset:256 sc1
    buffer_load_dwordx2 v[68:69], v22, s[64:67], s46 offen offset:128 sc1
    buffer_load_dwordx2 v[70:71], v22, s[64:67], s46 offen offset:384 sc1
    s_waitcnt vmcnt(0)
    v_xor_b32 v72, 0xbf800000, v65
    v_xor_b32 v73, 0xbf800000, v67
    v_min_u32 v72, v72, v73
    v_xor_b32 v73, 0xbf800000, v69
    v_min_u32 v72, v72, v73
    v_xor_b32 v73, 0xbf800000, v71
    v_min_u32 v72, v72, v73
    v_cmp_eq_u32 vcc, 0, v72
    s_cbranch_vccz L_tb_71
    s_add_u32 s87, s87, 1
    s_cmp_lt_u32 s87, 0x200000
    s_cbranch_scc1 L_tl_100
    s_branch L_end
L_ps_72:
    buffer_store_dword v23, off, s[64:67], s12 offset:2304 sc1
    s_branch L_pb_73
L_fs_74:
    s_mov_b32 s87, 0
L_fl_101:
    buffer_load_dword v16, v4, s[64:67], s13 offen offset:2304 sc1
    s_waitcnt vmcnt(0)
    v_cmp_eq_u32 vcc, 0, v16
    s_cbranch_vccz L_fb_75
    s_add_u32 s87, s87, 1
    s_cmp_lt_u32 s87, 0x200000
    s_cbranch_scc1 L_fl_101
    s_branch L_end
L_ts_76:
    s_mov_b32 s87, 0
L_tl_102:
    s_add_u32 s46, s9, 0x20800
    buffer_load_dwordx2 v[64:65], v22, s[64:67], s46 offen offset:0 sc1
    buffer_load_dwordx2 v[66:67], v22, s[64:67], s46 offen offset:256 sc1
    buffer_load_dwordx2 v[68:69], v22, s[64:67], s46 offen offset:128 sc1
    buffer_load_dwordx2 v[70:71], v22, s[64:67], s46 offen offset:384 sc1
    s_waitcnt vmcnt(0)
    v_xor_b32 v72, 0xbf800000, v65
    v_xor_b32 v73, 0xbf800000, v67
    v_min_u32 v72, v72, v73
    v_xor_b32 v73, 0xbf800000, v69
    v_min_u32 v72, v72, v73
    v_xor_b32 v73, 0xbf800000, v71
    v_min_u32 v72, v72, v73
    v_cmp_eq_u32 vcc, 0, v72
    s_cbranch_vccz L_tb_77
    s_add_u32 s87, s87, 1
    s_cmp_lt_u32 s87, 0x200000
    s_cbranch_scc1 L_tl_102
    s_branch L_end
L_ps_78:
    buffer_store_dword v23, off, s[64:67], s26 offset:2048 sc1
    s_branch L_pb_79
L_fs_80:
    s_mov_b32 s87, 0
L_fl_103:
    buffer_load_dword v16, v5, s[64:67], s27 offen offset:2048 sc1
    s_waitcnt vmcnt(0)
    v_cmp_eq_u32 vcc, 0, v16
    s_cbranch_vccz L_fb_81
    s_add_u32 s87, s87, 1
    s_cmp_lt_u32 s87, 0x200000
    s_cbranch_scc1 L_fl_103
    s_branch L_end
L_ps_82:
    buffer_store_dword v23, off, s[64:67], s26 offset:2304 sc1
    s_branch L_pb_83
L_fs_84:
    s_mov_b32 s87, 0
L_fl_104:
    buffer_load_dword v16, v5, s[64:67], s27 offen offset:2304 sc1
    s_waitcnt vmcnt(0)
    v_cmp_eq_u32 vcc, 0, v16
    s_cbranch_vccz L_fb_85
    s_add_u32 s87, s87, 1
    s_cmp_lt_u32 s87, 0x200000
    s_cbranch_scc1 L_fl_104
    s_branch L_end
L_odd:
    ds_read_b128 a[224:227], v2 offset:0
    ds_read_b128 a[228:231], v3 offset:0
    ds_read_b128 a[232:235], v2 offset:1024
    ds_read_b128 a[236:239], v3 offset:1024
    ds_read_b128 a[240:243], v2 offset:2048
    ds_read_b128 a[244:247], v3 offset:2048
    ds_read_b128 a[248:251], v2 offset:4096
    ds_read_b128 a[252:255], v3 offset:4096
    s_waitcnt vmcnt(13) lgkmcnt(4)
    v_mfma_f32_16x16x32_bf16 v[208:211], a[224:227], v[80:83], 0
    buffer_load_dwordx4 v[120:123], v78, s[64:67], s34 offen offset:2048 sc1
    v_mfma_f32_16x16x32_bf16 v[212:215], a[228:231], v[80:83], 0
    s_waitcnt vmcnt(13)
    v_mfma_f32_16x16x32_bf16 v[216:219], a[224:227], v[84:87], 0
    v_mfma_f32_16x16x32_bf16 v[220:223], a[228:231], v[84:87], 0
    v_mfma_f32_16x16x32_bf16 v[224:227], a[232:235], v[80:83], 0
    buffer_load_dwordx4 v[124:127], v78, s[64:67], s34 offen offset:2304 sc1
    v_mfma_f32_16x16x32_bf16 v[228:231], a[236:239], v[80:83], 0
    v_mfma_f32_16x16x32_bf16 v[232:235], a[232:235], v[84:87], 0
    ds_read_b128 a[224:227], v2 offset:5120
    ds_read_b128 a[228:231], v3 offset:5120
    v_mfma_f32_16x16x32_bf16 v[236:239], a[236:239], v[84:87], 0
    s_waitcnt lgkmcnt(2)
    v_mfma_f32_16x16x32_bf16 v[240:243], a[240:243], v[80:83], 0
    buffer_load_dwordx4 v[128:131], v78, s[64:67], s35 offen offset:0 sc1
    v_mfma_f32_16x16x32_bf16 v[244:247], a[244:247], v[80:83], 0
    v_mfma_f32_16x16x32_bf16 v[248:251], a[240:243], v[84:87], 0
    ds_read_b128 a[232:235], v2 offset:6144
    ds_read_b128 a[236:239], v3 offset:6144
    v_mfma_f32_16x16x32_bf16 v[252:255], a[244:247], v[84:87], 0
    s_waitcnt vmcnt(13)
    v_mfma_f32_16x16x32_bf16 v[208:211], a[248:251], v[88:91], v[208:211]
    buffer_load_dwordx4 v[132:135], v78, s[64:67], s35 offen offset:256 sc1
    v_mfma_f32_16x16x32_bf16 v[212:215], a[252:255], v[88:91], v[212:215]
    v_mfma_f32_16x16x32_bf16 v[216:219], a[248:251], v[92:95], v[216:219]
    ds_read_b128 a[240:243], v2 offset:8192
    ds_read_b128 a[244:247], v3 offset:8192
    v_mfma_f32_16x16x32_bf16 v[220:223], a[252:255], v[92:95], v[220:223]
    s_waitcnt lgkmcnt(2)
    v_mfma_f32_16x16x32_bf16 v[224:227], a[224:227], v[88:91], v[224:227]
    buffer_load_dwordx4 v[136:139], v78, s[64:67], s35 offen offset:2048 sc1
    v_mfma_f32_16x16x32_bf16 v[228:231], a[228:231], v[88:91], v[228:231]
    s_add_u32 s80, s8, 0x8000
    v_add_u32 v79, s80, v0
    v_mfma_f32_16x16x32_bf16 v[232:235], a[224:227], v[92:95], v[232:235]
    ds_read_b128 a[248:251], v2 offset:9216
    ds_read_b128 a[252:255], v3 offset:9216
    v_mfma_f32_16x16x32_bf16 v[236:239], a[228:231], v[92:95], v[236:239]
    v_mfma_f32_16x16x32_bf16 v[240:243], a[232:235], v[88:91], v[240:243]
    buffer_load_dwordx4 v[140:143], v78, s[64:67], s35 offen offset:2304 sc1
    v_mfma_f32_16x16x32_bf16 v[244:247], a[236:239], v[88:91], v[244:247]
    v_mfma_f32_16x16x32_bf16 v[248:251], a[232:235], v[92:95], v[248:251]
    ds_read_b128 a[224:227], v2 offset:10240
    ds_read_b128 a[228:231], v3 offset:10240
    v_mfma_f32_16x16x32_bf16 v[252:255], a[236:239], v[92:95], v[252:255]
    s_add_u32 s46, s9, 0x0
    buffer_load_dwordx2 v[64:65], v22, s[64:67], s46 offen offset:0 sc1
    s_waitcnt vmcnt(15) lgkmcnt(2)
    v_mfma_f32_16x16x32_bf16 v[208:211], a[240:243], v[96:99], v[208:211]
    buffer_load_dwordx4 v[80:83], v78, s[64:67], s36 offen offset:0 sc1
    v_mfma_f32_16x16x32_bf16 v[212:215], a[244:247], v[96:99], v[212:215]
    buffer_load_dwordx2 v[66:67], v22, s[64:67], s46 offen offset:256 sc1
    v_mfma_f32_16x16x32_bf16 v[216:219], a[240:243], v[100:103], v[216:219]
    ds_read_b128 a[232:235], v2 offset:12288
    ds_read_b128 a[236:239], v3 offset:12288
    v_mfma_f32_16x16x32_bf16 v[220:223], a[244:247], v[100:103], v[220:223]
    buffer_load_dwordx2 v[68:69], v22, s[64:67], s46 offen offset:128 sc1
    v_mfma_f32_16x16x32_bf16 v[224:227], a[248:251], v[96:99], v[224:227]
    buffer_load_dwordx4 v[84:87], v78, s[64:67], s36 offen offset:256 sc1
    v_mfma_f32_16x16x32_bf16 v[228:231], a[252:255], v[96:99], v[228:231]
    v_mfma_f32_16x16x32_bf16 v[232:235], a[248:251], v[100:103], v[232:235]
    ds_read_b128 a[240:243], v2 offset:13312
    ds_read_b128 a[244:247], v3 offset:13312
    v_mfma_f32_16x16x32_bf16 v[236:239], a[252:255], v[100:103], v[236:239]
    buffer_load_dwordx2 v[70:71], v22, s[64:67], s46 offen offset:384 sc1
    s_waitcnt lgkmcnt(2)
    v_mfma_f32_16x16x32_bf16 v[240:243], a[224:227], v[96:99], v[240:243]
    buffer_load_dwordx4 v[88:91], v78, s[64:67], s36 offen offset:2048 sc1
    v_mfma_f32_16x16x32_bf16 v[244:247], a[228:231], v[96:99], v[244:247]
    v_mfma_f32_16x16x32_bf16 v[248:251], a[224:227], v[100:103], v[248:251]
    ds_read_b128 a[248:251], v2 offset:14336
    ds_read_b128 a[252:255], v3 offset:14336
    v_mfma_f32_16x16x32_bf16 v[252:255], a[228:231], v[100:103], v[252:255]
    s_waitcnt vmcnt(19)
    v_mfma_f32_16x16x32_bf16 v[208:211], a[232:235], v[104:107], v[208:211]
    buffer_load_dwordx4 v[92:95], v78, s[64:67], s36 offen offset:2304 sc1
    v_mfma_f32_16x16x32_bf16 v[212:215], a[236:239], v[104:107], v[212:215]
    v_mfma_f32_16x16x32_bf16 v[216:219], a[232:235], v[108:111], v[216:219]
    ds_read_b128 a[224:227], v2 offset:16384
    ds_read_b128 a[228:231], v3 offset:16384
    v_mfma_f32_16x16x32_bf16 v[220:223], a[236:239], v[108:111], v[220:223]
    s_waitcnt lgkmcnt(2)
    v_mfma_f32_16x16x32_bf16 v[224:227], a[240:243], v[104:107], v[224:227]
    buffer_load_dwordx4 v[96:99], v78, s[64:67], s37 offen offset:0 sc1
    v_mfma_f32_16x16x32_bf16 v[228:231], a[244:247], v[104:107], v[228:231]
    v_mfma_f32_16x16x32_bf16 v[232:235], a[240:243], v[108:111], v[232:235]
    ds_read_b128 a[232:235], v2 offset:17408
    ds_read_b128 a[236:239], v3 offset:17408
    v_mfma_f32_16x16x32_bf16 v[236:239], a[244:247], v[108:111], v[236:239]
    v_mfma_f32_16x16x32_bf16 v[240:243], a[248:251], v[104:107], v[240:243]
    buffer_load_dwordx4 v[100:103], v78, s[64:67], s37 offen offset:256 sc1
    v_mfma_f32_16x16x32_bf16 v[244:247], a[252:255], v[104:107], v[244:247]
    v_mfma_f32_16x16x32_bf16 v[248:251], a[248:251], v[108:111], v[248:251]
    ds_read_b128 a[240:243], v2 offset:18432
    ds_read_b128 a[244:247], v3 offset:18432
    v_mfma_f32_16x16x32_bf16 v[252:255], a[252:255], v[108:111], v[252:255]
    s_waitcnt vmcnt(20) lgkmcnt(2)
    v_mfma_f32_16x16x32_bf16 v[208:211], a[224:227], v[112:115], v[208:211]
    s_lshl_b32 s14, s70, 1
    s_add_u32 s14, s14, s3
    buffer_load_dwordx4 a[64:67], v2, s[64:67], s14 offen offset:0 sc1
    v_mfma_f32_16x16x32_bf16 v[212:215], a[228:231], v[112:115], v[212:215]
    v_mfma_f32_16x16x32_bf16 v[216:219], a[224:227], v[116:119], v[216:219]
    ds_read_b128 a[248:251], v2 offset:20480
    ds_read_b128 a[252:255], v3 offset:20480
    v_mfma_f32_16x16x32_bf16 v[220:223], a[228:231], v[116:119], v[220:223]
    v_mfma_f32_16x16x32_bf16 v[224:227], a[232:235], v[112:115], v[224:227]
    buffer_load_dwordx4 a[68:71], v2, s[64:67], s14 offen offset:1024 sc1
    v_mfma_f32_16x16x32_bf16 v[228:231], a[236:239], v[112:115], v[228:231]
    v_mfma_f32_16x16x32_bf16 v[232:235], a[232:235], v[116:119], v[232:235]
    ds_read_b128 a[224:227], v2 offset:21504
    ds_read_b128 a[228:231], v3 offset:21504
    v_mfma_f32_16x16x32_bf16 v[236:239], a[236:239], v[116:119], v[236:239]
    s_waitcnt lgkmcnt(2)
    v_mfma_f32_16x16x32_bf16 v[240:243], a[240:243], v[112:115], v[240:243]
    buffer_load_dwordx4 a[72:75], v2, s[64:67], s14 offen offset:2048 sc1
    v_mfma_f32_16x16x32_bf16 v[244:247], a[244:247], v[112:115], v[244:247]
    v_mfma_f32_16x16x32_bf16 v[248:251], a[240:243], v[116:119], v[248:251]
    ds_read_b128 a[232:235], v2 offset:22528
    ds_read_b128 a[236:239], v3 offset:22528
    v_mfma_f32_16x16x32_bf16 v[252:255], a[244:247], v[116:119], v[252:255]
    s_waitcnt vmcnt(17)
    v_mfma_f32_16x16x32_bf16 v[208:211], a[248:251], v[120:123], v[208:211]
    buffer_load_dwordx4 a[76:79], v2, s[64:67], s14 offen offset:3072 sc1
    v_mfma_f32_16x16x32_bf16 v[212:215], a[252:255], v[120:123], v[212:215]
    v_mfma_f32_16x16x32_bf16 v[216:219], a[248:251], v[124:127], v[216:219]
    ds_read_b128 a[240:243], v2 offset:24576
    ds_read_b128 a[244:247], v3 offset:24576
    v_mfma_f32_16x16x32_bf16 v[220:223], a[252:255], v[124:127], v[220:223]
    s_waitcnt lgkmcnt(2)
    v_mfma_f32_16x16x32_bf16 v[224:227], a[224:227], v[120:123], v[224:227]
    buffer_load_dwordx4 v[104:107], v78, s[64:67], s37 offen offset:2048 sc1
    v_mfma_f32_16x16x32_bf16 v[228:231], a[228:231], v[120:123], v[228:231]
    v_mfma_f32_16x16x32_bf16 v[232:235], a[224:227], v[124:127], v[232:235]
    ds_read_b128 a[248:251], v2 offset:25600
    ds_read_b128 a[252:255], v3 offset:25600
    v_mfma_f32_16x16x32_bf16 v[236:239], a[228:231], v[124:127], v[236:239]
    v_mfma_f32_16x16x32_bf16 v[240:243], a[232:235], v[120:123], v[240:243]
    buffer_load_dwordx4 v[108:111], v78, s[64:67], s37 offen offset:2304 sc1
    v_mfma_f32_16x16x32_bf16 v[244:247], a[236:239], v[120:123], v[244:247]
    v_mfma_f32_16x16x32_bf16 v[248:251], a[232:235], v[124:127], v[248:251]
    ds_read_b128 a[224:227], v2 offset:26624
    ds_read_b128 a[228:231], v3 offset:26624
    v_mfma_f32_16x16x32_bf16 v[252:255], a[236:239], v[124:127], v[252:255]
    s_waitcnt vmcnt(18) lgkmcnt(2)
    v_mfma_f32_16x16x32_bf16 v[208:211], a[240:243], v[128:131], v[208:211]
    buffer_load_dwordx4 v[112:115], v78, s[64:67], s38 offen offset:0 sc1
    v_mfma_f32_16x16x32_bf16 v[212:215], a[244:247], v[128:131], v[212:215]
    s_waitcnt vmcnt(11)
    v_min3_i32 v72, v65, v67, v69
    v_mfma_f32_16x16x32_bf16 v[216:219], a[240:243], v[132:135], v[216:219]
    ds_read_b128 a[232:235], v2 offset:28672
    ds_read_b128 a[236:239], v3 offset:28672
    v_mfma_f32_16x16x32_bf16 v[220:223], a[244:247], v[132:135], v[220:223]
    v_min_i32 v72, v72, v71
    v_mfma_f32_16x16x32_bf16 v[224:227], a[248:251], v[128:131], v[224:227]
    buffer_load_dwordx4 v[116:119], v78, s[64:67], s38 offen offset:256 sc1
    v_mfma_f32_16x16x32_bf16 v[228:231], a[252:255], v[128:131], v[228:231]
    v_cmp_gt_i32 vcc, 0, v72
    s_cbranch_vccnz L_ts_105
L_tb_106:
    v_mfma_f32_16x16x32_bf16 v[232:235], a[248:251], v[132:135], v[232:235]
    ds_read_b128 a[240:243], v2 offset:29696
    ds_read_b128 a[244:247], v3 offset:29696
    v_mfma_f32_16x16x32_bf16 v[236:239], a[252:255], v[132:135], v[236:239]
    v_add_f32 v64, v64, v66
    s_waitcnt lgkmcnt(2)
    v_mfma_f32_16x16x32_bf16 v[240:243], a[224:227], v[128:131], v[240:243]
    buffer_load_dwordx4 v[120:123], v78, s[64:67], s38 offen offset:2048 sc1
    v_mfma_f32_16x16x32_bf16 v[244:247], a[228:231], v[128:131], v[244:247]
    v_add_f32 v68, v68, v70
    v_add_f32 v65, v65, v67
    v_mfma_f32_16x16x32_bf16 v[248:251], a[224:227], v[132:135], v[248:251]
    ds_read_b128 a[248:251], v2 offset:30720
    ds_read_b128 a[252:255], v3 offset:30720
    v_mfma_f32_16x16x32_bf16 v[252:255], a[228:231], v[132:135], v[252:255]
    v_add_f32 v69, v69, v71
    v_permlane32_swap_b32 v64, v68
    v_mfma_f32_16x16x32_bf16 v[208:211], a[232:235], v[136:139], v[208:211]
    buffer_load_dwordx4 v[124:127], v78, s[64:67], s38 offen offset:2304 sc1
    v_mfma_f32_16x16x32_bf16 v[212:215], a[236:239], v[136:139], v[212:215]
    v_add_f32 v64, v64, v68
    v_permlane32_swap_b32 v65, v69
    v_mfma_f32_16x16x32_bf16 v[216:219], a[232:235], v[140:143], v[216:219]
    ds_read_b128 a[224:227], v2 offset:32768
    ds_read_b128 a[228:231], v3 offset:32768
    v_mfma_f32_16x16x32_bf16 v[220:223], a[236:239], v[140:143], v[220:223]
    v_add_f32 v65, v65, v69
    s_waitcnt lgkmcnt(2)
    v_mfma_f32_16x16x32_bf16 v[224:227], a[240:243], v[136:139], v[224:227]
    buffer_load_dwordx4 v[128:131], v78, s[64:67], s39 offen offset:0 sc1
    v_mfma_f32_16x16x32_bf16 v[228:231], a[244:247], v[136:139], v[228:231]
    v_permlane16_swap_b32 v64, v65
    v_add_f32 v64, v64, v65
    v_mfma_f32_16x16x32_bf16 v[232:235], a[240:243], v[140:143], v[232:235]
    ds_read_b128 a[232:235], v2 offset:33792
    ds_read_b128 a[236:239], v3 offset:33792
    v_mfma_f32_16x16x32_bf16 v[236:239], a[244:247], v[140:143], v[236:239]
    v_mul_f32 v64, 0x3b000000, v64
    v_mov_b32 v65, v64
    v_mfma_f32_16x16x32_bf16 v[240:243], a[248:251], v[136:139], v[240:243]
    s_add_u32 s14, s14, 4096
    buffer_load_dwordx4 a[80:83], v2, s[64:67], s14 offen offset:0 sc1
    v_mfma_f32_16x16x32_bf16 v[244:247], a[252:255], v[136:139], v[244:247]
    v_permlane16_swap_b32 v64, v65
    v_fma_f32 v65, -v64, v64, v65
    v_mfma_f32_16x16x32_bf16 v[248:251], a[248:251], v[140:143], v[248:251]
    ds_read_b128 a[240:243], v2 offset:34816
    ds_read_b128 a[244:247], v3 offset:34816
    v_mfma_f32_16x16x32_bf16 v[252:255], a[252:255], v[140:143], v[252:255]
    v_cvt_pk_bf16_f32 v37, v64, 0
    s_waitcnt lgkmcnt(2)
    v_mfma_f32_16x16x32_bf16 v[208:211], a[224:227], v[80:83], v[208:211]
    buffer_load_dwordx4 a[84:87], v2, s[64:67], s14 offen offset:1024 sc1
    v_mfma_f32_16x16x32_bf16 v[212:215], a[228:231], v[80:83], v[212:215]
    v_max_f32 v65, 0, v65
    v_lshlrev_b32 v67, 16, v37
    v_mfma_f32_16x16x32_bf16 v[216:219], a[224:227], v[84:87], v[216:219]
    ds_read_b128 a[248:251], v2 offset:36864
    ds_read_b128 a[252:255], v3 offset:36864
    v_mfma_f32_16x16x32_bf16 v[220:223], a[228:231], v[84:87], v[220:223]
    v_add_f32 v19, 0x3727c5ac, v65
    v_sub_f32 v67, v64, v67
    v_mfma_f32_16x16x32_bf16 v[224:227], a[232:235], v[80:83], v[224:227]
    buffer_load_dwordx4 a[88:91], v2, s[64:67], s14 offen offset:2048 sc1
    v_mfma_f32_16x16x32_bf16 v[228:231], a[236:239], v[80:83], v[228:231]
    v_rsq_f32 v18, v19
    v_mfma_f32_16x16x32_bf16 v[232:235], a[232:235], v[84:87], v[232:235]
    ds_read_b128 a[224:227], v2 offset:37888
    ds_read_b128 a[228:231], v3 offset:37888
    v_mfma_f32_16x16x32_bf16 v[236:239], a[236:239], v[84:87], v[236:239]
    v_cvt_pk_bf16_f32 v36, v64, v67
    s_waitcnt lgkmcnt(2)
    v_mfma_f32_16x16x32_bf16 v[240:243], a[240:243], v[80:83], v[240:243]
    buffer_load_dwordx4 a[92:95], v2, s[64:67], s14 offen offset:3072 sc1
    v_mfma_f32_16x16x32_bf16 v[244:247], a[244:247], v[80:83], v[244:247]
    v_mul_f32 v18, 0xbfb8aa3b, v18
    v_mov_b32 v21, v19
    v_mfma_f32_16x16x32_bf16 v[248:251], a[240:243], v[84:87], v[248:251]
    ds_read_b128 a[232:235], v2 offset:38912
    ds_read_b128 a[236:239], v3 offset:38912
    v_mfma_f32_16x16x32_bf16 v[252:255], a[244:247], v[84:87], v[252:255]
    v_mov_b32 v39, v37
    v_mov_b32 v38, v36
    s_waitcnt vmcnt(17)
    v_mfma_f32_16x16x32_bf16 v[208:211], a[248:251], v[88:91], v[208:211]
    buffer_load_dwordx4 v[132:135], v78, s[64:67], s39 offen offset:256 sc1
    v_mfma_f32_16x16x32_bf16 v[212:215], a[252:255], v[88:91], v[212:215]
    v_mov_b32 v20, v18
    v_permlane32_swap_b32 v19, v21
    v_mfma_f32_16x16x32_bf16 v[216:219], a[248:251], v[92:95], v[216:219]
    ds_read_b128 a[240:243], v2 offset:40960
    ds_read_b128 a[244:247], v3 offset:40960
    v_mfma_f32_16x16x32_bf16 v[220:223], a[252:255], v[92:95], v[220:223]
    v_permlane32_swap_b32 v37, v39
    s_waitcnt lgkmcnt(2)
    v_mfma_f32_16x16x32_bf16 v[224:227], a[224:227], v[88:91], v[224:227]
    buffer_load_dwordx4 v[136:139], v78, s[64:67], s39 offen offset:2048 sc1
    v_mfma_f32_16x16x32_bf16 v[228:231], a[228:231], v[88:91], v[228:231]
    v_permlane32_swap_b32 v36, v38
    v_permlane32_swap_b32 v18, v20
    v_mfma_f32_16x16x32_bf16 v[232:235], a[224:227], v[92:95], v[232:235]
    ds_read_b128 a[248:251], v2 offset:41984
    ds_read_b128 a[252:255], v3 offset:41984
    v_mfma_f32_16x16x32_bf16 v[236:239], a[228:231], v[92:95], v[236:239]
    s_lshl_b64 s[40:41], s[44:45], 0
    v_cndmask_b32 v24, 0, v36, s[40:41]
    v_mfma_f32_16x16x32_bf16 v[240:243], a[232:235], v[88:91], v[240:243]
    buffer_load_dwordx4 v[140:143], v78, s[64:67], s39 offen offset:2304 sc1
    v_mfma_f32_16x16x32_bf16 v[244:247], a[236:239], v[88:91], v[244:247]
    v_cndmask_b32 v25, 0, v37, s[40:41]
    v_cndmask_b32 v26, 0, v38, s[40:41]
    v_mfma_f32_16x16x32_bf16 v[248:251], a[232:235], v[92:95], v[248:251]
    ds_read_b128 a[224:227], v2 offset:43008
    ds_read_b128 a[228:231], v3 offset:43008
    v_mfma_f32_16x16x32_bf16 v[252:255], a[236:239], v[92:95], v[252:255]
    v_cndmask_b32 v27, 0, v39, s[40:41]
    s_waitcnt vmcnt(18) lgkmcnt(2)
    v_mfma_f32_16x16x32_bf16 v[208:211], a[240:243], v[96:99], v[208:211]
    buffer_load_dwordx4 v[80:83], v79, s[64:67], s32 offen offset:0 sc1
    v_mfma_f32_16x16x32_bf16 v[212:215], a[244:247], v[96:99], v[212:215]
    v_mfma_f32_16x16x32_bf16 v[216:219], a[240:243], v[100:103], v[216:219]
    ds_read_b128 a[232:235], v2 offset:45056
    ds_read_b128 a[236:239], v3 offset:45056
    v_mfma_f32_16x16x32_bf16 v[220:223], a[244:247], v[100:103], v[220:223]
    v_mfma_f32_16x16x32_bf16 v[224:227], a[248:251], v[96:99], v[224:227]
    buffer_load_dwordx4 v[84:87], v79, s[64:67], s32 offen offset:256 sc1
    v_mfma_f32_16x16x32_bf16 v[228:231], a[252:255], v[96:99], v[228:231]
    v_mfma_f32_16x16x32_bf16 v[232:235], a[248:251], v[100:103], v[232:235]
    ds_read_b128 a[240:243], v2 offset:49152
    ds_read_b128 a[244:247], v3 offset:49152
    v_mfma_f32_16x16x32_bf16 v[236:239], a[252:255], v[100:103], v[236:239]
    s_waitcnt lgkmcnt(2)
    v_mfma_f32_16x16x32_bf16 v[240:243], a[224:227], v[96:99], v[240:243]
    buffer_load_dwordx4 v[88:91], v79, s[64:67], s32 offen offset:2048 sc1
    v_mfma_f32_16x16x32_bf16 v[244:247], a[228:231], v[96:99], v[244:247]
    v_mfma_f32_16x16x32_bf16 v[248:251], a[224:227], v[100:103], v[248:251]
    ds_read_b128 a[248:251], v2 offset:53248
    ds_read_b128 a[252:255], v3 offset:53248
    v_mfma_f32_16x16x32_bf16 v[252:255], a[228:231], v[100:103], v[252:255]
    s_waitcnt vmcnt(15)
    v_mfma_f32_16x16x32_bf16 v[208:211], a[232:235], v[104:107], v[208:211]
    s_lshl_b32 s14, s71, 1
    s_add_u32 s14, s14, s3
    buffer_load_dwordx4 a[96:99], v2, s[64:67], s14 offen offset:0 sc1
    v_mfma_f32_16x16x32_bf16 v[212:215], a[236:239], v[104:107], v[212:215]
    v_mfma_f32_16x16x32_bf16 v[216:219], a[232:235], v[108:111], v[216:219]
    ds_read_b128 a[224:227], v2 offset:57344
    ds_read_b128 a[228:231], v3 offset:57344
    v_mfma_f32_16x16x32_bf16 v[220:223], a[236:239], v[108:111], v[220:223]
    s_waitcnt vmcnt(14) lgkmcnt(2)
    v_mfma_f32_16x16x32_bf16 v[208:211], a[240:243], v[112:115], v[208:211]
    buffer_load_dwordx4 a[100:103], v2, s[64:67], s14 offen offset:1024 sc1
    v_mfma_f32_16x16x32_bf16 v[212:215], a[244:247], v[112:115], v[212:215]
    v_mfma_f32_16x16x32_bf16 v[216:219], a[240:243], v[116:119], v[216:219]
    ds_read_b128 a[232:235], v2 offset:61440
    ds_read_b128 a[236:239], v3 offset:61440
    v_mfma_f32_16x16x32_bf16 v[220:223], a[244:247], v[116:119], v[220:223]
    s_waitcnt vmcnt(13)
    v_mfma_f32_16x16x32_bf16 v[208:211], a[248:251], v[120:123], v[208:211]
    buffer_load_dwordx4 a[104:107], v2, s[64:67], s14 offen offset:2048 sc1
    v_mfma_f32_16x16x32_bf16 v[212:215], a[252:255], v[120:123], v[212:215]
    v_mfma_f32_16x16x32_bf16 v[216:219], a[248:251], v[124:127], v[216:219]
    ds_read_b128 a[240:243], v2 offset:46080
    ds_read_b128 a[244:247], v3 offset:46080
    v_mfma_f32_16x16x32_bf16 v[220:223], a[252:255], v[124:127], v[220:223]
    s_waitcnt vmcnt(8) lgkmcnt(2)
    v_mfma_f32_16x16x32_bf16 v[208:211], a[224:227], v[128:131], v[208:211]
    buffer_load_dwordx4 a[108:111], v2, s[64:67], s14 offen offset:3072 sc1
    v_mfma_f32_16x16x32_bf16 v[212:215], a[228:231], v[128:131], v[212:215]
    v_mfma_f32_16x16x32_bf16 v[216:219], a[224:227], v[132:135], v[216:219]
    ds_read_b128 a[248:251], v2 offset:50176
    ds_read_b128 a[252:255], v3 offset:50176
    v_mfma_f32_16x16x32_bf16 v[220:223], a[228:231], v[132:135], v[220:223]
    s_waitcnt vmcnt(7)
    v_mfma_f32_16x16x32_bf16 v[208:211], a[232:235], v[136:139], v[208:211]
    buffer_load_dwordx4 v[92:95], v79, s[64:67], s32 offen offset:2304 sc1
    v_mfma_f32_16x16x32_bf16 v[212:215], a[236:239], v[136:139], v[212:215]
    v_mfma_f32_16x16x32_bf16 v[216:219], a[232:235], v[140:143], v[216:219]
    ds_read_b128 a[224:227], v2 offset:54272
    ds_read_b128 a[228:231], v3 offset:54272
    v_mfma_f32_16x16x32_bf16 v[220:223], a[236:239], v[140:143], v[220:223]
    v_mfma_f32_16x16x32_bf16 v[208:211], v[28:31], v[24:27], v[208:211]
    buffer_load_dwordx4 v[96:99], v79, s[64:67], s33 offen offset:0 sc1
    v_mfma_f32_16x16x32_bf16 v[212:215], v[32:35], v[24:27], v[212:215]
    v_mfma_f32_16x16x32_bf16 v[216:219], v[28:31], v[26:29], v[216:219]
    v_mfma_f32_16x16x32_bf16 v[220:223], v[32:35], v[26:29], v[220:223]
    s_waitcnt lgkmcnt(2)
    v_mfma_f32_16x16x32_bf16 v[224:227], a[240:243], v[104:107], v[224:227]
    buffer_load_dwordx4 v[100:103], v79, s[64:67], s33 offen offset:256 sc1
    v_mfma_f32_16x16x32_bf16 v[228:231], a[244:247], v[104:107], v[228:231]
    s_lshl_b64 s[40:41], s[44:45], 16
    v_cndmask_b32 v24, 0, v36, s[40:41]
    v_cndmask_b32 v25, 0, v37, s[40:41]
    v_cndmask_b32 v26, 0, v38, s[40:41]
    v_mfma_f32_16x16x32_bf16 v[232:235], a[240:243], v[108:111], v[232:235]
    ds_read_b128 a[232:235], v2 offset:58368
    ds_read_b128 a[236:239], v3 offset:58368
    v_cndmask_b32 v27, 0, v39, s[40:41]
    v_mfma_f32_16x16x32_bf16 v[236:239], a[244:247], v[108:111], v[236:239]
    v_mfma_f32_16x16x32_bf16 v[224:227], a[248:251], v[112:115], v[224:227]
    v_mfma_f32_16x16x32_bf16 v[228:231], a[252:255], v[112:115], v[228:231]
    v_mfma_f32_16x16x32_bf16 v[232:235], a[248:251], v[116:119], v[232:235]
    ds_read_b128 a[240:243], v2 offset:62464
    ds_read_b128 a[244:247], v3 offset:62464
    v_mfma_f32_16x16x32_bf16 v[236:239], a[252:255], v[116:119], v[236:239]
    s_add_u32 s96, s10, 0x1000
    v_mul_f32 v212, v208, v212
    v_mul_f32 v208, v18, v208
    s_waitcnt lgkmcnt(2)
    v_mfma_f32_16x16x32_bf16 v[224:227], a[224:227], v[120:123], v[224:227]
    v_mul_f32 v213, v209, v213
    v_mul_f32 v209, v18, v209
    v_mul_f32 v214, v210, v214
    v_mfma_f32_16x16x32_bf16 v[228:231], a[228:231], v[120:123], v[228:231]
    v_exp_f32 v208, v208
    v_mul_f32 v210, v18, v210
    v_fma_f32 v208, v208, v19, v19
    v_mfma_f32_16x16x32_bf16 v[232:235], a[224:227], v[124:127], v[232:235]
    ds_read_b128 a[248:251], v2 offset:47104
    ds_read_b128 a[252:255], v3 offset:47104
    v_mul_f32 v215, v211, v215
    v_mfma_f32_16x16x32_bf16 v[236:239], a[228:231], v[124:127], v[236:239]
    v_exp_f32 v209, v209
    v_mul_f32 v211, v18, v211
    v_fma_f32 v209, v209, v19, v19
    v_mfma_f32_16x16x32_bf16 v[224:227], a[232:235], v[128:131], v[224:227]
    v_exp_f32 v210, v210
    v_mul_f32 v220, v216, v220
    v_mfma_f32_16x16x32_bf16 v[228:231], a[236:239], v[128:131], v[228:231]
    v_rcp_f32 v208, v208
    v_mul_f32 v216, v20, v216
    v_fma_f32 v210, v210, v19, v19
    v_mfma_f32_16x16x32_bf16 v[232:235], a[232:235], v[132:135], v[232:235]
    ds_read_b128 a[224:227], v2 offset:51200
    ds_read_b128 a[228:231], v3 offset:51200
    v_mfma_f32_16x16x32_bf16 v[236:239], a[236:239], v[132:135], v[236:239]
    v_exp_f32 v211, v211
    v_mul_f32 v212, v212, v208
    s_waitcnt lgkmcnt(2)
    v_mfma_f32_16x16x32_bf16 v[224:227], a[240:243], v[136:139], v[224:227]
    v_rcp_f32 v209, v209
    v_mul_f32 v221, v217, v221
    v_mfma_f32_16x16x32_bf16 v[228:231], a[244:247], v[136:139], v[228:231]
    s_add_u32 s14, s14, 4096
    buffer_load_dwordx4 a[112:115], v2, s[64:67], s14 offen offset:0 sc1
    v_mul_f32 v217, v20, v217
    v_fma_f32 v211, v211, v19, v19
    v_mfma_f32_16x16x32_bf16 v[232:235], a[240:243], v[140:143], v[232:235]
    ds_read_b128 a[232:235], v2 offset:55296
    ds_read_b128 a[236:239], v3 offset:55296
    v_mfma_f32_16x16x32_bf16 v[236:239], a[244:247], v[140:143], v[236:239]
    v_exp_f32 v216, v216
    v_rcp_f32 v210, v210
    v_mfma_f32_16x16x32_bf16 v[224:227], v[28:31], v[24:27], v[224:227]
    v_mul_f32 v213, v213, v209
    v_mul_f32 v222, v218, v222
    v_mul_f32 v218, v20, v218
    v_mfma_f32_16x16x32_bf16 v[228:231], v[32:35], v[24:27], v[228:231]
    buffer_load_dwordx4 a[116:119], v2, s[64:67], s14 offen offset:1024 sc1
    v_exp_f32 v217, v217
    v_mfma_f32_16x16x32_bf16 v[232:235], v[28:31], v[26:29], v[232:235]
    v_fma_f32 v216, v216, v21, v21
    v_rcp_f32 v211, v211
    v_mfma_f32_16x16x32_bf16 v[236:239], v[32:35], v[26:29], v[236:239]
    v_mul_f32 v214, v214, v210
    v_cvt_pk_bf16_f32 v208, v212, v213
    v_mul_f32 v223, v219, v223
    v_mul_f32 v219, v20, v219
    v_mfma_f32_16x16x32_bf16 v[240:243], a[248:251], v[104:107], v[240:243]
    v_exp_f32 v218, v218
    v_fma_f32 v217, v217, v21, v21
    v_mfma_f32_16x16x32_bf16 v[244:247], a[252:255], v[104:107], v[244:247]
    buffer_load_dwordx4 a[120:123], v2, s[64:67], s14 offen offset:2048 sc1
    s_lshl_b64 s[40:41], s[44:45], 32
    v_cndmask_b32 v24, 0, v36, s[40:41]
    v_mfma_f32_16x16x32_bf16 v[248:251], a[248:251], v[108:111], v[248:251]
    ds_read_b128 a[240:243], v2 offset:59392
    ds_read_b128 a[244:247], v3 offset:59392
    v_cndmask_b32 v25, 0, v37, s[40:41]
    v_mfma_f32_16x16x32_bf16 v[252:255], a[252:255], v[108:111], v[252:255]
    v_cndmask_b32 v26, 0, v38, s[40:41]
    v_cndmask_b32 v27, 0, v39, s[40:41]
    v_mul_f32 v215, v215, v211
    s_waitcnt lgkmcnt(2)
    v_mfma_f32_16x16x32_bf16 v[240:243], a[224:227], v[112:115], v[240:243]
    v_rcp_f32 v216, v216
    v_fma_f32 v218, v218, v21, v21
    v_mfma_f32_16x16x32_bf16 v[244:247], a[228:231], v[112:115], v[244:247]
    buffer_load_dwordx4 a[124:127], v2, s[64:67], s14 offen offset:3072 sc1
    v_exp_f32 v219, v219
    v_mfma_f32_16x16x32_bf16 v[248:251], a[224:227], v[116:119], v[248:251]
    ds_read_b128 a[248:251], v2 offset:63488
    ds_read_b128 a[252:255], v3 offset:63488
    v_mul_f32 v220, v220, v216
    v_mfma_f32_16x16x32_bf16 v[252:255], a[228:231], v[116:119], v[252:255]
    v_rcp_f32 v217, v217
    v_cvt_pk_bf16_f32 v209, v214, v215
    v_fma_f32 v219, v219, v21, v21
    v_mfma_f32_16x16x32_bf16 v[240:243], a[232:235], v[120:123], v[240:243]
    v_rcp_f32 v218, v218
    v_mul_f32 v221, v221, v217
    v_mfma_f32_16x16x32_bf16 v[244:247], a[236:239], v[120:123], v[244:247]
    buffer_load_dwordx4 v[104:107], v79, s[64:67], s33 offen offset:2048 sc1
    v_rcp_f32 v219, v219
    v_mfma_f32_16x16x32_bf16 v[248:251], a[232:235], v[124:127], v[248:251]
    ds_read_b128 a[224:227], v2 offset:0
    ds_read_b128 a[228:231], v3 offset:0
    v_mul_f32 v222, v222, v218
    v_mfma_f32_16x16x32_bf16 v[252:255], a[236:239], v[124:127], v[252:255]
    v_cvt_pk_bf16_f32 v210, v220, v221
    v_mul_f32 v223, v223, v219
    v_cvt_pk_bf16_f32 v211, v222, v223
    s_waitcnt lgkmcnt(2)
    v_mfma_f32_16x16x32_bf16 v[240:243], a[240:243], v[128:131], v[240:243]
    v_permlane16_swap_b32 v208, v210
    v_permlane16_swap_b32 v209, v211
    v_mfma_f32_16x16x32_bf16 v[244:247], a[244:247], v[128:131], v[244:247]
    buffer_load_dwordx4 v[108:111], v79, s[64:67], s33 offen offset:2304 sc1
    buffer_store_dwordx4 v[208:211], v2, s[64:67], s96 offen sc1
    v_mfma_f32_16x16x32_bf16 v[248:251], a[240:243], v[132:135], v[248:251]
    ds_read_b128 a[232:235], v2 offset:1024
    ds_read_b128 a[236:239], v3 offset:1024
    v_mfma_f32_16x16x32_bf16 v[252:255], a[244:247], v[132:135], v[252:255]
    s_add_u32 s97, s10, 0x1400
    v_mul_f32 v228, v224, v228
    v_mul_f32 v224, v18, v224
    v_mul_f32 v229, v225, v229
    v_mfma_f32_16x16x32_bf16 v[240:243], a[248:251], v[136:139], v[240:243]
    v_mul_f32 v225, v18, v225
    v_exp_f32 v224, v224
    v_mfma_f32_16x16x32_bf16 v[244:247], a[252:255], v[136:139], v[244:247]
    buffer_load_dwordx4 v[112:115], v79, s[64:67], s34 offen offset:0 sc1
    v_mul_f32 v230, v226, v230
    v_mul_f32 v226, v18, v226
    v_mfma_f32_16x16x32_bf16 v[248:251], a[248:251], v[140:143], v[248:251]
    ds_read_b128 a[240:243], v2 offset:2048
    ds_read_b128 a[244:247], v3 offset:2048
    v_fma_f32 v224, v224, v19, v19
    v_mfma_f32_16x16x32_bf16 v[252:255], a[252:255], v[140:143], v[252:255]
    v_exp_f32 v225, v225
    v_mul_f32 v231, v227, v231
    v_mfma_f32_16x16x32_bf16 v[240:243], v[28:31], v[24:27], v[240:243]
    v_mul_f32 v227, v18, v227
    v_exp_f32 v226, v226
    v_mfma_f32_16x16x32_bf16 v[244:247], v[32:35], v[24:27], v[244:247]
    buffer_load_dwordx4 v[116:119], v79, s[64:67], s34 offen offset:256 sc1
    v_fma_f32 v225, v225, v19, v19
    v_mul_f32 v236, v232, v236
    v_mfma_f32_16x16x32_bf16 v[248:251], v[28:31], v[26:29], v[248:251]
    v_rcp_f32 v224, v224
    v_mul_f32 v232, v20, v232
    v_mfma_f32_16x16x32_bf16 v[252:255], v[32:35], v[26:29], v[252:255]
    v_exp_f32 v227, v227
    v_fma_f32 v226, v226, v19, v19
    v_mul_f32 v228, v228, v224
    ds_read_b128 a[248:251], v2 offset:3072
    ds_read_b128 a[252:255], v3 offset:3072
    s_waitcnt vmcnt(18) lgkmcnt(4)
    v_mfma_f32_16x16x32_bf16 v[144:147], a[224:227], v[80:83], 0
    s_add_u32 s46, s9, 0x800
    buffer_load_dwordx2 v[64:65], v22, s[64:67], s46 offen offset:0 sc1
    v_mfma_f32_16x16x32_bf16 v[148:151], a[228:231], v[80:83], 0
    buffer_load_dwordx4 v[120:123], v79, s[64:67], s34 offen offset:2048 sc1
    v_rcp_f32 v225, v225
    s_waitcnt vmcnt(19)
    v_mfma_f32_16x16x32_bf16 v[152:155], a[224:227], v[84:87], 0
    buffer_load_dwordx2 v[66:67], v22, s[64:67], s46 offen offset:256 sc1
    v_mfma_f32_16x16x32_bf16 v[156:159], a[228:231], v[84:87], 0
    v_mul_f32 v237, v233, v237
    v_mul_f32 v233, v20, v233
    v_exp_f32 v232, v232
    v_mfma_f32_16x16x32_bf16 v[160:163], a[232:235], v[80:83], 0
    buffer_load_dwordx2 v[68:69], v22, s[64:67], s46 offen offset:128 sc1
    v_mfma_f32_16x16x32_bf16 v[164:167], a[236:239], v[80:83], 0
    buffer_load_dwordx4 v[124:127], v79, s[64:67], s34 offen offset:2304 sc1
    v_fma_f32 v227, v227, v19, v19
    v_mul_f32 v229, v229, v225
    v_mfma_f32_16x16x32_bf16 v[168:171], a[232:235], v[84:87], 0
    ds_read_b128 a[224:227], v2 offset:4096
    ds_read_b128 a[228:231], v3 offset:4096
    v_mul_f32 v238, v234, v238
    v_mfma_f32_16x16x32_bf16 v[172:175], a[236:239], v[84:87], 0
    buffer_load_dwordx2 v[70:71], v22, s[64:67], s46 offen offset:384 sc1
    s_waitcnt lgkmcnt(2)
    v_mfma_f32_16x16x32_bf16 v[176:179], a[240:243], v[80:83], 0
    v_rcp_f32 v226, v226
    v_mul_f32 v234, v20, v234
    v_mfma_f32_16x16x32_bf16 v[180:183], a[244:247], v[80:83], 0
    buffer_load_dwordx4 v[128:131], v79, s[64:67], s35 offen offset:0 sc1
    v_exp_f32 v233, v233
    v_mfma_f32_16x16x32_bf16 v[184:187], a[240:243], v[84:87], 0
    ds_read_b128 a[232:235], v2 offset:5120
    ds_read_b128 a[236:239], v3 offset:5120
    v_fma_f32 v232, v232, v21, v21
    v_mfma_f32_16x16x32_bf16 v[188:191], a[244:247], v[84:87], 0
    v_rcp_f32 v227, v227
    v_mul_f32 v230, v230, v226
    v_cvt_pk_bf16_f32 v224, v228, v229
    v_mfma_f32_16x16x32_bf16 v[192:195], a[248:251], v[80:83], 0
    v_mul_f32 v239, v235, v239
    v_mul_f32 v235, v20, v235
    v_fma_f32 v233, v233, v21, v21
    v_mfma_f32_16x16x32_bf16 v[196:199], a[252:255], v[80:83], 0
    s_lshl_b32 s14, s72, 1
    s_add_u32 s14, s14, s3
    buffer_load_dwordx4 a[128:131], v2, s[64:67], s14 offen offset:0 sc1
    v_exp_f32 v234, v234
    v_mfma_f32_16x16x32_bf16 v[200:203], a[248:251], v[84:87], 0
    ds_read_b128 a[240:243], v2 offset:6144
    ds_read_b128 a[244:247], v3 offset:6144
    v_mul_f32 v231, v231, v227
    v_mfma_f32_16x16x32_bf16 v[204:207], a[252:255], v[84:87], 0
    v_rcp_f32 v232, v232
    v_fma_f32 v234, v234, v21, v21
    s_waitcnt vmcnt(19) lgkmcnt(2)
    v_mfma_f32_16x16x32_bf16 v[144:147], a[224:227], v[88:91], v[144:147]
    v_exp_f32 v235, v235
    v_mul_f32 v236, v236, v232
    v_mfma_f32_16x16x32_bf16 v[148:151], a[228:231], v[88:91], v[148:151]
    buffer_load_dwordx4 a[132:135], v2, s[64:67], s14 offen offset:1024 sc1
    v_rcp_f32 v233, v233
    v_mfma_f32_16x16x32_bf16 v[152:155], a[224:227], v[92:95], v[152:155]
    ds_read_b128 a[248:251], v2 offset:7168
    ds_read_b128 a[252:255], v3 offset:7168
    v_cvt_pk_bf16_f32 v225, v230, v231
    v_mfma_f32_16x16x32_bf16 v[156:159], a[228:231], v[92:95], v[156:159]
    v_fma_f32 v235, v235, v21, v21
    v_rcp_f32 v234, v234
    v_mul_f32 v237, v237, v233
    v_mfma_f32_16x16x32_bf16 v[160:163], a[232:235], v[88:91], v[160:163]
    v_rcp_f32 v235, v235
    v_mul_f32 v238, v238, v234
    v_mfma_f32_16x16x32_bf16 v[164:167], a[236:239], v[88:91], v[164:167]
    buffer_load_dwordx4 a[136:139], v2, s[64:67], s14 offen offset:2048 sc1
    v_cvt_pk_bf16_f32 v226, v236, v237
    v_mul_f32 v239, v239, v235
    v_mfma_f32_16x16x32_bf16 v[168:171], a[232:235], v[92:95], v[168:171]
    ds_read_b128 a[224:227], v2 offset:8192
    ds_read_b128 a[228:231], v3 offset:8192
    v_cvt_pk_bf16_f32 v227, v238, v239
    v_mfma_f32_16x16x32_bf16 v[172:175], a[236:239], v[92:95], v[172:175]
    v_permlane16_swap_b32 v224, v226
    v_permlane16_swap_b32 v225, v227
    s_waitcnt lgkmcnt(2)
    v_mfma_f32_16x16x32_bf16 v[176:179], a[240:243], v[88:91], v[176:179]
    buffer_store_dwordx4 v[224:227], v2, s[64:67], s97 offen sc1
    v_mfma_f32_16x16x32_bf16 v[180:183], a[244:247], v[88:91], v[180:183]
    buffer_load_dwordx4 a[140:143], v2, s[64:67], s14 offen offset:3072 sc1
    s_add_u32 s98, s10, 0x1800
    v_mul_f32 v244, v240, v244
    v_mfma_f32_16x16x32_bf16 v[184:187], a[240:243], v[92:95], v[184:187]
    ds_read_b128 a[232:235], v2 offset:9216
    ds_read_b128 a[236:239], v3 offset:9216
    v_mul_f32 v240, v18, v240
    v_mfma_f32_16x16x32_bf16 v[188:191], a[244:247], v[92:95], v[188:191]
    v_mul_f32 v245, v241, v245
    v_mul_f32 v241, v18, v241
    v_exp_f32 v240, v240
    v_mfma_f32_16x16x32_bf16 v[192:195], a[248:251], v[88:91], v[192:195]
    v_mul_f32 v246, v242, v246
    v_mul_f32 v242, v18, v242
    v_fma_f32 v240, v240, v19, v19
    v_mfma_f32_16x16x32_bf16 v[196:199], a[252:255], v[88:91], v[196:199]
    buffer_load_dwordx4 v[132:135], v79, s[64:67], s35 offen offset:256 sc1
    v_exp_f32 v241, v241
    v_mfma_f32_16x16x32_bf16 v[200:203], a[248:251], v[92:95], v[200:203]
    ds_read_b128 a[240:243], v2 offset:10240
    ds_read_b128 a[244:247], v3 offset:10240
    v_mul_f32 v247, v243, v247
    v_mfma_f32_16x16x32_bf16 v[204:207], a[252:255], v[92:95], v[204:207]
    v_mul_f32 v243, v18, v243
    v_exp_f32 v242, v242
    s_waitcnt vmcnt(22) lgkmcnt(2)
    v_mfma_f32_16x16x32_bf16 v[144:147], a[224:227], v[96:99], v[144:147]
    v_fma_f32 v241, v241, v19, v19
    v_rcp_f32 v240, v240
    v_mfma_f32_16x16x32_bf16 v[148:151], a[228:231], v[96:99], v[148:151]
    buffer_load_dwordx4 v[136:139], v79, s[64:67], s35 offen offset:2048 sc1
    v_mul_f32 v252, v248, v252
    v_mul_f32 v248, v20, v248
    v_mfma_f32_16x16x32_bf16 v[152:155], a[224:227], v[100:103], v[152:155]
    ds_read_b128 a[248:251], v2 offset:11264
    ds_read_b128 a[252:255], v3 offset:11264
    v_fma_f32 v242, v242, v19, v19
    v_mfma_f32_16x16x32_bf16 v[156:159], a[228:231], v[100:103], v[156:159]
    v_exp_f32 v243, v243
    v_rcp_f32 v241, v241
    v_mfma_f32_16x16x32_bf16 v[160:163], a[232:235], v[96:99], v[160:163]
    v_mul_f32 v244, v244, v240
    v_mul_f32 v253, v249, v253
    v_mul_f32 v249, v20, v249
    v_mfma_f32_16x16x32_bf16 v[164:167], a[236:239], v[96:99], v[164:167]
    buffer_load_dwordx4 v[140:143], v79, s[64:67], s35 offen offset:2304 sc1
    v_exp_f32 v248, v248
    v_mfma_f32_16x16x32_bf16 v[168:171], a[232:235], v[100:103], v[168:171]
    ds_read_b128 a[224:227], v2 offset:12288
    ds_read_b128 a[228:231], v3 offset:12288
    v_fma_f32 v243, v243, v19, v19
    v_mfma_f32_16x16x32_bf16 v[172:175], a[236:239], v[100:103], v[172:175]
    v_rcp_f32 v242, v242
    v_mul_f32 v245, v245, v241
    s_waitcnt lgkmcnt(2)
    v_mfma_f32_16x16x32_bf16 v[176:179], a[240:243], v[96:99], v[176:179]
    v_mul_f32 v254, v250, v254
    v_mul_f32 v250, v20, v250
    v_fma_f32 v248, v248, v21, v21
    v_mfma_f32_16x16x32_bf16 v[180:183], a[244:247], v[96:99], v[180:183]
    buffer_load_dwordx4 v[80:83], v79, s[64:67], s36 offen offset:0 sc1
    v_exp_f32 v249, v249
    v_mfma_f32_16x16x32_bf16 v[184:187], a[240:243], v[100:103], v[184:187]
    ds_read_b128 a[232:235], v2 offset:13312
    ds_read_b128 a[236:239], v3 offset:13312
    v_mul_f32 v246, v246, v242
    v_mfma_f32_16x16x32_bf16 v[188:191], a[244:247], v[100:103], v[188:191]
    v_rcp_f32 v243, v243
    v_cvt_pk_bf16_f32 v240, v244, v245
    v_mul_f32 v255, v251, v255
    v_mfma_f32_16x16x32_bf16 v[192:195], a[248:251], v[96:99], v[192:195]
    v_mul_f32 v251, v20, v251
    v_exp_f32 v250, v250
    v_mfma_f32_16x16x32_bf16 v[196:199], a[252:255], v[96:99], v[196:199]
    buffer_load_dwordx4 v[84:87], v79, s[64:67], s36 offen offset:256 sc1
    v_fma_f32 v249, v249, v21, v21
    v_mul_f32 v247, v247, v243
    v_mfma_f32_16x16x32_bf16 v[200:203], a[248:251], v[100:103], v[200:203]
    ds_read_b128 a[240:243], v2 offset:14336
    ds_read_b128 a[244:247], v3 offset:14336
    v_mfma_f32_16x16x32_bf16 v[204:207], a[252:255], v[100:103], v[204:207]
    v_rcp_f32 v248, v248
    v_fma_f32 v250, v250, v21, v21
    s_waitcnt vmcnt(20) lgkmcnt(2)
    v_mfma_f32_16x16x32_bf16 v[144:147], a[224:227], v[104:107], v[144:147]
    v_exp_f32 v251, v251
    v_mul_f32 v252, v252, v248
    v_mfma_f32_16x16x32_bf16 v[148:151], a[228:231], v[104:107], v[148:151]
    buffer_load_dwordx4 v[88:91], v79, s[64:67], s36 offen offset:2048 sc1
    v_rcp_f32 v249, v249
    v_mfma_f32_16x16x32_bf16 v[152:155], a[224:227], v[108:111], v[152:155]
    ds_read_b128 a[248:251], v2 offset:15360
    ds_read_b128 a[252:255], v3 offset:15360
    v_cvt_pk_bf16_f32 v241, v246, v247
    v_mfma_f32_16x16x32_bf16 v[156:159], a[228:231], v[108:111], v[156:159]
    v_fma_f32 v251, v251, v21, v21
    v_rcp_f32 v250, v250
    v_mul_f32 v253, v253, v249
    v_mfma_f32_16x16x32_bf16 v[160:163], a[232:235], v[104:107], v[160:163]
    v_rcp_f32 v251, v251
    v_mul_f32 v254, v254, v250
    v_mfma_f32_16x16x32_bf16 v[164:167], a[236:239], v[104:107], v[164:167]
    s_add_u32 s14, s14, 4096
    buffer_load_dwordx4 a[144:147], v2, s[64:67], s14 offen offset:0 sc1
    v_cvt_pk_bf16_f32 v242, v252, v253
    v_mul_f32 v255, v255, v251
    v_mfma_f32_16x16x32_bf16 v[168:171], a[232:235], v[108:111], v[168:171]
    ds_read_b128 a[224:227], v2 offset:16384
    ds_read_b128 a[228:231], v3 offset:16384
    v_cvt_pk_bf16_f32 v243, v254, v255
    v_mfma_f32_16x16x32_bf16 v[172:175], a[236:239], v[108:111], v[172:175]
    v_permlane16_swap_b32 v240, v242
    v_permlane16_swap_b32 v241, v243
    s_waitcnt lgkmcnt(2)
    v_mfma_f32_16x16x32_bf16 v[176:179], a[240:243], v[104:107], v[176:179]
    buffer_store_dwordx4 v[240:243], v2, s[64:67], s98 offen sc1
    v_mfma_f32_16x16x32_bf16 v[180:183], a[244:247], v[104:107], v[180:183]
    buffer_load_dwordx4 a[148:151], v2, s[64:67], s14 offen offset:1024 sc1
    v_mfma_f32_16x16x32_bf16 v[184:187], a[240:243], v[108:111], v[184:187]
    ds_read_b128 a[232:235], v2 offset:17408
    ds_read_b128 a[236:239], v3 offset:17408
    v_mfma_f32_16x16x32_bf16 v[188:191], a[244:247], v[108:111], v[188:191]
    s_waitcnt vmcnt(15)
    v_min3_i32 v72, v65, v67, v69
    v_min_i32 v72, v72, v71
    v_mfma_f32_16x16x32_bf16 v[192:195], a[248:251], v[104:107], v[192:195]
    v_cmp_gt_i32 vcc, 0, v72
    s_cbranch_vccnz L_ts_107
L_tb_108:
    v_mfma_f32_16x16x32_bf16 v[196:199], a[252:255], v[104:107], v[196:199]
    buffer_load_dwordx4 a[152:155], v2, s[64:67], s14 offen offset:2048 sc1
    v_add_f32 v64, v64, v66
    v_mfma_f32_16x16x32_bf16 v[200:203], a[248:251], v[108:111], v[200:203]
    ds_read_b128 a[240:243], v2 offset:18432
    ds_read_b128 a[244:247], v3 offset:18432
    v_mfma_f32_16x16x32_bf16 v[204:207], a[252:255], v[108:111], v[204:207]
    v_add_f32 v68, v68, v70
    v_add_f32 v65, v65, v67
    s_waitcnt lgkmcnt(2)
    v_mfma_f32_16x16x32_bf16 v[144:147], a[224:227], v[112:115], v[144:147]
    v_add_f32 v69, v69, v71
    v_permlane32_swap_b32 v64, v68
    v_mfma_f32_16x16x32_bf16 v[148:151], a[228:231], v[112:115], v[148:151]
    buffer_load_dwordx4 a[156:159], v2, s[64:67], s14 offen offset:3072 sc1
    v_add_f32 v64, v64, v68
    v_mfma_f32_16x16x32_bf16 v[152:155], a[224:227], v[116:119], v[152:155]
    ds_read_b128 a[248:251], v2 offset:19456
    ds_read_b128 a[252:255], v3 offset:19456
    v_mfma_f32_16x16x32_bf16 v[156:159], a[228:231], v[116:119], v[156:159]
    v_permlane32_swap_b32 v65, v69
    v_add_f32 v65, v65, v69
    s_nop 1
    v_permlane16_swap_b32 v64, v65
    v_mfma_f32_16x16x32_bf16 v[160:163], a[232:235], v[112:115], v[160:163]
    v_add_f32 v64, v64, v65
    v_mul_f32 v64, 0x3b000000, v64
    v_mfma_f32_16x16x32_bf16 v[164:167], a[236:239], v[112:115], v[164:167]
    buffer_load_dwordx4 v[92:95], v79, s[64:67], s36 offen offset:2304 sc1
    v_mov_b32 v65, v64
    v_mfma_f32_16x16x32_bf16 v[168:171], a[232:235], v[116:119], v[168:171]
    ds_read_b128 a[224:227], v2 offset:20480
    ds_read_b128 a[228:231], v3 offset:20480
    v_mfma_f32_16x16x32_bf16 v[172:175], a[236:239], v[116:119], v[172:175]
    v_permlane16_swap_b32 v64, v65
    v_fma_f32 v65, -v64, v64, v65
    s_waitcnt lgkmcnt(2)
    v_mfma_f32_16x16x32_bf16 v[176:179], a[240:243], v[112:115], v[176:179]
    v_cvt_pk_bf16_f32 v37, v64, 0
    v_max_f32 v65, 0, v65
    v_mfma_f32_16x16x32_bf16 v[180:183], a[244:247], v[112:115], v[180:183]
    buffer_load_dwordx4 v[96:99], v79, s[64:67], s37 offen offset:0 sc1
    v_lshlrev_b32 v67, 16, v37
    v_mfma_f32_16x16x32_bf16 v[184:187], a[240:243], v[116:119], v[184:187]
    ds_read_b128 a[232:235], v2 offset:21504
    ds_read_b128 a[236:239], v3 offset:21504
    v_mfma_f32_16x16x32_bf16 v[188:191], a[244:247], v[116:119], v[188:191]
    v_add_f32 v57, 0x3727c5ac, v65
    v_sub_f32 v67, v64, v67
    v_cvt_pk_bf16_f32 v36, v64, v67
    v_mfma_f32_16x16x32_bf16 v[192:195], a[248:251], v[112:115], v[192:195]
    v_rsq_f32 v56, v57
    v_mfma_f32_16x16x32_bf16 v[196:199], a[252:255], v[112:115], v[196:199]
    buffer_load_dwordx4 v[100:103], v79, s[64:67], s37 offen offset:256 sc1
    v_mul_f32 v56, 0xbfb8aa3b, v56
    v_mfma_f32_16x16x32_bf16 v[200:203], a[248:251], v[116:119], v[200:203]
    ds_read_b128 a[240:243], v2 offset:22528
    ds_read_b128 a[244:247], v3 offset:22528
    v_mfma_f32_16x16x32_bf16 v[204:207], a[252:255], v[116:119], v[204:207]
    v_mov_b32 v59, v57
    v_mov_b32 v39, v37
    s_waitcnt lgkmcnt(2)
    v_mfma_f32_16x16x32_bf16 v[144:147], a[224:227], v[120:123], v[144:147]
    v_mov_b32 v38, v36
    v_mov_b32 v58, v56
    v_mfma_f32_16x16x32_bf16 v[148:151], a[228:231], v[120:123], v[148:151]
    buffer_load_dwordx4 v[104:107], v79, s[64:67], s37 offen offset:2048 sc1
    v_permlane32_swap_b32 v57, v59
    v_mfma_f32_16x16x32_bf16 v[152:155], a[224:227], v[124:127], v[152:155]
    ds_read_b128 a[248:251], v2 offset:23552
    ds_read_b128 a[252:255], v3 offset:23552
    v_mfma_f32_16x16x32_bf16 v[156:159], a[228:231], v[124:127], v[156:159]
    v_permlane32_swap_b32 v37, v39
    v_permlane32_swap_b32 v36, v38
    v_permlane32_swap_b32 v56, v58
    v_mfma_f32_16x16x32_bf16 v[160:163], a[232:235], v[120:123], v[160:163]
    s_lshl_b64 s[40:41], s[44:45], 0
    v_cndmask_b32 v24, 0, v36, s[40:41]
    v_mfma_f32_16x16x32_bf16 v[164:167], a[236:239], v[120:123], v[164:167]
    buffer_load_dwordx4 v[108:111], v79, s[64:67], s37 offen offset:2304 sc1
    v_cndmask_b32 v25, 0, v37, s[40:41]
    v_mfma_f32_16x16x32_bf16 v[168:171], a[232:235], v[124:127], v[168:171]
    ds_read_b128 a[224:227], v2 offset:24576
    ds_read_b128 a[228:231], v3 offset:24576
    v_mfma_f32_16x16x32_bf16 v[172:175], a[236:239], v[124:127], v[172:175]
    v_cndmask_b32 v26, 0, v38, s[40:41]
    v_cndmask_b32 v27, 0, v39, s[40:41]
    s_waitcnt lgkmcnt(2)
    v_mfma_f32_16x16x32_bf16 v[176:179], a[240:243], v[120:123], v[176:179]
    v_mfma_f32_16x16x32_bf16 v[180:183], a[244:247], v[120:123], v[180:183]
    buffer_load_dwordx4 v[112:115], v79, s[64:67], s38 offen offset:0 sc1
    v_mfma_f32_16x16x32_bf16 v[184:187], a[240:243], v[124:127], v[184:187]
    ds_read_b128 a[232:235], v2 offset:25600
    ds_read_b128 a[236:239], v3 offset:25600
    v_mfma_f32_16x16x32_bf16 v[188:191], a[244:247], v[124:127], v[188:191]
    v_mfma_f32_16x16x32_bf16 v[192:195], a[248:251], v[120:123], v[192:195]
    s_waitcnt vmcnt(9)
    s_cmp_eq_u32 s16, 0
    s_cbranch_scc1 L_ps_109
    buffer_store_dword v23, off, s[64:67], s26 offset:0
L_pb_110:
    v_mfma_f32_16x16x32_bf16 v[196:199], a[252:255], v[120:123], v[196:199]
    buffer_load_dwordx4 v[116:119], v79, s[64:67], s38 offen offset:256 sc1
    v_mfma_f32_16x16x32_bf16 v[200:203], a[248:251], v[124:127], v[200:203]
    ds_read_b128 a[240:243], v2 offset:26624
    ds_read_b128 a[244:247], v3 offset:26624
    v_mfma_f32_16x16x32_bf16 v[204:207], a[252:255], v[124:127], v[204:207]
    s_waitcnt lgkmcnt(2)
    v_mfma_f32_16x16x32_bf16 v[144:147], a[224:227], v[128:131], v[144:147]
    v_mfma_f32_16x16x32_bf16 v[148:151], a[228:231], v[128:131], v[148:151]
    s_lshl_b32 s14, s73, 1
    s_add_u32 s14, s14, s3
    buffer_load_dwordx4 a[160:163], v2, s[64:67], s14 offen offset:0 sc1
    v_mfma_f32_16x16x32_bf16 v[152:155], a[224:227], v[132:135], v[152:155]
    ds_read_b128 a[248:251], v2 offset:27648
    ds_read_b128 a[252:255], v3 offset:27648
    v_mfma_f32_16x16x32_bf16 v[156:159], a[228:231], v[132:135], v[156:159]
    v_mfma_f32_16x16x32_bf16 v[160:163], a[232:235], v[128:131], v[160:163]
    v_mfma_f32_16x16x32_bf16 v[164:167], a[236:239], v[128:131], v[164:167]
    buffer_load_dwordx4 a[164:167], v2, s[64:67], s14 offen offset:1024 sc1
    v_mfma_f32_16x16x32_bf16 v[168:171], a[232:235], v[132:135], v[168:171]
    ds_read_b128 a[224:227], v2 offset:28672
    ds_read_b128 a[228:231], v3 offset:28672
    v_mfma_f32_16x16x32_bf16 v[172:175], a[236:239], v[132:135], v[172:175]
    s_waitcnt lgkmcnt(2)
    v_mfma_f32_16x16x32_bf16 v[176:179], a[240:243], v[128:131], v[176:179]
    v_mfma_f32_16x16x32_bf16 v[180:183], a[244:247], v[128:131], v[180:183]
    buffer_load_dwordx4 a[168:171], v2, s[64:67], s14 offen offset:2048 sc1
    v_mfma_f32_16x16x32_bf16 v[184:187], a[240:243], v[132:135], v[184:187]
    ds_read_b128 a[232:235], v2 offset:29696
    ds_read_b128 a[236:239], v3 offset:29696
    v_mfma_f32_16x16x32_bf16 v[188:191], a[244:247], v[132:135], v[188:191]
    v_mfma_f32_16x16x32_bf16 v[192:195], a[248:251], v[128:131], v[192:195]
    v_mfma_f32_16x16x32_bf16 v[196:199], a[252:255], v[128:131], v[196:199]
    buffer_load_dwordx4 a[172:175], v2, s[64:67], s14 offen offset:3072 sc1
    v_mfma_f32_16x16x32_bf16 v[200:203], a[248:251], v[132:135], v[200:203]
    ds_read_b128 a[240:243], v2 offset:30720
    ds_read_b128 a[244:247], v3 offset:30720
    v_mfma_f32_16x16x32_bf16 v[204:207], a[252:255], v[132:135], v[204:207]
    s_waitcnt lgkmcnt(2)
    v_mfma_f32_16x16x32_bf16 v[144:147], a[224:227], v[136:139], v[144:147]
    v_mfma_f32_16x16x32_bf16 v[148:151], a[228:231], v[136:139], v[148:151]
    buffer_load_dwordx4 v[120:123], v79, s[64:67], s38 offen offset:2048 sc1
    v_mfma_f32_16x16x32_bf16 v[152:155], a[224:227], v[140:143], v[152:155]
    ds_read_b128 a[248:251], v2 offset:31744
    ds_read_b128 a[252:255], v3 offset:31744
    v_mfma_f32_16x16x32_bf16 v[156:159], a[228:231], v[140:143], v[156:159]
    v_mfma_f32_16x16x32_bf16 v[160:163], a[232:235], v[136:139], v[160:163]
    v_mfma_f32_16x16x32_bf16 v[164:167], a[236:239], v[136:139], v[164:167]
    buffer_load_dwordx4 v[124:127], v79, s[64:67], s38 offen offset:2304 sc1
    v_mfma_f32_16x16x32_bf16 v[168:171], a[232:235], v[140:143], v[168:171]
    ds_read_b128 a[224:227], v2 offset:32768
    ds_read_b128 a[228:231], v3 offset:32768
    v_mfma_f32_16x16x32_bf16 v[172:175], a[236:239], v[140:143], v[172:175]
    s_waitcnt lgkmcnt(2)
    v_mfma_f32_16x16x32_bf16 v[176:179], a[240:243], v[136:139], v[176:179]
    v_mfma_f32_16x16x32_bf16 v[180:183], a[244:247], v[136:139], v[180:183]
    buffer_load_dwordx4 v[128:131], v79, s[64:67], s39 offen offset:0 sc1
    v_mfma_f32_16x16x32_bf16 v[184:187], a[240:243], v[140:143], v[184:187]
    ds_read_b128 a[232:235], v2 offset:33792
    ds_read_b128 a[236:239], v3 offset:33792
    v_mfma_f32_16x16x32_bf16 v[188:191], a[244:247], v[140:143], v[188:191]
    v_mfma_f32_16x16x32_bf16 v[192:195], a[248:251], v[136:139], v[192:195]
    v_mfma_f32_16x16x32_bf16 v[196:199], a[252:255], v[136:139], v[196:199]
    buffer_load_dwordx4 v[132:135], v79, s[64:67], s39 offen offset:256 sc1
    v_mfma_f32_16x16x32_bf16 v[200:203], a[248:251], v[140:143], v[200:203]
    ds_read_b128 a[240:243], v2 offset:34816
    ds_read_b128 a[244:247], v3 offset:34816
    v_mfma_f32_16x16x32_bf16 v[204:207], a[252:255], v[140:143], v[204:207]
    s_waitcnt lgkmcnt(2)
    v_mfma_f32_16x16x32_bf16 v[144:147], a[224:227], v[80:83], v[144:147]
    v_mfma_f32_16x16x32_bf16 v[148:151], a[228:231], v[80:83], v[148:151]
    buffer_load_dwordx4 v[136:139], v79, s[64:67], s39 offen offset:2048 sc1
    v_mfma_f32_16x16x32_bf16 v[152:155], a[224:227], v[84:87], v[152:155]
    ds_read_b128 a[248:251], v2 offset:35840
    ds_read_b128 a[252:255], v3 offset:35840
    v_mfma_f32_16x16x32_bf16 v[156:159], a[228:231], v[84:87], v[156:159]
    v_mfma_f32_16x16x32_bf16 v[160:163], a[232:235], v[80:83], v[160:163]
    v_mfma_f32_16x16x32_bf16 v[164:167], a[236:239], v[80:83], v[164:167]
    buffer_load_dwordx4 v[140:143], v79, s[64:67], s39 offen offset:2304 sc1
    v_mfma_f32_16x16x32_bf16 v[168:171], a[232:235], v[84:87], v[168:171]
    ds_read_b128 a[224:227], v2 offset:36864
    ds_read_b128 a[228:231], v3 offset:36864
    v_mfma_f32_16x16x32_bf16 v[172:175], a[236:239], v[84:87], v[172:175]
    s_waitcnt lgkmcnt(2)
    v_mfma_f32_16x16x32_bf16 v[176:179], a[240:243], v[80:83], v[176:179]
    v_mfma_f32_16x16x32_bf16 v[180:183], a[244:247], v[80:83], v[180:183]
    s_add_u32 s14, s14, 4096
    buffer_load_dwordx4 a[176:179], v2, s[64:67], s14 offen offset:0 sc1
    v_mfma_f32_16x16x32_bf16 v[184:187], a[240:243], v[84:87], v[184:187]
    ds_read_b128 a[232:235], v2 offset:37888
    ds_read_b128 a[236:239], v3 offset:37888
    v_mfma_f32_16x16x32_bf16 v[188:191], a[244:247], v[84:87], v[188:191]
    v_mfma_f32_16x16x32_bf16 v[192:195], a[248:251], v[80:83], v[192:195]
    v_mfma_f32_16x16x32_bf16 v[196:199], a[252:255], v[80:83], v[196:199]
    buffer_load_dwordx4 a[180:183], v2, s[64:67], s14 offen offset:1024 sc1
    v_mfma_f32_16x16x32_bf16 v[200:203], a[248:251], v[84:87], v[200:203]
    ds_read_b128 a[240:243], v2 offset:38912
    ds_read_b128 a[244:247], v3 offset:38912
    v_mfma_f32_16x16x32_bf16 v[204:207], a[252:255], v[84:87], v[204:207]
    s_waitcnt vmcnt(19) lgkmcnt(2)
    v_mfma_f32_16x16x32_bf16 v[144:147], a[224:227], v[88:91], v[144:147]
    v_mfma_f32_16x16x32_bf16 v[148:151], a[228:231], v[88:91], v[148:151]
    buffer_load_dwordx4 a[184:187], v2, s[64:67], s14 offen offset:2048 sc1
    v_mfma_f32_16x16x32_bf16 v[152:155], a[224:227], v[92:95], v[152:155]
    ds_read_b128 a[248:251], v2 offset:39936
    ds_read_b128 a[252:255], v3 offset:39936
    v_mfma_f32_16x16x32_bf16 v[156:159], a[228:231], v[92:95], v[156:159]
    v_mfma_f32_16x16x32_bf16 v[160:163], a[232:235], v[88:91], v[160:163]
    v_mfma_f32_16x16x32_bf16 v[164:167], a[236:239], v[88:91], v[164:167]
    buffer_load_dwordx4 a[188:191], v2, s[64:67], s14 offen offset:3072 sc1
    v_mfma_f32_16x16x32_bf16 v[168:171], a[232:235], v[92:95], v[168:171]
    ds_read_b128 a[224:227], v2 offset:40960
    ds_read_b128 a[228:231], v3 offset:40960
    v_mfma_f32_16x16x32_bf16 v[172:175], a[236:239], v[92:95], v[172:175]
    s_waitcnt lgkmcnt(2)
    v_mfma_f32_16x16x32_bf16 v[176:179], a[240:243], v[88:91], v[176:179]
    v_mfma_f32_16x16x32_bf16 v[180:183], a[244:247], v[88:91], v[180:183]
    v_mfma_f32_16x16x32_bf16 v[184:187], a[240:243], v[92:95], v[184:187]
    ds_read_b128 a[232:235], v2 offset:41984
    ds_read_b128 a[236:239], v3 offset:41984
    v_mfma_f32_16x16x32_bf16 v[188:191], a[244:247], v[92:95], v[188:191]
    v_mfma_f32_16x16x32_bf16 v[192:195], a[248:251], v[88:91], v[192:195]
    v_mfma_f32_16x16x32_bf16 v[196:199], a[252:255], v[88:91], v[196:199]
    v_mfma_f32_16x16x32_bf16 v[200:203], a[248:251], v[92:95], v[200:203]
    ds_read_b128 a[240:243], v2 offset:43008
    ds_read_b128 a[244:247], v3 offset:43008
    v_mfma_f32_16x16x32_bf16 v[204:207], a[252:255], v[92:95], v[204:207]
    s_waitcnt vmcnt(19) lgkmcnt(2)
    v_mfma_f32_16x16x32_bf16 v[144:147], a[224:227], v[96:99], v[144:147]
    v_mfma_f32_16x16x32_bf16 v[148:151], a[228:231], v[96:99], v[148:151]
    v_mfma_f32_16x16x32_bf16 v[152:155], a[224:227], v[100:103], v[152:155]
    ds_read_b128 a[248:251], v2 offset:44032
    ds_read_b128 a[252:255], v3 offset:44032
    v_mfma_f32_16x16x32_bf16 v[156:159], a[228:231], v[100:103], v[156:159]
    v_mfma_f32_16x16x32_bf16 v[160:163], a[232:235], v[96:99], v[160:163]
    v_mfma_f32_16x16x32_bf16 v[164:167], a[236:239], v[96:99], v[164:167]
    v_mfma_f32_16x16x32_bf16 v[168:171], a[232:235], v[100:103], v[168:171]
    ds_read_b128 a[224:227], v2 offset:45056
    ds_read_b128 a[228:231], v3 offset:45056
    v_mfma_f32_16x16x32_bf16 v[172:175], a[236:239], v[100:103], v[172:175]
    s_waitcnt lgkmcnt(2)
    v_mfma_f32_16x16x32_bf16 v[176:179], a[240:243], v[96:99], v[176:179]
    v_mfma_f32_16x16x32_bf16 v[180:183], a[244:247], v[96:99], v[180:183]
    v_mfma_f32_16x16x32_bf16 v[184:187], a[240:243], v[100:103], v[184:187]
    ds_read_b128 a[232:235], v2 offset:49152
    ds_read_b128 a[236:239], v3 offset:49152
    v_mfma_f32_16x16x32_bf16 v[188:191], a[244:247], v[100:103], v[188:191]
    v_mfma_f32_16x16x32_bf16 v[192:195], a[248:251], v[96:99], v[192:195]
    v_mfma_f32_16x16x32_bf16 v[196:199], a[252:255], v[96:99], v[196:199]
    v_mfma_f32_16x16x32_bf16 v[200:203], a[248:251], v[100:103], v[200:203]
    ds_read_b128 a[240:243], v2 offset:53248
    ds_read_b128 a[244:247], v3 offset:53248
    v_mfma_f32_16x16x32_bf16 v[204:207], a[252:255], v[100:103], v[204:207]
    s_waitcnt vmcnt(17) lgkmcnt(2)
    v_mfma_f32_16x16x32_bf16 v[144:147], a[224:227], v[104:107], v[144:147]
    v_mfma_f32_16x16x32_bf16 v[148:151], a[228:231], v[104:107], v[148:151]
    v_mfma_f32_16x16x32_bf16 v[152:155], a[224:227], v[108:111], v[152:155]
    ds_read_b128 a[248:251], v2 offset:57344
    ds_read_b128 a[252:255], v3 offset:57344
    v_mfma_f32_16x16x32_bf16 v[156:159], a[228:231], v[108:111], v[156:159]
    s_lshl_b32 s14, s74, 1
    s_add_u32 s14, s14, s3
    buffer_load_dwordx4 a[192:195], v2, s[64:67], s14 offen offset:0 sc1
    s_waitcnt vmcnt(15)
    v_mfma_f32_16x16x32_bf16 v[144:147], a[232:235], v[112:115], v[144:147]
    v_mfma_f32_16x16x32_bf16 v[148:151], a[236:239], v[112:115], v[148:151]
    v_mfma_f32_16x16x32_bf16 v[152:155], a[232:235], v[116:119], v[152:155]
    ds_read_b128 a[224:227], v2 offset:61440
    ds_read_b128 a[228:231], v3 offset:61440
    v_mfma_f32_16x16x32_bf16 v[156:159], a[236:239], v[116:119], v[156:159]
    s_waitcnt vmcnt(9) lgkmcnt(2)
    v_mfma_f32_16x16x32_bf16 v[144:147], a[240:243], v[120:123], v[144:147]
    buffer_load_dwordx4 a[196:199], v2, s[64:67], s14 offen offset:1024 sc1
    v_mfma_f32_16x16x32_bf16 v[148:151], a[244:247], v[120:123], v[148:151]
    v_mfma_f32_16x16x32_bf16 v[152:155], a[240:243], v[124:127], v[152:155]
    ds_read_b128 a[232:235], v2 offset:46080
    ds_read_b128 a[236:239], v3 offset:46080
    v_mfma_f32_16x16x32_bf16 v[156:159], a[244:247], v[124:127], v[156:159]
    s_waitcnt vmcnt(8)
    v_mfma_f32_16x16x32_bf16 v[144:147], a[248:251], v[128:131], v[144:147]
    buffer_load_dwordx4 a[200:203], v2, s[64:67], s14 offen offset:2048 sc1
    v_mfma_f32_16x16x32_bf16 v[148:151], a[252:255], v[128:131], v[148:151]
    v_mfma_f32_16x16x32_bf16 v[152:155], a[248:251], v[132:135], v[152:155]
    ds_read_b128 a[240:243], v2 offset:50176
    ds_read_b128 a[244:247], v3 offset:50176
    v_mfma_f32_16x16x32_bf16 v[156:159], a[252:255], v[132:135], v[156:159]
    s_waitcnt vmcnt(7) lgkmcnt(2)
    v_mfma_f32_16x16x32_bf16 v[144:147], a[224:227], v[136:139], v[144:147]
    buffer_load_dwordx4 a[204:207], v2, s[64:67], s14 offen offset:3072 sc1
    v_mfma_f32_16x16x32_bf16 v[148:151], a[228:231], v[136:139], v[148:151]
    v_mfma_f32_16x16x32_bf16 v[152:155], a[224:227], v[140:143], v[152:155]
    ds_read_b128 a[248:251], v2 offset:54272
    ds_read_b128 a[252:255], v3 offset:54272
    v_mfma_f32_16x16x32_bf16 v[156:159], a[228:231], v[140:143], v[156:159]
    v_mfma_f32_16x16x32_bf16 v[144:147], v[28:31], v[24:27], v[144:147]
    v_mfma_f32_16x16x32_bf16 v[148:151], v[32:35], v[24:27], v[148:151]
    v_mfma_f32_16x16x32_bf16 v[152:155], v[28:31], v[26:29], v[152:155]
    v_mfma_f32_16x16x32_bf16 v[156:159], v[32:35], v[26:29], v[156:159]
    v_mfma_f32_16x16x32_bf16 v[160:163], a[232:235], v[104:107], v[160:163]
    v_mfma_f32_16x16x32_bf16 v[164:167], a[236:239], v[104:107], v[164:167]
    s_lshl_b64 s[40:41], s[44:45], 16
    v_cndmask_b32 v24, 0, v36, s[40:41]
    v_mfma_f32_16x16x32_bf16 v[168:171], a[232:235], v[108:111], v[168:171]
    ds_read_b128 a[224:227], v2 offset:58368
    ds_read_b128 a[228:231], v3 offset:58368
    v_mfma_f32_16x16x32_bf16 v[172:175], a[236:239], v[108:111], v[172:175]
    v_cndmask_b32 v25, 0, v37, s[40:41]
    s_waitcnt lgkmcnt(2)
    v_mfma_f32_16x16x32_bf16 v[160:163], a[240:243], v[112:115], v[160:163]
    v_cndmask_b32 v26, 0, v38, s[40:41]
    v_cndmask_b32 v27, 0, v39, s[40:41]
    v_mfma_f32_16x16x32_bf16 v[164:167], a[244:247], v[112:115], v[164:167]
    buffer_load_dword v16, v5, s[64:67], s27 offen offset:0 sc1
    v_mfma_f32_16x16x32_bf16 v[168:171], a[240:243], v[116:119], v[168:171]
    ds_read_b128 a[232:235], v2 offset:62464
    ds_read_b128 a[236:239], v3 offset:62464
    v_mfma_f32_16x16x32_bf16 v[172:175], a[244:247], v[116:119], v[172:175]
    s_add_u32 s96, s10, 0x1d000
    v_mul_f32 v148, v144, v148
    v_mfma_f32_16x16x32_bf16 v[160:163], a[248:251], v[120:123], v[160:163]
    v_mul_f32 v144, v56, v144
    v_mul_f32 v149, v145, v149
    v_mfma_f32_16x16x32_bf16 v[164:167], a[252:255], v[120:123], v[164:167]
    v_mul_f32 v145, v56, v145
    v_mul_f32 v150, v146, v150
    v_mfma_f32_16x16x32_bf16 v[168:171], a[248:251], v[124:127], v[168:171]
    ds_read_b128 a[240:243], v2 offset:47104
    ds_read_b128 a[244:247], v3 offset:47104
    v_mfma_f32_16x16x32_bf16 v[172:175], a[252:255], v[124:127], v[172:175]
    v_mul_f32 v146, v56, v146
    s_waitcnt lgkmcnt(2)
    v_mfma_f32_16x16x32_bf16 v[160:163], a[224:227], v[128:131], v[160:163]
    v_exp_f32 v144, v144
    v_mfma_f32_16x16x32_bf16 v[164:167], a[228:231], v[128:131], v[164:167]
    v_exp_f32 v145, v145
    v_mfma_f32_16x16x32_bf16 v[168:171], a[224:227], v[132:135], v[168:171]
    ds_read_b128 a[248:251], v2 offset:51200
    ds_read_b128 a[252:255], v3 offset:51200
    v_mfma_f32_16x16x32_bf16 v[172:175], a[228:231], v[132:135], v[172:175]
    v_fma_f32 v144, v144, v57, v57
    v_mul_f32 v151, v147, v151
    v_mfma_f32_16x16x32_bf16 v[160:163], a[232:235], v[136:139], v[160:163]
    v_mul_f32 v147, v56, v147
    v_fma_f32 v145, v145, v57, v57
    v_mfma_f32_16x16x32_bf16 v[164:167], a[236:239], v[136:139], v[164:167]
    v_exp_f32 v146, v146
    v_mfma_f32_16x16x32_bf16 v[168:171], a[232:235], v[140:143], v[168:171]
    ds_read_b128 a[224:227], v2 offset:55296
    ds_read_b128 a[228:231], v3 offset:55296
    v_mfma_f32_16x16x32_bf16 v[172:175], a[236:239], v[140:143], v[172:175]
    v_mul_f32 v156, v152, v156
    v_mfma_f32_16x16x32_bf16 v[160:163], v[28:31], v[24:27], v[160:163]
    v_rcp_f32 v144, v144
    v_mfma_f32_16x16x32_bf16 v[164:167], v[32:35], v[24:27], v[164:167]
    s_add_u32 s14, s14, 4096
    buffer_load_dwordx4 a[208:211], v2, s[64:67], s14 offen offset:0 sc1
    v_mfma_f32_16x16x32_bf16 v[168:171], v[28:31], v[26:29], v[168:171]
    v_mul_f32 v152, v58, v152
    v_fma_f32 v146, v146, v57, v57
    v_mfma_f32_16x16x32_bf16 v[172:175], v[32:35], v[26:29], v[172:175]
    v_exp_f32 v147, v147
    s_waitcnt lgkmcnt(2)
    v_mfma_f32_16x16x32_bf16 v[176:179], a[240:243], v[104:107], v[176:179]
    v_rcp_f32 v145, v145
    v_mfma_f32_16x16x32_bf16 v[180:183], a[244:247], v[104:107], v[180:183]
    buffer_load_dwordx4 a[212:215], v2, s[64:67], s14 offen offset:1024 sc1
    v_mfma_f32_16x16x32_bf16 v[184:187], a[240:243], v[108:111], v[184:187]
    ds_read_b128 a[232:235], v2 offset:59392
    ds_read_b128 a[236:239], v3 offset:59392
    v_mfma_f32_16x16x32_bf16 v[188:191], a[244:247], v[108:111], v[188:191]
    s_lshl_b64 s[40:41], s[44:45], 32
    v_cndmask_b32 v24, 0, v36, s[40:41]
    v_mfma_f32_16x16x32_bf16 v[176:179], a[248:251], v[112:115], v[176:179]
    v_cndmask_b32 v25, 0, v37, s[40:41]
    v_cndmask_b32 v26, 0, v38, s[40:41]
    v_mfma_f32_16x16x32_bf16 v[180:183], a[252:255], v[112:115], v[180:183]
    buffer_load_dwordx4 a[216:219], v2, s[64:67], s14 offen offset:2048 sc1
    v_mfma_f32_16x16x32_bf16 v[184:187], a[248:251], v[116:119], v[184:187]
    ds_read_b128 a[240:243], v2 offset:63488
    ds_read_b128 a[244:247], v3 offset:63488
    v_mfma_f32_16x16x32_bf16 v[188:191], a[252:255], v[116:119], v[188:191]
    v_cndmask_b32 v27, 0, v39, s[40:41]
    s_waitcnt lgkmcnt(2)
    v_mfma_f32_16x16x32_bf16 v[176:179], a[224:227], v[120:123], v[176:179]
    v_mul_f32 v148, v148, v144
    v_mul_f32 v157, v153, v157
    v_mfma_f32_16x16x32_bf16 v[180:183], a[228:231], v[120:123], v[180:183]
    buffer_load_dwordx4 a[220:223], v2, s[64:67], s14 offen offset:3072 sc1
    v_mfma_f32_16x16x32_bf16 v[184:187], a[224:227], v[124:127], v[184:187]
    ds_read_b128 a[248:251], v2 offset:48128
    ds_read_b128 a[252:255], v3 offset:48128
    v_mfma_f32_16x16x32_bf16 v[188:191], a[228:231], v[124:127], v[188:191]
    v_mul_f32 v153, v58, v153
    v_fma_f32 v147, v147, v57, v57
    v_mfma_f32_16x16x32_bf16 v[176:179], a[232:235], v[128:131], v[176:179]
    v_exp_f32 v152, v152
    v_mfma_f32_16x16x32_bf16 v[180:183], a[236:239], v[128:131], v[180:183]
    s_waitcnt vmcnt(4)
    v_cmp_eq_u32 vcc, 0, v16
    s_cbranch_vccnz L_fs_111
L_fb_112:
    s_add_u32 s80, s11, 0x0
    v_add_u32 v78, s80, v0
    buffer_load_dwordx4 v[80:83], v78, s[64:67], s68 offen offset:0 sc1
    v_mfma_f32_16x16x32_bf16 v[184:187], a[232:235], v[132:135], v[184:187]
    ds_read_b128 a[224:227], v2 offset:52224
    ds_read_b128 a[228:231], v3 offset:52224
    v_mfma_f32_16x16x32_bf16 v[188:191], a[236:239], v[132:135], v[188:191]
    v_mul_f32 v149, v149, v145
    s_waitcnt lgkmcnt(2)
    v_mfma_f32_16x16x32_bf16 v[176:179], a[240:243], v[136:139], v[176:179]
    v_rcp_f32 v146, v146
    v_mfma_f32_16x16x32_bf16 v[180:183], a[244:247], v[136:139], v[180:183]
    buffer_load_dwordx4 v[84:87], v78, s[64:67], s68 offen offset:256 sc1
    v_mfma_f32_16x16x32_bf16 v[184:187], a[240:243], v[140:143], v[184:187]
    ds_read_b128 a[232:235], v2 offset:56320
    ds_read_b128 a[236:239], v3 offset:56320
    v_mfma_f32_16x16x32_bf16 v[188:191], a[244:247], v[140:143], v[188:191]
    v_mul_f32 v158, v154, v158
    v_mul_f32 v154, v58, v154
    v_mfma_f32_16x16x32_bf16 v[176:179], v[28:31], v[24:27], v[176:179]
    v_exp_f32 v153, v153
    v_mfma_f32_16x16x32_bf16 v[180:183], v[32:35], v[24:27], v[180:183]
    buffer_load_dwordx4 v[88:91], v78, s[64:67], s68 offen offset:2048 sc1
    v_mfma_f32_16x16x32_bf16 v[184:187], v[28:31], v[26:29], v[184:187]
    v_fma_f32 v152, v152, v59, v59
    v_mul_f32 v150, v150, v146
    v_mfma_f32_16x16x32_bf16 v[188:191], v[32:35], v[26:29], v[188:191]
    v_rcp_f32 v147, v147
    v_mfma_f32_16x16x32_bf16 v[192:195], a[248:251], v[104:107], v[192:195]
    v_cvt_pk_bf16_f32 v144, v148, v149
    v_mul_f32 v159, v155, v159
    v_mfma_f32_16x16x32_bf16 v[196:199], a[252:255], v[104:107], v[196:199]
    buffer_load_dwordx4 v[92:95], v78, s[64:67], s68 offen offset:2304 sc1
    v_mfma_f32_16x16x32_bf16 v[200:203], a[248:251], v[108:111], v[200:203]
    ds_read_b128 a[240:243], v2 offset:60416
    ds_read_b128 a[244:247], v3 offset:60416
    v_mfma_f32_16x16x32_bf16 v[204:207], a[252:255], v[108:111], v[204:207]
    s_lshl_b64 s[40:41], s[44:45], 48
    s_waitcnt lgkmcnt(2)
    v_mfma_f32_16x16x32_bf16 v[192:195], a[224:227], v[112:115], v[192:195]
    v_cndmask_b32 v24, 0, v36, s[40:41]
    v_cndmask_b32 v25, 0, v37, s[40:41]
    v_mfma_f32_16x16x32_bf16 v[196:199], a[228:231], v[112:115], v[196:199]
    buffer_load_dwordx4 v[96:99], v78, s[64:67], s69 offen offset:0 sc1
    v_mfma_f32_16x16x32_bf16 v[200:203], a[224:227], v[116:119], v[200:203]
    ds_read_b128 a[248:251], v2 offset:64512
    ds_read_b128 a[252:255], v3 offset:64512
    v_mfma_f32_16x16x32_bf16 v[204:207], a[228:231], v[116:119], v[204:207]
    v_cndmask_b32 v26, 0, v38, s[40:41]
    v_cndmask_b32 v27, 0, v39, s[40:41]
    v_mfma_f32_16x16x32_bf16 v[192:195], a[232:235], v[120:123], v[192:195]
    v_mul_f32 v155, v58, v155
    v_fma_f32 v153, v153, v59, v59
    v_mfma_f32_16x16x32_bf16 v[196:199], a[236:239], v[120:123], v[196:199]
    buffer_load_dwordx4 v[100:103], v78, s[64:67], s69 offen offset:256 sc1
    v_mfma_f32_16x16x32_bf16 v[200:203], a[232:235], v[124:127], v[200:203]
    v_exp_f32 v154, v154
    v_mfma_f32_16x16x32_bf16 v[204:207], a[236:239], v[124:127], v[204:207]
    v_mul_f32 v151, v151, v147
    s_waitcnt lgkmcnt(0)
    v_mfma_f32_16x16x32_bf16 v[192:195], a[240:243], v[128:131], v[192:195]
    v_rcp_f32 v152, v152
    v_mfma_f32_16x16x32_bf16 v[196:199], a[244:247], v[128:131], v[196:199]
    buffer_load_dwordx4 v[104:107], v78, s[64:67], s69 offen offset:2048 sc1
    v_mfma_f32_16x16x32_bf16 v[200:203], a[240:243], v[132:135], v[200:203]
    v_exp_f32 v155, v155
    v_mfma_f32_16x16x32_bf16 v[204:207], a[244:247], v[132:135], v[204:207]
    v_fma_f32 v154, v154, v59, v59
    v_mul_f32 v156, v156, v152
    v_mfma_f32_16x16x32_bf16 v[192:195], a[248:251], v[136:139], v[192:195]
    v_rcp_f32 v153, v153
    v_mfma_f32_16x16x32_bf16 v[196:199], a[252:255], v[136:139], v[196:199]
    buffer_load_dwordx4 v[108:111], v78, s[64:67], s69 offen offset:2304 sc1
    v_mfma_f32_16x16x32_bf16 v[200:203], a[248:251], v[140:143], v[200:203]
    v_cvt_pk_bf16_f32 v145, v150, v151
    v_fma_f32 v155, v155, v59, v59
    v_mfma_f32_16x16x32_bf16 v[204:207], a[252:255], v[140:143], v[204:207]
    v_mul_f32 v157, v157, v153
    v_mfma_f32_16x16x32_bf16 v[192:195], v[28:31], v[24:27], v[192:195]
    v_rcp_f32 v154, v154
    v_mfma_f32_16x16x32_bf16 v[196:199], v[32:35], v[24:27], v[196:199]
    buffer_load_dwordx4 v[112:115], v78, s[64:67], s70 offen offset:0 sc1
    v_mfma_f32_16x16x32_bf16 v[200:203], v[28:31], v[26:29], v[200:203]
    v_rcp_f32 v155, v155
    v_mfma_f32_16x16x32_bf16 v[204:207], v[32:35], v[26:29], v[204:207]
    v_mul_f32 v158, v158, v154
    v_cvt_pk_bf16_f32 v146, v156, v157
    v_mul_f32 v159, v159, v155
    v_cvt_pk_bf16_f32 v147, v158, v159
    v_permlane16_swap_b32 v144, v146
    s_nop 0
    v_permlane16_swap_b32 v145, v147
    buffer_store_dwordx4 v[144:147], v2, s[64:67], s96 offen sc1
    s_add_u32 s97, s10, 0x1d400
    v_pk_mul_f32 v[164:165], v[160:161], v[164:165]
    v_pk_mul_f32 v[160:161], v[160:161], v[56:57] op_sel_hi:[1,0]
    v_pk_mul_f32 v[166:167], v[162:163], v[166:167]
    v_pk_mul_f32 v[162:163], v[162:163], v[56:57] op_sel_hi:[1,0]
    v_pk_mul_f32 v[172:173], v[168:169], v[172:173]
    v_pk_mul_f32 v[168:169], v[168:169], v[58:59] op_sel_hi:[1,0]
    v_pk_mul_f32 v[174:175], v[170:171], v[174:175]
    v_pk_mul_f32 v[170:171], v[170:171], v[58:59] op_sel_hi:[1,0]
    buffer_load_dwordx4 v[116:119], v78, s[64:67], s70 offen offset:256 sc1
    v_exp_f32 v160, v160
    v_exp_f32 v161, v161
    v_exp_f32 v162, v162
    v_exp_f32 v163, v163
    v_exp_f32 v168, v168
    v_exp_f32 v169, v169
    buffer_load_dwordx4 v[120:123], v78, s[64:67], s70 offen offset:2048 sc1
    v_exp_f32 v170, v170
    v_exp_f32 v171, v171
    v_pk_fma_f32 v[160:161], v[160:161], v[56:57], v[56:57] op_sel:[0,1,1] op_sel_hi:[1,1,1]
    v_pk_fma_f32 v[162:163], v[162:163], v[56:57], v[56:57] op_sel:[0,1,1] op_sel_hi:[1,1,1]
    v_pk_fma_f32 v[168:169], v[168:169], v[58:59], v[58:59] op_sel:[0,1,1] op_sel_hi:[1,1,1]
    v_pk_fma_f32 v[170:171], v[170:171], v[58:59], v[58:59] op_sel:[0,1,1] op_sel_hi:[1,1,1]
    v_rcp_f32 v160, v160
    v_rcp_f32 v161, v161
    v_rcp_f32 v162, v162
    v_rcp_f32 v163, v163
    buffer_load_dwordx4 v[124:127], v78, s[64:67], s70 offen offset:2304 sc1
    v_rcp_f32 v168, v168
    v_rcp_f32 v169, v169
    v_rcp_f32 v170, v170
    v_rcp_f32 v171, v171
    v_pk_mul_f32 v[164:165], v[164:165], v[160:161]
    v_pk_mul_f32 v[166:167], v[166:167], v[162:163]
    v_pk_mul_f32 v[172:173], v[172:173], v[168:169]
    v_pk_mul_f32 v[174:175], v[174:175], v[170:171]
    v_cvt_pk_bf16_f32 v160, v164, v165
    v_cvt_pk_bf16_f32 v161, v166, v167
    v_cvt_pk_bf16_f32 v162, v172, v173
    v_cvt_pk_bf16_f32 v163, v174, v175
    s_nop 0
    v_permlane16_swap_b32 v160, v162
    v_permlane16_swap_b32 v161, v163
    buffer_store_dwordx4 v[160:163], v2, s[64:67], s97 offen sc1
    s_add_u32 s98, s10, 0x1d800
    v_pk_mul_f32 v[180:181], v[176:177], v[180:181]
    v_pk_mul_f32 v[176:177], v[176:177], v[56:57] op_sel_hi:[1,0]
    v_pk_mul_f32 v[182:183], v[178:179], v[182:183]
    v_pk_mul_f32 v[178:179], v[178:179], v[56:57] op_sel_hi:[1,0]
    v_pk_mul_f32 v[188:189], v[184:185], v[188:189]
    v_pk_mul_f32 v[184:185], v[184:185], v[58:59] op_sel_hi:[1,0]
    v_pk_mul_f32 v[190:191], v[186:187], v[190:191]
    v_pk_mul_f32 v[186:187], v[186:187], v[58:59] op_sel_hi:[1,0]
    buffer_load_dwordx4 v[128:131], v78, s[64:67], s71 offen offset:0 sc1
    v_exp_f32 v176, v176
    v_exp_f32 v177, v177
    v_exp_f32 v178, v178
    v_exp_f32 v179, v179
    v_exp_f32 v184, v184
    v_exp_f32 v185, v185
    buffer_load_dwordx4 v[132:135], v78, s[64:67], s71 offen offset:256 sc1
    v_exp_f32 v186, v186
    v_exp_f32 v187, v187
    v_pk_fma_f32 v[176:177], v[176:177], v[56:57], v[56:57] op_sel:[0,1,1] op_sel_hi:[1,1,1]
    v_pk_fma_f32 v[178:179], v[178:179], v[56:57], v[56:57] op_sel:[0,1,1] op_sel_hi:[1,1,1]
    v_pk_fma_f32 v[184:185], v[184:185], v[58:59], v[58:59] op_sel:[0,1,1] op_sel_hi:[1,1,1]
    v_pk_fma_f32 v[186:187], v[186:187], v[58:59], v[58:59] op_sel:[0,1,1] op_sel_hi:[1,1,1]
    v_rcp_f32 v176, v176
    v_rcp_f32 v177, v177
    v_rcp_f32 v178, v178
    v_rcp_f32 v179, v179
    buffer_load_dwordx4 v[136:139], v78, s[64:67], s71 offen offset:2048 sc1
    v_rcp_f32 v184, v184
    v_rcp_f32 v185, v185
    v_rcp_f32 v186, v186
    v_rcp_f32 v187, v187
    v_pk_mul_f32 v[180:181], v[180:181], v[176:177]
    v_pk_mul_f32 v[182:183], v[182:183], v[178:179]
    v_pk_mul_f32 v[188:189], v[188:189], v[184:185]
    v_pk_mul_f32 v[190:191], v[190:191], v[186:187]
    v_cvt_pk_bf16_f32 v176, v180, v181
    v_cvt_pk_bf16_f32 v177, v182, v183
    v_cvt_pk_bf16_f32 v178, v188, v189
    v_cvt_pk_bf16_f32 v179, v190, v191
    s_nop 0
    v_permlane16_swap_b32 v176, v178
    v_permlane16_swap_b32 v177, v179
    buffer_store_dwordx4 v[176:179], v2, s[64:67], s98 offen sc1
    s_add_u32 s99, s10, 0x1cc00
    v_pk_mul_f32 v[196:197], v[192:193], v[196:197]
    v_pk_mul_f32 v[192:193], v[192:193], v[56:57] op_sel_hi:[1,0]
    v_pk_mul_f32 v[198:199], v[194:195], v[198:199]
    v_pk_mul_f32 v[194:195], v[194:195], v[56:57] op_sel_hi:[1,0]
    v_pk_mul_f32 v[204:205], v[200:201], v[204:205]
    v_pk_mul_f32 v[200:201], v[200:201], v[58:59] op_sel_hi:[1,0]
    v_pk_mul_f32 v[206:207], v[202:203], v[206:207]
    v_pk_mul_f32 v[202:203], v[202:203], v[58:59] op_sel_hi:[1,0]
    buffer_load_dwordx4 v[140:143], v78, s[64:67], s71 offen offset:2304 sc1
    v_exp_f32 v192, v192
    v_exp_f32 v193, v193
    v_exp_f32 v194, v194
    v_exp_f32 v195, v195
    v_exp_f32 v200, v200
    v_exp_f32 v201, v201
    v_exp_f32 v202, v202
    v_exp_f32 v203, v203
    v_pk_fma_f32 v[192:193], v[192:193], v[56:57], v[56:57] op_sel:[0,1,1] op_sel_hi:[1,1,1]
    v_pk_fma_f32 v[194:195], v[194:195], v[56:57], v[56:57] op_sel:[0,1,1] op_sel_hi:[1,1,1]
    v_pk_fma_f32 v[200:201], v[200:201], v[58:59], v[58:59] op_sel:[0,1,1] op_sel_hi:[1,1,1]
    v_pk_fma_f32 v[202:203], v[202:203], v[58:59], v[58:59] op_sel:[0,1,1] op_sel_hi:[1,1,1]
    v_rcp_f32 v192, v192
    v_rcp_f32 v193, v193
    v_rcp_f32 v194, v194
    v_rcp_f32 v195, v195
    v_rcp_f32 v200, v200
    v_rcp_f32 v201, v201
    v_rcp_f32 v202, v202
    v_rcp_f32 v203, v203
    v_pk_mul_f32 v[196:197], v[196:197], v[192:193]
    v_pk_mul_f32 v[198:199], v[198:199], v[194:195]
    v_pk_mul_f32 v[204:205], v[204:205], v[200:201]
    v_pk_mul_f32 v[206:207], v[206:207], v[202:203]
    v_cvt_pk_bf16_f32 v192, v196, v197
    v_cvt_pk_bf16_f32 v193, v198, v199
    v_cvt_pk_bf16_f32 v194, v204, v205
    v_cvt_pk_bf16_f32 v195, v206, v207
    s_nop 0
    v_permlane16_swap_b32 v192, v194
    v_permlane16_swap_b32 v193, v195
    buffer_store_dwordx4 v[192:195], v2, s[64:67], s99 offen sc1
    s_waitcnt lgkmcnt(0)
    s_waitcnt vmcnt(19)
    v_mfma_f32_16x16x32_bf16 v[208:211], a[0:3], v[80:83], 0
    v_mfma_f32_16x16x32_bf16 v[212:215], a[4:7], v[80:83], 0
    v_mfma_f32_16x16x32_bf16 v[216:219], a[8:11], v[80:83], 0
    v_mfma_f32_16x16x32_bf16 v[220:223], a[12:15], v[80:83], 0
    s_waitcnt vmcnt(18)
    v_mfma_f32_16x16x32_bf16 v[224:227], a[0:3], v[84:87], 0
    buffer_load_dwordx4 v[80:83], v78, s[64:67], s72 offen offset:0 sc1
    v_mfma_f32_16x16x32_bf16 v[228:231], a[4:7], v[84:87], 0
    v_mfma_f32_16x16x32_bf16 v[232:235], a[8:11], v[84:87], 0
    v_mfma_f32_16x16x32_bf16 v[236:239], a[12:15], v[84:87], 0
    s_waitcnt vmcnt(18)
    v_mfma_f32_16x16x32_bf16 v[208:211], a[16:19], v[88:91], v[208:211]
    buffer_load_dwordx4 v[84:87], v78, s[64:67], s72 offen offset:256 sc1
    v_mfma_f32_16x16x32_bf16 v[212:215], a[20:23], v[88:91], v[212:215]
    v_mfma_f32_16x16x32_bf16 v[216:219], a[24:27], v[88:91], v[216:219]
    v_mfma_f32_16x16x32_bf16 v[220:223], a[28:31], v[88:91], v[220:223]
    s_waitcnt vmcnt(18)
    v_mfma_f32_16x16x32_bf16 v[224:227], a[16:19], v[92:95], v[224:227]
    buffer_load_dwordx4 v[88:91], v78, s[64:67], s72 offen offset:2048 sc1
    v_mfma_f32_16x16x32_bf16 v[228:231], a[20:23], v[92:95], v[228:231]
    v_mfma_f32_16x16x32_bf16 v[232:235], a[24:27], v[92:95], v[232:235]
    v_mfma_f32_16x16x32_bf16 v[236:239], a[28:31], v[92:95], v[236:239]
    s_waitcnt vmcnt(18)
    v_mfma_f32_16x16x32_bf16 v[208:211], a[32:35], v[96:99], v[208:211]
    buffer_load_dwordx4 v[92:95], v78, s[64:67], s72 offen offset:2304 sc1
    v_mfma_f32_16x16x32_bf16 v[212:215], a[36:39], v[96:99], v[212:215]
    v_mfma_f32_16x16x32_bf16 v[216:219], a[40:43], v[96:99], v[216:219]
    v_mfma_f32_16x16x32_bf16 v[220:223], a[44:47], v[96:99], v[220:223]
    s_waitcnt vmcnt(18)
    v_mfma_f32_16x16x32_bf16 v[224:227], a[32:35], v[100:103], v[224:227]
    buffer_load_dwordx4 v[96:99], v78, s[64:67], s73 offen offset:0 sc1
    v_mfma_f32_16x16x32_bf16 v[228:231], a[36:39], v[100:103], v[228:231]
    v_mfma_f32_16x16x32_bf16 v[232:235], a[40:43], v[100:103], v[232:235]
    v_mfma_f32_16x16x32_bf16 v[236:239], a[44:47], v[100:103], v[236:239]
    s_waitcnt vmcnt(18)
    v_mfma_f32_16x16x32_bf16 v[208:211], a[48:51], v[104:107], v[208:211]
    buffer_load_dwordx4 v[100:103], v78, s[64:67], s73 offen offset:256 sc1
    v_mfma_f32_16x16x32_bf16 v[212:215], a[52:55], v[104:107], v[212:215]
    v_mfma_f32_16x16x32_bf16 v[216:219], a[56:59], v[104:107], v[216:219]
    v_mfma_f32_16x16x32_bf16 v[220:223], a[60:63], v[104:107], v[220:223]
    s_waitcnt vmcnt(18)
    v_mfma_f32_16x16x32_bf16 v[224:227], a[48:51], v[108:111], v[224:227]
    buffer_load_dwordx4 v[104:107], v78, s[64:67], s73 offen offset:2048 sc1
    v_mfma_f32_16x16x32_bf16 v[228:231], a[52:55], v[108:111], v[228:231]
    v_mfma_f32_16x16x32_bf16 v[232:235], a[56:59], v[108:111], v[232:235]
    v_mfma_f32_16x16x32_bf16 v[236:239], a[60:63], v[108:111], v[236:239]
    s_waitcnt vmcnt(18)
    v_mfma_f32_16x16x32_bf16 v[208:211], a[64:67], v[112:115], v[208:211]
    buffer_load_dwordx4 v[108:111], v78, s[64:67], s73 offen offset:2304 sc1
    v_mfma_f32_16x16x32_bf16 v[212:215], a[68:71], v[112:115], v[212:215]
    v_mfma_f32_16x16x32_bf16 v[216:219], a[72:75], v[112:115], v[216:219]
    v_mfma_f32_16x16x32_bf16 v[220:223], a[76:79], v[112:115], v[220:223]
    s_waitcnt vmcnt(17)
    v_mfma_f32_16x16x32_bf16 v[224:227], a[64:67], v[116:119], v[224:227]
    buffer_load_dwordx4 v[112:115], v78, s[64:67], s74 offen offset:0 sc1
    v_mfma_f32_16x16x32_bf16 v[228:231], a[68:71], v[116:119], v[228:231]
    v_mfma_f32_16x16x32_bf16 v[232:235], a[72:75], v[116:119], v[232:235]
    v_mfma_f32_16x16x32_bf16 v[236:239], a[76:79], v[116:119], v[236:239]
    s_waitcnt vmcnt(17)
    v_mfma_f32_16x16x32_bf16 v[208:211], a[80:83], v[120:123], v[208:211]
    buffer_load_dwordx4 v[116:119], v78, s[64:67], s74 offen offset:256 sc1
    v_mfma_f32_16x16x32_bf16 v[212:215], a[84:87], v[120:123], v[212:215]
    v_mfma_f32_16x16x32_bf16 v[216:219], a[88:91], v[120:123], v[216:219]
    v_mfma_f32_16x16x32_bf16 v[220:223], a[92:95], v[120:123], v[220:223]
    s_waitcnt vmcnt(10)
    s_cmp_eq_u32 s16, 0
    s_cbranch_scc1 L_ps_113
    buffer_store_dword v23, off, s[64:67], s26 offset:256
L_pb_114:
    s_add_u32 s80, s10, 0x1cc00
    v_lshlrev_b32 v16, 3, v2
    s_mov_b32 exec_hi, 0
    buffer_load_dword v16, v16, s[64:67], s80 offen sc1
    s_mov_b64 exec, -1
    v_mfma_f32_16x16x32_bf16 v[224:227], a[80:83], v[124:127], v[224:227]
    buffer_load_dwordx4 v[120:123], v78, s[64:67], s74 offen offset:2048 sc1
    v_mfma_f32_16x16x32_bf16 v[228:231], a[84:87], v[124:127], v[228:231]
    v_mfma_f32_16x16x32_bf16 v[232:235], a[88:91], v[124:127], v[232:235]
    v_mfma_f32_16x16x32_bf16 v[236:239], a[92:95], v[124:127], v[236:239]
    v_mfma_f32_16x16x32_bf16 v[208:211], a[96:99], v[128:131], v[208:211]
    buffer_load_dwordx4 v[124:127], v78, s[64:67], s74 offen offset:2304 sc1
    v_mfma_f32_16x16x32_bf16 v[212:215], a[100:103], v[128:131], v[212:215]
    v_mfma_f32_16x16x32_bf16 v[216:219], a[104:107], v[128:131], v[216:219]
    v_mfma_f32_16x16x32_bf16 v[220:223], a[108:111], v[128:131], v[220:223]
    v_mfma_f32_16x16x32_bf16 v[224:227], a[96:99], v[132:135], v[224:227]
    v_mfma_f32_16x16x32_bf16 v[228:231], a[100:103], v[132:135], v[228:231]
    v_mfma_f32_16x16x32_bf16 v[232:235], a[104:107], v[132:135], v[232:235]
    v_mfma_f32_16x16x32_bf16 v[236:239], a[108:111], v[132:135], v[236:239]
    v_mfma_f32_16x16x32_bf16 v[208:211], a[112:115], v[136:139], v[208:211]
    v_mfma_f32_16x16x32_bf16 v[212:215], a[116:119], v[136:139], v[212:215]
    v_mfma_f32_16x16x32_bf16 v[216:219], a[120:123], v[136:139], v[216:219]
    v_mfma_f32_16x16x32_bf16 v[220:223], a[124:127], v[136:139], v[220:223]
    v_mfma_f32_16x16x32_bf16 v[224:227], a[112:115], v[140:143], v[224:227]
    v_mfma_f32_16x16x32_bf16 v[228:231], a[116:119], v[140:143], v[228:231]
    v_mfma_f32_16x16x32_bf16 v[232:235], a[120:123], v[140:143], v[232:235]
    v_mfma_f32_16x16x32_bf16 v[236:239], a[124:127], v[140:143], v[236:239]
    s_waitcnt vmcnt(13)
    v_mfma_f32_16x16x32_bf16 v[208:211], a[128:131], v[80:83], v[208:211]
    v_mfma_f32_16x16x32_bf16 v[212:215], a[132:135], v[80:83], v[212:215]
    v_mfma_f32_16x16x32_bf16 v[216:219], a[136:139], v[80:83], v[216:219]
    v_mfma_f32_16x16x32_bf16 v[220:223], a[140:143], v[80:83], v[220:223]
    s_waitcnt vmcnt(12)
    v_mfma_f32_16x16x32_bf16 v[224:227], a[128:131], v[84:87], v[224:227]
    v_mfma_f32_16x16x32_bf16 v[228:231], a[132:135], v[84:87], v[228:231]
    v_mfma_f32_16x16x32_bf16 v[232:235], a[136:139], v[84:87], v[232:235]
    v_mfma_f32_16x16x32_bf16 v[236:239], a[140:143], v[84:87], v[236:239]
    s_waitcnt vmcnt(11)
    v_mfma_f32_16x16x32_bf16 v[208:211], a[144:147], v[88:91], v[208:211]
    v_mfma_f32_16x16x32_bf16 v[212:215], a[148:151], v[88:91], v[212:215]
    v_mfma_f32_16x16x32_bf16 v[216:219], a[152:155], v[88:91], v[216:219]
    v_mfma_f32_16x16x32_bf16 v[220:223], a[156:159], v[88:91], v[220:223]
    s_waitcnt vmcnt(10)
    v_mfma_f32_16x16x32_bf16 v[224:227], a[144:147], v[92:95], v[224:227]
    v_mfma_f32_16x16x32_bf16 v[228:231], a[148:151], v[92:95], v[228:231]
    v_mfma_f32_16x16x32_bf16 v[232:235], a[152:155], v[92:95], v[232:235]
    v_mfma_f32_16x16x32_bf16 v[236:239], a[156:159], v[92:95], v[236:239]
    s_waitcnt vmcnt(9)
    v_mfma_f32_16x16x32_bf16 v[208:211], a[160:163], v[96:99], v[208:211]
    v_mfma_f32_16x16x32_bf16 v[212:215], a[164:167], v[96:99], v[212:215]
    v_mfma_f32_16x16x32_bf16 v[216:219], a[168:171], v[96:99], v[216:219]
    v_mfma_f32_16x16x32_bf16 v[220:223], a[172:175], v[96:99], v[220:223]
    s_waitcnt vmcnt(8)
    v_mfma_f32_16x16x32_bf16 v[224:227], a[160:163], v[100:103], v[224:227]
    v_mfma_f32_16x16x32_bf16 v[228:231], a[164:167], v[100:103], v[228:231]
    v_mfma_f32_16x16x32_bf16 v[232:235], a[168:171], v[100:103], v[232:235]
    v_mfma_f32_16x16x32_bf16 v[236:239], a[172:175], v[100:103], v[236:239]
    s_waitcnt vmcnt(7)
    v_mfma_f32_16x16x32_bf16 v[208:211], a[176:179], v[104:107], v[208:211]
    v_mfma_f32_16x16x32_bf16 v[212:215], a[180:183], v[104:107], v[212:215]
    v_mfma_f32_16x16x32_bf16 v[216:219], a[184:187], v[104:107], v[216:219]
    v_mfma_f32_16x16x32_bf16 v[220:223], a[188:191], v[104:107], v[220:223]
    s_waitcnt vmcnt(6)
    v_mfma_f32_16x16x32_bf16 v[224:227], a[176:179], v[108:111], v[224:227]
    v_mfma_f32_16x16x32_bf16 v[228:231], a[180:183], v[108:111], v[228:231]
    buffer_load_dword v16, v5, s[64:67], s27 offen offset:256 sc1
    v_mfma_f32_16x16x32_bf16 v[232:235], a[184:187], v[108:111], v[232:235]
    v_mfma_f32_16x16x32_bf16 v[236:239], a[188:191], v[108:111], v[236:239]
    s_waitcnt vmcnt(6)
    v_mfma_f32_16x16x32_bf16 v[208:211], a[192:195], v[112:115], v[208:211]
    v_mfma_f32_16x16x32_bf16 v[212:215], a[196:199], v[112:115], v[212:215]
    v_mfma_f32_16x16x32_bf16 v[216:219], a[200:203], v[112:115], v[216:219]
    v_mfma_f32_16x16x32_bf16 v[220:223], a[204:207], v[112:115], v[220:223]
    s_waitcnt vmcnt(2)
    v_mfma_f32_16x16x32_bf16 v[208:211], a[208:211], v[120:123], v[208:211]
    v_xor_b32 v73, 64, v8
    v_xor_b32 v74, 128, v8
    v_xor_b32 v75, 192, v8
    v_mfma_f32_16x16x32_bf16 v[212:215], a[212:215], v[120:123], v[212:215]
    v_mfma_f32_16x16x32_bf16 v[216:219], a[216:219], v[120:123], v[216:219]
    v_mfma_f32_16x16x32_bf16 v[220:223], a[220:223], v[120:123], v[220:223]
    v_mfma_f32_16x16x32_bf16 v[224:227], a[192:195], v[116:119], v[224:227]
    v_mfma_f32_16x16x32_bf16 v[228:231], a[196:199], v[116:119], v[228:231]
    v_mfma_f32_16x16x32_bf16 v[232:235], a[200:203], v[116:119], v[232:235]
    ds_write_b128 v8, v[208:211]
    v_mfma_f32_16x16x32_bf16 v[236:239], a[204:207], v[116:119], v[236:239]
    s_nop 0
    ds_write_b128 v73, v[212:215]
    s_waitcnt vmcnt(1)
    v_mfma_f32_16x16x32_bf16 v[224:227], a[208:211], v[124:127], v[224:227]
    ds_write_b128 v74, v[216:219]
    v_mfma_f32_16x16x32_bf16 v[228:231], a[212:215], v[124:127], v[228:231]
    s_waitcnt vmcnt(0)
    v_cmp_eq_u32 vcc, 0, v16
    s_cbranch_vccnz L_fs_115
L_fb_116:
    s_add_u32 s80, s11, 0x1c000
    v_add_u32 v79, s80, v0
    ds_write_b128 v75, v[220:223]
    v_mfma_f32_16x16x32_bf16 v[232:235], a[216:219], v[124:127], v[232:235]
    buffer_load_dwordx4 v[128:131], v79, s[64:67], s68 offen offset:0 sc1
    v_mfma_f32_16x16x32_bf16 v[236:239], a[220:223], v[124:127], v[236:239]
    buffer_load_dwordx4 v[132:135], v79, s[64:67], s68 offen offset:256 sc1
    buffer_load_dwordx4 v[136:139], v79, s[64:67], s68 offen offset:2048 sc1
    ds_write_b128 v8, v[224:227] offset:4096
    ds_write_b128 v73, v[228:231] offset:4096
    s_nop 1
    ds_write_b128 v74, v[232:235] offset:4096
    s_nop 0
    ds_write_b128 v75, v[236:239] offset:4096
    buffer_load_dwordx4 v[140:143], v79, s[64:67], s68 offen offset:2304 sc1
    buffer_load_dwordx4 v[80:83], v79, s[64:67], s69 offen offset:0 sc1
    v_lshlrev_b32 v176, 16, v40
    v_and_b32 v177, 0xffff0000, v40
    v_lshlrev_b32 v178, 16, v41
    v_and_b32 v179, 0xffff0000, v41
    v_lshlrev_b32 v180, 16, v42
    v_and_b32 v181, 0xffff0000, v42
    v_lshlrev_b32 v182, 16, v43
    v_and_b32 v183, 0xffff0000, v43
    s_waitcnt lgkmcnt(0)
    s_barrier
    ds_read_b128 v[144:147], v9 offset:0
    ds_read_b128 v[148:151], v10 offset:0
    ds_read_b128 v[152:155], v9 offset:8192
    ds_read_b128 v[156:159], v10 offset:8192
    ds_read_b128 v[160:163], v9 offset:16384
    ds_read_b128 v[164:167], v10 offset:16384
    ds_read_b128 v[168:171], v9 offset:24576
    ds_read_b128 v[172:175], v10 offset:24576
    buffer_load_dwordx4 v[84:87], v79, s[64:67], s69 offen offset:256 sc1
    buffer_load_dwordx4 v[88:91], v79, s[64:67], s69 offen offset:2048 sc1
    s_waitcnt lgkmcnt(7)
    v_pk_add_f32 v[176:177], v[176:177], v[144:145]
    v_pk_add_f32 v[178:179], v[178:179], v[146:147]
    s_waitcnt lgkmcnt(6)
    v_pk_add_f32 v[180:181], v[180:181], v[148:149]
    v_pk_add_f32 v[182:183], v[182:183], v[150:151]
    s_waitcnt lgkmcnt(5)
    v_pk_add_f32 v[176:177], v[176:177], v[152:153]
    v_pk_add_f32 v[178:179], v[178:179], v[154:155]
    s_waitcnt lgkmcnt(4)
    v_pk_add_f32 v[180:181], v[180:181], v[156:157]
    v_pk_add_f32 v[182:183], v[182:183], v[158:159]
    s_waitcnt lgkmcnt(3)
    v_pk_add_f32 v[176:177], v[176:177], v[160:161]
    v_pk_add_f32 v[178:179], v[178:179], v[162:163]
    s_waitcnt lgkmcnt(2)
    v_pk_add_f32 v[180:181], v[180:181], v[164:165]
    v_pk_add_f32 v[182:183], v[182:183], v[166:167]
    s_waitcnt lgkmcnt(1)
    v_pk_add_f32 v[176:177], v[176:177], v[168:169]
    v_pk_add_f32 v[178:179], v[178:179], v[170:171]
    buffer_load_dwordx4 v[92:95], v79, s[64:67], s69 offen offset:2304 sc1
    buffer_load_dwordx4 v[96:99], v79, s[64:67], s70 offen offset:0 sc1
    s_waitcnt lgkmcnt(0)
    v_pk_add_f32 v[180:181], v[180:181], v[172:173]
    v_pk_add_f32 v[182:183], v[182:183], v[174:175]
    v_pk_add_f32 v[76:77], v[176:177], v[178:179]
    v_pk_mul_f32 v[18:19], v[176:177], v[176:177]
    v_pk_add_f32 v[76:77], v[76:77], v[180:181]
    v_pk_fma_f32 v[18:19], v[178:179], v[178:179], v[18:19]
    v_pk_add_f32 v[76:77], v[76:77], v[182:183]
    v_pk_fma_f32 v[18:19], v[180:181], v[180:181], v[18:19]
    v_pk_fma_f32 v[18:19], v[182:183], v[182:183], v[18:19]
    v_add_f32 v19, v18, v19
    v_add_f32 v18, v76, v77
    s_nop 1
    v_permlane32_swap_b32 v18, v19
    v_add_f32 v18, v18, v19
    v_mov_b32 v76, v18
    s_nop 1
    v_permlane16_swap_b32 v18, v76
    v_add_f32 v18, v18, v76
    s_nop 1
    v_add_f32_dpp v18, v18, v18 row_ror:8 row_mask:0xf bank_mask:0xf
    v_mov_b32 v19, v18
    s_nop 1
    v_permlane32_swap_b32 v18, v19
    s_mov_b64 exec, 0xff
    s_cmp_eq_u32 s16, 0
    s_cbranch_scc1 L_ps_117
    buffer_store_dwordx2 v[18:19], v17, s[64:67], s25 offen offset:0
L_pb_118:
    s_mov_b64 exec, -1
    s_waitcnt vmcnt(9)
    v_mfma_f32_16x16x32_bf16 v[208:211], a[0:3], v[128:131], 0
    buffer_load_dwordx4 v[100:103], v79, s[64:67], s70 offen offset:256 sc1
    v_mfma_f32_16x16x32_bf16 v[212:215], a[4:7], v[128:131], 0
    s_barrier
    v_mfma_f32_16x16x32_bf16 v[216:219], a[8:11], v[128:131], 0
    v_mfma_f32_16x16x32_bf16 v[220:223], a[12:15], v[128:131], 0
    s_waitcnt vmcnt(9)
    v_mfma_f32_16x16x32_bf16 v[224:227], a[0:3], v[132:135], 0
    buffer_load_dwordx4 v[104:107], v79, s[64:67], s70 offen offset:2048 sc1
    v_mfma_f32_16x16x32_bf16 v[228:231], a[4:7], v[132:135], 0
    v_mfma_f32_16x16x32_bf16 v[232:235], a[8:11], v[132:135], 0
    v_mfma_f32_16x16x32_bf16 v[236:239], a[12:15], v[132:135], 0
    s_waitcnt vmcnt(9)
    v_mfma_f32_16x16x32_bf16 v[208:211], a[16:19], v[136:139], v[208:211]
    buffer_load_dwordx4 v[108:111], v79, s[64:67], s70 offen offset:2304 sc1
    v_mfma_f32_16x16x32_bf16 v[212:215], a[20:23], v[136:139], v[212:215]
    v_mfma_f32_16x16x32_bf16 v[216:219], a[24:27], v[136:139], v[216:219]
    v_mfma_f32_16x16x32_bf16 v[220:223], a[28:31], v[136:139], v[220:223]
    s_waitcnt vmcnt(9)
    v_mfma_f32_16x16x32_bf16 v[224:227], a[16:19], v[140:143], v[224:227]
    buffer_load_dwordx4 v[112:115], v79, s[64:67], s71 offen offset:0 sc1
    v_mfma_f32_16x16x32_bf16 v[228:231], a[20:23], v[140:143], v[228:231]
    v_mfma_f32_16x16x32_bf16 v[232:235], a[24:27], v[140:143], v[232:235]
    v_mfma_f32_16x16x32_bf16 v[236:239], a[28:31], v[140:143], v[236:239]
    s_waitcnt vmcnt(9)
    v_mfma_f32_16x16x32_bf16 v[208:211], a[32:35], v[80:83], v[208:211]
    buffer_load_dwordx4 v[116:119], v79, s[64:67], s71 offen offset:256 sc1
    v_mfma_f32_16x16x32_bf16 v[212:215], a[36:39], v[80:83], v[212:215]
    v_mfma_f32_16x16x32_bf16 v[216:219], a[40:43], v[80:83], v[216:219]
    v_mfma_f32_16x16x32_bf16 v[220:223], a[44:47], v[80:83], v[220:223]
    s_waitcnt vmcnt(9)
    v_mfma_f32_16x16x32_bf16 v[224:227], a[32:35], v[84:87], v[224:227]
    buffer_load_dwordx4 v[120:123], v79, s[64:67], s71 offen offset:2048 sc1
    v_mfma_f32_16x16x32_bf16 v[228:231], a[36:39], v[84:87], v[228:231]
    v_mfma_f32_16x16x32_bf16 v[232:235], a[40:43], v[84:87], v[232:235]
    v_mfma_f32_16x16x32_bf16 v[236:239], a[44:47], v[84:87], v[236:239]
    buffer_load_dwordx2 v[18:19], v17, s[64:67], s6 offen offset:0 sc1
    s_waitcnt vmcnt(10)
    v_mfma_f32_16x16x32_bf16 v[208:211], a[48:51], v[88:91], v[208:211]
    buffer_load_dwordx4 v[124:127], v79, s[64:67], s71 offen offset:2304 sc1
    v_mfma_f32_16x16x32_bf16 v[212:215], a[52:55], v[88:91], v[212:215]
    v_mfma_f32_16x16x32_bf16 v[216:219], a[56:59], v[88:91], v[216:219]
    v_mfma_f32_16x16x32_bf16 v[220:223], a[60:63], v[88:91], v[220:223]
    s_waitcnt vmcnt(10)
    v_mfma_f32_16x16x32_bf16 v[224:227], a[48:51], v[92:95], v[224:227]
    buffer_load_dwordx4 v[128:131], v79, s[64:67], s72 offen offset:0 sc1
    v_mfma_f32_16x16x32_bf16 v[228:231], a[52:55], v[92:95], v[228:231]
    v_mfma_f32_16x16x32_bf16 v[232:235], a[56:59], v[92:95], v[232:235]
    v_mfma_f32_16x16x32_bf16 v[236:239], a[60:63], v[92:95], v[236:239]
    s_waitcnt vmcnt(10)
    v_mfma_f32_16x16x32_bf16 v[208:211], a[64:67], v[96:99], v[208:211]
    buffer_load_dwordx4 v[132:135], v79, s[64:67], s72 offen offset:256 sc1
    v_mfma_f32_16x16x32_bf16 v[212:215], a[68:71], v[96:99], v[212:215]
    v_mfma_f32_16x16x32_bf16 v[216:219], a[72:75], v[96:99], v[216:219]
    v_mfma_f32_16x16x32_bf16 v[220:223], a[76:79], v[96:99], v[220:223]
    s_waitcnt vmcnt(9)
    v_mfma_f32_16x16x32_bf16 v[224:227], a[64:67], v[100:103], v[224:227]
    buffer_load_dwordx4 v[136:139], v79, s[64:67], s72 offen offset:2048 sc1
    v_mfma_f32_16x16x32_bf16 v[228:231], a[68:71], v[100:103], v[228:231]
    v_mfma_f32_16x16x32_bf16 v[232:235], a[72:75], v[100:103], v[232:235]
    v_mfma_f32_16x16x32_bf16 v[236:239], a[76:79], v[100:103], v[236:239]
    s_waitcnt vmcnt(9)
    v_mfma_f32_16x16x32_bf16 v[208:211], a[80:83], v[104:107], v[208:211]
    buffer_load_dwordx4 v[140:143], v79, s[64:67], s72 offen offset:2304 sc1
    v_mfma_f32_16x16x32_bf16 v[212:215], a[84:87], v[104:107], v[212:215]
    v_mfma_f32_16x16x32_bf16 v[216:219], a[88:91], v[104:107], v[216:219]
    v_mfma_f32_16x16x32_bf16 v[220:223], a[92:95], v[104:107], v[220:223]
    s_waitcnt vmcnt(9)
    v_mfma_f32_16x16x32_bf16 v[224:227], a[80:83], v[108:111], v[224:227]
    buffer_load_dwordx4 v[80:83], v79, s[64:67], s73 offen offset:0 sc1
    v_mfma_f32_16x16x32_bf16 v[228:231], a[84:87], v[108:111], v[228:231]
    v_mfma_f32_16x16x32_bf16 v[232:235], a[88:91], v[108:111], v[232:235]
    v_mfma_f32_16x16x32_bf16 v[236:239], a[92:95], v[108:111], v[236:239]
    s_waitcnt vmcnt(9)
    v_mfma_f32_16x16x32_bf16 v[208:211], a[96:99], v[112:115], v[208:211]
    buffer_load_dwordx4 v[84:87], v79, s[64:67], s73 offen offset:256 sc1
    v_mfma_f32_16x16x32_bf16 v[212:215], a[100:103], v[112:115], v[212:215]
    v_mfma_f32_16x16x32_bf16 v[216:219], a[104:107], v[112:115], v[216:219]
    v_mfma_f32_16x16x32_bf16 v[220:223], a[108:111], v[112:115], v[220:223]
    s_waitcnt vmcnt(9)
    v_mfma_f32_16x16x32_bf16 v[224:227], a[96:99], v[116:119], v[224:227]
    buffer_load_dwordx4 v[88:91], v79, s[64:67], s73 offen offset:2048 sc1
    v_mfma_f32_16x16x32_bf16 v[228:231], a[100:103], v[116:119], v[228:231]
    v_mfma_f32_16x16x32_bf16 v[232:235], a[104:107], v[116:119], v[232:235]
    v_mfma_f32_16x16x32_bf16 v[236:239], a[108:111], v[116:119], v[236:239]
    s_waitcnt vmcnt(9)
    v_mfma_f32_16x16x32_bf16 v[208:211], a[112:115], v[120:123], v[208:211]
    buffer_load_dwordx4 v[92:95], v79, s[64:67], s73 offen offset:2304 sc1
    v_mfma_f32_16x16x32_bf16 v[212:215], a[116:119], v[120:123], v[212:215]
    v_mfma_f32_16x16x32_bf16 v[216:219], a[120:123], v[120:123], v[216:219]
    v_mfma_f32_16x16x32_bf16 v[220:223], a[124:127], v[120:123], v[220:223]
    s_waitcnt vmcnt(9)
    v_cmp_eq_u32 vcc, 0xbf800000, v19
    s_cbranch_vccnz L_ss_119
L_sb_120:
    s_waitcnt vmcnt(8)
    v_mfma_f32_16x16x32_bf16 v[224:227], a[112:115], v[124:127], v[224:227]
    buffer_load_dwordx4 v[96:99], v79, s[64:67], s74 offen offset:0 sc1
    v_mfma_f32_16x16x32_bf16 v[228:231], a[116:119], v[124:127], v[228:231]
    v_permlane32_swap_b32 v18, v19
    v_add_f32 v18, v18, v19
    v_mfma_f32_16x16x32_bf16 v[232:235], a[120:123], v[124:127], v[232:235]
    v_mov_b32 v76, v18
    s_nop 1
    v_permlane16_swap_b32 v18, v76
    v_mfma_f32_16x16x32_bf16 v[236:239], a[124:127], v[124:127], v[236:239]
    v_add_f32 v18, v18, v76
    s_waitcnt vmcnt(8)
    v_mfma_f32_16x16x32_bf16 v[208:211], a[128:131], v[128:131], v[208:211]
    buffer_load_dwordx4 v[100:103], v79, s[64:67], s74 offen offset:256 sc1
    v_mfma_f32_16x16x32_bf16 v[212:215], a[132:135], v[128:131], v[212:215]
    v_add_f32_dpp v18, v18, v18 row_ror:8 row_mask:0xf bank_mask:0xf
    v_mov_b32 v19, v18
    v_mfma_f32_16x16x32_bf16 v[216:219], a[136:139], v[128:131], v[216:219]
    s_nop 0
    v_permlane32_swap_b32 v18, v19
    v_mul_f32 v18, 0x3b000000, v18
    v_mfma_f32_16x16x32_bf16 v[220:223], a[140:143], v[128:131], v[220:223]
    v_mul_f32 v19, 0x3b000000, v19
    s_waitcnt vmcnt(8)
    v_mfma_f32_16x16x32_bf16 v[224:227], a[128:131], v[132:135], v[224:227]
    buffer_load_dwordx4 v[104:107], v79, s[64:67], s74 offen offset:2048 sc1
    v_mfma_f32_16x16x32_bf16 v[228:231], a[132:135], v[132:135], v[228:231]
    v_lshlrev_b32 v184, 16, v48
    v_and_b32 v185, 0xffff0000, v48
    v_mfma_f32_16x16x32_bf16 v[232:235], a[136:139], v[132:135], v[232:235]
    v_fma_f32 v19, -v18, v18, v19
    v_lshlrev_b32 v186, 16, v49
    v_mfma_f32_16x16x32_bf16 v[236:239], a[140:143], v[132:135], v[236:239]
    v_and_b32 v187, 0xffff0000, v49
    s_waitcnt vmcnt(8)
    v_mfma_f32_16x16x32_bf16 v[208:211], a[144:147], v[136:139], v[208:211]
    buffer_load_dwordx4 v[108:111], v79, s[64:67], s74 offen offset:2304 sc1
    v_mfma_f32_16x16x32_bf16 v[212:215], a[148:151], v[136:139], v[212:215]
    v_max_f32 v19, 0, v19
    v_lshlrev_b32 v188, 16, v50
    v_mfma_f32_16x16x32_bf16 v[216:219], a[152:155], v[136:139], v[216:219]
    v_and_b32 v189, 0xffff0000, v50
    v_add_f32 v19, 0x3727c5ac, v19
    v_mfma_f32_16x16x32_bf16 v[220:223], a[156:159], v[136:139], v[220:223]
    v_lshlrev_b32 v190, 16, v51
    s_waitcnt vmcnt(8)
    v_mfma_f32_16x16x32_bf16 v[224:227], a[144:147], v[140:143], v[224:227]
    v_rsq_f32 v19, v19
    v_mfma_f32_16x16x32_bf16 v[228:231], a[148:151], v[140:143], v[228:231]
    v_and_b32 v191, 0xffff0000, v51
    v_mul_f32 v18, v18, v19
    v_mfma_f32_16x16x32_bf16 v[232:235], a[152:155], v[140:143], v[232:235]
    v_fma_f32 v76, v176, v19, -v18
    v_fma_f32 v77, v177, v19, -v18
    v_mfma_f32_16x16x32_bf16 v[236:239], a[156:159], v[140:143], v[236:239]
    v_fmac_f32 v176, v76, v184
    s_waitcnt vmcnt(7)
    v_mfma_f32_16x16x32_bf16 v[208:211], a[160:163], v[80:83], v[208:211]
    v_fmac_f32 v177, v77, v185
    v_fma_f32 v76, v178, v19, -v18
    v_mfma_f32_16x16x32_bf16 v[212:215], a[164:167], v[80:83], v[212:215]
    v_fma_f32 v77, v179, v19, -v18
    v_fmac_f32 v178, v76, v186
    v_mfma_f32_16x16x32_bf16 v[216:219], a[168:171], v[80:83], v[216:219]
    v_fmac_f32 v179, v77, v187
    v_fma_f32 v76, v180, v19, -v18
    v_mfma_f32_16x16x32_bf16 v[220:223], a[172:175], v[80:83], v[220:223]
    v_fma_f32 v77, v181, v19, -v18
    s_waitcnt vmcnt(6)
    v_mfma_f32_16x16x32_bf16 v[224:227], a[160:163], v[84:87], v[224:227]
    v_fmac_f32 v180, v76, v188
    v_fmac_f32 v181, v77, v189
    v_mfma_f32_16x16x32_bf16 v[228:231], a[164:167], v[84:87], v[228:231]
    v_fma_f32 v76, v182, v19, -v18
    v_fma_f32 v77, v183, v19, -v18
    v_mfma_f32_16x16x32_bf16 v[232:235], a[168:171], v[84:87], v[232:235]
    v_fmac_f32 v182, v76, v190
    v_fmac_f32 v183, v77, v191
    v_mfma_f32_16x16x32_bf16 v[236:239], a[172:175], v[84:87], v[236:239]
    v_cvt_pk_bf16_f32 v40, v176, v177
    s_waitcnt vmcnt(5)
    v_mfma_f32_16x16x32_bf16 v[208:211], a[176:179], v[88:91], v[208:211]
    v_cvt_pk_bf16_f32 v41, v178, v179
    v_cvt_pk_bf16_f32 v42, v180, v181
    v_mfma_f32_16x16x32_bf16 v[212:215], a[180:183], v[88:91], v[212:215]
    v_cvt_pk_bf16_f32 v43, v182, v183
    v_mfma_f32_16x16x32_bf16 v[216:219], a[184:187], v[88:91], v[216:219]
    s_add_u32 s80, s4, 0x200000
    buffer_store_dwordx4 v[40:43], v12, s[64:67], s80 offen sc1
    v_mfma_f32_16x16x32_bf16 v[220:223], a[188:191], v[88:91], v[220:223]
    v_lshlrev_b32 v176, 16, v40
    s_waitcnt vmcnt(5)
    v_mfma_f32_16x16x32_bf16 v[224:227], a[176:179], v[92:95], v[224:227]
    v_and_b32 v177, 0xffff0000, v40
    v_lshlrev_b32 v178, 16, v41
    v_mfma_f32_16x16x32_bf16 v[228:231], a[180:183], v[92:95], v[228:231]
    v_and_b32 v179, 0xffff0000, v41
    v_lshlrev_b32 v180, 16, v42
    v_mfma_f32_16x16x32_bf16 v[232:235], a[184:187], v[92:95], v[232:235]
    v_and_b32 v181, 0xffff0000, v42
    v_lshlrev_b32 v182, 16, v43
    v_mfma_f32_16x16x32_bf16 v[236:239], a[188:191], v[92:95], v[236:239]
    v_and_b32 v183, 0xffff0000, v43
    s_waitcnt vmcnt(4)
    v_mfma_f32_16x16x32_bf16 v[208:211], a[192:195], v[96:99], v[208:211]
    v_add_f32 v18, v176, v177
    v_mul_f32 v19, v176, v176
    v_mfma_f32_16x16x32_bf16 v[212:215], a[196:199], v[96:99], v[212:215]
    v_fmac_f32 v19, v177, v177
    v_add_f32 v18, v18, v178
    v_mfma_f32_16x16x32_bf16 v[216:219], a[200:203], v[96:99], v[216:219]
    v_fmac_f32 v19, v178, v178
    v_add_f32 v18, v18, v179
    v_mfma_f32_16x16x32_bf16 v[220:223], a[204:207], v[96:99], v[220:223]
    v_fmac_f32 v19, v179, v179
    s_waitcnt vmcnt(2)
    v_mfma_f32_16x16x32_bf16 v[208:211], a[208:211], v[104:107], v[208:211]
    v_xor_b32 v73, 64, v8
    v_xor_b32 v74, 128, v8
    v_xor_b32 v75, 192, v8
    v_mfma_f32_16x16x32_bf16 v[212:215], a[212:215], v[104:107], v[212:215]
    v_add_f32 v18, v18, v180
    v_fmac_f32 v19, v180, v180
    v_mfma_f32_16x16x32_bf16 v[216:219], a[216:219], v[104:107], v[216:219]
    v_add_f32 v18, v18, v181
    v_fmac_f32 v19, v181, v181
    v_mfma_f32_16x16x32_bf16 v[220:223], a[220:223], v[104:107], v[220:223]
    v_add_f32 v18, v18, v182
    v_mfma_f32_16x16x32_bf16 v[224:227], a[192:195], v[100:103], v[224:227]
    v_fmac_f32 v19, v182, v182
    v_add_f32 v18, v18, v183
    v_mfma_f32_16x16x32_bf16 v[228:231], a[196:199], v[100:103], v[228:231]
    v_fmac_f32 v19, v183, v183
    s_nop 1
    v_permlane32_swap_b32 v18, v19
    v_mfma_f32_16x16x32_bf16 v[232:235], a[200:203], v[100:103], v[232:235]
    ds_write_b128 v8, v[208:211]
    v_mfma_f32_16x16x32_bf16 v[236:239], a[204:207], v[100:103], v[236:239]
    ds_write_b128 v73, v[212:215]
    s_waitcnt vmcnt(1)
    v_mfma_f32_16x16x32_bf16 v[224:227], a[208:211], v[108:111], v[224:227]
    ds_write_b128 v74, v[216:219]
    v_mfma_f32_16x16x32_bf16 v[228:231], a[212:215], v[108:111], v[228:231]
    ds_write_b128 v75, v[220:223]
    v_mfma_f32_16x16x32_bf16 v[232:235], a[216:219], v[108:111], v[232:235]
    v_add_f32 v18, v18, v19
    v_mov_b32 v76, v18
    v_mfma_f32_16x16x32_bf16 v[236:239], a[220:223], v[108:111], v[236:239]
    s_nop 0
    v_permlane16_swap_b32 v18, v76
    v_add_f32 v18, v18, v76
    s_nop 1
    v_add_f32_dpp v18, v18, v18 row_ror:8 row_mask:0xf bank_mask:0xf
    v_mov_b32 v19, v18
    s_nop 1
    v_permlane32_swap_b32 v18, v19
    s_add_u32 s80, s5, 0x20000
    s_mov_b64 exec, 0xff
    s_cmp_eq_u32 s16, 0
    s_cbranch_scc1 L_ps_121
    buffer_store_dwordx2 v[18:19], v17, s[64:67], s80 offen
L_pb_122:
    s_mov_b64 exec, -1
    s_waitcnt vmcnt(1)
    s_cmp_eq_u32 s16, 0
    s_cbranch_scc1 L_ps_123
    buffer_store_dword v23, off, s[64:67], s12 offset:2048
L_pb_124:
    ds_write_b128 v8, v[224:227] offset:4096
    ds_write_b128 v73, v[228:231] offset:4096
    ds_write_b128 v74, v[232:235] offset:4096
    ds_write_b128 v75, v[236:239] offset:4096
    v_lshlrev_b32 v176, 16, v44
    v_and_b32 v177, 0xffff0000, v44
    v_lshlrev_b32 v178, 16, v45
    v_and_b32 v179, 0xffff0000, v45
    v_lshlrev_b32 v180, 16, v46
    v_and_b32 v181, 0xffff0000, v46
    v_lshlrev_b32 v182, 16, v47
    v_and_b32 v183, 0xffff0000, v47
    s_waitcnt lgkmcnt(0)
    s_barrier
    ds_read_b128 v[144:147], v9 offset:0
    ds_read_b128 v[148:151], v10 offset:0
    ds_read_b128 v[152:155], v9 offset:8192
    ds_read_b128 v[156:159], v10 offset:8192
    ds_read_b128 v[160:163], v9 offset:16384
    ds_read_b128 v[164:167], v10 offset:16384
    ds_read_b128 v[168:171], v9 offset:24576
    ds_read_b128 v[172:175], v10 offset:24576
    buffer_load_dword v16, v4, s[64:67], s13 offen offset:2048 sc1
    s_waitcnt lgkmcnt(7)
    v_pk_add_f32 v[176:177], v[176:177], v[144:145]
    v_pk_add_f32 v[178:179], v[178:179], v[146:147]
    s_waitcnt lgkmcnt(6)
    v_pk_add_f32 v[180:181], v[180:181], v[148:149]
    v_pk_add_f32 v[182:183], v[182:183], v[150:151]
    s_waitcnt lgkmcnt(5)
    v_pk_add_f32 v[176:177], v[176:177], v[152:153]
    v_pk_add_f32 v[178:179], v[178:179], v[154:155]
    s_waitcnt lgkmcnt(4)
    v_pk_add_f32 v[180:181], v[180:181], v[156:157]
    v_pk_add_f32 v[182:183], v[182:183], v[158:159]
    s_waitcnt lgkmcnt(3)
    v_pk_add_f32 v[176:177], v[176:177], v[160:161]
    v_pk_add_f32 v[178:179], v[178:179], v[162:163]
    s_waitcnt lgkmcnt(2)
    v_pk_add_f32 v[180:181], v[180:181], v[164:165]
    v_pk_add_f32 v[182:183], v[182:183], v[166:167]
    s_waitcnt lgkmcnt(1)
    v_pk_add_f32 v[176:177], v[176:177], v[168:169]
    v_pk_add_f32 v[178:179], v[178:179], v[170:171]
    s_waitcnt lgkmcnt(0)
    v_pk_add_f32 v[180:181], v[180:181], v[172:173]
    v_pk_add_f32 v[182:183], v[182:183], v[174:175]
    v_pk_add_f32 v[76:77], v[176:177], v[178:179]
    v_pk_mul_f32 v[56:57], v[176:177], v[176:177]
    v_pk_add_f32 v[76:77], v[76:77], v[180:181]
    v_pk_fma_f32 v[56:57], v[178:179], v[178:179], v[56:57]
    v_pk_add_f32 v[76:77], v[76:77], v[182:183]
    v_pk_fma_f32 v[56:57], v[180:181], v[180:181], v[56:57]
    v_pk_fma_f32 v[56:57], v[182:183], v[182:183], v[56:57]
    v_add_f32 v57, v56, v57
    v_add_f32 v56, v76, v77
    s_nop 1
    v_permlane32_swap_b32 v56, v57
    v_add_f32 v56, v56, v57
    v_mov_b32 v76, v56
    s_nop 1
    v_permlane16_swap_b32 v56, v76
    v_add_f32 v56, v56, v76
    s_nop 1
    v_add_f32_dpp v56, v56, v56 row_ror:8 row_mask:0xf bank_mask:0xf
    v_mov_b32 v57, v56
    s_nop 1
    v_permlane32_swap_b32 v56, v57
    s_mov_b64 exec, 0xff
    s_cmp_eq_u32 s16, 0
    s_cbranch_scc1 L_ps_125
    buffer_store_dwordx2 v[56:57], v17, s[64:67], s25 offen offset:2048
L_pb_126:
    s_mov_b64 exec, -1
    s_barrier
    s_waitcnt vmcnt(1)
    v_cmp_eq_u32 vcc, 0, v16
    s_cbranch_vccnz L_fs_127
L_fb_128:
    s_add_u32 s80, s8, 0x200000
    v_add_u32 v78, s80, v0
    buffer_load_dwordx4 v[112:115], v78, s[64:67], s32 offen offset:0 sc1
    buffer_load_dwordx4 v[116:119], v78, s[64:67], s32 offen offset:256 sc1
    buffer_load_dwordx4 v[120:123], v78, s[64:67], s32 offen offset:2048 sc1
    buffer_load_dwordx4 v[124:127], v78, s[64:67], s32 offen offset:2304 sc1
    buffer_load_dwordx4 v[128:131], v78, s[64:67], s33 offen offset:0 sc1
    ds_read_b128 a[224:227], v2 offset:0
    ds_read_b128 a[228:231], v3 offset:0
    ds_read_b128 a[232:235], v2 offset:1024
    ds_read_b128 a[236:239], v3 offset:1024
    ds_read_b128 a[240:243], v2 offset:2048
    ds_read_b128 a[244:247], v3 offset:2048
    ds_read_b128 a[248:251], v2 offset:4096
    ds_read_b128 a[252:255], v3 offset:4096
    s_waitcnt vmcnt(4) lgkmcnt(4)
    v_mfma_f32_16x16x32_bf16 v[208:211], a[224:227], v[112:115], 0
    buffer_load_dwordx4 v[132:135], v78, s[64:67], s33 offen offset:256 sc1
    v_mfma_f32_16x16x32_bf16 v[212:215], a[228:231], v[112:115], 0
    s_waitcnt vmcnt(4)
    v_mfma_f32_16x16x32_bf16 v[216:219], a[224:227], v[116:119], 0
    v_mfma_f32_16x16x32_bf16 v[220:223], a[228:231], v[116:119], 0
    v_mfma_f32_16x16x32_bf16 v[224:227], a[232:235], v[112:115], 0
    buffer_load_dwordx4 v[136:139], v78, s[64:67], s33 offen offset:2048 sc1
    buffer_load_dwordx2 v[56:57], v17, s[64:67], s6 offen offset:2048 sc1
    v_mfma_f32_16x16x32_bf16 v[228:231], a[236:239], v[112:115], 0
    v_mfma_f32_16x16x32_bf16 v[232:235], a[232:235], v[116:119], 0
    ds_read_b128 a[224:227], v2 offset:5120
    ds_read_b128 a[228:231], v3 offset:5120
    v_mfma_f32_16x16x32_bf16 v[236:239], a[236:239], v[116:119], 0
    s_waitcnt lgkmcnt(2)
    v_mfma_f32_16x16x32_bf16 v[240:243], a[240:243], v[112:115], 0
    buffer_load_dwordx4 v[140:143], v78, s[64:67], s33 offen offset:2304 sc1
    v_mfma_f32_16x16x32_bf16 v[244:247], a[244:247], v[112:115], 0
    v_mfma_f32_16x16x32_bf16 v[248:251], a[240:243], v[116:119], 0
    ds_read_b128 a[232:235], v2 offset:6144
    ds_read_b128 a[236:239], v3 offset:6144
    v_mfma_f32_16x16x32_bf16 v[252:255], a[244:247], v[116:119], 0
    s_waitcnt vmcnt(5)
    v_mfma_f32_16x16x32_bf16 v[208:211], a[248:251], v[120:123], v[208:211]
    buffer_load_dwordx4 v[80:83], v78, s[64:67], s34 offen offset:0 sc1
    v_mfma_f32_16x16x32_bf16 v[212:215], a[252:255], v[120:123], v[212:215]
    v_mfma_f32_16x16x32_bf16 v[216:219], a[248:251], v[124:127], v[216:219]
    ds_read_b128 a[240:243], v2 offset:8192
    ds_read_b128 a[244:247], v3 offset:8192
    v_mfma_f32_16x16x32_bf16 v[220:223], a[252:255], v[124:127], v[220:223]
    s_waitcnt lgkmcnt(2)
    v_mfma_f32_16x16x32_bf16 v[224:227], a[224:227], v[120:123], v[224:227]
    buffer_load_dwordx4 v[84:87], v78, s[64:67], s34 offen offset:256 sc1
    v_mfma_f32_16x16x32_bf16 v[228:231], a[228:231], v[120:123], v[228:231]
    v_mfma_f32_16x16x32_bf16 v[232:235], a[224:227], v[124:127], v[232:235]
    ds_read_b128 a[248:251], v2 offset:9216
    ds_read_b128 a[252:255], v3 offset:9216
    v_mfma_f32_16x16x32_bf16 v[236:239], a[228:231], v[124:127], v[236:239]
    v_mfma_f32_16x16x32_bf16 v[240:243], a[232:235], v[120:123], v[240:243]
    buffer_load_dwordx4 v[88:91], v78, s[64:67], s34 offen offset:2048 sc1
    v_mfma_f32_16x16x32_bf16 v[244:247], a[236:239], v[120:123], v[244:247]
    v_mfma_f32_16x16x32_bf16 v[248:251], a[232:235], v[124:127], v[248:251]
    ds_read_b128 a[224:227], v2 offset:10240
    ds_read_b128 a[228:231], v3 offset:10240
    v_mfma_f32_16x16x32_bf16 v[252:255], a[236:239], v[124:127], v[252:255]
    s_add_u32 s46, s9, 0x20000
    buffer_load_dwordx2 v[64:65], v22, s[64:67], s46 offen offset:0 sc1
    s_waitcnt vmcnt(7) lgkmcnt(2)
    v_mfma_f32_16x16x32_bf16 v[208:211], a[240:243], v[128:131], v[208:211]
    buffer_load_dwordx4 v[92:95], v78, s[64:67], s34 offen offset:2304 sc1
    v_mfma_f32_16x16x32_bf16 v[212:215], a[244:247], v[128:131], v[212:215]
    buffer_load_dwordx2 v[66:67], v22, s[64:67], s46 offen offset:256 sc1
    v_mfma_f32_16x16x32_bf16 v[216:219], a[240:243], v[132:135], v[216:219]
    ds_read_b128 a[232:235], v2 offset:12288
    ds_read_b128 a[236:239], v3 offset:12288
    v_mfma_f32_16x16x32_bf16 v[220:223], a[244:247], v[132:135], v[220:223]
    buffer_load_dwordx2 v[68:69], v22, s[64:67], s46 offen offset:128 sc1
    v_mfma_f32_16x16x32_bf16 v[224:227], a[248:251], v[128:131], v[224:227]
    buffer_load_dwordx4 v[96:99], v78, s[64:67], s35 offen offset:0 sc1
    v_mfma_f32_16x16x32_bf16 v[228:231], a[252:255], v[128:131], v[228:231]
    buffer_load_dwordx2 v[70:71], v22, s[64:67], s46 offen offset:384 sc1
    v_mfma_f32_16x16x32_bf16 v[232:235], a[248:251], v[132:135], v[232:235]
    ds_read_b128 a[240:243], v2 offset:13312
    ds_read_b128 a[244:247], v3 offset:13312
    v_mfma_f32_16x16x32_bf16 v[236:239], a[252:255], v[132:135], v[236:239]
    s_waitcnt lgkmcnt(2)
    v_mfma_f32_16x16x32_bf16 v[240:243], a[224:227], v[128:131], v[240:243]
    buffer_load_dwordx4 v[100:103], v78, s[64:67], s35 offen offset:256 sc1
    v_mfma_f32_16x16x32_bf16 v[244:247], a[228:231], v[128:131], v[244:247]
    v_mfma_f32_16x16x32_bf16 v[248:251], a[224:227], v[132:135], v[248:251]
    ds_read_b128 a[248:251], v2 offset:14336
    ds_read_b128 a[252:255], v3 offset:14336
    v_mfma_f32_16x16x32_bf16 v[252:255], a[228:231], v[132:135], v[252:255]
    s_waitcnt vmcnt(10)
    v_mfma_f32_16x16x32_bf16 v[208:211], a[232:235], v[136:139], v[208:211]
    buffer_load_dwordx4 v[104:107], v78, s[64:67], s35 offen offset:2048 sc1
    v_cmp_eq_u32 vcc, 0xbf800000, v57
    s_cbranch_vccnz L_ss_129
L_sb_130:
    v_mfma_f32_16x16x32_bf16 v[212:215], a[236:239], v[136:139], v[212:215]
    v_permlane32_swap_b32 v56, v57
    v_add_f32 v56, v56, v57
    v_mov_b32 v76, v56
    s_nop 1
    v_permlane16_swap_b32 v56, v76
    v_mfma_f32_16x16x32_bf16 v[216:219], a[232:235], v[140:143], v[216:219]
    ds_read_b128 a[224:227], v2 offset:16384
    ds_read_b128 a[228:231], v3 offset:16384
    v_add_f32 v56, v56, v76
    s_nop 1
    v_add_f32_dpp v56, v56, v56 row_ror:8 row_mask:0xf bank_mask:0xf
    v_mfma_f32_16x16x32_bf16 v[220:223], a[236:239], v[140:143], v[220:223]
    v_mov_b32 v57, v56
    s_nop 1
    v_permlane32_swap_b32 v56, v57
    v_mul_f32 v56, 0x3b000000, v56
    s_waitcnt lgkmcnt(2)
    v_mfma_f32_16x16x32_bf16 v[224:227], a[240:243], v[136:139], v[224:227]
    buffer_load_dwordx4 v[108:111], v78, s[64:67], s35 offen offset:2304 sc1
    v_mul_f32 v57, 0x3b000000, v57
    v_lshlrev_b32 v184, 16, v52
    v_mfma_f32_16x16x32_bf16 v[228:231], a[244:247], v[136:139], v[228:231]
    v_and_b32 v185, 0xffff0000, v52
    v_fma_f32 v57, -v56, v56, v57
    v_lshlrev_b32 v186, 16, v53
    v_and_b32 v187, 0xffff0000, v53
    v_mfma_f32_16x16x32_bf16 v[232:235], a[240:243], v[140:143], v[232:235]
    ds_read_b128 a[232:235], v2 offset:17408
    ds_read_b128 a[236:239], v3 offset:17408
    v_max_f32 v57, 0, v57
    v_lshlrev_b32 v188, 16, v54
    v_mfma_f32_16x16x32_bf16 v[236:239], a[244:247], v[140:143], v[236:239]
    v_and_b32 v189, 0xffff0000, v54
    v_add_f32 v57, 0x3727c5ac, v57
    v_rsq_f32 v57, v57
    v_mfma_f32_16x16x32_bf16 v[240:243], a[248:251], v[136:139], v[240:243]
    buffer_load_dwordx4 v[112:115], v78, s[64:67], s36 offen offset:0 sc1
    v_lshlrev_b32 v190, 16, v55
    v_and_b32 v191, 0xffff0000, v55
    v_mfma_f32_16x16x32_bf16 v[244:247], a[252:255], v[136:139], v[244:247]
    v_mul_f32 v56, v56, v57
    v_fma_f32 v76, v176, v57, -v56
    v_fma_f32 v77, v177, v57, -v56
    v_fmac_f32 v176, v76, v184
    v_mfma_f32_16x16x32_bf16 v[248:251], a[248:251], v[140:143], v[248:251]
    ds_read_b128 a[240:243], v2 offset:18432
    ds_read_b128 a[244:247], v3 offset:18432
    v_fmac_f32 v177, v77, v185
    v_fma_f32 v76, v178, v57, -v56
    v_mfma_f32_16x16x32_bf16 v[252:255], a[252:255], v[140:143], v[252:255]
    v_fma_f32 v77, v179, v57, -v56
    v_fmac_f32 v178, v76, v186
    v_fmac_f32 v179, v77, v187
    s_waitcnt vmcnt(11) lgkmcnt(2)
    v_mfma_f32_16x16x32_bf16 v[208:211], a[224:227], v[80:83], v[208:211]
    buffer_load_dwordx4 v[116:119], v78, s[64:67], s36 offen offset:256 sc1
    v_fma_f32 v76, v180, v57, -v56
    v_fma_f32 v77, v181, v57, -v56
    v_mfma_f32_16x16x32_bf16 v[212:215], a[228:231], v[80:83], v[212:215]
    v_fmac_f32 v180, v76, v188
    v_fmac_f32 v181, v77, v189
    v_fma_f32 v76, v182, v57, -v56
    v_fma_f32 v77, v183, v57, -v56
    v_mfma_f32_16x16x32_bf16 v[216:219], a[224:227], v[84:87], v[216:219]
    ds_read_b128 a[248:251], v2 offset:20480
    ds_read_b128 a[252:255], v3 offset:20480
    v_fmac_f32 v182, v76, v190
    v_fmac_f32 v183, v77, v191
    v_mfma_f32_16x16x32_bf16 v[220:223], a[228:231], v[84:87], v[220:223]
    v_cvt_pk_bf16_f32 v44, v176, v177
    v_cvt_pk_bf16_f32 v45, v178, v179
    v_cvt_pk_bf16_f32 v46, v180, v181
    v_cvt_pk_bf16_f32 v47, v182, v183
    v_mfma_f32_16x16x32_bf16 v[224:227], a[232:235], v[80:83], v[224:227]
    buffer_load_dwordx4 v[120:123], v78, s[64:67], s36 offen offset:2048 sc1
    v_mfma_f32_16x16x32_bf16 v[228:231], a[236:239], v[80:83], v[228:231]
    s_add_u32 s81, s4, 0x208000
    buffer_store_dwordx4 v[44:47], v12, s[64:67], s81 offen sc1
    v_mfma_f32_16x16x32_bf16 v[232:235], a[232:235], v[84:87], v[232:235]
    ds_read_b128 a[224:227], v2 offset:21504
    ds_read_b128 a[228:231], v3 offset:21504
    v_lshlrev_b32 v176, 16, v44
    v_and_b32 v177, 0xffff0000, v44
    v_mfma_f32_16x16x32_bf16 v[236:239], a[236:239], v[84:87], v[236:239]
    v_lshlrev_b32 v178, 16, v45
    v_and_b32 v179, 0xffff0000, v45
    v_lshlrev_b32 v180, 16, v46
    s_waitcnt lgkmcnt(2)
    v_mfma_f32_16x16x32_bf16 v[240:243], a[240:243], v[80:83], v[240:243]
    buffer_load_dwordx4 v[124:127], v78, s[64:67], s36 offen offset:2304 sc1
    v_and_b32 v181, 0xffff0000, v46
    v_lshlrev_b32 v182, 16, v47
    v_mfma_f32_16x16x32_bf16 v[244:247], a[244:247], v[80:83], v[244:247]
    v_and_b32 v183, 0xffff0000, v47
    v_add_f32 v56, v176, v177
    v_mul_f32 v57, v176, v176
    v_fmac_f32 v57, v177, v177
    v_mfma_f32_16x16x32_bf16 v[248:251], a[240:243], v[84:87], v[248:251]
    ds_read_b128 a[232:235], v2 offset:22528
    ds_read_b128 a[236:239], v3 offset:22528
    v_add_f32 v56, v56, v178
    v_fmac_f32 v57, v178, v178
    v_mfma_f32_16x16x32_bf16 v[252:255], a[244:247], v[84:87], v[252:255]
    v_add_f32 v56, v56, v179
    v_fmac_f32 v57, v179, v179
    v_add_f32 v56, v56, v180
    v_fmac_f32 v57, v180, v180
    s_waitcnt vmcnt(12)
    v_mfma_f32_16x16x32_bf16 v[208:211], a[248:251], v[88:91], v[208:211]
    buffer_load_dwordx4 v[128:131], v78, s[64:67], s37 offen offset:0 sc1
    v_add_f32 v56, v56, v181
    v_fmac_f32 v57, v181, v181
    v_mfma_f32_16x16x32_bf16 v[212:215], a[252:255], v[88:91], v[212:215]
    v_add_f32 v56, v56, v182
    v_fmac_f32 v57, v182, v182
    v_add_f32 v56, v56, v183
    v_fmac_f32 v57, v183, v183
    v_mfma_f32_16x16x32_bf16 v[216:219], a[248:251], v[92:95], v[216:219]
    ds_read_b128 a[240:243], v2 offset:24576
    ds_read_b128 a[244:247], v3 offset:24576
    v_permlane32_swap_b32 v56, v57
    v_add_f32 v56, v56, v57
    v_mfma_f32_16x16x32_bf16 v[220:223], a[252:255], v[92:95], v[220:223]
    v_mov_b32 v76, v56
    s_nop 1
    v_permlane16_swap_b32 v56, v76
    v_add_f32 v56, v56, v76
    s_waitcnt lgkmcnt(2)
    v_mfma_f32_16x16x32_bf16 v[224:227], a[224:227], v[88:91], v[224:227]
    buffer_load_dwordx4 v[132:135], v78, s[64:67], s37 offen offset:256 sc1
    v_add_f32_dpp v56, v56, v56 row_ror:8 row_mask:0xf bank_mask:0xf
    v_mov_b32 v57, v56
    v_mfma_f32_16x16x32_bf16 v[228:231], a[228:231], v[88:91], v[228:231]
    s_nop 0
    v_permlane32_swap_b32 v56, v57
    s_add_u32 s81, s5, 0x20800
    s_mov_b64 exec, 0xff
    s_cmp_eq_u32 s16, 0
    s_cbranch_scc1 L_ps_131
    buffer_store_dwordx2 v[56:57], v17, s[64:67], s81 offen
L_pb_132:
    s_mov_b64 exec, -1
    v_mfma_f32_16x16x32_bf16 v[232:235], a[224:227], v[92:95], v[232:235]
    ds_read_b128 a[248:251], v2 offset:25600
    ds_read_b128 a[252:255], v3 offset:25600
    v_mfma_f32_16x16x32_bf16 v[236:239], a[228:231], v[92:95], v[236:239]
    v_mfma_f32_16x16x32_bf16 v[240:243], a[232:235], v[88:91], v[240:243]
    buffer_load_dwordx4 v[136:139], v78, s[64:67], s37 offen offset:2048 sc1
    v_mfma_f32_16x16x32_bf16 v[244:247], a[236:239], v[88:91], v[244:247]
    s_waitcnt vmcnt(12)
    v_min3_i32 v72, v65, v67, v69
    v_mfma_f32_16x16x32_bf16 v[248:251], a[232:235], v[92:95], v[248:251]
    ds_read_b128 a[224:227], v2 offset:26624
    ds_read_b128 a[228:231], v3 offset:26624
    v_mfma_f32_16x16x32_bf16 v[252:255], a[236:239], v[92:95], v[252:255]
    v_min_i32 v72, v72, v71
    s_waitcnt vmcnt(11) lgkmcnt(2)
    v_mfma_f32_16x16x32_bf16 v[208:211], a[240:243], v[96:99], v[208:211]
    buffer_load_dwordx4 v[140:143], v78, s[64:67], s37 offen offset:2304 sc1
    v_mfma_f32_16x16x32_bf16 v[212:215], a[244:247], v[96:99], v[212:215]
    v_cmp_gt_i32 vcc, 0, v72
    s_cbranch_vccnz L_ts_133
L_tb_134:
    v_mfma_f32_16x16x32_bf16 v[216:219], a[240:243], v[100:103], v[216:219]
    ds_read_b128 a[232:235], v2 offset:28672
    ds_read_b128 a[236:239], v3 offset:28672
    v_mfma_f32_16x16x32_bf16 v[220:223], a[244:247], v[100:103], v[220:223]
    v_add_f32 v64, v64, v66
    v_add_f32 v68, v68, v70
    v_mfma_f32_16x16x32_bf16 v[224:227], a[248:251], v[96:99], v[224:227]
    buffer_load_dwordx4 v[80:83], v78, s[64:67], s38 offen offset:0 sc1
    v_mfma_f32_16x16x32_bf16 v[228:231], a[252:255], v[96:99], v[228:231]
    v_add_f32 v65, v65, v67
    v_add_f32 v69, v69, v71
    v_mfma_f32_16x16x32_bf16 v[232:235], a[248:251], v[100:103], v[232:235]
    ds_read_b128 a[240:243], v2 offset:29696
    ds_read_b128 a[244:247], v3 offset:29696
    v_mfma_f32_16x16x32_bf16 v[236:239], a[252:255], v[100:103], v[236:239]
    v_permlane32_swap_b32 v64, v68
    s_waitcnt lgkmcnt(2)
    v_mfma_f32_16x16x32_bf16 v[240:243], a[224:227], v[96:99], v[240:243]
    buffer_load_dwordx4 v[84:87], v78, s[64:67], s38 offen offset:256 sc1
    v_mfma_f32_16x16x32_bf16 v[244:247], a[228:231], v[96:99], v[244:247]
    v_add_f32 v64, v64, v68
    v_permlane32_swap_b32 v65, v69
    v_mfma_f32_16x16x32_bf16 v[248:251], a[224:227], v[100:103], v[248:251]
    ds_read_b128 a[248:251], v2 offset:30720
    ds_read_b128 a[252:255], v3 offset:30720
    v_mfma_f32_16x16x32_bf16 v[252:255], a[228:231], v[100:103], v[252:255]
    v_add_f32 v65, v65, v69
    s_nop 1
    v_permlane16_swap_b32 v64, v65
    s_waitcnt vmcnt(12)
    v_mfma_f32_16x16x32_bf16 v[208:211], a[232:235], v[104:107], v[208:211]
    buffer_load_dwordx4 v[88:91], v78, s[64:67], s38 offen offset:2048 sc1
    v_mfma_f32_16x16x32_bf16 v[212:215], a[236:239], v[104:107], v[212:215]
    v_add_f32 v64, v64, v65
    v_mul_f32 v64, 0x3b000000, v64
    v_mfma_f32_16x16x32_bf16 v[216:219], a[232:235], v[108:111], v[216:219]
    ds_read_b128 a[224:227], v2 offset:32768
    ds_read_b128 a[228:231], v3 offset:32768
    v_mfma_f32_16x16x32_bf16 v[220:223], a[236:239], v[108:111], v[220:223]
    v_mov_b32 v65, v64
    s_waitcnt lgkmcnt(2)
    v_mfma_f32_16x16x32_bf16 v[224:227], a[240:243], v[104:107], v[224:227]
    buffer_load_dwordx4 v[92:95], v78, s[64:67], s38 offen offset:2304 sc1
    v_mfma_f32_16x16x32_bf16 v[228:231], a[244:247], v[104:107], v[228:231]
    v_permlane16_swap_b32 v64, v65
    v_fma_f32 v65, -v64, v64, v65
    v_mfma_f32_16x16x32_bf16 v[232:235], a[240:243], v[108:111], v[232:235]
    ds_read_b128 a[232:235], v2 offset:33792
    ds_read_b128 a[236:239], v3 offset:33792
    v_mfma_f32_16x16x32_bf16 v[236:239], a[244:247], v[108:111], v[236:239]
    v_cvt_pk_bf16_f32 v37, v64, 0
    v_max_f32 v65, 0, v65
    v_mfma_f32_16x16x32_bf16 v[240:243], a[248:251], v[104:107], v[240:243]
    buffer_load_dwordx4 v[96:99], v78, s[64:67], s39 offen offset:0 sc1
    v_mfma_f32_16x16x32_bf16 v[244:247], a[252:255], v[104:107], v[244:247]
    v_lshlrev_b32 v67, 16, v37
    v_add_f32 v19, 0x3727c5ac, v65
    v_mfma_f32_16x16x32_bf16 v[248:251], a[248:251], v[108:111], v[248:251]
    ds_read_b128 a[240:243], v2 offset:34816
    ds_read_b128 a[244:247], v3 offset:34816
    v_mfma_f32_16x16x32_bf16 v[252:255], a[252:255], v[108:111], v[252:255]
    v_sub_f32 v67, v64, v67
    s_waitcnt vmcnt(13) lgkmcnt(2)
    v_mfma_f32_16x16x32_bf16 v[208:211], a[224:227], v[112:115], v[208:211]
    buffer_load_dwordx4 v[100:103], v78, s[64:67], s39 offen offset:256 sc1
    v_mfma_f32_16x16x32_bf16 v[212:215], a[228:231], v[112:115], v[212:215]
    s_waitcnt vmcnt(12)
    s_cmp_eq_u32 s16, 0
    s_cbranch_scc1 L_ps_135
    buffer_store_dword v23, off, s[64:67], s12 offset:2304
L_pb_136:
    v_mfma_f32_16x16x32_bf16 v[216:219], a[224:227], v[116:119], v[216:219]
    ds_read_b128 a[248:251], v2 offset:36864
    ds_read_b128 a[252:255], v3 offset:36864
    v_mfma_f32_16x16x32_bf16 v[220:223], a[228:231], v[116:119], v[220:223]
    v_rsq_f32 v18, v19
    v_mfma_f32_16x16x32_bf16 v[224:227], a[232:235], v[112:115], v[224:227]
    buffer_load_dwordx4 v[104:107], v78, s[64:67], s39 offen offset:2048 sc1
    v_mfma_f32_16x16x32_bf16 v[228:231], a[236:239], v[112:115], v[228:231]
    v_cvt_pk_bf16_f32 v36, v64, v67
    v_mul_f32 v18, 0xbfb8aa3b, v18
    v_mfma_f32_16x16x32_bf16 v[232:235], a[232:235], v[116:119], v[232:235]
    ds_read_b128 a[224:227], v2 offset:37888
    ds_read_b128 a[228:231], v3 offset:37888
    v_mfma_f32_16x16x32_bf16 v[236:239], a[236:239], v[116:119], v[236:239]
    v_mov_b32 v21, v19
    s_waitcnt lgkmcnt(2)
    v_mfma_f32_16x16x32_bf16 v[240:243], a[240:243], v[112:115], v[240:243]
    buffer_load_dwordx4 v[108:111], v78, s[64:67], s39 offen offset:2304 sc1
    v_mfma_f32_16x16x32_bf16 v[244:247], a[244:247], v[112:115], v[244:247]
    v_mov_b32 v39, v37
    v_mov_b32 v38, v36
    v_mfma_f32_16x16x32_bf16 v[248:251], a[240:243], v[116:119], v[248:251]
    ds_read_b128 a[232:235], v2 offset:38912
    ds_read_b128 a[236:239], v3 offset:38912
    v_mfma_f32_16x16x32_bf16 v[252:255], a[244:247], v[116:119], v[252:255]
    v_mov_b32 v20, v18
    v_permlane32_swap_b32 v19, v21
    s_waitcnt vmcnt(14)
    v_mfma_f32_16x16x32_bf16 v[208:211], a[248:251], v[120:123], v[208:211]
    v_permlane32_swap_b32 v37, v39
    v_permlane32_swap_b32 v36, v38
    v_mfma_f32_16x16x32_bf16 v[212:215], a[252:255], v[120:123], v[212:215]
    v_permlane32_swap_b32 v18, v20
    s_lshl_b64 s[40:41], s[44:45], 0
    v_mfma_f32_16x16x32_bf16 v[216:219], a[248:251], v[124:127], v[216:219]
    ds_read_b128 a[240:243], v2 offset:40960
    ds_read_b128 a[244:247], v3 offset:40960
    v_mfma_f32_16x16x32_bf16 v[220:223], a[252:255], v[124:127], v[220:223]
    v_cndmask_b32 v24, 0, v36, s[40:41]
    s_waitcnt lgkmcnt(2)
    v_mfma_f32_16x16x32_bf16 v[224:227], a[224:227], v[120:123], v[224:227]
    v_cndmask_b32 v25, 0, v37, s[40:41]
    v_cndmask_b32 v26, 0, v38, s[40:41]
    v_mfma_f32_16x16x32_bf16 v[228:231], a[228:231], v[120:123], v[228:231]
    v_cndmask_b32 v27, 0, v39, s[40:41]
    v_mfma_f32_16x16x32_bf16 v[232:235], a[224:227], v[124:127], v[232:235]
    ds_read_b128 a[248:251], v2 offset:41984
    ds_read_b128 a[252:255], v3 offset:41984
    v_mfma_f32_16x16x32_bf16 v[236:239], a[228:231], v[124:127], v[236:239]
    v_mfma_f32_16x16x32_bf16 v[240:243], a[232:235], v[120:123], v[240:243]
    v_mfma_f32_16x16x32_bf16 v[244:247], a[236:239], v[120:123], v[244:247]
    v_mfma_f32_16x16x32_bf16 v[248:251], a[232:235], v[124:127], v[248:251]
    ds_read_b128 a[224:227], v2 offset:43008
    ds_read_b128 a[228:231], v3 offset:43008
    v_mfma_f32_16x16x32_bf16 v[252:255], a[236:239], v[124:127], v[252:255]
    s_waitcnt vmcnt(12) lgkmcnt(2)
    v_mfma_f32_16x16x32_bf16 v[208:211], a[240:243], v[128:131], v[208:211]
    v_mfma_f32_16x16x32_bf16 v[212:215], a[244:247], v[128:131], v[212:215]
    v_mfma_f32_16x16x32_bf16 v[216:219], a[240:243], v[132:135], v[216:219]
    ds_read_b128 a[232:235], v2 offset:45056
    ds_read_b128 a[236:239], v3 offset:45056
    v_mfma_f32_16x16x32_bf16 v[220:223], a[244:247], v[132:135], v[220:223]
    v_mfma_f32_16x16x32_bf16 v[224:227], a[248:251], v[128:131], v[224:227]
    v_mfma_f32_16x16x32_bf16 v[228:231], a[252:255], v[128:131], v[228:231]
    v_mfma_f32_16x16x32_bf16 v[232:235], a[248:251], v[132:135], v[232:235]
    ds_read_b128 a[240:243], v2 offset:49152
    ds_read_b128 a[244:247], v3 offset:49152
    v_mfma_f32_16x16x32_bf16 v[236:239], a[252:255], v[132:135], v[236:239]
    s_waitcnt lgkmcnt(2)
    v_mfma_f32_16x16x32_bf16 v[240:243], a[224:227], v[128:131], v[240:243]
    v_mfma_f32_16x16x32_bf16 v[244:247], a[228:231], v[128:131], v[244:247]
    v_mfma_f32_16x16x32_bf16 v[248:251], a[224:227], v[132:135], v[248:251]
    ds_read_b128 a[248:251], v2 offset:53248
    ds_read_b128 a[252:255], v3 offset:53248
    v_mfma_f32_16x16x32_bf16 v[252:255], a[228:231], v[132:135], v[252:255]
    s_waitcnt vmcnt(9)
    v_mfma_f32_16x16x32_bf16 v[208:211], a[232:235], v[136:139], v[208:211]
    v_mfma_f32_16x16x32_bf16 v[212:215], a[236:239], v[136:139], v[212:215]
    v_mfma_f32_16x16x32_bf16 v[216:219], a[232:235], v[140:143], v[216:219]
    ds_read_b128 a[224:227], v2 offset:57344
    ds_read_b128 a[228:231], v3 offset:57344
    v_mfma_f32_16x16x32_bf16 v[220:223], a[236:239], v[140:143], v[220:223]
    s_waitcnt vmcnt(7) lgkmcnt(2)
    v_mfma_f32_16x16x32_bf16 v[208:211], a[240:243], v[80:83], v[208:211]
    v_mfma_f32_16x16x32_bf16 v[212:215], a[244:247], v[80:83], v[212:215]
    v_mfma_f32_16x16x32_bf16 v[216:219], a[240:243], v[84:87], v[216:219]
    ds_read_b128 a[232:235], v2 offset:61440
    ds_read_b128 a[236:239], v3 offset:61440
    v_mfma_f32_16x16x32_bf16 v[220:223], a[244:247], v[84:87], v[220:223]
    s_waitcnt vmcnt(5)
    v_mfma_f32_16x16x32_bf16 v[208:211], a[248:251], v[88:91], v[208:211]
    v_mfma_f32_16x16x32_bf16 v[212:215], a[252:255], v[88:91], v[212:215]
    v_mfma_f32_16x16x32_bf16 v[216:219], a[248:251], v[92:95], v[216:219]
    ds_read_b128 a[240:243], v2 offset:46080
    ds_read_b128 a[244:247], v3 offset:46080
    v_mfma_f32_16x16x32_bf16 v[220:223], a[252:255], v[92:95], v[220:223]
    s_waitcnt vmcnt(3) lgkmcnt(2)
    v_mfma_f32_16x16x32_bf16 v[208:211], a[224:227], v[96:99], v[208:211]
    v_mfma_f32_16x16x32_bf16 v[212:215], a[228:231], v[96:99], v[212:215]
    v_mfma_f32_16x16x32_bf16 v[216:219], a[224:227], v[100:103], v[216:219]
    ds_read_b128 a[248:251], v2 offset:50176
    ds_read_b128 a[252:255], v3 offset:50176
    v_mfma_f32_16x16x32_bf16 v[220:223], a[228:231], v[100:103], v[220:223]
    s_waitcnt vmcnt(0)
    v_mfma_f32_16x16x32_bf16 v[208:211], a[232:235], v[104:107], v[208:211]
    v_mfma_f32_16x16x32_bf16 v[212:215], a[236:239], v[104:107], v[212:215]
    buffer_load_dword v16, v4, s[64:67], s13 offen offset:2304 sc1
    v_mfma_f32_16x16x32_bf16 v[216:219], a[232:235], v[108:111], v[216:219]
    ds_read_b128 a[224:227], v2 offset:54272
    ds_read_b128 a[228:231], v3 offset:54272
    v_mfma_f32_16x16x32_bf16 v[220:223], a[236:239], v[108:111], v[220:223]
    v_mfma_f32_16x16x32_bf16 v[208:211], v[28:31], v[24:27], v[208:211]
    v_mfma_f32_16x16x32_bf16 v[212:215], v[32:35], v[24:27], v[212:215]
    v_mfma_f32_16x16x32_bf16 v[216:219], v[28:31], v[26:29], v[216:219]
    v_mfma_f32_16x16x32_bf16 v[220:223], v[32:35], v[26:29], v[220:223]
    s_waitcnt lgkmcnt(2)
    v_mfma_f32_16x16x32_bf16 v[224:227], a[240:243], v[136:139], v[224:227]
    v_mfma_f32_16x16x32_bf16 v[228:231], a[244:247], v[136:139], v[228:231]
    s_lshl_b64 s[40:41], s[44:45], 16
    v_cndmask_b32 v24, 0, v36, s[40:41]
    v_mfma_f32_16x16x32_bf16 v[232:235], a[240:243], v[140:143], v[232:235]
    ds_read_b128 a[232:235], v2 offset:58368
    ds_read_b128 a[236:239], v3 offset:58368
    v_cndmask_b32 v25, 0, v37, s[40:41]
    v_mfma_f32_16x16x32_bf16 v[236:239], a[244:247], v[140:143], v[236:239]
    v_cndmask_b32 v26, 0, v38, s[40:41]
    v_cndmask_b32 v27, 0, v39, s[40:41]
    v_mfma_f32_16x16x32_bf16 v[224:227], a[248:251], v[80:83], v[224:227]
    v_mfma_f32_16x16x32_bf16 v[228:231], a[252:255], v[80:83], v[228:231]
    v_mfma_f32_16x16x32_bf16 v[232:235], a[248:251], v[84:87], v[232:235]
    ds_read_b128 a[240:243], v2 offset:62464
    ds_read_b128 a[244:247], v3 offset:62464
    v_mfma_f32_16x16x32_bf16 v[236:239], a[252:255], v[84:87], v[236:239]
    s_add_u32 s96, s10, 0x701000
    v_mul_f32 v212, v208, v212
    s_waitcnt lgkmcnt(2)
    v_mfma_f32_16x16x32_bf16 v[224:227], a[224:227], v[88:91], v[224:227]
    v_mul_f32 v208, v18, v208
    v_mul_f32 v213, v209, v213
    v_mfma_f32_16x16x32_bf16 v[228:231], a[228:231], v[88:91], v[228:231]
    v_mul_f32 v209, v18, v209
    v_exp_f32 v208, v208
    v_mfma_f32_16x16x32_bf16 v[232:235], a[224:227], v[92:95], v[232:235]
    ds_read_b128 a[248:251], v2 offset:47104
    ds_read_b128 a[252:255], v3 offset:47104
    v_mul_f32 v214, v210, v214
    v_mfma_f32_16x16x32_bf16 v[236:239], a[228:231], v[92:95], v[236:239]
    v_mul_f32 v210, v18, v210
    v_fma_f32 v208, v208, v19, v19
    v_mfma_f32_16x16x32_bf16 v[224:227], a[232:235], v[96:99], v[224:227]
    v_exp_f32 v209, v209
    v_mul_f32 v215, v211, v215
    v_mfma_f32_16x16x32_bf16 v[228:231], a[236:239], v[96:99], v[228:231]
    s_waitcnt vmcnt(0)
    v_cmp_eq_u32 vcc, 0, v16
    s_cbranch_vccnz L_fs_137
L_fb_138:
    s_add_u32 s80, s8, 0x208000
    v_add_u32 v79, s80, v0
    buffer_load_dwordx4 v[112:115], v79, s[64:67], s32 offen offset:0 sc1
    v_mfma_f32_16x16x32_bf16 v[232:235], a[232:235], v[100:103], v[232:235]
    ds_read_b128 a[224:227], v2 offset:51200
    ds_read_b128 a[228:231], v3 offset:51200
    v_mul_f32 v211, v18, v211
    v_mfma_f32_16x16x32_bf16 v[236:239], a[236:239], v[100:103], v[236:239]
    v_exp_f32 v210, v210
    s_waitcnt lgkmcnt(2)
    v_mfma_f32_16x16x32_bf16 v[224:227], a[240:243], v[104:107], v[224:227]
    v_fma_f32 v209, v209, v19, v19
    v_mul_f32 v220, v216, v220
    v_mfma_f32_16x16x32_bf16 v[228:231], a[244:247], v[104:107], v[228:231]
    buffer_load_dwordx4 v[116:119], v79, s[64:67], s32 offen offset:256 sc1
    v_mul_f32 v216, v20, v216
    v_mfma_f32_16x16x32_bf16 v[232:235], a[240:243], v[108:111], v[232:235]
    ds_read_b128 a[232:235], v2 offset:55296
    ds_read_b128 a[236:239], v3 offset:55296
    v_mfma_f32_16x16x32_bf16 v[236:239], a[244:247], v[108:111], v[236:239]
    v_rcp_f32 v208, v208
    v_fma_f32 v210, v210, v19, v19
    v_mfma_f32_16x16x32_bf16 v[224:227], v[28:31], v[24:27], v[224:227]
    v_exp_f32 v211, v211
    v_mul_f32 v212, v212, v208
    v_mfma_f32_16x16x32_bf16 v[228:231], v[32:35], v[24:27], v[228:231]
    buffer_load_dwordx4 v[120:123], v79, s[64:67], s32 offen offset:2048 sc1
    v_mfma_f32_16x16x32_bf16 v[232:235], v[28:31], v[26:29], v[232:235]
    v_rcp_f32 v209, v209
    v_mul_f32 v221, v217, v221
    v_mfma_f32_16x16x32_bf16 v[236:239], v[32:35], v[26:29], v[236:239]
    v_mul_f32 v217, v20, v217
    v_fma_f32 v211, v211, v19, v19
    v_mfma_f32_16x16x32_bf16 v[240:243], a[248:251], v[136:139], v[240:243]
    v_exp_f32 v216, v216
    v_mul_f32 v213, v213, v209
    v_mfma_f32_16x16x32_bf16 v[244:247], a[252:255], v[136:139], v[244:247]
    buffer_load_dwordx4 v[124:127], v79, s[64:67], s32 offen offset:2304 sc1
    s_lshl_b64 s[40:41], s[44:45], 32
    v_mfma_f32_16x16x32_bf16 v[248:251], a[248:251], v[140:143], v[248:251]
    ds_read_b128 a[240:243], v2 offset:59392
    ds_read_b128 a[244:247], v3 offset:59392
    v_mfma_f32_16x16x32_bf16 v[252:255], a[252:255], v[140:143], v[252:255]
    v_cndmask_b32 v24, 0, v36, s[40:41]
    v_cndmask_b32 v25, 0, v37, s[40:41]
    s_waitcnt lgkmcnt(2)
    v_mfma_f32_16x16x32_bf16 v[240:243], a[224:227], v[80:83], v[240:243]
    v_cndmask_b32 v26, 0, v38, s[40:41]
    v_cndmask_b32 v27, 0, v39, s[40:41]
    v_mfma_f32_16x16x32_bf16 v[244:247], a[228:231], v[80:83], v[244:247]
    buffer_load_dwordx4 v[128:131], v79, s[64:67], s33 offen offset:0 sc1
    v_mul_f32 v222, v218, v222
    v_mfma_f32_16x16x32_bf16 v[248:251], a[224:227], v[84:87], v[248:251]
    ds_read_b128 a[248:251], v2 offset:63488
    ds_read_b128 a[252:255], v3 offset:63488
    v_mul_f32 v218, v20, v218
    v_mfma_f32_16x16x32_bf16 v[252:255], a[228:231], v[84:87], v[252:255]
    v_rcp_f32 v210, v210
    v_mfma_f32_16x16x32_bf16 v[240:243], a[232:235], v[88:91], v[240:243]
    v_exp_f32 v217, v217
    v_fma_f32 v216, v216, v21, v21
    v_mfma_f32_16x16x32_bf16 v[244:247], a[236:239], v[88:91], v[244:247]
    buffer_load_dwordx4 v[132:135], v79, s[64:67], s33 offen offset:256 sc1
    v_mfma_f32_16x16x32_bf16 v[248:251], a[232:235], v[92:95], v[248:251]
    ds_read_b128 a[224:227], v2 offset:0
    ds_read_b128 a[228:231], v3 offset:0
    v_mul_f32 v214, v214, v210
    v_mfma_f32_16x16x32_bf16 v[252:255], a[236:239], v[92:95], v[252:255]
    v_rcp_f32 v211, v211
    s_waitcnt lgkmcnt(2)
    v_mfma_f32_16x16x32_bf16 v[240:243], a[240:243], v[96:99], v[240:243]
    v_cvt_pk_bf16_f32 v208, v212, v213
    v_mul_f32 v223, v219, v223
    v_mfma_f32_16x16x32_bf16 v[244:247], a[244:247], v[96:99], v[244:247]
    buffer_load_dwordx4 v[136:139], v79, s[64:67], s33 offen offset:2048 sc1
    v_mul_f32 v219, v20, v219
    v_mfma_f32_16x16x32_bf16 v[248:251], a[240:243], v[100:103], v[248:251]
    ds_read_b128 a[232:235], v2 offset:1024
    ds_read_b128 a[236:239], v3 offset:1024
    v_mfma_f32_16x16x32_bf16 v[252:255], a[244:247], v[100:103], v[252:255]
    v_exp_f32 v218, v218
    v_fma_f32 v217, v217, v21, v21
    v_mfma_f32_16x16x32_bf16 v[240:243], a[248:251], v[104:107], v[240:243]
    v_rcp_f32 v216, v216
    v_mul_f32 v215, v215, v211
    v_mfma_f32_16x16x32_bf16 v[244:247], a[252:255], v[104:107], v[244:247]
    buffer_load_dwordx4 v[140:143], v79, s[64:67], s33 offen offset:2304 sc1
    v_mfma_f32_16x16x32_bf16 v[248:251], a[248:251], v[108:111], v[248:251]
    ds_read_b128 a[240:243], v2 offset:2048
    ds_read_b128 a[244:247], v3 offset:2048
    v_fma_f32 v218, v218, v21, v21
    v_mfma_f32_16x16x32_bf16 v[252:255], a[252:255], v[108:111], v[252:255]
    v_mfma_f32_16x16x32_bf16 v[240:243], v[28:31], v[24:27], v[240:243]
    v_exp_f32 v219, v219
    v_mul_f32 v220, v220, v216
    v_mfma_f32_16x16x32_bf16 v[244:247], v[32:35], v[24:27], v[244:247]
    buffer_load_dwordx4 v[80:83], v79, s[64:67], s34 offen offset:0 sc1
    v_cvt_pk_bf16_f32 v209, v214, v215
    v_mfma_f32_16x16x32_bf16 v[248:251], v[28:31], v[26:29], v[248:251]
    v_rcp_f32 v217, v217
    v_mfma_f32_16x16x32_bf16 v[252:255], v[32:35], v[26:29], v[252:255]
    v_fma_f32 v219, v219, v21, v21
    v_rcp_f32 v218, v218
    ds_read_b128 a[248:251], v2 offset:3072
    ds_read_b128 a[252:255], v3 offset:3072
    s_waitcnt vmcnt(8) lgkmcnt(4)
    v_mfma_f32_16x16x32_bf16 v[144:147], a[224:227], v[112:115], 0
    s_add_u32 s46, s9, 0x20800
    buffer_load_dwordx2 v[64:65], v22, s[64:67], s46 offen offset:0 sc1
    v_mfma_f32_16x16x32_bf16 v[148:151], a[228:231], v[112:115], 0
    buffer_load_dwordx4 v[84:87], v79, s[64:67], s34 offen offset:256 sc1
    v_mul_f32 v221, v221, v217
    s_waitcnt vmcnt(9)
    v_mfma_f32_16x16x32_bf16 v[152:155], a[224:227], v[116:119], 0
    buffer_load_dwordx2 v[66:67], v22, s[64:67], s46 offen offset:256 sc1
    v_mfma_f32_16x16x32_bf16 v[156:159], a[228:231], v[116:119], 0
    v_rcp_f32 v219, v219
    v_mfma_f32_16x16x32_bf16 v[160:163], a[232:235], v[112:115], 0
    buffer_load_dwordx2 v[68:69], v22, s[64:67], s46 offen offset:128 sc1
    v_mfma_f32_16x16x32_bf16 v[164:167], a[236:239], v[112:115], 0
    buffer_load_dwordx4 v[88:91], v79, s[64:67], s34 offen offset:2048 sc1
    v_mfma_f32_16x16x32_bf16 v[168:171], a[232:235], v[116:119], 0
    ds_read_b128 a[224:227], v2 offset:4096
    ds_read_b128 a[228:231], v3 offset:4096
    v_mul_f32 v222, v222, v218
    v_mfma_f32_16x16x32_bf16 v[172:175], a[236:239], v[116:119], 0
    buffer_load_dwordx2 v[70:71], v22, s[64:67], s46 offen offset:384 sc1
    s_waitcnt lgkmcnt(2)
    v_mfma_f32_16x16x32_bf16 v[176:179], a[240:243], v[112:115], 0
    v_cvt_pk_bf16_f32 v210, v220, v221
    v_mul_f32 v223, v223, v219
    v_mfma_f32_16x16x32_bf16 v[180:183], a[244:247], v[112:115], 0
    buffer_load_dwordx4 v[92:95], v79, s[64:67], s34 offen offset:2304 sc1
    v_cvt_pk_bf16_f32 v211, v222, v223
    v_mfma_f32_16x16x32_bf16 v[184:187], a[240:243], v[116:119], 0
    ds_read_b128 a[232:235], v2 offset:5120
    ds_read_b128 a[236:239], v3 offset:5120
    v_mfma_f32_16x16x32_bf16 v[188:191], a[244:247], v[116:119], 0
    v_permlane16_swap_b32 v208, v210
    v_permlane16_swap_b32 v209, v211
    v_mfma_f32_16x16x32_bf16 v[192:195], a[248:251], v[112:115], 0
    buffer_store_dwordx4 v[208:211], v2, s[64:67], s96 offen sc1
    v_mfma_f32_16x16x32_bf16 v[196:199], a[252:255], v[112:115], 0
    buffer_load_dwordx4 v[96:99], v79, s[64:67], s35 offen offset:0 sc1
    v_mfma_f32_16x16x32_bf16 v[200:203], a[248:251], v[116:119], 0
    ds_read_b128 a[240:243], v2 offset:6144
    ds_read_b128 a[244:247], v3 offset:6144
    v_mfma_f32_16x16x32_bf16 v[204:207], a[252:255], v[116:119], 0
    s_waitcnt vmcnt(14) lgkmcnt(2)
    v_mfma_f32_16x16x32_bf16 v[144:147], a[224:227], v[120:123], v[144:147]
    s_add_u32 s97, s10, 0x701400
    v_mul_f32 v228, v224, v228
    v_mul_f32 v224, v18, v224
    v_mfma_f32_16x16x32_bf16 v[148:151], a[228:231], v[120:123], v[148:151]
    buffer_load_dwordx4 v[100:103], v79, s[64:67], s35 offen offset:256 sc1
    v_mul_f32 v229, v225, v229
    v_mfma_f32_16x16x32_bf16 v[152:155], a[224:227], v[124:127], v[152:155]
    ds_read_b128 a[248:251], v2 offset:7168
    ds_read_b128 a[252:255], v3 offset:7168
    v_mfma_f32_16x16x32_bf16 v[156:159], a[228:231], v[124:127], v[156:159]
    v_mul_f32 v225, v18, v225
    v_exp_f32 v224, v224
    v_mfma_f32_16x16x32_bf16 v[160:163], a[232:235], v[120:123], v[160:163]
    v_mul_f32 v230, v226, v230
    v_mul_f32 v226, v18, v226
    v_mfma_f32_16x16x32_bf16 v[164:167], a[236:239], v[120:123], v[164:167]
    buffer_load_dwordx4 v[104:107], v79, s[64:67], s35 offen offset:2048 sc1
    v_fma_f32 v224, v224, v19, v19
    v_mfma_f32_16x16x32_bf16 v[168:171], a[232:235], v[124:127], v[168:171]
    ds_read_b128 a[224:227], v2 offset:8192
    ds_read_b128 a[228:231], v3 offset:8192
    v_mul_f32 v231, v227, v231
    v_mfma_f32_16x16x32_bf16 v[172:175], a[236:239], v[124:127], v[172:175]
    v_mul_f32 v227, v18, v227
    s_waitcnt lgkmcnt(2)
    v_mfma_f32_16x16x32_bf16 v[176:179], a[240:243], v[120:123], v[176:179]
    v_exp_f32 v225, v225
    s_nop 0
    v_fma_f32 v225, v225, v19, v19
    v_mfma_f32_16x16x32_bf16 v[180:183], a[244:247], v[120:123], v[180:183]
    buffer_load_dwordx4 v[108:111], v79, s[64:67], s35 offen offset:2304 sc1
    v_mfma_f32_16x16x32_bf16 v[184:187], a[240:243], v[124:127], v[184:187]
    ds_read_b128 a[232:235], v2 offset:9216
    ds_read_b128 a[236:239], v3 offset:9216
    v_mfma_f32_16x16x32_bf16 v[188:191], a[244:247], v[124:127], v[188:191]
    v_exp_f32 v226, v226
    v_mul_f32 v236, v232, v236
    v_mfma_f32_16x16x32_bf16 v[192:195], a[248:251], v[120:123], v[192:195]
    v_rcp_f32 v224, v224
    v_mfma_f32_16x16x32_bf16 v[196:199], a[252:255], v[120:123], v[196:199]
    buffer_load_dwordx4 v[112:115], v79, s[64:67], s36 offen offset:0 sc1
    v_mul_f32 v232, v20, v232
    v_mfma_f32_16x16x32_bf16 v[200:203], a[248:251], v[124:127], v[200:203]
    ds_read_b128 a[240:243], v2 offset:10240
    ds_read_b128 a[244:247], v3 offset:10240
    v_mfma_f32_16x16x32_bf16 v[204:207], a[252:255], v[124:127], v[204:207]
    v_exp_f32 v227, v227
    s_waitcnt vmcnt(16) lgkmcnt(2)
    v_mfma_f32_16x16x32_bf16 v[144:147], a[224:227], v[128:131], v[144:147]
    v_fma_f32 v226, v226, v19, v19
    v_rcp_f32 v225, v225
    v_mfma_f32_16x16x32_bf16 v[148:151], a[228:231], v[128:131], v[148:151]
    buffer_load_dwordx4 v[116:119], v79, s[64:67], s36 offen offset:256 sc1
    v_mfma_f32_16x16x32_bf16 v[152:155], a[224:227], v[132:135], v[152:155]
    ds_read_b128 a[248:251], v2 offset:11264
    ds_read_b128 a[252:255], v3 offset:11264
    v_mul_f32 v228, v228, v224
    v_mfma_f32_16x16x32_bf16 v[156:159], a[228:231], v[132:135], v[156:159]
    v_mul_f32 v237, v233, v237
    v_mul_f32 v233, v20, v233
    v_mfma_f32_16x16x32_bf16 v[160:163], a[232:235], v[128:131], v[160:163]
    v_exp_f32 v232, v232
    v_fma_f32 v227, v227, v19, v19
    v_mfma_f32_16x16x32_bf16 v[164:167], a[236:239], v[128:131], v[164:167]
    buffer_load_dwordx4 v[120:123], v79, s[64:67], s36 offen offset:2048 sc1
    v_mul_f32 v229, v229, v225
    v_mfma_f32_16x16x32_bf16 v[168:171], a[232:235], v[132:135], v[168:171]
    ds_read_b128 a[224:227], v2 offset:12288
    ds_read_b128 a[228:231], v3 offset:12288
    v_mfma_f32_16x16x32_bf16 v[172:175], a[236:239], v[132:135], v[172:175]
    v_rcp_f32 v226, v226
    s_waitcnt lgkmcnt(2)
    v_mfma_f32_16x16x32_bf16 v[176:179], a[240:243], v[128:131], v[176:179]
    v_mul_f32 v238, v234, v238
    v_mul_f32 v234, v20, v234
    v_mfma_f32_16x16x32_bf16 v[180:183], a[244:247], v[128:131], v[180:183]
    buffer_load_dwordx4 v[124:127], v79, s[64:67], s36 offen offset:2304 sc1
    v_fma_f32 v232, v232, v21, v21
    v_mfma_f32_16x16x32_bf16 v[184:187], a[240:243], v[132:135], v[184:187]
    ds_read_b128 a[232:235], v2 offset:13312
    ds_read_b128 a[236:239], v3 offset:13312
    v_mfma_f32_16x16x32_bf16 v[188:191], a[244:247], v[132:135], v[188:191]
    v_exp_f32 v233, v233
    v_mfma_f32_16x16x32_bf16 v[192:195], a[248:251], v[128:131], v[192:195]
    v_rcp_f32 v227, v227
    v_mul_f32 v230, v230, v226
    v_mfma_f32_16x16x32_bf16 v[196:199], a[252:255], v[128:131], v[196:199]
    v_cvt_pk_bf16_f32 v224, v228, v229
    v_mul_f32 v239, v235, v239
    v_mfma_f32_16x16x32_bf16 v[200:203], a[248:251], v[132:135], v[200:203]
    ds_read_b128 a[240:243], v2 offset:14336
    ds_read_b128 a[244:247], v3 offset:14336
    v_mul_f32 v235, v20, v235
    v_mfma_f32_16x16x32_bf16 v[204:207], a[252:255], v[132:135], v[204:207]
    v_exp_f32 v234, v234
    s_waitcnt vmcnt(17) lgkmcnt(2)
    v_mfma_f32_16x16x32_bf16 v[144:147], a[224:227], v[136:139], v[144:147]
    buffer_load_dwordx4 v[128:131], v79, s[64:67], s37 offen offset:0 sc1
    v_mfma_f32_16x16x32_bf16 v[148:151], a[228:231], v[136:139], v[148:151]
    v_fma_f32 v233, v233, v21, v21
    v_rcp_f32 v232, v232
    v_mfma_f32_16x16x32_bf16 v[152:155], a[224:227], v[140:143], v[152:155]
    ds_read_b128 a[248:251], v2 offset:15360
    ds_read_b128 a[252:255], v3 offset:15360
    v_mfma_f32_16x16x32_bf16 v[156:159], a[228:231], v[140:143], v[156:159]
    v_mul_f32 v231, v231, v227
    v_exp_f32 v235, v235
    v_mfma_f32_16x16x32_bf16 v[160:163], a[232:235], v[136:139], v[160:163]
    buffer_load_dwordx4 v[132:135], v79, s[64:67], s37 offen offset:256 sc1
    v_fma_f32 v234, v234, v21, v21
    v_mfma_f32_16x16x32_bf16 v[164:167], a[236:239], v[136:139], v[164:167]
    v_rcp_f32 v233, v233
    v_mfma_f32_16x16x32_bf16 v[168:171], a[232:235], v[140:143], v[168:171]
    ds_read_b128 a[224:227], v2 offset:16384
    ds_read_b128 a[228:231], v3 offset:16384
    v_mul_f32 v236, v236, v232
    v_mfma_f32_16x16x32_bf16 v[172:175], a[236:239], v[140:143], v[172:175]
    v_cvt_pk_bf16_f32 v225, v230, v231
    s_waitcnt lgkmcnt(2)
    v_mfma_f32_16x16x32_bf16 v[176:179], a[240:243], v[136:139], v[176:179]
    v_fma_f32 v235, v235, v21, v21
    v_rcp_f32 v234, v234
    v_mfma_f32_16x16x32_bf16 v[180:183], a[244:247], v[136:139], v[180:183]
    v_mul_f32 v237, v237, v233
    v_rcp_f32 v235, v235
    v_mfma_f32_16x16x32_bf16 v[184:187], a[240:243], v[140:143], v[184:187]
    ds_read_b128 a[232:235], v2 offset:17408
    ds_read_b128 a[236:239], v3 offset:17408
    v_mfma_f32_16x16x32_bf16 v[188:191], a[244:247], v[140:143], v[188:191]
    v_mul_f32 v238, v238, v234
    v_cvt_pk_bf16_f32 v226, v236, v237
    v_mul_f32 v239, v239, v235
    v_mfma_f32_16x16x32_bf16 v[192:195], a[248:251], v[136:139], v[192:195]
    v_cvt_pk_bf16_f32 v227, v238, v239
    v_permlane16_swap_b32 v224, v226
    v_mfma_f32_16x16x32_bf16 v[196:199], a[252:255], v[136:139], v[196:199]
    v_permlane16_swap_b32 v225, v227
    buffer_store_dwordx4 v[224:227], v2, s[64:67], s97 offen sc1
    v_mfma_f32_16x16x32_bf16 v[200:203], a[248:251], v[140:143], v[200:203]
    ds_read_b128 a[240:243], v2 offset:18432
    ds_read_b128 a[244:247], v3 offset:18432
    v_mfma_f32_16x16x32_bf16 v[204:207], a[252:255], v[140:143], v[204:207]
    s_waitcnt vmcnt(17) lgkmcnt(2)
    v_mfma_f32_16x16x32_bf16 v[144:147], a[224:227], v[80:83], v[144:147]
    buffer_load_dwordx4 v[136:139], v79, s[64:67], s37 offen offset:2048 sc1
    v_mfma_f32_16x16x32_bf16 v[148:151], a[228:231], v[80:83], v[148:151]
    s_add_u32 s98, s10, 0x701800
    v_mul_f32 v244, v240, v244
    v_mfma_f32_16x16x32_bf16 v[152:155], a[224:227], v[84:87], v[152:155]
    ds_read_b128 a[248:251], v2 offset:19456
    ds_read_b128 a[252:255], v3 offset:19456
    v_mul_f32 v240, v18, v240
    v_mfma_f32_16x16x32_bf16 v[156:159], a[228:231], v[84:87], v[156:159]
    v_mul_f32 v245, v241, v245
    v_mul_f32 v241, v18, v241
    v_mul_f32 v246, v242, v246
    v_mfma_f32_16x16x32_bf16 v[160:163], a[232:235], v[80:83], v[160:163]
    buffer_load_dwordx4 v[140:143], v79, s[64:67], s37 offen offset:2304 sc1
    v_mfma_f32_16x16x32_bf16 v[164:167], a[236:239], v[80:83], v[164:167]
    v_exp_f32 v240, v240
    v_mul_f32 v242, v18, v242
    v_mfma_f32_16x16x32_bf16 v[168:171], a[232:235], v[84:87], v[168:171]
    ds_read_b128 a[224:227], v2 offset:20480
    ds_read_b128 a[228:231], v3 offset:20480
    v_mfma_f32_16x16x32_bf16 v[172:175], a[236:239], v[84:87], v[172:175]
    v_exp_f32 v241, v241
    s_waitcnt lgkmcnt(2)
    v_mfma_f32_16x16x32_bf16 v[176:179], a[240:243], v[80:83], v[176:179]
    v_fma_f32 v240, v240, v19, v19
    v_mul_f32 v247, v243, v247
    v_mul_f32 v243, v18, v243
    v_mfma_f32_16x16x32_bf16 v[180:183], a[244:247], v[80:83], v[180:183]
    v_exp_f32 v242, v242
    v_mfma_f32_16x16x32_bf16 v[184:187], a[240:243], v[84:87], v[184:187]
    ds_read_b128 a[232:235], v2 offset:21504
    ds_read_b128 a[236:239], v3 offset:21504
    v_fma_f32 v241, v241, v19, v19
    v_mfma_f32_16x16x32_bf16 v[188:191], a[244:247], v[84:87], v[188:191]
    v_rcp_f32 v240, v240
    v_mfma_f32_16x16x32_bf16 v[192:195], a[248:251], v[80:83], v[192:195]
    v_mul_f32 v252, v248, v252
    v_mul_f32 v248, v20, v248
    v_fma_f32 v242, v242, v19, v19
    v_mfma_f32_16x16x32_bf16 v[196:199], a[252:255], v[80:83], v[196:199]
    v_exp_f32 v243, v243
    v_mul_f32 v244, v244, v240
    v_mfma_f32_16x16x32_bf16 v[200:203], a[248:251], v[84:87], v[200:203]
    ds_read_b128 a[240:243], v2 offset:22528
    ds_read_b128 a[244:247], v3 offset:22528
    v_mfma_f32_16x16x32_bf16 v[204:207], a[252:255], v[84:87], v[204:207]
    v_rcp_f32 v241, v241
    s_waitcnt vmcnt(14) lgkmcnt(2)
    v_mfma_f32_16x16x32_bf16 v[144:147], a[224:227], v[88:91], v[144:147]
    buffer_load_dwordx4 v[80:83], v79, s[64:67], s38 offen offset:0 sc1
    v_mfma_f32_16x16x32_bf16 v[148:151], a[228:231], v[88:91], v[148:151]
    v_mul_f32 v253, v249, v253
    v_mul_f32 v249, v20, v249
    v_fma_f32 v243, v243, v19, v19
    v_mfma_f32_16x16x32_bf16 v[152:155], a[224:227], v[92:95], v[152:155]
    ds_read_b128 a[248:251], v2 offset:23552
    ds_read_b128 a[252:255], v3 offset:23552
    v_mfma_f32_16x16x32_bf16 v[156:159], a[228:231], v[92:95], v[156:159]
    v_exp_f32 v248, v248
    v_mfma_f32_16x16x32_bf16 v[160:163], a[232:235], v[88:91], v[160:163]
    buffer_load_dwordx4 v[84:87], v79, s[64:67], s38 offen offset:256 sc1
    v_mul_f32 v245, v245, v241
    v_mfma_f32_16x16x32_bf16 v[164:167], a[236:239], v[88:91], v[164:167]
    v_rcp_f32 v242, v242
    v_mfma_f32_16x16x32_bf16 v[168:171], a[232:235], v[92:95], v[168:171]
    ds_read_b128 a[224:227], v2 offset:24576
    ds_read_b128 a[228:231], v3 offset:24576
    v_mul_f32 v254, v250, v254
    v_mfma_f32_16x16x32_bf16 v[172:175], a[236:239], v[92:95], v[172:175]
    v_mul_f32 v250, v20, v250
    v_fma_f32 v248, v248, v21, v21
    s_waitcnt lgkmcnt(2)
    v_mfma_f32_16x16x32_bf16 v[176:179], a[240:243], v[88:91], v[176:179]
    v_exp_f32 v249, v249
    v_mfma_f32_16x16x32_bf16 v[180:183], a[244:247], v[88:91], v[180:183]
    v_rcp_f32 v243, v243
    v_mul_f32 v246, v246, v242
    v_mfma_f32_16x16x32_bf16 v[184:187], a[240:243], v[92:95], v[184:187]
    ds_read_b128 a[232:235], v2 offset:25600
    ds_read_b128 a[236:239], v3 offset:25600
    v_mfma_f32_16x16x32_bf16 v[188:191], a[244:247], v[92:95], v[188:191]
    v_cvt_pk_bf16_f32 v240, v244, v245
    v_mul_f32 v255, v251, v255
    v_mul_f32 v251, v20, v251
    v_mfma_f32_16x16x32_bf16 v[192:195], a[248:251], v[88:91], v[192:195]
    v_exp_f32 v250, v250
    v_fma_f32 v249, v249, v21, v21
    v_mfma_f32_16x16x32_bf16 v[196:199], a[252:255], v[88:91], v[196:199]
    v_rcp_f32 v248, v248
    v_mfma_f32_16x16x32_bf16 v[200:203], a[248:251], v[92:95], v[200:203]
    ds_read_b128 a[240:243], v2 offset:26624
    ds_read_b128 a[244:247], v3 offset:26624
    v_mul_f32 v247, v247, v243
    v_mfma_f32_16x16x32_bf16 v[204:207], a[252:255], v[92:95], v[204:207]
    v_fma_f32 v250, v250, v21, v21
    s_waitcnt vmcnt(13) lgkmcnt(2)
    v_mfma_f32_16x16x32_bf16 v[144:147], a[224:227], v[96:99], v[144:147]
    buffer_load_dwordx4 v[88:91], v79, s[64:67], s38 offen offset:2048 sc1
    v_mfma_f32_16x16x32_bf16 v[148:151], a[228:231], v[96:99], v[148:151]
    v_exp_f32 v251, v251
    v_mul_f32 v252, v252, v248
    v_mfma_f32_16x16x32_bf16 v[152:155], a[224:227], v[100:103], v[152:155]
    ds_read_b128 a[248:251], v2 offset:27648
    ds_read_b128 a[252:255], v3 offset:27648
    v_mfma_f32_16x16x32_bf16 v[156:159], a[228:231], v[100:103], v[156:159]
    v_rcp_f32 v249, v249
    v_cvt_pk_bf16_f32 v241, v246, v247
    v_mfma_f32_16x16x32_bf16 v[160:163], a[232:235], v[96:99], v[160:163]
    buffer_load_dwordx4 v[92:95], v79, s[64:67], s38 offen offset:2304 sc1
    v_mfma_f32_16x16x32_bf16 v[164:167], a[236:239], v[96:99], v[164:167]
    v_fma_f32 v251, v251, v21, v21
    v_rcp_f32 v250, v250
    v_mfma_f32_16x16x32_bf16 v[168:171], a[232:235], v[100:103], v[168:171]
    ds_read_b128 a[224:227], v2 offset:28672
    ds_read_b128 a[228:231], v3 offset:28672
    v_mul_f32 v253, v253, v249
    v_mfma_f32_16x16x32_bf16 v[172:175], a[236:239], v[100:103], v[172:175]
    v_mul_f32 v254, v254, v250
    s_waitcnt lgkmcnt(2)
    v_mfma_f32_16x16x32_bf16 v[176:179], a[240:243], v[96:99], v[176:179]
    v_rcp_f32 v251, v251
    v_cvt_pk_bf16_f32 v242, v252, v253
    v_mfma_f32_16x16x32_bf16 v[180:183], a[244:247], v[96:99], v[180:183]
    v_mul_f32 v255, v255, v251
    v_cvt_pk_bf16_f32 v243, v254, v255
    v_mfma_f32_16x16x32_bf16 v[184:187], a[240:243], v[100:103], v[184:187]
    ds_read_b128 a[232:235], v2 offset:29696
    ds_read_b128 a[236:239], v3 offset:29696
    v_permlane16_swap_b32 v240, v242
    v_mfma_f32_16x16x32_bf16 v[188:191], a[244:247], v[100:103], v[188:191]
    v_permlane16_swap_b32 v241, v243
    buffer_store_dwordx4 v[240:243], v2, s[64:67], s98 offen sc1
    v_mfma_f32_16x16x32_bf16 v[192:195], a[248:251], v[96:99], v[192:195]
    v_min3_i32 v72, v65, v67, v69
    v_mfma_f32_16x16x32_bf16 v[196:199], a[252:255], v[96:99], v[196:199]
    v_min_i32 v72, v72, v71
    v_cmp_gt_i32 vcc, 0, v72
    s_cbranch_vccnz L_ts_139
L_tb_140:
    v_mfma_f32_16x16x32_bf16 v[200:203], a[248:251], v[100:103], v[200:203]
    ds_read_b128 a[240:243], v2 offset:30720
    ds_read_b128 a[244:247], v3 offset:30720
    v_mfma_f32_16x16x32_bf16 v[204:207], a[252:255], v[100:103], v[204:207]
    v_add_f32 v64, v64, v66
    v_add_f32 v68, v68, v70
    s_waitcnt vmcnt(14) lgkmcnt(2)
    v_mfma_f32_16x16x32_bf16 v[144:147], a[224:227], v[104:107], v[144:147]
    buffer_load_dwordx4 v[96:99], v79, s[64:67], s39 offen offset:0 sc1
    v_mfma_f32_16x16x32_bf16 v[148:151], a[228:231], v[104:107], v[148:151]
    v_add_f32 v65, v65, v67
    v_add_f32 v69, v69, v71
    v_permlane32_swap_b32 v64, v68
    v_mfma_f32_16x16x32_bf16 v[152:155], a[224:227], v[108:111], v[152:155]
    ds_read_b128 a[248:251], v2 offset:31744
    ds_read_b128 a[252:255], v3 offset:31744
    v_mfma_f32_16x16x32_bf16 v[156:159], a[228:231], v[108:111], v[156:159]
    v_add_f32 v64, v64, v68
    v_permlane32_swap_b32 v65, v69
    v_add_f32 v65, v65, v69
    v_mfma_f32_16x16x32_bf16 v[160:163], a[232:235], v[104:107], v[160:163]
    buffer_load_dwordx4 v[100:103], v79, s[64:67], s39 offen offset:256 sc1
    v_mfma_f32_16x16x32_bf16 v[164:167], a[236:239], v[104:107], v[164:167]
    v_permlane16_swap_b32 v64, v65
    v_add_f32 v64, v64, v65
    v_mul_f32 v64, 0x3b000000, v64
    v_mfma_f32_16x16x32_bf16 v[168:171], a[232:235], v[108:111], v[168:171]
    ds_read_b128 a[224:227], v2 offset:32768
    ds_read_b128 a[228:231], v3 offset:32768
    v_mfma_f32_16x16x32_bf16 v[172:175], a[236:239], v[108:111], v[172:175]
    v_mov_b32 v65, v64
    s_nop 1
    v_permlane16_swap_b32 v64, v65
    s_waitcnt lgkmcnt(2)
    v_mfma_f32_16x16x32_bf16 v[176:179], a[240:243], v[104:107], v[176:179]
    v_fma_f32 v65, -v64, v64, v65
    v_cvt_pk_bf16_f32 v37, v64, 0
    v_mfma_f32_16x16x32_bf16 v[180:183], a[244:247], v[104:107], v[180:183]
    v_max_f32 v65, 0, v65
    v_lshlrev_b32 v67, 16, v37
    v_add_f32 v57, 0x3727c5ac, v65
    v_mfma_f32_16x16x32_bf16 v[184:187], a[240:243], v[108:111], v[184:187]
    ds_read_b128 a[232:235], v2 offset:33792
    ds_read_b128 a[236:239], v3 offset:33792
    v_mfma_f32_16x16x32_bf16 v[188:191], a[244:247], v[108:111], v[188:191]
    v_sub_f32 v67, v64, v67
    v_rsq_f32 v56, v57
    v_mfma_f32_16x16x32_bf16 v[192:195], a[248:251], v[104:107], v[192:195]
    v_cvt_pk_bf16_f32 v36, v64, v67
    v_mul_f32 v56, 0xbfb8aa3b, v56
    v_mfma_f32_16x16x32_bf16 v[196:199], a[252:255], v[104:107], v[196:199]
    v_mov_b32 v59, v57
    v_mov_b32 v39, v37
    v_mov_b32 v38, v36
    v_mfma_f32_16x16x32_bf16 v[200:203], a[248:251], v[108:111], v[200:203]
    ds_read_b128 a[240:243], v2 offset:34816
    ds_read_b128 a[244:247], v3 offset:34816
    v_mfma_f32_16x16x32_bf16 v[204:207], a[252:255], v[108:111], v[204:207]
    v_mov_b32 v58, v56
    v_permlane32_swap_b32 v57, v59
    s_waitcnt vmcnt(14) lgkmcnt(2)
    v_mfma_f32_16x16x32_bf16 v[144:147], a[224:227], v[112:115], v[144:147]
    buffer_load_dwordx4 v[104:107], v79, s[64:67], s39 offen offset:2048 sc1
    v_mfma_f32_16x16x32_bf16 v[148:151], a[228:231], v[112:115], v[148:151]
    v_permlane32_swap_b32 v37, v39
    v_permlane32_swap_b32 v36, v38
    v_permlane32_swap_b32 v56, v58
    v_mfma_f32_16x16x32_bf16 v[152:155], a[224:227], v[116:119], v[152:155]
    ds_read_b128 a[248:251], v2 offset:35840
    ds_read_b128 a[252:255], v3 offset:35840
    v_mfma_f32_16x16x32_bf16 v[156:159], a[228:231], v[116:119], v[156:159]
    s_lshl_b64 s[40:41], s[44:45], 0
    v_cndmask_b32 v24, 0, v36, s[40:41]
    v_cndmask_b32 v25, 0, v37, s[40:41]
    v_mfma_f32_16x16x32_bf16 v[160:163], a[232:235], v[112:115], v[160:163]
    buffer_load_dwordx4 v[108:111], v79, s[64:67], s39 offen offset:2304 sc1
    v_mfma_f32_16x16x32_bf16 v[164:167], a[236:239], v[112:115], v[164:167]
    v_cndmask_b32 v26, 0, v38, s[40:41]
    v_cndmask_b32 v27, 0, v39, s[40:41]
    v_mfma_f32_16x16x32_bf16 v[168:171], a[232:235], v[116:119], v[168:171]
    ds_read_b128 a[224:227], v2 offset:36864
    ds_read_b128 a[228:231], v3 offset:36864
    v_mfma_f32_16x16x32_bf16 v[172:175], a[236:239], v[116:119], v[172:175]
    s_waitcnt lgkmcnt(2)
    v_mfma_f32_16x16x32_bf16 v[176:179], a[240:243], v[112:115], v[176:179]
    v_mfma_f32_16x16x32_bf16 v[180:183], a[244:247], v[112:115], v[180:183]
    v_mfma_f32_16x16x32_bf16 v[184:187], a[240:243], v[116:119], v[184:187]
    ds_read_b128 a[232:235], v2 offset:37888
    ds_read_b128 a[236:239], v3 offset:37888
    v_mfma_f32_16x16x32_bf16 v[188:191], a[244:247], v[116:119], v[188:191]
    v_mfma_f32_16x16x32_bf16 v[192:195], a[248:251], v[112:115], v[192:195]
    v_mfma_f32_16x16x32_bf16 v[196:199], a[252:255], v[112:115], v[196:199]
    v_mfma_f32_16x16x32_bf16 v[200:203], a[248:251], v[116:119], v[200:203]
    ds_read_b128 a[240:243], v2 offset:38912
    ds_read_b128 a[244:247], v3 offset:38912
    v_mfma_f32_16x16x32_bf16 v[204:207], a[252:255], v[116:119], v[204:207]
    s_waitcnt vmcnt(4)
    s_cmp_eq_u32 s16, 0
    s_cbranch_scc1 L_ps_141
    buffer_store_dword v23, off, s[64:67], s26 offset:2048
L_pb_142:
    s_waitcnt lgkmcnt(2)
    v_mfma_f32_16x16x32_bf16 v[144:147], a[224:227], v[120:123], v[144:147]
    v_mfma_f32_16x16x32_bf16 v[148:151], a[228:231], v[120:123], v[148:151]
    v_mfma_f32_16x16x32_bf16 v[152:155], a[224:227], v[124:127], v[152:155]
    ds_read_b128 a[248:251], v2 offset:39936
    ds_read_b128 a[252:255], v3 offset:39936
    v_mfma_f32_16x16x32_bf16 v[156:159], a[228:231], v[124:127], v[156:159]
    v_mfma_f32_16x16x32_bf16 v[160:163], a[232:235], v[120:123], v[160:163]
    v_mfma_f32_16x16x32_bf16 v[164:167], a[236:239], v[120:123], v[164:167]
    v_mfma_f32_16x16x32_bf16 v[168:171], a[232:235], v[124:127], v[168:171]
    ds_read_b128 a[224:227], v2 offset:40960
    ds_read_b128 a[228:231], v3 offset:40960
    v_mfma_f32_16x16x32_bf16 v[172:175], a[236:239], v[124:127], v[172:175]
    s_waitcnt lgkmcnt(2)
    v_mfma_f32_16x16x32_bf16 v[176:179], a[240:243], v[120:123], v[176:179]
    v_mfma_f32_16x16x32_bf16 v[180:183], a[244:247], v[120:123], v[180:183]
    v_mfma_f32_16x16x32_bf16 v[184:187], a[240:243], v[124:127], v[184:187]
    ds_read_b128 a[232:235], v2 offset:41984
    ds_read_b128 a[236:239], v3 offset:41984
    v_mfma_f32_16x16x32_bf16 v[188:191], a[244:247], v[124:127], v[188:191]
    v_mfma_f32_16x16x32_bf16 v[192:195], a[248:251], v[120:123], v[192:195]
    v_mfma_f32_16x16x32_bf16 v[196:199], a[252:255], v[120:123], v[196:199]
    v_mfma_f32_16x16x32_bf16 v[200:203], a[248:251], v[124:127], v[200:203]
    ds_read_b128 a[240:243], v2 offset:43008
    ds_read_b128 a[244:247], v3 offset:43008
    v_mfma_f32_16x16x32_bf16 v[204:207], a[252:255], v[124:127], v[204:207]
    s_waitcnt lgkmcnt(2)
    v_mfma_f32_16x16x32_bf16 v[144:147], a[224:227], v[128:131], v[144:147]
    v_mfma_f32_16x16x32_bf16 v[148:151], a[228:231], v[128:131], v[148:151]
    v_mfma_f32_16x16x32_bf16 v[152:155], a[224:227], v[132:135], v[152:155]
    ds_read_b128 a[248:251], v2 offset:44032
    ds_read_b128 a[252:255], v3 offset:44032
    v_mfma_f32_16x16x32_bf16 v[156:159], a[228:231], v[132:135], v[156:159]
    v_mfma_f32_16x16x32_bf16 v[160:163], a[232:235], v[128:131], v[160:163]
    v_mfma_f32_16x16x32_bf16 v[164:167], a[236:239], v[128:131], v[164:167]
    v_mfma_f32_16x16x32_bf16 v[168:171], a[232:235], v[132:135], v[168:171]
    ds_read_b128 a[224:227], v2 offset:45056
    ds_read_b128 a[228:231], v3 offset:45056
    v_mfma_f32_16x16x32_bf16 v[172:175], a[236:239], v[132:135], v[172:175]
    s_waitcnt lgkmcnt(2)
    v_mfma_f32_16x16x32_bf16 v[176:179], a[240:243], v[128:131], v[176:179]
    v_mfma_f32_16x16x32_bf16 v[180:183], a[244:247], v[128:131], v[180:183]
    v_mfma_f32_16x16x32_bf16 v[184:187], a[240:243], v[132:135], v[184:187]
    ds_read_b128 a[232:235], v2 offset:49152
    ds_read_b128 a[236:239], v3 offset:49152
    v_mfma_f32_16x16x32_bf16 v[188:191], a[244:247], v[132:135], v[188:191]
    v_mfma_f32_16x16x32_bf16 v[192:195], a[248:251], v[128:131], v[192:195]
    v_mfma_f32_16x16x32_bf16 v[196:199], a[252:255], v[128:131], v[196:199]
    v_mfma_f32_16x16x32_bf16 v[200:203], a[248:251], v[132:135], v[200:203]
    ds_read_b128 a[240:243], v2 offset:53248
    ds_read_b128 a[244:247], v3 offset:53248
    v_mfma_f32_16x16x32_bf16 v[204:207], a[252:255], v[132:135], v[204:207]
    s_waitcnt lgkmcnt(2)
    v_mfma_f32_16x16x32_bf16 v[144:147], a[224:227], v[136:139], v[144:147]
    v_mfma_f32_16x16x32_bf16 v[148:151], a[228:231], v[136:139], v[148:151]
    v_mfma_f32_16x16x32_bf16 v[152:155], a[224:227], v[140:143], v[152:155]
    ds_read_b128 a[248:251], v2 offset:57344
    ds_read_b128 a[252:255], v3 offset:57344
    v_mfma_f32_16x16x32_bf16 v[156:159], a[228:231], v[140:143], v[156:159]
    v_mfma_f32_16x16x32_bf16 v[144:147], a[232:235], v[80:83], v[144:147]
    v_mfma_f32_16x16x32_bf16 v[148:151], a[236:239], v[80:83], v[148:151]
    v_mfma_f32_16x16x32_bf16 v[152:155], a[232:235], v[84:87], v[152:155]
    ds_read_b128 a[224:227], v2 offset:61440
    ds_read_b128 a[228:231], v3 offset:61440
    v_mfma_f32_16x16x32_bf16 v[156:159], a[236:239], v[84:87], v[156:159]
    s_waitcnt lgkmcnt(2)
    v_mfma_f32_16x16x32_bf16 v[144:147], a[240:243], v[88:91], v[144:147]
    v_mfma_f32_16x16x32_bf16 v[148:151], a[244:247], v[88:91], v[148:151]
    v_mfma_f32_16x16x32_bf16 v[152:155], a[240:243], v[92:95], v[152:155]
    ds_read_b128 a[232:235], v2 offset:46080
    ds_read_b128 a[236:239], v3 offset:46080
    v_mfma_f32_16x16x32_bf16 v[156:159], a[244:247], v[92:95], v[156:159]
    s_waitcnt vmcnt(3)
    v_mfma_f32_16x16x32_bf16 v[144:147], a[248:251], v[96:99], v[144:147]
    v_mfma_f32_16x16x32_bf16 v[148:151], a[252:255], v[96:99], v[148:151]
    v_mfma_f32_16x16x32_bf16 v[152:155], a[248:251], v[100:103], v[152:155]
    ds_read_b128 a[240:243], v2 offset:50176
    ds_read_b128 a[244:247], v3 offset:50176
    v_mfma_f32_16x16x32_bf16 v[156:159], a[252:255], v[100:103], v[156:159]
    s_waitcnt vmcnt(1) lgkmcnt(2)
    v_mfma_f32_16x16x32_bf16 v[144:147], a[224:227], v[104:107], v[144:147]
    v_mfma_f32_16x16x32_bf16 v[148:151], a[228:231], v[104:107], v[148:151]
    v_mfma_f32_16x16x32_bf16 v[152:155], a[224:227], v[108:111], v[152:155]
    ds_read_b128 a[248:251], v2 offset:54272
    ds_read_b128 a[252:255], v3 offset:54272
    v_mfma_f32_16x16x32_bf16 v[156:159], a[228:231], v[108:111], v[156:159]
    v_mfma_f32_16x16x32_bf16 v[144:147], v[28:31], v[24:27], v[144:147]
    v_mfma_f32_16x16x32_bf16 v[148:151], v[32:35], v[24:27], v[148:151]
    v_mfma_f32_16x16x32_bf16 v[152:155], v[28:31], v[26:29], v[152:155]
    v_mfma_f32_16x16x32_bf16 v[156:159], v[32:35], v[26:29], v[156:159]
    v_mfma_f32_16x16x32_bf16 v[160:163], a[232:235], v[136:139], v[160:163]
    v_mfma_f32_16x16x32_bf16 v[164:167], a[236:239], v[136:139], v[164:167]
    s_lshl_b64 s[40:41], s[44:45], 16
    v_cndmask_b32 v24, 0, v36, s[40:41]
    v_mfma_f32_16x16x32_bf16 v[168:171], a[232:235], v[140:143], v[168:171]
    ds_read_b128 a[224:227], v2 offset:58368
    ds_read_b128 a[228:231], v3 offset:58368
    v_mfma_f32_16x16x32_bf16 v[172:175], a[236:239], v[140:143], v[172:175]
    v_cndmask_b32 v25, 0, v37, s[40:41]
    s_waitcnt lgkmcnt(2)
    v_mfma_f32_16x16x32_bf16 v[160:163], a[240:243], v[80:83], v[160:163]
    v_cndmask_b32 v26, 0, v38, s[40:41]
    v_cndmask_b32 v27, 0, v39, s[40:41]
    v_mfma_f32_16x16x32_bf16 v[164:167], a[244:247], v[80:83], v[164:167]
    v_mfma_f32_16x16x32_bf16 v[168:171], a[240:243], v[84:87], v[168:171]
    ds_read_b128 a[232:235], v2 offset:62464
    ds_read_b128 a[236:239], v3 offset:62464
    v_mfma_f32_16x16x32_bf16 v[172:175], a[244:247], v[84:87], v[172:175]
    s_add_u32 s96, s10, 0x71d000
    v_mul_f32 v148, v144, v148
    v_mfma_f32_16x16x32_bf16 v[160:163], a[248:251], v[88:91], v[160:163]
    v_mul_f32 v144, v56, v144
    v_mul_f32 v149, v145, v149
    v_mfma_f32_16x16x32_bf16 v[164:167], a[252:255], v[88:91], v[164:167]
    buffer_load_dword v16, v5, s[64:67], s27 offen offset:2048 sc1
    v_mul_f32 v145, v56, v145
    v_mul_f32 v150, v146, v150
    v_mfma_f32_16x16x32_bf16 v[168:171], a[248:251], v[92:95], v[168:171]
    ds_read_b128 a[240:243], v2 offset:47104
    ds_read_b128 a[244:247], v3 offset:47104
    v_mfma_f32_16x16x32_bf16 v[172:175], a[252:255], v[92:95], v[172:175]
    v_mul_f32 v146, v56, v146
    s_waitcnt lgkmcnt(2)
    v_mfma_f32_16x16x32_bf16 v[160:163], a[224:227], v[96:99], v[160:163]
    v_exp_f32 v144, v144
    v_mfma_f32_16x16x32_bf16 v[164:167], a[228:231], v[96:99], v[164:167]
    v_exp_f32 v145, v145
    v_mfma_f32_16x16x32_bf16 v[168:171], a[224:227], v[100:103], v[168:171]
    ds_read_b128 a[248:251], v2 offset:51200
    ds_read_b128 a[252:255], v3 offset:51200
    v_mfma_f32_16x16x32_bf16 v[172:175], a[228:231], v[100:103], v[172:175]
    v_fma_f32 v144, v144, v57, v57
    v_mul_f32 v151, v147, v151
    v_mfma_f32_16x16x32_bf16 v[160:163], a[232:235], v[104:107], v[160:163]
    v_mul_f32 v147, v56, v147
    v_fma_f32 v145, v145, v57, v57
    v_mfma_f32_16x16x32_bf16 v[164:167], a[236:239], v[104:107], v[164:167]
    v_exp_f32 v146, v146
    v_mfma_f32_16x16x32_bf16 v[168:171], a[232:235], v[108:111], v[168:171]
    ds_read_b128 a[224:227], v2 offset:55296
    ds_read_b128 a[228:231], v3 offset:55296
    v_mfma_f32_16x16x32_bf16 v[172:175], a[236:239], v[108:111], v[172:175]
    v_mul_f32 v156, v152, v156
    v_mfma_f32_16x16x32_bf16 v[160:163], v[28:31], v[24:27], v[160:163]
    v_rcp_f32 v144, v144
    v_mfma_f32_16x16x32_bf16 v[164:167], v[32:35], v[24:27], v[164:167]
    v_mul_f32 v152, v58, v152
    v_fma_f32 v146, v146, v57, v57
    v_mfma_f32_16x16x32_bf16 v[168:171], v[28:31], v[26:29], v[168:171]
    v_exp_f32 v147, v147
    v_mfma_f32_16x16x32_bf16 v[172:175], v[32:35], v[26:29], v[172:175]
    v_rcp_f32 v145, v145
    s_waitcnt lgkmcnt(2)
    v_mfma_f32_16x16x32_bf16 v[176:179], a[240:243], v[136:139], v[176:179]
    v_mul_f32 v148, v148, v144
    v_mul_f32 v157, v153, v157
    v_mfma_f32_16x16x32_bf16 v[180:183], a[244:247], v[136:139], v[180:183]
    s_lshl_b64 s[40:41], s[44:45], 32
    v_cndmask_b32 v24, 0, v36, s[40:41]
    v_mfma_f32_16x16x32_bf16 v[184:187], a[240:243], v[140:143], v[184:187]
    ds_read_b128 a[232:235], v2 offset:59392
    ds_read_b128 a[236:239], v3 offset:59392
    v_mfma_f32_16x16x32_bf16 v[188:191], a[244:247], v[140:143], v[188:191]
    v_cndmask_b32 v25, 0, v37, s[40:41]
    v_cndmask_b32 v26, 0, v38, s[40:41]
    v_mfma_f32_16x16x32_bf16 v[176:179], a[248:251], v[80:83], v[176:179]
    v_cndmask_b32 v27, 0, v39, s[40:41]
    v_mul_f32 v153, v58, v153
    v_mfma_f32_16x16x32_bf16 v[180:183], a[252:255], v[80:83], v[180:183]
    s_waitcnt vmcnt(0)
    v_cmp_eq_u32 vcc, 0, v16
    s_cbranch_vccnz L_fs_143
L_fb_144:
    s_add_u32 s80, s11, 0x700000
    v_add_u32 v78, s80, v0
    buffer_load_dwordx4 v[112:115], v78, s[64:67], s68 offen offset:0 sc1
    v_mfma_f32_16x16x32_bf16 v[184:187], a[248:251], v[84:87], v[184:187]
    ds_read_b128 a[240:243], v2 offset:63488
    ds_read_b128 a[244:247], v3 offset:63488
    v_mfma_f32_16x16x32_bf16 v[188:191], a[252:255], v[84:87], v[188:191]
    v_fma_f32 v147, v147, v57, v57
    s_waitcnt lgkmcnt(2)
    v_mfma_f32_16x16x32_bf16 v[176:179], a[224:227], v[88:91], v[176:179]
    v_exp_f32 v152, v152
    v_mfma_f32_16x16x32_bf16 v[180:183], a[228:231], v[88:91], v[180:183]
    buffer_load_dwordx4 v[116:119], v78, s[64:67], s68 offen offset:256 sc1
    v_mfma_f32_16x16x32_bf16 v[184:187], a[224:227], v[92:95], v[184:187]
    ds_read_b128 a[248:251], v2 offset:48128
    ds_read_b128 a[252:255], v3 offset:48128
    v_mfma_f32_16x16x32_bf16 v[188:191], a[228:231], v[92:95], v[188:191]
    v_rcp_f32 v146, v146
    v_mfma_f32_16x16x32_bf16 v[176:179], a[232:235], v[96:99], v[176:179]
    v_mul_f32 v149, v149, v145
    v_mul_f32 v158, v154, v158
    v_mfma_f32_16x16x32_bf16 v[180:183], a[236:239], v[96:99], v[180:183]
    buffer_load_dwordx4 v[120:123], v78, s[64:67], s68 offen offset:2048 sc1
    v_mfma_f32_16x16x32_bf16 v[184:187], a[232:235], v[100:103], v[184:187]
    ds_read_b128 a[224:227], v2 offset:52224
    ds_read_b128 a[228:231], v3 offset:52224
    v_mfma_f32_16x16x32_bf16 v[188:191], a[236:239], v[100:103], v[188:191]
    v_mul_f32 v154, v58, v154
    s_waitcnt lgkmcnt(2)
    v_mfma_f32_16x16x32_bf16 v[176:179], a[240:243], v[104:107], v[176:179]
    v_exp_f32 v153, v153
    v_mfma_f32_16x16x32_bf16 v[180:183], a[244:247], v[104:107], v[180:183]
    buffer_load_dwordx4 v[124:127], v78, s[64:67], s68 offen offset:2304 sc1
    v_mfma_f32_16x16x32_bf16 v[184:187], a[240:243], v[108:111], v[184:187]
    ds_read_b128 a[232:235], v2 offset:56320
    ds_read_b128 a[236:239], v3 offset:56320
    v_mfma_f32_16x16x32_bf16 v[188:191], a[244:247], v[108:111], v[188:191]
    v_fma_f32 v152, v152, v59, v59
    v_mul_f32 v150, v150, v146
    v_mfma_f32_16x16x32_bf16 v[176:179], v[28:31], v[24:27], v[176:179]
    v_rcp_f32 v147, v147
    v_mfma_f32_16x16x32_bf16 v[180:183], v[32:35], v[24:27], v[180:183]
    buffer_load_dwordx4 v[128:131], v78, s[64:67], s69 offen offset:0 sc1
    v_mfma_f32_16x16x32_bf16 v[184:187], v[28:31], v[26:29], v[184:187]
    v_cvt_pk_bf16_f32 v144, v148, v149
    v_mul_f32 v159, v155, v159
    v_mfma_f32_16x16x32_bf16 v[188:191], v[32:35], v[26:29], v[188:191]
    v_mul_f32 v155, v58, v155
    v_fma_f32 v153, v153, v59, v59
    v_mfma_f32_16x16x32_bf16 v[192:195], a[248:251], v[136:139], v[192:195]
    v_exp_f32 v154, v154
    v_mfma_f32_16x16x32_bf16 v[196:199], a[252:255], v[136:139], v[196:199]
    buffer_load_dwordx4 v[132:135], v78, s[64:67], s69 offen offset:256 sc1
    v_mfma_f32_16x16x32_bf16 v[200:203], a[248:251], v[140:143], v[200:203]
    ds_read_b128 a[240:243], v2 offset:60416
    ds_read_b128 a[244:247], v3 offset:60416
    v_mfma_f32_16x16x32_bf16 v[204:207], a[252:255], v[140:143], v[204:207]
    s_lshl_b64 s[40:41], s[44:45], 48
    s_waitcnt lgkmcnt(2)
    v_mfma_f32_16x16x32_bf16 v[192:195], a[224:227], v[80:83], v[192:195]
    v_cndmask_b32 v24, 0, v36, s[40:41]
    v_cndmask_b32 v25, 0, v37, s[40:41]
    v_mfma_f32_16x16x32_bf16 v[196:199], a[228:231], v[80:83], v[196:199]
    buffer_load_dwordx4 v[136:139], v78, s[64:67], s69 offen offset:2048 sc1
    v_mfma_f32_16x16x32_bf16 v[200:203], a[224:227], v[84:87], v[200:203]
    ds_read_b128 a[248:251], v2 offset:64512
    ds_read_b128 a[252:255], v3 offset:64512
    v_mfma_f32_16x16x32_bf16 v[204:207], a[228:231], v[84:87], v[204:207]
    v_cndmask_b32 v26, 0, v38, s[40:41]
    v_cndmask_b32 v27, 0, v39, s[40:41]
    v_mfma_f32_16x16x32_bf16 v[192:195], a[232:235], v[88:91], v[192:195]
    v_rcp_f32 v152, v152
    v_mfma_f32_16x16x32_bf16 v[196:199], a[236:239], v[88:91], v[196:199]
    buffer_load_dwordx4 v[140:143], v78, s[64:67], s69 offen offset:2304 sc1
    v_mfma_f32_16x16x32_bf16 v[200:203], a[232:235], v[92:95], v[200:203]
    v_mul_f32 v151, v151, v147
    v_fma_f32 v154, v154, v59, v59
    v_mfma_f32_16x16x32_bf16 v[204:207], a[236:239], v[92:95], v[204:207]
    s_waitcnt lgkmcnt(0)
    v_mfma_f32_16x16x32_bf16 v[192:195], a[240:243], v[96:99], v[192:195]
    v_exp_f32 v155, v155
    v_mfma_f32_16x16x32_bf16 v[196:199], a[244:247], v[96:99], v[196:199]
    buffer_load_dwordx4 v[80:83], v78, s[64:67], s70 offen offset:0 sc1
    v_mfma_f32_16x16x32_bf16 v[200:203], a[240:243], v[100:103], v[200:203]
    v_rcp_f32 v153, v153
    v_mfma_f32_16x16x32_bf16 v[204:207], a[244:247], v[100:103], v[204:207]
    v_mul_f32 v156, v156, v152
    v_cvt_pk_bf16_f32 v145, v150, v151
    v_mfma_f32_16x16x32_bf16 v[192:195], a[248:251], v[104:107], v[192:195]
    v_fma_f32 v155, v155, v59, v59
    v_mul_f32 v157, v157, v153
    v_mfma_f32_16x16x32_bf16 v[196:199], a[252:255], v[104:107], v[196:199]
    buffer_load_dwordx4 v[84:87], v78, s[64:67], s70 offen offset:256 sc1
    v_mfma_f32_16x16x32_bf16 v[200:203], a[248:251], v[108:111], v[200:203]
    v_rcp_f32 v154, v154
    v_mfma_f32_16x16x32_bf16 v[204:207], a[252:255], v[108:111], v[204:207]
    v_mul_f32 v158, v158, v154
    v_mfma_f32_16x16x32_bf16 v[192:195], v[28:31], v[24:27], v[192:195]
    v_rcp_f32 v155, v155
    v_mfma_f32_16x16x32_bf16 v[196:199], v[32:35], v[24:27], v[196:199]
    buffer_load_dwordx4 v[88:91], v78, s[64:67], s70 offen offset:2048 sc1
    v_mfma_f32_16x16x32_bf16 v[200:203], v[28:31], v[26:29], v[200:203]
    v_cvt_pk_bf16_f32 v146, v156, v157
    v_mul_f32 v159, v159, v155
    v_mfma_f32_16x16x32_bf16 v[204:207], v[32:35], v[26:29], v[204:207]
    v_cvt_pk_bf16_f32 v147, v158, v159
    v_permlane16_swap_b32 v144, v146
    s_nop 0
    v_permlane16_swap_b32 v145, v147
    buffer_store_dwordx4 v[144:147], v2, s[64:67], s96 offen sc1
    s_add_u32 s97, s10, 0x71d400
    v_pk_mul_f32 v[164:165], v[160:161], v[164:165]
    v_pk_mul_f32 v[160:161], v[160:161], v[56:57] op_sel_hi:[1,0]
    v_pk_mul_f32 v[166:167], v[162:163], v[166:167]
    v_pk_mul_f32 v[162:163], v[162:163], v[56:57] op_sel_hi:[1,0]
    v_pk_mul_f32 v[172:173], v[168:169], v[172:173]
    v_pk_mul_f32 v[168:169], v[168:169], v[58:59] op_sel_hi:[1,0]
    v_pk_mul_f32 v[174:175], v[170:171], v[174:175]
    v_pk_mul_f32 v[170:171], v[170:171], v[58:59] op_sel_hi:[1,0]
    buffer_load_dwordx4 v[92:95], v78, s[64:67], s70 offen offset:2304 sc1
    v_exp_f32 v160, v160
    v_exp_f32 v161, v161
    v_exp_f32 v162, v162
    v_exp_f32 v163, v163
    v_exp_f32 v168, v168
    v_exp_f32 v169, v169
    buffer_load_dwordx4 v[96:99], v78, s[64:67], s71 offen offset:0 sc1
    v_exp_f32 v170, v170
    v_exp_f32 v171, v171
    v_pk_fma_f32 v[160:161], v[160:161], v[56:57], v[56:57] op_sel:[0,1,1] op_sel_hi:[1,1,1]
    v_pk_fma_f32 v[162:163], v[162:163], v[56:57], v[56:57] op_sel:[0,1,1] op_sel_hi:[1,1,1]
    v_pk_fma_f32 v[168:169], v[168:169], v[58:59], v[58:59] op_sel:[0,1,1] op_sel_hi:[1,1,1]
    v_pk_fma_f32 v[170:171], v[170:171], v[58:59], v[58:59] op_sel:[0,1,1] op_sel_hi:[1,1,1]
    v_rcp_f32 v160, v160
    v_rcp_f32 v161, v161
    v_rcp_f32 v162, v162
    v_rcp_f32 v163, v163
    buffer_load_dwordx4 v[100:103], v78, s[64:67], s71 offen offset:256 sc1
    v_rcp_f32 v168, v168
    v_rcp_f32 v169, v169
    v_rcp_f32 v170, v170
    v_rcp_f32 v171, v171
    v_pk_mul_f32 v[164:165], v[164:165], v[160:161]
    v_pk_mul_f32 v[166:167], v[166:167], v[162:163]
    v_pk_mul_f32 v[172:173], v[172:173], v[168:169]
    v_pk_mul_f32 v[174:175], v[174:175], v[170:171]
    v_cvt_pk_bf16_f32 v160, v164, v165
    v_cvt_pk_bf16_f32 v161, v166, v167
    v_cvt_pk_bf16_f32 v162, v172, v173
    v_cvt_pk_bf16_f32 v163, v174, v175
    s_nop 0
    v_permlane16_swap_b32 v160, v162
    v_permlane16_swap_b32 v161, v163
    buffer_store_dwordx4 v[160:163], v2, s[64:67], s97 offen sc1
    s_add_u32 s98, s10, 0x71d800
    v_pk_mul_f32 v[180:181], v[176:177], v[180:181]
    v_pk_mul_f32 v[176:177], v[176:177], v[56:57] op_sel_hi:[1,0]
    v_pk_mul_f32 v[182:183], v[178:179], v[182:183]
    v_pk_mul_f32 v[178:179], v[178:179], v[56:57] op_sel_hi:[1,0]
    v_pk_mul_f32 v[188:189], v[184:185], v[188:189]
    v_pk_mul_f32 v[184:185], v[184:185], v[58:59] op_sel_hi:[1,0]
    v_pk_mul_f32 v[190:191], v[186:187], v[190:191]
    v_pk_mul_f32 v[186:187], v[186:187], v[58:59] op_sel_hi:[1,0]
    buffer_load_dwordx4 v[104:107], v78, s[64:67], s71 offen offset:2048 sc1
    v_exp_f32 v176, v176
    v_exp_f32 v177, v177
    v_exp_f32 v178, v178
    v_exp_f32 v179, v179
    v_exp_f32 v184, v184
    v_exp_f32 v185, v185
    buffer_load_dwordx4 v[108:111], v78, s[64:67], s71 offen offset:2304 sc1
    v_exp_f32 v186, v186
    v_exp_f32 v187, v187
    v_pk_fma_f32 v[176:177], v[176:177], v[56:57], v[56:57] op_sel:[0,1,1] op_sel_hi:[1,1,1]
    v_pk_fma_f32 v[178:179], v[178:179], v[56:57], v[56:57] op_sel:[0,1,1] op_sel_hi:[1,1,1]
    v_pk_fma_f32 v[184:185], v[184:185], v[58:59], v[58:59] op_sel:[0,1,1] op_sel_hi:[1,1,1]
    v_pk_fma_f32 v[186:187], v[186:187], v[58:59], v[58:59] op_sel:[0,1,1] op_sel_hi:[1,1,1]
    v_rcp_f32 v176, v176
    v_rcp_f32 v177, v177
    v_rcp_f32 v178, v178
    v_rcp_f32 v179, v179
    v_rcp_f32 v184, v184
    v_rcp_f32 v185, v185
    v_rcp_f32 v186, v186
    v_rcp_f32 v187, v187
    v_pk_mul_f32 v[180:181], v[180:181], v[176:177]
    v_pk_mul_f32 v[182:183], v[182:183], v[178:179]
    v_pk_mul_f32 v[188:189], v[188:189], v[184:185]
    v_pk_mul_f32 v[190:191], v[190:191], v[186:187]
    v_cvt_pk_bf16_f32 v176, v180, v181
    v_cvt_pk_bf16_f32 v177, v182, v183
    v_cvt_pk_bf16_f32 v178, v188, v189
    v_cvt_pk_bf16_f32 v179, v190, v191
    s_nop 0
    v_permlane16_swap_b32 v176, v178
    v_permlane16_swap_b32 v177, v179
    buffer_store_dwordx4 v[176:179], v2, s[64:67], s98 offen sc1
    s_add_u32 s99, s10, 0x71cc00
    v_pk_mul_f32 v[196:197], v[192:193], v[196:197]
    v_pk_mul_f32 v[192:193], v[192:193], v[56:57] op_sel_hi:[1,0]
    v_pk_mul_f32 v[198:199], v[194:195], v[198:199]
    v_pk_mul_f32 v[194:195], v[194:195], v[56:57] op_sel_hi:[1,0]
    v_pk_mul_f32 v[204:205], v[200:201], v[204:205]
    v_pk_mul_f32 v[200:201], v[200:201], v[58:59] op_sel_hi:[1,0]
    v_pk_mul_f32 v[206:207], v[202:203], v[206:207]
    v_pk_mul_f32 v[202:203], v[202:203], v[58:59] op_sel_hi:[1,0]
    v_exp_f32 v192, v192
    v_exp_f32 v193, v193
    v_exp_f32 v194, v194
    v_exp_f32 v195, v195
    v_exp_f32 v200, v200
    v_exp_f32 v201, v201
    v_exp_f32 v202, v202
    v_exp_f32 v203, v203
    v_pk_fma_f32 v[192:193], v[192:193], v[56:57], v[56:57] op_sel:[0,1,1] op_sel_hi:[1,1,1]
    v_pk_fma_f32 v[194:195], v[194:195], v[56:57], v[56:57] op_sel:[0,1,1] op_sel_hi:[1,1,1]
    v_pk_fma_f32 v[200:201], v[200:201], v[58:59], v[58:59] op_sel:[0,1,1] op_sel_hi:[1,1,1]
    v_pk_fma_f32 v[202:203], v[202:203], v[58:59], v[58:59] op_sel:[0,1,1] op_sel_hi:[1,1,1]
    v_rcp_f32 v192, v192
    v_rcp_f32 v193, v193
    v_rcp_f32 v194, v194
    v_rcp_f32 v195, v195
    v_rcp_f32 v200, v200
    v_rcp_f32 v201, v201
    v_rcp_f32 v202, v202
    v_rcp_f32 v203, v203
    v_pk_mul_f32 v[196:197], v[196:197], v[192:193]
    v_pk_mul_f32 v[198:199], v[198:199], v[194:195]
    v_pk_mul_f32 v[204:205], v[204:205], v[200:201]
    v_pk_mul_f32 v[206:207], v[206:207], v[202:203]
    v_cvt_pk_bf16_f32 v192, v196, v197
    v_cvt_pk_bf16_f32 v193, v198, v199
    v_cvt_pk_bf16_f32 v194, v204, v205
    v_cvt_pk_bf16_f32 v195, v206, v207
    s_nop 0
    v_permlane16_swap_b32 v192, v194
    v_permlane16_swap_b32 v193, v195
    buffer_store_dwordx4 v[192:195], v2, s[64:67], s99 offen sc1
    s_waitcnt lgkmcnt(0)
    s_waitcnt vmcnt(19)
    v_mfma_f32_16x16x32_bf16 v[208:211], a[0:3], v[112:115], 0
    v_mfma_f32_16x16x32_bf16 v[212:215], a[4:7], v[112:115], 0
    v_mfma_f32_16x16x32_bf16 v[216:219], a[8:11], v[112:115], 0
    v_mfma_f32_16x16x32_bf16 v[220:223], a[12:15], v[112:115], 0
    s_waitcnt vmcnt(18)
    v_mfma_f32_16x16x32_bf16 v[224:227], a[0:3], v[116:119], 0
    buffer_load_dwordx4 v[112:115], v78, s[64:67], s72 offen offset:0 sc1
    v_mfma_f32_16x16x32_bf16 v[228:231], a[4:7], v[116:119], 0
    v_mfma_f32_16x16x32_bf16 v[232:235], a[8:11], v[116:119], 0
    v_mfma_f32_16x16x32_bf16 v[236:239], a[12:15], v[116:119], 0
    s_waitcnt vmcnt(18)
    v_mfma_f32_16x16x32_bf16 v[208:211], a[16:19], v[120:123], v[208:211]
    buffer_load_dwordx4 v[116:119], v78, s[64:67], s72 offen offset:256 sc1
    v_mfma_f32_16x16x32_bf16 v[212:215], a[20:23], v[120:123], v[212:215]
    v_mfma_f32_16x16x32_bf16 v[216:219], a[24:27], v[120:123], v[216:219]
    v_mfma_f32_16x16x32_bf16 v[220:223], a[28:31], v[120:123], v[220:223]
    s_waitcnt vmcnt(18)
    v_mfma_f32_16x16x32_bf16 v[224:227], a[16:19], v[124:127], v[224:227]
    buffer_load_dwordx4 v[120:123], v78, s[64:67], s72 offen offset:2048 sc1
    v_mfma_f32_16x16x32_bf16 v[228:231], a[20:23], v[124:127], v[228:231]
    v_mfma_f32_16x16x32_bf16 v[232:235], a[24:27], v[124:127], v[232:235]
    v_mfma_f32_16x16x32_bf16 v[236:239], a[28:31], v[124:127], v[236:239]
    s_waitcnt vmcnt(18)
    v_mfma_f32_16x16x32_bf16 v[208:211], a[32:35], v[128:131], v[208:211]
    buffer_load_dwordx4 v[124:127], v78, s[64:67], s72 offen offset:2304 sc1
    v_mfma_f32_16x16x32_bf16 v[212:215], a[36:39], v[128:131], v[212:215]
    v_mfma_f32_16x16x32_bf16 v[216:219], a[40:43], v[128:131], v[216:219]
    v_mfma_f32_16x16x32_bf16 v[220:223], a[44:47], v[128:131], v[220:223]
    s_waitcnt vmcnt(18)
    v_mfma_f32_16x16x32_bf16 v[224:227], a[32:35], v[132:135], v[224:227]
    buffer_load_dwordx4 v[128:131], v78, s[64:67], s73 offen offset:0 sc1
    v_mfma_f32_16x16x32_bf16 v[228:231], a[36:39], v[132:135], v[228:231]
    v_mfma_f32_16x16x32_bf16 v[232:235], a[40:43], v[132:135], v[232:235]
    v_mfma_f32_16x16x32_bf16 v[236:239], a[44:47], v[132:135], v[236:239]
    s_waitcnt vmcnt(18)
    v_mfma_f32_16x16x32_bf16 v[208:211], a[48:51], v[136:139], v[208:211]
    buffer_load_dwordx4 v[132:135], v78, s[64:67], s73 offen offset:256 sc1
    v_mfma_f32_16x16x32_bf16 v[212:215], a[52:55], v[136:139], v[212:215]
    v_mfma_f32_16x16x32_bf16 v[216:219], a[56:59], v[136:139], v[216:219]
    v_mfma_f32_16x16x32_bf16 v[220:223], a[60:63], v[136:139], v[220:223]
    s_waitcnt vmcnt(18)
    v_mfma_f32_16x16x32_bf16 v[224:227], a[48:51], v[140:143], v[224:227]
    buffer_load_dwordx4 v[136:139], v78, s[64:67], s73 offen offset:2048 sc1
    v_mfma_f32_16x16x32_bf16 v[228:231], a[52:55], v[140:143], v[228:231]
    v_mfma_f32_16x16x32_bf16 v[232:235], a[56:59], v[140:143], v[232:235]
    v_mfma_f32_16x16x32_bf16 v[236:239], a[60:63], v[140:143], v[236:239]
    s_waitcnt vmcnt(18)
    v_mfma_f32_16x16x32_bf16 v[208:211], a[64:67], v[80:83], v[208:211]
    buffer_load_dwordx4 v[140:143], v78, s[64:67], s73 offen offset:2304 sc1
    v_mfma_f32_16x16x32_bf16 v[212:215], a[68:71], v[80:83], v[212:215]
    v_mfma_f32_16x16x32_bf16 v[216:219], a[72:75], v[80:83], v[216:219]
    v_mfma_f32_16x16x32_bf16 v[220:223], a[76:79], v[80:83], v[220:223]
    s_waitcnt vmcnt(18)
    v_mfma_f32_16x16x32_bf16 v[224:227], a[64:67], v[84:87], v[224:227]
    buffer_load_dwordx4 v[80:83], v78, s[64:67], s74 offen offset:0 sc1
    v_mfma_f32_16x16x32_bf16 v[228:231], a[68:71], v[84:87], v[228:231]
    v_mfma_f32_16x16x32_bf16 v[232:235], a[72:75], v[84:87], v[232:235]
    v_mfma_f32_16x16x32_bf16 v[236:239], a[76:79], v[84:87], v[236:239]
    s_waitcnt vmcnt(18)
    v_mfma_f32_16x16x32_bf16 v[208:211], a[80:83], v[88:91], v[208:211]
    buffer_load_dwordx4 v[84:87], v78, s[64:67], s74 offen offset:256 sc1
    v_mfma_f32_16x16x32_bf16 v[212:215], a[84:87], v[88:91], v[212:215]
    v_mfma_f32_16x16x32_bf16 v[216:219], a[88:91], v[88:91], v[216:219]
    v_mfma_f32_16x16x32_bf16 v[220:223], a[92:95], v[88:91], v[220:223]
    s_waitcnt vmcnt(10)
    s_cmp_eq_u32 s16, 0
    s_cbranch_scc1 L_ps_145
    buffer_store_dword v23, off, s[64:67], s26 offset:2304
L_pb_146:
    s_add_u32 s80, s10, 0x71cc00
    v_lshlrev_b32 v16, 3, v2
    s_mov_b32 exec_hi, 0
    buffer_load_dword v16, v16, s[64:67], s80 offen sc1
    s_mov_b64 exec, -1
    v_mfma_f32_16x16x32_bf16 v[224:227], a[80:83], v[92:95], v[224:227]
    buffer_load_dwordx4 v[88:91], v78, s[64:67], s74 offen offset:2048 sc1
    v_mfma_f32_16x16x32_bf16 v[228:231], a[84:87], v[92:95], v[228:231]
    v_mfma_f32_16x16x32_bf16 v[232:235], a[88:91], v[92:95], v[232:235]
    v_mfma_f32_16x16x32_bf16 v[236:239], a[92:95], v[92:95], v[236:239]
    v_mfma_f32_16x16x32_bf16 v[208:211], a[96:99], v[96:99], v[208:211]
    buffer_load_dwordx4 v[92:95], v78, s[64:67], s74 offen offset:2304 sc1
    v_mfma_f32_16x16x32_bf16 v[212:215], a[100:103], v[96:99], v[212:215]
    v_mfma_f32_16x16x32_bf16 v[216:219], a[104:107], v[96:99], v[216:219]
    v_mfma_f32_16x16x32_bf16 v[220:223], a[108:111], v[96:99], v[220:223]
    v_mfma_f32_16x16x32_bf16 v[224:227], a[96:99], v[100:103], v[224:227]
    v_mfma_f32_16x16x32_bf16 v[228:231], a[100:103], v[100:103], v[228:231]
    v_mfma_f32_16x16x32_bf16 v[232:235], a[104:107], v[100:103], v[232:235]
    v_mfma_f32_16x16x32_bf16 v[236:239], a[108:111], v[100:103], v[236:239]
    v_mfma_f32_16x16x32_bf16 v[208:211], a[112:115], v[104:107], v[208:211]
    v_mfma_f32_16x16x32_bf16 v[212:215], a[116:119], v[104:107], v[212:215]
    v_mfma_f32_16x16x32_bf16 v[216:219], a[120:123], v[104:107], v[216:219]
    v_mfma_f32_16x16x32_bf16 v[220:223], a[124:127], v[104:107], v[220:223]
    v_mfma_f32_16x16x32_bf16 v[224:227], a[112:115], v[108:111], v[224:227]
    v_mfma_f32_16x16x32_bf16 v[228:231], a[116:119], v[108:111], v[228:231]
    v_mfma_f32_16x16x32_bf16 v[232:235], a[120:123], v[108:111], v[232:235]
    v_mfma_f32_16x16x32_bf16 v[236:239], a[124:127], v[108:111], v[236:239]
    s_waitcnt vmcnt(13)
    v_mfma_f32_16x16x32_bf16 v[208:211], a[128:131], v[112:115], v[208:211]
    v_mfma_f32_16x16x32_bf16 v[212:215], a[132:135], v[112:115], v[212:215]
    v_mfma_f32_16x16x32_bf16 v[216:219], a[136:139], v[112:115], v[216:219]
    v_mfma_f32_16x16x32_bf16 v[220:223], a[140:143], v[112:115], v[220:223]
    s_waitcnt vmcnt(12)
    v_mfma_f32_16x16x32_bf16 v[224:227], a[128:131], v[116:119], v[224:227]
    v_mfma_f32_16x16x32_bf16 v[228:231], a[132:135], v[116:119], v[228:231]
    v_mfma_f32_16x16x32_bf16 v[232:235], a[136:139], v[116:119], v[232:235]
    v_mfma_f32_16x16x32_bf16 v[236:239], a[140:143], v[116:119], v[236:239]
    s_waitcnt vmcnt(11)
    v_mfma_f32_16x16x32_bf16 v[208:211], a[144:147], v[120:123], v[208:211]
    v_mfma_f32_16x16x32_bf16 v[212:215], a[148:151], v[120:123], v[212:215]
    v_mfma_f32_16x16x32_bf16 v[216:219], a[152:155], v[120:123], v[216:219]
    v_mfma_f32_16x16x32_bf16 v[220:223], a[156:159], v[120:123], v[220:223]
    s_waitcnt vmcnt(10)
    v_mfma_f32_16x16x32_bf16 v[224:227], a[144:147], v[124:127], v[224:227]
    v_mfma_f32_16x16x32_bf16 v[228:231], a[148:151], v[124:127], v[228:231]
    v_mfma_f32_16x16x32_bf16 v[232:235], a[152:155], v[124:127], v[232:235]
    v_mfma_f32_16x16x32_bf16 v[236:239], a[156:159], v[124:127], v[236:239]
    s_waitcnt vmcnt(9)
    v_mfma_f32_16x16x32_bf16 v[208:211], a[160:163], v[128:131], v[208:211]
    v_mfma_f32_16x16x32_bf16 v[212:215], a[164:167], v[128:131], v[212:215]
    buffer_load_dword v16, v5, s[64:67], s27 offen offset:2304 sc1
    v_mfma_f32_16x16x32_bf16 v[216:219], a[168:171], v[128:131], v[216:219]
    v_mfma_f32_16x16x32_bf16 v[220:223], a[172:175], v[128:131], v[220:223]
    s_waitcnt vmcnt(9)
    v_mfma_f32_16x16x32_bf16 v[224:227], a[160:163], v[132:135], v[224:227]
    v_mfma_f32_16x16x32_bf16 v[228:231], a[164:167], v[132:135], v[228:231]
    v_mfma_f32_16x16x32_bf16 v[232:235], a[168:171], v[132:135], v[232:235]
    v_mfma_f32_16x16x32_bf16 v[236:239], a[172:175], v[132:135], v[236:239]
    s_waitcnt vmcnt(8)
    v_mfma_f32_16x16x32_bf16 v[208:211], a[176:179], v[136:139], v[208:211]
    v_mfma_f32_16x16x32_bf16 v[212:215], a[180:183], v[136:139], v[212:215]
    v_mfma_f32_16x16x32_bf16 v[216:219], a[184:187], v[136:139], v[216:219]
    v_mfma_f32_16x16x32_bf16 v[220:223], a[188:191], v[136:139], v[220:223]
    s_waitcnt vmcnt(7)
    v_mfma_f32_16x16x32_bf16 v[224:227], a[176:179], v[140:143], v[224:227]
    v_mfma_f32_16x16x32_bf16 v[228:231], a[180:183], v[140:143], v[228:231]
    v_mfma_f32_16x16x32_bf16 v[232:235], a[184:187], v[140:143], v[232:235]
    v_mfma_f32_16x16x32_bf16 v[236:239], a[188:191], v[140:143], v[236:239]
    s_waitcnt vmcnt(6)
    v_mfma_f32_16x16x32_bf16 v[208:211], a[192:195], v[80:83], v[208:211]
    v_mfma_f32_16x16x32_bf16 v[212:215], a[196:199], v[80:83], v[212:215]
    s_waitcnt vmcnt(0)
    v_cmp_eq_u32 vcc, 0, v16
    s_cbranch_vccnz L_fs_147
L_fb_148:
    s_add_u32 s80, s11, 0x71c000
    v_add_u32 v79, s80, v0
    v_mfma_f32_16x16x32_bf16 v[216:219], a[200:203], v[80:83], v[216:219]
    buffer_load_dwordx4 v[96:99], v79, s[64:67], s68 offen offset:0 sc1
    v_mfma_f32_16x16x32_bf16 v[220:223], a[204:207], v[80:83], v[220:223]
    v_mfma_f32_16x16x32_bf16 v[208:211], a[208:211], v[88:91], v[208:211]
    buffer_load_dwordx4 v[100:103], v79, s[64:67], s68 offen offset:256 sc1
    v_xor_b32 v73, 64, v8
    v_xor_b32 v74, 128, v8
    v_xor_b32 v75, 192, v8
    v_mfma_f32_16x16x32_bf16 v[212:215], a[212:215], v[88:91], v[212:215]
    v_mfma_f32_16x16x32_bf16 v[216:219], a[216:219], v[88:91], v[216:219]
    buffer_load_dwordx4 v[104:107], v79, s[64:67], s68 offen offset:2048 sc1
    v_mfma_f32_16x16x32_bf16 v[220:223], a[220:223], v[88:91], v[220:223]
    v_mfma_f32_16x16x32_bf16 v[224:227], a[192:195], v[84:87], v[224:227]
    buffer_load_dwordx4 v[108:111], v79, s[64:67], s68 offen offset:2304 sc1
    v_mfma_f32_16x16x32_bf16 v[228:231], a[196:199], v[84:87], v[228:231]
    v_mfma_f32_16x16x32_bf16 v[232:235], a[200:203], v[84:87], v[232:235]
    buffer_load_dwordx4 v[112:115], v79, s[64:67], s69 offen offset:0 sc1
    ds_write_b128 v8, v[208:211]
    v_mfma_f32_16x16x32_bf16 v[236:239], a[204:207], v[84:87], v[236:239]
    ds_write_b128 v73, v[212:215]
    v_mfma_f32_16x16x32_bf16 v[224:227], a[208:211], v[92:95], v[224:227]
    buffer_load_dwordx4 v[116:119], v79, s[64:67], s69 offen offset:256 sc1
    ds_write_b128 v74, v[216:219]
    v_mfma_f32_16x16x32_bf16 v[228:231], a[212:215], v[92:95], v[228:231]
    ds_write_b128 v75, v[220:223]
    v_mfma_f32_16x16x32_bf16 v[232:235], a[216:219], v[92:95], v[232:235]
    buffer_load_dwordx4 v[120:123], v79, s[64:67], s69 offen offset:2048 sc1
    v_mfma_f32_16x16x32_bf16 v[236:239], a[220:223], v[92:95], v[236:239]
    buffer_load_dwordx4 v[124:127], v79, s[64:67], s69 offen offset:2304 sc1
    buffer_load_dwordx4 v[128:131], v79, s[64:67], s70 offen offset:0 sc1
    ds_write_b128 v8, v[224:227] offset:4096
    s_nop 0
    ds_write_b128 v73, v[228:231] offset:4096
    s_nop 0
    ds_write_b128 v74, v[232:235] offset:4096
    s_nop 0
    ds_write_b128 v75, v[236:239] offset:4096
    buffer_load_dwordx4 v[132:135], v79, s[64:67], s70 offen offset:256 sc1
    buffer_load_dwordx4 v[136:139], v79, s[64:67], s70 offen offset:2048 sc1
    s_waitcnt lgkmcnt(0)
    s_barrier
    s_waitcnt vmcnt(10)
    v_mfma_f32_16x16x32_bf16 v[208:211], a[0:3], v[96:99], 0
    buffer_load_dwordx4 v[140:143], v79, s[64:67], s70 offen offset:2304 sc1
    v_mfma_f32_16x16x32_bf16 v[212:215], a[4:7], v[96:99], 0
    ds_read_b128 v[144:147], v9 offset:0
    ds_read_b128 v[148:151], v10 offset:0
    v_mfma_f32_16x16x32_bf16 v[216:219], a[8:11], v[96:99], 0
    buffer_load_dwordx4 v[80:83], v79, s[64:67], s71 offen offset:0 sc1
    v_mfma_f32_16x16x32_bf16 v[220:223], a[12:15], v[96:99], 0
    ds_read_b128 v[152:155], v9 offset:8192
    s_waitcnt vmcnt(11)
    v_mfma_f32_16x16x32_bf16 v[224:227], a[0:3], v[100:103], 0
    buffer_load_dwordx4 v[84:87], v79, s[64:67], s71 offen offset:256 sc1
    v_mfma_f32_16x16x32_bf16 v[228:231], a[4:7], v[100:103], 0
    ds_read_b128 v[156:159], v10 offset:8192
    ds_read_b128 v[160:163], v9 offset:16384
    v_mfma_f32_16x16x32_bf16 v[232:235], a[8:11], v[100:103], 0
    buffer_load_dwordx4 v[88:91], v79, s[64:67], s71 offen offset:2048 sc1
    v_mfma_f32_16x16x32_bf16 v[236:239], a[12:15], v[100:103], 0
    ds_read_b128 v[164:167], v10 offset:16384
    s_waitcnt vmcnt(12)
    v_mfma_f32_16x16x32_bf16 v[208:211], a[16:19], v[104:107], v[208:211]
    buffer_load_dwordx4 v[92:95], v79, s[64:67], s71 offen offset:2304 sc1
    v_mfma_f32_16x16x32_bf16 v[212:215], a[20:23], v[104:107], v[212:215]
    ds_read_b128 v[168:171], v9 offset:24576
    ds_read_b128 v[172:175], v10 offset:24576
    v_mfma_f32_16x16x32_bf16 v[216:219], a[24:27], v[104:107], v[216:219]
    buffer_load_dwordx4 v[96:99], v79, s[64:67], s72 offen offset:0 sc1
    v_mfma_f32_16x16x32_bf16 v[220:223], a[28:31], v[104:107], v[220:223]
    v_lshlrev_b32 v176, 16, v40
    s_waitcnt vmcnt(13)
    v_mfma_f32_16x16x32_bf16 v[224:227], a[16:19], v[108:111], v[224:227]
    buffer_load_dwordx4 v[100:103], v79, s[64:67], s72 offen offset:256 sc1
    v_mfma_f32_16x16x32_bf16 v[228:231], a[20:23], v[108:111], v[228:231]
    v_and_b32 v177, 0xffff0000, v40
    v_lshlrev_b32 v178, 16, v41
    v_mfma_f32_16x16x32_bf16 v[232:235], a[24:27], v[108:111], v[232:235]
    buffer_load_dwordx4 v[104:107], v79, s[64:67], s72 offen offset:2048 sc1
    v_mfma_f32_16x16x32_bf16 v[236:239], a[28:31], v[108:111], v[236:239]
    v_and_b32 v179, 0xffff0000, v41
    s_waitcnt vmcnt(14)
    v_mfma_f32_16x16x32_bf16 v[208:211], a[32:35], v[112:115], v[208:211]
    buffer_load_dwordx4 v[108:111], v79, s[64:67], s72 offen offset:2304 sc1
    v_mfma_f32_16x16x32_bf16 v[212:215], a[36:39], v[112:115], v[212:215]
    v_lshlrev_b32 v180, 16, v42
    v_and_b32 v181, 0xffff0000, v42
    v_mfma_f32_16x16x32_bf16 v[216:219], a[40:43], v[112:115], v[216:219]
    v_lshlrev_b32 v182, 16, v43
    v_and_b32 v183, 0xffff0000, v43
    v_mfma_f32_16x16x32_bf16 v[220:223], a[44:47], v[112:115], v[220:223]
    s_waitcnt vmcnt(14)
    v_mfma_f32_16x16x32_bf16 v[224:227], a[32:35], v[116:119], v[224:227]
    buffer_load_dwordx4 v[112:115], v79, s[64:67], s73 offen offset:0 sc1
    v_mfma_f32_16x16x32_bf16 v[228:231], a[36:39], v[116:119], v[228:231]
    s_waitcnt lgkmcnt(7)
    v_add_f32 v176, v176, v144
    v_mfma_f32_16x16x32_bf16 v[232:235], a[40:43], v[116:119], v[232:235]
    v_add_f32 v177, v177, v145
    v_add_f32 v178, v178, v146
    v_mfma_f32_16x16x32_bf16 v[236:239], a[44:47], v[116:119], v[236:239]
    v_add_f32 v179, v179, v147
    s_waitcnt vmcnt(14)
    v_mfma_f32_16x16x32_bf16 v[208:211], a[48:51], v[120:123], v[208:211]
    buffer_load_dwordx4 v[116:119], v79, s[64:67], s73 offen offset:256 sc1
    v_mfma_f32_16x16x32_bf16 v[212:215], a[52:55], v[120:123], v[212:215]
    s_waitcnt lgkmcnt(6)
    v_add_f32 v180, v180, v148
    v_mfma_f32_16x16x32_bf16 v[216:219], a[56:59], v[120:123], v[216:219]
    v_add_f32 v181, v181, v149
    v_add_f32 v182, v182, v150
    v_mfma_f32_16x16x32_bf16 v[220:223], a[60:63], v[120:123], v[220:223]
    v_add_f32 v183, v183, v151
    s_waitcnt vmcnt(14)
    v_mfma_f32_16x16x32_bf16 v[224:227], a[48:51], v[124:127], v[224:227]
    buffer_load_dwordx4 v[120:123], v79, s[64:67], s73 offen offset:2048 sc1
    v_mfma_f32_16x16x32_bf16 v[228:231], a[52:55], v[124:127], v[228:231]
    s_waitcnt lgkmcnt(5)
    v_add_f32 v176, v176, v152
    v_mfma_f32_16x16x32_bf16 v[232:235], a[56:59], v[124:127], v[232:235]
    v_add_f32 v177, v177, v153
    v_add_f32 v178, v178, v154
    v_mfma_f32_16x16x32_bf16 v[236:239], a[60:63], v[124:127], v[236:239]
    v_add_f32 v179, v179, v155
    s_waitcnt vmcnt(14)
    v_mfma_f32_16x16x32_bf16 v[208:211], a[64:67], v[128:131], v[208:211]
    buffer_load_dwordx4 v[124:127], v79, s[64:67], s73 offen offset:2304 sc1
    v_mfma_f32_16x16x32_bf16 v[212:215], a[68:71], v[128:131], v[212:215]
    s_waitcnt lgkmcnt(4)
    v_add_f32 v180, v180, v156
    v_mfma_f32_16x16x32_bf16 v[216:219], a[72:75], v[128:131], v[216:219]
    v_add_f32 v181, v181, v157
    v_add_f32 v182, v182, v158
    v_mfma_f32_16x16x32_bf16 v[220:223], a[76:79], v[128:131], v[220:223]
    v_add_f32 v183, v183, v159
    s_waitcnt vmcnt(14)
    v_mfma_f32_16x16x32_bf16 v[224:227], a[64:67], v[132:135], v[224:227]
    buffer_load_dwordx4 v[128:131], v79, s[64:67], s74 offen offset:0 sc1
    v_mfma_f32_16x16x32_bf16 v[228:231], a[68:71], v[132:135], v[228:231]
    s_waitcnt lgkmcnt(3)
    v_add_f32 v176, v176, v160
    v_mfma_f32_16x16x32_bf16 v[232:235], a[72:75], v[132:135], v[232:235]
    v_add_f32 v177, v177, v161
    v_add_f32 v178, v178, v162
    v_mfma_f32_16x16x32_bf16 v[236:239], a[76:79], v[132:135], v[236:239]
    v_add_f32 v179, v179, v163
    s_waitcnt vmcnt(14)
    v_mfma_f32_16x16x32_bf16 v[208:211], a[80:83], v[136:139], v[208:211]
    buffer_load_dwordx4 v[132:135], v79, s[64:67], s74 offen offset:256 sc1
    v_mfma_f32_16x16x32_bf16 v[212:215], a[84:87], v[136:139], v[212:215]
    s_waitcnt lgkmcnt(2)
    v_add_f32 v180, v180, v164
    v_mfma_f32_16x16x32_bf16 v[216:219], a[88:91], v[136:139], v[216:219]
    v_add_f32 v181, v181, v165
    v_add_f32 v182, v182, v166
    v_mfma_f32_16x16x32_bf16 v[220:223], a[92:95], v[136:139], v[220:223]
    v_add_f32 v183, v183, v167
    s_waitcnt vmcnt(14)
    v_mfma_f32_16x16x32_bf16 v[224:227], a[80:83], v[140:143], v[224:227]
    buffer_load_dwordx4 v[136:139], v79, s[64:67], s74 offen offset:2048 sc1
    v_mfma_f32_16x16x32_bf16 v[228:231], a[84:87], v[140:143], v[228:231]
    s_waitcnt lgkmcnt(1)
    v_add_f32 v176, v176, v168
    v_mfma_f32_16x16x32_bf16 v[232:235], a[88:91], v[140:143], v[232:235]
    v_add_f32 v177, v177, v169
    v_add_f32 v178, v178, v170
    v_mfma_f32_16x16x32_bf16 v[236:239], a[92:95], v[140:143], v[236:239]
    v_add_f32 v179, v179, v171
    s_waitcnt vmcnt(14)
    v_mfma_f32_16x16x32_bf16 v[208:211], a[96:99], v[80:83], v[208:211]
    buffer_load_dwordx4 v[140:143], v79, s[64:67], s74 offen offset:2304 sc1
    v_mfma_f32_16x16x32_bf16 v[212:215], a[100:103], v[80:83], v[212:215]
    s_waitcnt lgkmcnt(0)
    v_add_f32 v180, v180, v172
    v_mfma_f32_16x16x32_bf16 v[216:219], a[104:107], v[80:83], v[216:219]
    v_add_f32 v181, v181, v173
    v_add_f32 v182, v182, v174
    v_mfma_f32_16x16x32_bf16 v[220:223], a[108:111], v[80:83], v[220:223]
    v_add_f32 v183, v183, v175
    s_waitcnt vmcnt(14)
    v_mfma_f32_16x16x32_bf16 v[224:227], a[96:99], v[84:87], v[224:227]
    s_barrier
    v_cvt_pk_bf16_f32 v40, v176, v177
    v_mfma_f32_16x16x32_bf16 v[228:231], a[100:103], v[84:87], v[228:231]
    v_cvt_pk_bf16_f32 v41, v178, v179
    v_cvt_pk_bf16_f32 v42, v180, v181
    v_mfma_f32_16x16x32_bf16 v[232:235], a[104:107], v[84:87], v[232:235]
    v_cvt_pk_bf16_f32 v43, v182, v183
    v_mfma_f32_16x16x32_bf16 v[236:239], a[108:111], v[84:87], v[236:239]
    s_waitcnt vmcnt(13)
    v_mfma_f32_16x16x32_bf16 v[208:211], a[112:115], v[88:91], v[208:211]
    s_add_u32 s80, s7, 0
    buffer_store_dwordx4 v[40:43], v13, s[60:63], s80 offen
    v_mfma_f32_16x16x32_bf16 v[212:215], a[116:119], v[88:91], v[212:215]
    v_mfma_f32_16x16x32_bf16 v[216:219], a[120:123], v[88:91], v[216:219]
    v_mfma_f32_16x16x32_bf16 v[220:223], a[124:127], v[88:91], v[220:223]
    s_waitcnt vmcnt(13)
    v_mfma_f32_16x16x32_bf16 v[224:227], a[112:115], v[92:95], v[224:227]
    v_mfma_f32_16x16x32_bf16 v[228:231], a[116:119], v[92:95], v[228:231]
    v_mfma_f32_16x16x32_bf16 v[232:235], a[120:123], v[92:95], v[232:235]
    v_mfma_f32_16x16x32_bf16 v[236:239], a[124:127], v[92:95], v[236:239]
    s_waitcnt vmcnt(12)
    v_mfma_f32_16x16x32_bf16 v[208:211], a[128:131], v[96:99], v[208:211]
    v_mfma_f32_16x16x32_bf16 v[212:215], a[132:135], v[96:99], v[212:215]
    v_mfma_f32_16x16x32_bf16 v[216:219], a[136:139], v[96:99], v[216:219]
    v_mfma_f32_16x16x32_bf16 v[220:223], a[140:143], v[96:99], v[220:223]
    s_waitcnt vmcnt(11)
    v_mfma_f32_16x16x32_bf16 v[224:227], a[128:131], v[100:103], v[224:227]
    v_mfma_f32_16x16x32_bf16 v[228:231], a[132:135], v[100:103], v[228:231]
    v_mfma_f32_16x16x32_bf16 v[232:235], a[136:139], v[100:103], v[232:235]
    v_mfma_f32_16x16x32_bf16 v[236:239], a[140:143], v[100:103], v[236:239]
    s_waitcnt vmcnt(10)
    v_mfma_f32_16x16x32_bf16 v[208:211], a[144:147], v[104:107], v[208:211]
    v_mfma_f32_16x16x32_bf16 v[212:215], a[148:151], v[104:107], v[212:215]
    v_mfma_f32_16x16x32_bf16 v[216:219], a[152:155], v[104:107], v[216:219]
    v_mfma_f32_16x16x32_bf16 v[220:223], a[156:159], v[104:107], v[220:223]
    s_waitcnt vmcnt(9)
    v_mfma_f32_16x16x32_bf16 v[224:227], a[144:147], v[108:111], v[224:227]
    v_mfma_f32_16x16x32_bf16 v[228:231], a[148:151], v[108:111], v[228:231]
    v_mfma_f32_16x16x32_bf16 v[232:235], a[152:155], v[108:111], v[232:235]
    v_mfma_f32_16x16x32_bf16 v[236:239], a[156:159], v[108:111], v[236:239]
    s_waitcnt vmcnt(8)
    v_mfma_f32_16x16x32_bf16 v[208:211], a[160:163], v[112:115], v[208:211]
    v_mfma_f32_16x16x32_bf16 v[212:215], a[164:167], v[112:115], v[212:215]
    v_mfma_f32_16x16x32_bf16 v[216:219], a[168:171], v[112:115], v[216:219]
    v_mfma_f32_16x16x32_bf16 v[220:223], a[172:175], v[112:115], v[220:223]
    s_waitcnt vmcnt(7)
    v_mfma_f32_16x16x32_bf16 v[224:227], a[160:163], v[116:119], v[224:227]
    v_mfma_f32_16x16x32_bf16 v[228:231], a[164:167], v[116:119], v[228:231]
    v_mfma_f32_16x16x32_bf16 v[232:235], a[168:171], v[116:119], v[232:235]
    v_mfma_f32_16x16x32_bf16 v[236:239], a[172:175], v[116:119], v[236:239]
    s_waitcnt vmcnt(6)
    v_mfma_f32_16x16x32_bf16 v[208:211], a[176:179], v[120:123], v[208:211]
    v_mfma_f32_16x16x32_bf16 v[212:215], a[180:183], v[120:123], v[212:215]
    v_mfma_f32_16x16x32_bf16 v[216:219], a[184:187], v[120:123], v[216:219]
    v_mfma_f32_16x16x32_bf16 v[220:223], a[188:191], v[120:123], v[220:223]
    s_waitcnt vmcnt(5)
    v_mfma_f32_16x16x32_bf16 v[224:227], a[176:179], v[124:127], v[224:227]
    v_mfma_f32_16x16x32_bf16 v[228:231], a[180:183], v[124:127], v[228:231]
    v_mfma_f32_16x16x32_bf16 v[232:235], a[184:187], v[124:127], v[232:235]
    v_mfma_f32_16x16x32_bf16 v[236:239], a[188:191], v[124:127], v[236:239]
    s_waitcnt vmcnt(4)
    v_mfma_f32_16x16x32_bf16 v[208:211], a[192:195], v[128:131], v[208:211]
    v_mfma_f32_16x16x32_bf16 v[212:215], a[196:199], v[128:131], v[212:215]
    v_mfma_f32_16x16x32_bf16 v[216:219], a[200:203], v[128:131], v[216:219]
    v_mfma_f32_16x16x32_bf16 v[220:223], a[204:207], v[128:131], v[220:223]
    s_waitcnt vmcnt(2)
    v_mfma_f32_16x16x32_bf16 v[208:211], a[208:211], v[136:139], v[208:211]
    v_xor_b32 v73, 64, v8
    v_xor_b32 v74, 128, v8
    v_xor_b32 v75, 192, v8
    v_mfma_f32_16x16x32_bf16 v[212:215], a[212:215], v[136:139], v[212:215]
    v_mfma_f32_16x16x32_bf16 v[216:219], a[216:219], v[136:139], v[216:219]
    v_mfma_f32_16x16x32_bf16 v[220:223], a[220:223], v[136:139], v[220:223]
    v_mfma_f32_16x16x32_bf16 v[224:227], a[192:195], v[132:135], v[224:227]
    v_mfma_f32_16x16x32_bf16 v[228:231], a[196:199], v[132:135], v[228:231]
    v_mfma_f32_16x16x32_bf16 v[232:235], a[200:203], v[132:135], v[232:235]
    ds_write_b128 v8, v[208:211]
    v_mfma_f32_16x16x32_bf16 v[236:239], a[204:207], v[132:135], v[236:239]
    s_nop 0
    ds_write_b128 v73, v[212:215]
    s_waitcnt vmcnt(1)
    v_mfma_f32_16x16x32_bf16 v[224:227], a[208:211], v[140:143], v[224:227]
    ds_write_b128 v74, v[216:219]
    v_mfma_f32_16x16x32_bf16 v[228:231], a[212:215], v[140:143], v[228:231]
    ds_write_b128 v75, v[220:223]
    v_mfma_f32_16x16x32_bf16 v[232:235], a[216:219], v[140:143], v[232:235]
    v_mfma_f32_16x16x32_bf16 v[236:239], a[220:223], v[140:143], v[236:239]
    s_nop 2
    ds_write_b128 v8, v[224:227] offset:4096
    s_nop 0
    ds_write_b128 v73, v[228:231] offset:4096
    s_nop 0
    ds_write_b128 v74, v[232:235] offset:4096
    ds_write_b128 v75, v[236:239] offset:4096
    v_lshlrev_b32 v176, 16, v44
    v_and_b32 v177, 0xffff0000, v44
    v_lshlrev_b32 v178, 16, v45
    v_and_b32 v179, 0xffff0000, v45
    v_lshlrev_b32 v180, 16, v46
    v_and_b32 v181, 0xffff0000, v46
    v_lshlrev_b32 v182, 16, v47
    v_and_b32 v183, 0xffff0000, v47
    s_waitcnt lgkmcnt(0)
    s_barrier
    ds_read_b128 v[144:147], v9 offset:0
    ds_read_b128 v[148:151], v10 offset:0
    ds_read_b128 v[152:155], v9 offset:8192
    ds_read_b128 v[156:159], v10 offset:8192
    ds_read_b128 v[160:163], v9 offset:16384
    ds_read_b128 v[164:167], v10 offset:16384
    ds_read_b128 v[168:171], v9 offset:24576
    ds_read_b128 v[172:175], v10 offset:24576
    s_waitcnt lgkmcnt(7)
    v_pk_add_f32 v[176:177], v[176:177], v[144:145]
    v_pk_add_f32 v[178:179], v[178:179], v[146:147]
    s_waitcnt lgkmcnt(6)
    v_pk_add_f32 v[180:181], v[180:181], v[148:149]
    v_pk_add_f32 v[182:183], v[182:183], v[150:151]
    s_waitcnt lgkmcnt(5)
    v_pk_add_f32 v[176:177], v[176:177], v[152:153]
    v_pk_add_f32 v[178:179], v[178:179], v[154:155]
    s_waitcnt lgkmcnt(4)
    v_pk_add_f32 v[180:181], v[180:181], v[156:157]
    v_pk_add_f32 v[182:183], v[182:183], v[158:159]
    s_waitcnt lgkmcnt(3)
    v_pk_add_f32 v[176:177], v[176:177], v[160:161]
    v_pk_add_f32 v[178:179], v[178:179], v[162:163]
    s_waitcnt lgkmcnt(2)
    v_pk_add_f32 v[180:181], v[180:181], v[164:165]
    v_pk_add_f32 v[182:183], v[182:183], v[166:167]
    s_waitcnt lgkmcnt(1)
    v_pk_add_f32 v[176:177], v[176:177], v[168:169]
    v_pk_add_f32 v[178:179], v[178:179], v[170:171]
    s_waitcnt lgkmcnt(0)
    v_pk_add_f32 v[180:181], v[180:181], v[172:173]
    v_pk_add_f32 v[182:183], v[182:183], v[174:175]
    v_cvt_pk_bf16_f32 v44, v176, v177
    v_cvt_pk_bf16_f32 v45, v178, v179
    v_cvt_pk_bf16_f32 v46, v180, v181
    v_cvt_pk_bf16_f32 v47, v182, v183
    s_add_u32 s80, s7, 32768
    buffer_store_dwordx4 v[44:47], v13, s[60:63], s80 offen
L_end:
L_exit:
    s_endpgm
L_ts_105:
    s_mov_b32 s87, 0
L_tl_149:
    s_add_u32 s46, s9, 0x0
    buffer_load_dwordx2 v[64:65], v22, s[64:67], s46 offen offset:0 sc1
    buffer_load_dwordx2 v[66:67], v22, s[64:67], s46 offen offset:256 sc1
    buffer_load_dwordx2 v[68:69], v22, s[64:67], s46 offen offset:128 sc1
    buffer_load_dwordx2 v[70:71], v22, s[64:67], s46 offen offset:384 sc1
    s_waitcnt vmcnt(0)
    v_xor_b32 v72, 0xbf800000, v65
    v_xor_b32 v73, 0xbf800000, v67
    v_min_u32 v72, v72, v73
    v_xor_b32 v73, 0xbf800000, v69
    v_min_u32 v72, v72, v73
    v_xor_b32 v73, 0xbf800000, v71
    v_min_u32 v72, v72, v73
    v_cmp_eq_u32 vcc, 0, v72
    s_cbranch_vccz L_tb_106
    s_add_u32 s87, s87, 1
    s_cmp_lt_u32 s87, 0x200000
    s_cbranch_scc1 L_tl_149
    s_branch L_end
L_ts_107:
    s_mov_b32 s87, 0
L_tl_150:
    s_add_u32 s46, s9, 0x800
    buffer_load_dwordx2 v[64:65], v22, s[64:67], s46 offen offset:0 sc1
    buffer_load_dwordx2 v[66:67], v22, s[64:67], s46 offen offset:256 sc1
    buffer_load_dwordx2 v[68:69], v22, s[64:67], s46 offen offset:128 sc1
    buffer_load_dwordx2 v[70:71], v22, s[64:67], s46 offen offset:384 sc1
    s_waitcnt vmcnt(0)
    v_xor_b32 v72, 0xbf800000, v65
    v_xor_b32 v73, 0xbf800000, v67
    v_min_u32 v72, v72, v73
    v_xor_b32 v73, 0xbf800000, v69
    v_min_u32 v72, v72, v73
    v_xor_b32 v73, 0xbf800000, v71
    v_min_u32 v72, v72, v73
    v_cmp_eq_u32 vcc, 0, v72
    s_cbranch_vccz L_tb_108
    s_add_u32 s87, s87, 1
    s_cmp_lt_u32 s87, 0x200000
    s_cbranch_scc1 L_tl_150
    s_branch L_end
L_ps_109:
    buffer_store_dword v23, off, s[64:67], s26 offset:0 sc1
    s_branch L_pb_110
L_fs_111:
    s_mov_b32 s87, 0
L_fl_151:
    buffer_load_dword v16, v5, s[64:67], s27 offen offset:0 sc1
    s_waitcnt vmcnt(0)
    v_cmp_eq_u32 vcc, 0, v16
    s_cbranch_vccz L_fb_112
    s_add_u32 s87, s87, 1
    s_cmp_lt_u32 s87, 0x200000
    s_cbranch_scc1 L_fl_151
    s_branch L_end
L_ps_113:
    buffer_store_dword v23, off, s[64:67], s26 offset:256 sc1
    s_branch L_pb_114
L_fs_115:
    s_mov_b32 s87, 0
L_fl_152:
    buffer_load_dword v16, v5, s[64:67], s27 offen offset:256 sc1
    s_waitcnt vmcnt(0)
    v_cmp_eq_u32 vcc, 0, v16
    s_cbranch_vccz L_fb_116
    s_add_u32 s87, s87, 1
    s_cmp_lt_u32 s87, 0x200000
    s_cbranch_scc1 L_fl_152
    s_branch L_end
L_ps_117:
    buffer_store_dwordx2 v[18:19], v17, s[64:67], s25 offen offset:0 sc1
    s_branch L_pb_118
L_ss_119:
    s_mov_b32 s87, 0
L_sl_153:
    buffer_load_dwordx2 v[18:19], v17, s[64:67], s6 offen offset:0 sc1
    s_waitcnt vmcnt(0)
    v_cmp_eq_u32 vcc, 0xbf800000, v19
    s_cbranch_vccz L_sb_120
    s_add_u32 s87, s87, 1
    s_cmp_lt_u32 s87, 0x200000
    s_cbranch_scc1 L_sl_153
    s_branch L_end
L_ps_121:
    buffer_store_dwordx2 v[18:19], v17, s[64:67], s80 offen sc1
    s_branch L_pb_122
L_ps_123:
    buffer_store_dword v23, off, s[64:67], s12 offset:2048 sc1
    s_branch L_pb_124
L_ps_125:
    buffer_store_dwordx2 v[56:57], v17, s[64:67], s25 offen offset:2048 sc1
    s_branch L_pb_126
L_fs_127:
    s_mov_b32 s87, 0
L_fl_154:
    buffer_load_dword v16, v4, s[64:67], s13 offen offset:2048 sc1
    s_waitcnt vmcnt(0)
    v_cmp_eq_u32 vcc, 0, v16
    s_cbranch_vccz L_fb_128
    s_add_u32 s87, s87, 1
    s_cmp_lt_u32 s87, 0x200000
    s_cbranch_scc1 L_fl_154
    s_branch L_end
L_ss_129:
    s_mov_b32 s87, 0
L_sl_155:
    buffer_load_dwordx2 v[56:57], v17, s[64:67], s6 offen offset:2048 sc1
    s_waitcnt vmcnt(0)
    v_cmp_eq_u32 vcc, 0xbf800000, v57
    s_cbranch_vccz L_sb_130
    s_add_u32 s87, s87, 1
    s_cmp_lt_u32 s87, 0x200000
    s_cbranch_scc1 L_sl_155
    s_branch L_end
L_ps_131:
    buffer_store_dwordx2 v[56:57], v17, s[64:67], s81 offen sc1
    s_branch L_pb_132
L_ts_133:
    s_mov_b32 s87, 0
L_tl_156:
    s_add_u32 s46, s9, 0x20000
    buffer_load_dwordx2 v[64:65], v22, s[64:67], s46 offen offset:0 sc1
    buffer_load_dwordx2 v[66:67], v22, s[64:67], s46 offen offset:256 sc1
    buffer_load_dwordx2 v[68:69], v22, s[64:67], s46 offen offset:128 sc1
    buffer_load_dwordx2 v[70:71], v22, s[64:67], s46 offen offset:384 sc1
    s_waitcnt vmcnt(0)
    v_xor_b32 v72, 0xbf800000, v65
    v_xor_b32 v73, 0xbf800000, v67
    v_min_u32 v72, v72, v73
    v_xor_b32 v73, 0xbf800000, v69
    v_min_u32 v72, v72, v73
    v_xor_b32 v73, 0xbf800000, v71
    v_min_u32 v72, v72, v73
    v_cmp_eq_u32 vcc, 0, v72
    s_cbranch_vccz L_tb_134
    s_add_u32 s87, s87, 1
    s_cmp_lt_u32 s87, 0x200000
    s_cbranch_scc1 L_tl_156
    s_branch L_end
L_ps_135:
    buffer_store_dword v23, off, s[64:67], s12 offset:2304 sc1
    s_branch L_pb_136
L_fs_137:
    s_mov_b32 s87, 0
L_fl_157:
    buffer_load_dword v16, v4, s[64:67], s13 offen offset:2304 sc1
    s_waitcnt vmcnt(0)
    v_cmp_eq_u32 vcc, 0, v16
    s_cbranch_vccz L_fb_138
    s_add_u32 s87, s87, 1
    s_cmp_lt_u32 s87, 0x200000
    s_cbranch_scc1 L_fl_157
    s_branch L_end
L_ts_139:
    s_mov_b32 s87, 0
L_tl_158:
    s_add_u32 s46, s9, 0x20800
    buffer_load_dwordx2 v[64:65], v22, s[64:67], s46 offen offset:0 sc1
    buffer_load_dwordx2 v[66:67], v22, s[64:67], s46 offen offset:256 sc1
    buffer_load_dwordx2 v[68:69], v22, s[64:67], s46 offen offset:128 sc1
    buffer_load_dwordx2 v[70:71], v22, s[64:67], s46 offen offset:384 sc1
    s_waitcnt vmcnt(0)
    v_xor_b32 v72, 0xbf800000, v65
    v_xor_b32 v73, 0xbf800000, v67
    v_min_u32 v72, v72, v73
    v_xor_b32 v73, 0xbf800000, v69
    v_min_u32 v72, v72, v73
    v_xor_b32 v73, 0xbf800000, v71
    v_min_u32 v72, v72, v73
    v_cmp_eq_u32 vcc, 0, v72
    s_cbranch_vccz L_tb_140
    s_add_u32 s87, s87, 1
    s_cmp_lt_u32 s87, 0x200000
    s_cbranch_scc1 L_tl_158
    s_branch L_end
L_ps_141:
    buffer_store_dword v23, off, s[64:67], s26 offset:2048 sc1
    s_branch L_pb_142
L_fs_143:
    s_mov_b32 s87, 0
L_fl_159:
    buffer_load_dword v16, v5, s[64:67], s27 offen offset:2048 sc1
    s_waitcnt vmcnt(0)
    v_cmp_eq_u32 vcc, 0, v16
    s_cbranch_vccz L_fb_144
    s_add_u32 s87, s87, 1
    s_cmp_lt_u32 s87, 0x200000
    s_cbranch_scc1 L_fl_159
    s_branch L_end
L_ps_145:
    buffer_store_dword v23, off, s[64:67], s26 offset:2304 sc1
    s_branch L_pb_146
L_fs_147:
    s_mov_b32 s87, 0
L_fl_160:
    buffer_load_dword v16, v5, s[64:67], s27 offen offset:2304 sc1
    s_waitcnt vmcnt(0)
    v_cmp_eq_u32 vcc, 0, v16
    s_cbranch_vccz L_fb_148
    s_add_u32 s87, s87, 1
    s_cmp_lt_u32 s87, 0x200000
    s_cbranch_scc1 L_fl_160
    s_branch L_end
L_codeend:
.set CODE_LEN, L_codeend-L_pfbase
.set CODE_SHARE, ((CODE_LEN>>5)+127)&0xffffff80
.section .rodata,"a"
.p2align 6
.amdhsa_kernel interleave_layers__ssm_conv_h3__swiglu_ffn__prompt_kernel
  .amdhsa_next_free_vgpr 512
  .amdhsa_next_free_sgpr 102
  .amdhsa_accum_offset 256
  .amdhsa_group_segment_fixed_size 0
  .amdhsa_kernarg_size 104
  .amdhsa_user_sgpr_count 2
  .amdhsa_user_sgpr_kernarg_segment_ptr 1
  .amdhsa_system_sgpr_workgroup_id_x 1
  .amdhsa_float_denorm_mode_32 3
.end_amdhsa_kernel
```
